```python
import torch

def _softmax(x, axis=-1):
    return torch.softmax(x, dim=axis)

def _gelu(x):
    return torch.nn.functional.gelu(x, approximate='tanh')

def _silu(x):
    return torch.nn.functional.silu(x)

def _sigmoid(x):
    return torch.sigmoid(x)

def _layernorm(x, axis=-1, eps=1e-05):
    m = x.mean(dim=axis, keepdim=True)
    v = x.var(dim=axis, keepdim=True, unbiased=False)
    return (x - m) / torch.sqrt(v + eps)

def _scatter_add(tgt, idx, src, axis=0):
    return tgt.clone().index_add_(axis, idx, src)

def _segment_sum(src, seg, n):
    out = torch.zeros((n,) + src.shape[1:], dtype=src.dtype)
    return out.index_add_(0, seg, src)

def _pad(x, pw):
    flat = tuple((v for pair in reversed(pw) for v in pair))
    return torch.nn.functional.pad(x, flat)
kernel_name = 'interleave_layers__sliding_local_dilated__mixer_gmlp__prompt'

def setup_inputs():

    _w = lambda a: (lambda t: t.to(torch.bfloat16) if t.is_floating_point() else t)(torch.as_tensor(a))

    def _A_setup():
        B, S, D = (1, 2048, 640)
        return {'x': _w((lambda *s: torch.randn(*s, dtype=torch.bfloat16) * 0.05)(B, S, D)), 'wqkv': _w((lambda *s: torch.randn(*s, dtype=torch.bfloat16) * 0.1)(D, 3 * D)), 'wo': _w((lambda *s: torch.randn(*s, dtype=torch.bfloat16) * 0.1)(D, D))}
    _A_in = _A_setup()

    def _B_setup():
        B, S, D, F = (1, 2048, 640, 1728)
        Fh = F // 2
        return {'x': _w((lambda *s: torch.randn(*s, dtype=torch.bfloat16) * 0.05)(B, S, D)), 'w_in': _w((lambda *s: torch.randn(*s, dtype=torch.bfloat16) * 0.8)(D, 2 * Fh)), 'w_sp': _w(0.01 * (lambda *s: torch.randn(*s, dtype=torch.bfloat16) * 0.8)(S, S)), 'b_sp': _w(1.0 + 0.01 * (lambda *s: torch.randn(*s, dtype=torch.bfloat16) * 0.05)(S)), 'w_out': _w((lambda *s: torch.randn(*s, dtype=torch.bfloat16) * 0.05)(Fh, D))}
    _B_in = _B_setup()
    return {'A_x': _A_in['x'], 'A_wqkv': _A_in['wqkv'], 'A_wo': _A_in['wo'], 'B_x': _B_in['x'], 'B_w_in': _B_in['w_in'], 'B_w_sp': _B_in['w_sp'], 'B_b_sp': _B_in['b_sp'], 'B_w_out': _B_in['w_out']}

def reference(A_x, A_wqkv, A_wo, B_x, B_w_in, B_w_sp, B_b_sp, B_w_out):

    def _A_ref(x, wqkv, wo):
        B, S, D = x.shape
        H = 32
        Dh = D // H
        W, dil = (8, 2)
        qkv = (lambda x, *d: x.permute(*d))((x @ wqkv).reshape(B, S, 3, H, Dh), 2, 0, 3, 1, 4)
        q, k, v = (qkv[0], qkv[1], qkv[2])
        scale = Dh ** (-0.5)
        pos = torch.arange(S)
        off = torch.arange(W) * dil
        idx = pos[:, None] - off[None, :]
        mask = idx >= 0
        idx_c = torch.where(mask, idx, 0).reshape(-1)
        kg = k[:, :, idx_c, :].reshape(B, H, S, W, Dh)
        vg = v[:, :, idx_c, :].reshape(B, H, S, W, Dh)
        logits = torch.einsum('bhsd,bhswd->bhsw', q, kg) * scale
        logits = torch.where(mask[None, None, :, :], logits, -1000000000.0)
        attn = _softmax(logits, axis=-1)
        o = torch.einsum('bhsw,bhswd->bhsd', attn, vg)
        return (lambda x, *d: x.permute(*d))(o, 0, 2, 1, 3).reshape(B, S, D) @ wo

    def _B_ref(x, w_in, w_sp, b_sp, w_out):
        B, S, D = x.shape
        F = w_in.shape[-1]
        Fh = F // 2
        z = _gelu(torch.einsum('bsd,df->bsf', x, w_in))
        z1 = z[..., :Fh].clone()
        z2 = _layernorm(z[..., Fh:], axis=-1)
        g = torch.einsum('ts,bsf->btf', w_sp, z2) + b_sp[None, :, None]
        return torch.einsum('bsf,fd->bsd', z1 * g, w_out)
    x = A_x
    x = x + _A_ref(_layernorm(x, axis=-1), A_wqkv, A_wo)
    x = x + _B_ref(_layernorm(x, axis=-1), B_w_in, B_w_sp, B_b_sp, B_w_out)
    x = x + _A_ref(_layernorm(x, axis=-1), A_wqkv, A_wo)
    x = x + _B_ref(_layernorm(x, axis=-1), B_w_in, B_w_sp, B_b_sp, B_w_out)
    return x
```

```asm
; @launch grid=(256,1,1) block=(256,1,1) lds=163840
.amdgcn_target "amdgcn-amd-amdhsa--gfx950"
.text
.p2align 8
.globl interleave_layers__sliding_local_dilated__mixer_gmlp__prompt_kernel
.type interleave_layers__sliding_local_dilated__mixer_gmlp__prompt_kernel,@function
interleave_layers__sliding_local_dilated__mixer_gmlp__prompt_kernel:
    s_getpc_b64 s[48:49]
    s_cmp_ge_u32 s2, 256
    s_cbranch_scc1 MK_end
    s_load_dwordx16 s[32:47], s[0:1], 0
    s_load_dwordx4 s[56:59], s[0:1], 72
    s_lshr_b32 s50, s2, 3
    v_lshlrev_b32 v1, 4, v0
    s_lshl_b32 s3, s50, 12
    v_add_u32 v1, s3, v1
    v_min_u32 v1, MK_codeend-interleave_layers__sliding_local_dilated__mixer_gmlp__prompt_kernel-32, v1
    global_load_dwordx4 v[252:255], v1, s[48:49]
    s_memrealtime s[60:61]
    v_lshrrev_b32 v1, 6, v0
    v_and_b32 v0, 63, v0
    v_readfirstlane_b32 s22, v1
    s_and_b32 s3, s2, 7
    s_and_b32 s21, s50, 7
    s_lshr_b32 s50, s50, 3
    s_lshl_b32 s3, s3, 2
    s_add_u32 s20, s3, s50
    s_max_u32 s23, s20, 1
    s_sub_u32 s23, s23, 1
    v_lshlrev_b32 v1, 4, v0
    v_and_b32 v4, 15, v0
    v_lshrrev_b32 v5, 4, v0
    v_lshlrev_b32 v9, 3, v0
    s_lshl_b32 s3, s21, 2
    s_add_u32 s3, s3, s22
    v_mul_u32_u24 v245, 3277, v0
    v_lshrrev_b32 v245, 16, v245
    v_mul_u32_u24 v246, 20, v245
    v_sub_u32 v246, v0, v246
    v_mov_b32 v244, v1
    s_cmp_ge_u32 s20, 20
    s_cbranch_scc1 BT_wou
    s_mul_i32 s48, s21, 160
    v_mul_u32_u24 v240, 1280, v245
    v_lshl_add_u32 v240, v246, 3, v240
    v_add_u32 v240, s48, v240
    v_mov_b32 v247, 0x7f000000
    v_cmp_le_u32 vcc, 60, v0
    s_nop 1
    v_cndmask_b32 v240, v240, v247, vcc
    s_lshl_b32 s50, s20, 3
    s_add_u32 s50, s50, s22
    s_waitcnt lgkmcnt(0)
    s_mov_b32 s12, s34
    s_and_b32 s13, s35, 0xffff
    s_mov_b32 s14, 0x258000
    s_mov_b32 s15, 0x20000
    s_mul_i32 s34, s50, 15360
    s_add_u32 s35, s34, 7680
    s_add_u32 s36, s34, 61440
    s_add_u32 s37, s34, 69120
    buffer_load_dwordx2 v[192:193], v240, s[12:15], s34 offen offset:0 nt
    buffer_load_dwordx2 v[194:195], v240, s[12:15], s34 offen offset:3840 nt
    buffer_load_dwordx2 v[196:197], v240, s[12:15], s35 offen offset:0 nt
    buffer_load_dwordx2 v[198:199], v240, s[12:15], s35 offen offset:3840 nt
    buffer_load_dwordx2 v[200:201], v240, s[12:15], s36 offen offset:0 nt
    buffer_load_dwordx2 v[202:203], v240, s[12:15], s36 offen offset:3840 nt
    buffer_load_dwordx2 v[204:205], v240, s[12:15], s37 offen offset:0 nt
    buffer_load_dwordx2 v[206:207], v240, s[12:15], s37 offen offset:3840 nt
    v_mul_u32_u24 v247, 13108, v246
    v_lshrrev_b32 v247, 16, v247
    v_mul_u32_u24 v248, 5, v247
    v_sub_u32 v248, v246, v248
    v_mad_u32_u24 v248, v245, 5, v248
    v_cndmask_b32 v247, v247, v246, vcc
    v_cndmask_b32 v248, v248, 15, vcc
    s_mov_b32 s48, 0x65483210
    s_mov_b32 s49, 0xfedba9c7
    v_lshlrev_b32 v248, 2, v248
    v_lshrrev_b64 v[250:251], v248, s[48:49]
    v_and_b32 v250, 15, v250
    v_lshl_add_u32 v242, v247, 4, v250
    v_and_b32 v245, 31, v0
    s_cmp_eq_u32 s21, 7
    s_cselect_b32 s48, 20, 28
    s_mov_b32 s49, 0x76543210
    s_cselect_b32 s49, 0x75463210, s49
    s_mul_i32 s51, s21, 224
    v_lshl_add_u32 v241, v245, 3, s51
    v_add_u32 v246, 1728, v241
    v_cmp_gt_u32 vcc, 32, v0
    s_nop 1
    v_cndmask_b32 v241, v241, v246, vcc
    v_cndmask_b32 v247, 8, 0, vcc
    v_mov_b32 v246, 0x7f000000
    v_cmp_le_u32 vcc, s48, v245
    s_nop 1
    v_cndmask_b32 v241, v241, v246, vcc
    v_and_b32 v246, 28, v245
    v_lshrrev_b32 v246, v246, s49
    v_and_b32 v243, 3, v245
    v_add_u32 v243, v243, v247
    v_and_b32 v247, 1, v246
    v_lshl_add_u32 v243, v247, 2, v243
    v_and_b32 v246, 6, v246
    v_lshl_add_u32 v243, v246, 3, v243
    s_mov_b32 s28, s40
    s_and_b32 s29, s41, 0xffff
    s_mov_b32 s30, 0x21c000
    s_mov_b32 s31, 0x20000
    s_mul_i32 s38, s50, 13824
    s_add_u32 s39, s38, 6912
    s_add_u32 s40, s38, 55296
    s_add_u32 s41, s38, 62208
    buffer_load_dwordx2 v[208:209], v241, s[28:31], s38 offen offset:0 nt
    buffer_load_dwordx2 v[210:211], v241, s[28:31], s38 offen offset:3456 nt
    buffer_load_dwordx2 v[212:213], v241, s[28:31], s39 offen offset:0 nt
    buffer_load_dwordx2 v[214:215], v241, s[28:31], s39 offen offset:3456 nt
    buffer_load_dwordx2 v[216:217], v241, s[28:31], s40 offen offset:0 nt
    buffer_load_dwordx2 v[218:219], v241, s[28:31], s40 offen offset:3456 nt
    buffer_load_dwordx2 v[220:221], v241, s[28:31], s41 offen offset:0 nt
    buffer_load_dwordx2 v[222:223], v241, s[28:31], s41 offen offset:3456 nt
    s_lshl_b32 s48, s3, 17
    s_mul_i32 s49, s20, 13
    s_lshr_b32 s49, s49, 6
    s_mul_i32 s49, s49, 3
    s_add_u32 s49, s49, s20
    s_lshl_b32 s49, s49, 12
    s_add_u32 s62, s48, s49
    s_add_u32 s62, s62, 0x3000000
    s_add_u32 s63, s62, 2048
    s_lshr_b32 s49, s49, 1
    s_add_u32 s64, s48, s49
    s_add_u32 s64, s64, 0x3400000
    s_add_u32 s65, s64, 65536
    s_branch BT_go
BT_wou:
    s_sub_u32 s50, s20, 20
    s_mul_i32 s48, s50, 3
    v_add_u32 v247, s48, v245
    s_mul_i32 s48, s21, 160
    v_lshl_add_u32 v248, v246, 3, s48
    v_mov_b32 v249, 0x7f000000
    v_cmp_le_u32 vcc, 60, v0
    s_nop 1
    v_cndmask_b32 v248, v248, v249, vcc
    s_cmp_eq_u32 s22, 3
    s_cselect_b64 vcc, -1, 0
    v_cndmask_b32 v244, v244, v249, vcc
    s_lshr_b32 s48, s22, 1
    s_lshl_b32 s49, s22, 1
    s_add_u32 s48, s48, s49
    s_mul_i32 s49, s22, 10
    s_sub_u32 s49, s49, 636
    v_mul_u32_u24 v249, 10, v247
    v_lshl_add_u32 v250, v249, 2, s49
    v_add_u32 v249, s48, v249
    v_cmp_le_u32 vcc, 16, v247
    s_nop 1
    v_cndmask_b32 v249, v249, v250, vcc
    v_cndmask_b32 v250, 1, 5, vcc
    v_add_u32 v250, v250, v249
    s_movk_i32 s51, 5120
    v_mad_u32_u24 v240, v249, s51, v248
    v_mad_u32_u24 v241, v250, s51, v248
    s_waitcnt lgkmcnt(0)
    s_mov_b32 s12, s36
    s_and_b32 s13, s37, 0xffff
    s_mov_b32 s14, 0xc8000
    s_mov_b32 s15, 0x20000
    buffer_load_dwordx2 v[192:193], v240, s[12:15], 0 offen offset:0 nt
    buffer_load_dwordx2 v[194:195], v240, s[12:15], 0 offen offset:1280 nt
    buffer_load_dwordx2 v[196:197], v240, s[12:15], 0 offen offset:2560 nt
    buffer_load_dwordx2 v[198:199], v240, s[12:15], 0 offen offset:3840 nt
    buffer_load_dwordx2 v[200:201], v241, s[12:15], 0 offen offset:0 nt
    buffer_load_dwordx2 v[202:203], v241, s[12:15], 0 offen offset:1280 nt
    buffer_load_dwordx2 v[204:205], v241, s[12:15], 0 offen offset:2560 nt
    buffer_load_dwordx2 v[206:207], v241, s[12:15], 0 offen offset:3840 nt
    v_mul_u32_u24 v249, 21846, v247
    v_lshrrev_b32 v249, 16, v249
    v_lshlrev_b32 v250, 3, v247
    v_lshl_add_u32 v249, v249, 2, v250
    v_add_u32 v250, 4, v249
    v_mul_u32_u24 v242, 56, v247
    v_subrev_u32 v242, 1264, v242
    v_add_u32 v243, 28, v242
    v_min_u32 v243, 212, v243
    v_cmp_le_u32 vcc, 23, v247
    s_nop 1
    v_cndmask_b32 v249, v249, v242, vcc
    v_cndmask_b32 v250, v250, v243, vcc
    v_mad_u32_u24 v249, v249, s51, v248
    v_mad_u32_u24 v250, v250, s51, v248
    s_mov_b32 s28, s46
    s_and_b32 s29, s47, 0xffff
    s_mov_b32 s30, 0x10e000
    s_mov_b32 s31, 0x20000
    s_mul_i32 s48, s22, 5120
    s_cmp_lt_u32 s50, 9
    s_cselect_b32 s48, s48, 0x7f000000
    buffer_load_dwordx2 v[208:209], v249, s[28:31], s48 offen offset:0 nt
    buffer_load_dwordx2 v[210:211], v249, s[28:31], s48 offen offset:1280 nt
    buffer_load_dwordx2 v[212:213], v249, s[28:31], s48 offen offset:2560 nt
    buffer_load_dwordx2 v[214:215], v249, s[28:31], s48 offen offset:3840 nt
    buffer_load_dwordx2 v[216:217], v250, s[28:31], s48 offen offset:0 nt
    buffer_load_dwordx2 v[218:219], v250, s[28:31], s48 offen offset:1280 nt
    buffer_load_dwordx2 v[220:221], v250, s[28:31], s48 offen offset:2560 nt
    buffer_load_dwordx2 v[222:223], v250, s[28:31], s48 offen offset:3840 nt
    s_and_b32 s48, s21, 1
    s_lshl_b32 s48, s48, 2
    v_subrev_u32 v242, s48, v246
    v_add_u32 v243, 20, v242
    v_cmp_gt_i32 vcc, 0, v242
    s_nop 1
    v_cndmask_b32 v242, v242, v243, vcc
    v_mad_u32_u24 v242, v245, 20, v242
    v_cmp_le_u32 vcc, 60, v0
    s_nop 1
    v_cndmask_b32 v242, v242, v0, vcc
    v_mov_b32 v243, v242
    s_mul_i32 s49, s50, 15360
    s_lshl_b32 s48, s22, 12
    s_add_u32 s49, s49, s48
    s_mul_i32 s62, s21, 107520
    s_add_u32 s62, s62, s49
    s_add_u32 s62, s62, 0x503000
    s_mul_i32 s64, s21, 139264
    s_add_u32 s64, s64, s49
    s_add_u32 s64, s64, 0x5d5000
    s_cmp_lt_u32 s50, 7
    s_cselect_b32 s62, s62, 0x7f000000
    s_cmp_lt_u32 s50, 9
    s_cselect_b32 s64, s64, 0x7f000000
    s_add_u32 s63, s62, 2048
    s_add_u32 s65, s64, 2048
BT_go:
    s_mov_b32 s52, s56
    s_and_b32 s53, s57, 0xffff
    s_mov_b32 s54, 0x100
    s_mov_b32 s55, 0x20000
    s_mov_b32 s4, s58
    s_and_b32 s5, s59, 0xffff
    s_mov_b32 s6, 0x3800000
    s_mov_b32 s7, 0x20000
    s_mov_b32 s24, s32
    s_and_b32 s25, s33, 0xffff
    s_mov_b32 s26, 0x280000
    s_mov_b32 s27, 0x20000
    s_lshl_b64 s[60:61], s[60:61], 4
    s_or_b32 s61, s61, 0x40000000
    s_or_b32 s50, s2, s22
    s_cmp_eq_u32 s50, 0
    s_cselect_b32 s50, 0, 0x7f000000
    v_mov_b32 v26, s60
    v_mov_b32 v27, s61
    v_lshlrev_b32 v245, 7, v0
    s_mov_b64 exec, 3
    buffer_store_dwordx2 v[26:27], v245, s[52:55], s50 offen sc1
    s_mov_b64 exec, -1
    s_and_b32 s48, s22, 1
    v_lshrrev_b32 v246, 3, v0
    v_xor_b32 v246, s48, v246
    v_and_b32 v240, 7, v0
    v_xor_b32 v240, v240, v246
    v_lshlrev_b32 v240, 4, v240
    s_movk_i32 s49, 2560
    v_mad_u32_u24 v240, v246, s49, v240
    s_add_u32 s47, s20, s21
    s_and_b32 s47, s47, 3
    s_sub_u32 s32, s21, 5
    s_cselect_b32 s32, s21, s32
    s_mul_i32 s58, s32, 20480
    s_lshr_b32 s49, s22, 1
    s_lshl_b32 s32, s32, 1
    s_add_u32 s32, s32, s49
    s_lshl_b32 s59, s32, 7
    s_mul_i32 s12, s49, 10240
    s_lshl_b32 s49, s48, 10
    s_add_u32 s12, s12, s49
    s_add_u32 s58, s58, s12
    s_mul_i32 s13, s20, 81920
    s_mul_i32 s49, s48, 20480
    s_add_u32 s13, s13, s49
    s_mul_i32 s14, s23, 81920
    s_mul_i32 s49, s48, 1280
    s_add_u32 s14, s14, s49
    s_sub_u32 s14, s14, s13
    s_add_u32 s14, s14, 61440
    s_add_u32 s59, s59, s13
    s_add_u32 s13, s13, 1280
    s_mov_b32 s8, s42
    s_and_b32 s9, s43, 0xffff
    s_mov_b32 s10, 0x800000
    s_mov_b32 s11, 0x20000
    s_mov_b32 s16, s44
    s_and_b32 s17, s45, 0xffff
    s_mov_b32 s18, 0x1000
    s_mov_b32 s19, 0x20000
    s_lshr_b32 s48, s21, 2
    s_lshl_b32 s48, s48, 5
    s_bfe_u32 s49, s21, 0x10001
    s_add_u32 s48, s48, s49
    s_and_b32 s49, s21, 1
    s_lshl_b32 s49, s49, 4
    s_add_u32 s48, s48, s49
    s_lshl_b32 s48, s48, 12
    s_lshl_b32 s66, s20, 18
    s_add_u32 s66, s66, s48
    s_lshl_b32 s48, s22, 10
    s_add_u32 s66, s66, s48
    s_lshl_b32 s67, s22, 13
    s_add_u32 s67, s67, 102400
    s_add_u32 s15, s59, 0
    s_add_u32 m0, s58, 0
    s_nop 0
    buffer_load_dwordx4 v240, s[24:27], s15 offen lds
    s_add_u32 s15, s59, 1280
    s_add_u32 m0, s58, 2048
    s_nop 0
    buffer_load_dwordx4 v240, s[24:27], s15 offen lds
    s_add_u32 s15, s59, 40960
    s_add_u32 m0, s58, 4096
    s_nop 0
    buffer_load_dwordx4 v240, s[24:27], s15 offen lds
    s_add_u32 s15, s59, 42240
    s_add_u32 m0, s58, 6144
    s_nop 0
    buffer_load_dwordx4 v240, s[24:27], s15 offen lds
    s_add_u32 s15, s59, s14
    s_add_u32 m0, s58, 8192
    s_nop 0
    buffer_load_dwordx4 v240, s[24:27], s15 offen lds
    s_add_u32 s58, s58, 20480
    s_cmp_ge_u32 s58, 102400
    s_cselect_b32 s58, s12, s58
    s_add_u32 s59, s59, 256
    s_sub_u32 s15, s59, 1280
    s_cmp_ge_u32 s59, s13
    s_cselect_b32 s59, s15, s59
    s_add_u32 s15, s59, 0
    s_add_u32 m0, s58, 0
    s_nop 0
    buffer_load_dwordx4 v240, s[24:27], s15 offen lds
    s_lshl_b32 s44, s20, 12
    s_lshl_b32 s45, s23, 12
    v_add_u32 v2, 51200, v1
    v_add_u32 v3, 102400, v1
    v_add_u32 v8, 51200, v9
    v_and_b32 v7, 31, v0
    v_lshlrev_b32 v28, 2, v4
    v_mov_b32 v36, 0x3f803f80
    v_mov_b32 v37, 0x3f803f80
    v_mov_b32 v38, 0x3f803f80
    v_mov_b32 v39, 0x3f803f80
    v_cmp_eq_u32 vcc, 0, v5
    s_nop 1
    v_cndmask_b32 v35, 0, -1, vcc
    s_mul_i32 s28, s21, 107520
    s_mul_i32 s29, s21, 139264
    s_lshl_b32 s30, s20, 18
    s_lshl_b32 s48, s22, 16
    s_add_u32 s30, s30, s48
    s_lshl_b32 s48, s20, 2
    s_add_u32 s48, s48, s22
    s_mul_i32 s31, s48, 20480
    s_mul_i32 s41, s48, 27648
    s_lshl_b32 s34, s20, 8
    s_add_u32 s34, s34, 0x700000
    s_lshl_b32 s48, s22, 3
    s_add_u32 s48, s48, s21
    s_lshl_b32 s35, s48, 3
    s_add_u32 s35, s35, s34
    s_lshl_b32 s42, s20, 12
    s_add_u32 s42, s42, 0x702000
    s_lshl_b32 s48, s48, 7
    s_add_u32 s43, s42, s48
    s_lshl_b32 s48, s21, 9
    s_add_u32 s46, s44, s48
    s_and_b32 s49, s21, 1
    s_mul_i32 s48, s21, 5
    s_add_u32 s50, s48, s49
    s_lshr_b32 s32, s50, 1
    s_add_u32 s33, s32, 2
    s_sub_u32 s51, s32, 1
    s_cmp_eq_u32 s49, 1
    s_cselect_b32 s33, s51, s33
    s_lshl_b32 s32, s32, 12
    s_lshl_b32 s33, s33, 12
    s_lshl_b32 s51, s22, 10
    s_mul_i32 s50, s20, 81920
    s_add_u32 s51, s51, s50
    s_add_u32 s32, s32, s51
    s_add_u32 s33, s33, s51
    s_lshl_b32 s51, s49, 9
    s_add_u32 s33, s33, s51
    s_mul_i32 s48, s21, 458752
    s_lshl_b32 s51, s20, 11
    s_add_u32 s36, s51, s48
    s_lshl_b32 s51, s22, 17
    s_add_u32 s36, s36, s51
    s_add_u32 s37, s36, 65536
    s_cmp_eq_u32 s22, 3
    s_cselect_b32 s37, 0x7f000000, s37
    s_lshl_b32 s51, s22, 14
    s_add_u32 s38, s51, s48
    s_mul_i32 s39, s21, 3072
    s_add_u32 s39, s39, s41
    s_lshl_b32 s40, s21, 9
    s_add_u32 s40, s40, s41
    s_add_u32 s40, s40, 23552
    s_lshl_b32 s48, s3, 9
    s_lshl_b32 s51, s3, 7
    s_add_u32 s51, s51, 16384
    v_mov_b32 v43, 0x7f000000
    v_add_u32 v41, s48, v1
    v_cmp_gt_u32 vcc, 2, v5
    s_nop 1
    v_cndmask_b32 v11, v43, v41, vcc
    v_lshlrev_b32 v41, 3, v4
    v_lshl_add_u32 v25, v5, 8, v41
    v_add_u32 v41, s51, v41
    v_cmp_eq_u32 vcc, 2, v5
    s_nop 1
    v_cndmask_b32 v12, v43, v41, vcc
    s_lshl_b32 s48, s22, 7
    v_lshlrev_b32 v41, 3, v4
    v_lshl_add_u32 v41, v5, 1, v41
    v_add_u32 v41, s48, v41
    v_and_b32 v42, 1, v5
    v_cmp_eq_u32 vcc, 0, v42
    s_nop 1
    v_cndmask_b32 v13, v43, v41, vcc
    s_mul_i32 s48, s22, 4608
    s_add_u32 s48, s48, 138240
    v_mul_u32_u24 v41, 48, v4
    v_add_u32 v41, s48, v41
    v_lshlrev_b32 v42, 3, v5
    v_subrev_u32 v43, 8, v42
    v_cmp_eq_u32 vcc, 0, v5
    s_nop 1
    v_cndmask_b32 v43, v43, 40, vcc
    v_add_u32 v29, v41, v43
    v_add_u32 v43, 16, v42
    v_cndmask_b32 v43, v43, 40, vcc
    v_add_u32 v30, v41, v43
    v_lshrrev_b32 v41, 2, v4
    v_and_b32 v42, 3, v4
    v_lshl_add_u32 v43, v5, 2, v41
    v_mul_u32_u24 v43, 48, v43
    v_add_u32 v43, s48, v43
    v_lshl_add_u32 v31, v42, 1, 0
    v_cmp_ge_u32 vcc, 4, v31
    s_nop 1
    v_cndmask_b32 v31, 0, v31, vcc
    v_lshl_add_u32 v31, v31, 3, v43
    v_lshl_add_u32 v32, v42, 1, 1
    v_cmp_ge_u32 vcc, 4, v32
    s_nop 1
    v_cndmask_b32 v32, 0, v32, vcc
    v_lshl_add_u32 v32, v32, 3, v43
    v_mul_u32_u24 v43, 144, v4
    v_lshl_add_u32 v43, v5, 3, v43
    v_add_u32 v33, s48, v43
    v_lshl_add_u32 v43, v5, 3, v41
    v_mul_u32_u24 v43, 72, v43
    v_lshl_add_u32 v43, v42, 3, v43
    v_add_u32 v34, s48, v43
    s_lshl_b32 s48, s22, 8
    s_movk_i32 s49, 1040
    v_lshrrev_b32 v246, 2, v242
    v_and_b32 v242, 3, v242
    v_lshl_add_u32 v242, v242, 6, s48
    v_mad_u32_u24 v242, v246, s49, v242
    v_add_u32 v242, 102400, v242
    v_lshrrev_b32 v246, 2, v243
    v_and_b32 v243, 3, v243
    v_lshl_add_u32 v243, v243, 6, s48
    v_mad_u32_u24 v243, v246, s49, v243
    v_add_u32 v243, 138240, v243
    s_mul_i32 s48, s22, 4160
    v_add_u32 v241, s48, v3
    s_mov_b32 s56, 0x05040100
    s_mov_b32 s57, 0x07060302
    s_and_b32 s50, s2, 1
    s_lshl_b32 s50, s50, 7
    v_mov_b32 v96, 0xf149f2ca
    v_lshlrev_b32 v97, 2, v5
    v_sub_u32 v98, v4, v97
    v_and_b32 v99, 4, v97
    v_sub_u32 v99, v99, v4
    v_lshrrev_b32 v100, 1, v5
    s_cmp_eq_u32 s20, 0
    s_cselect_b32 s48, 2, 0
    v_add_u32 v100, s48, v100
    v_subrev_u32 v101, 0, v98
    v_cmp_ge_u32 vcc, 7, v101
    s_nop 1
    v_cndmask_b32 v80, v96, 0, vcc
    v_cmp_ge_i32 vcc, -9, v101
    s_nop 1
    v_cndmask_b32 v84, v96, 0, vcc
    v_cmp_le_i32 vcc, 1, v99
    s_nop 1
    v_cndmask_b32 v101, v96, 0, vcc
    v_cmp_eq_u32 vcc, 0, v100
    s_nop 1
    v_cndmask_b32 v88, v96, v101, vcc
    v_cmp_eq_u32 vcc, 1, v100
    s_nop 1
    v_cndmask_b32 v92, v96, v101, vcc
    v_subrev_u32 v101, 1, v98
    v_cmp_ge_u32 vcc, 7, v101
    s_nop 1
    v_cndmask_b32 v81, v96, 0, vcc
    v_cmp_ge_i32 vcc, -9, v101
    s_nop 1
    v_cndmask_b32 v85, v96, 0, vcc
    v_cmp_le_i32 vcc, 0, v99
    s_nop 1
    v_cndmask_b32 v101, v96, 0, vcc
    v_cmp_eq_u32 vcc, 0, v100
    s_nop 1
    v_cndmask_b32 v89, v96, v101, vcc
    v_cmp_eq_u32 vcc, 1, v100
    s_nop 1
    v_cndmask_b32 v93, v96, v101, vcc
    v_subrev_u32 v101, 2, v98
    v_cmp_ge_u32 vcc, 7, v101
    s_nop 1
    v_cndmask_b32 v82, v96, 0, vcc
    v_cmp_ge_i32 vcc, -9, v101
    s_nop 1
    v_cndmask_b32 v86, v96, 0, vcc
    v_cmp_le_i32 vcc, -1, v99
    s_nop 1
    v_cndmask_b32 v101, v96, 0, vcc
    v_cmp_eq_u32 vcc, 0, v100
    s_nop 1
    v_cndmask_b32 v90, v96, v101, vcc
    v_cmp_eq_u32 vcc, 1, v100
    s_nop 1
    v_cndmask_b32 v94, v96, v101, vcc
    v_subrev_u32 v101, 3, v98
    v_cmp_ge_u32 vcc, 7, v101
    s_nop 1
    v_cndmask_b32 v83, v96, 0, vcc
    v_cmp_ge_i32 vcc, -9, v101
    s_nop 1
    v_cndmask_b32 v87, v96, 0, vcc
    v_cmp_le_i32 vcc, -2, v99
    s_nop 1
    v_cndmask_b32 v101, v96, 0, vcc
    v_cmp_eq_u32 vcc, 0, v100
    s_nop 1
    v_cndmask_b32 v91, v96, v101, vcc
    v_cmp_eq_u32 vcc, 1, v100
    s_nop 1
    v_cndmask_b32 v95, v96, v101, vcc
    ds_write_b128 v3, v[80:83] offset:54272
    ds_write_b128 v3, v[84:87] offset:55296
    ds_write_b128 v3, v[88:91] offset:56320
    ds_write_b128 v3, v[92:95] offset:57344
    s_add_u32 s15, s59, 1280
    s_add_u32 m0, s58, 2048
    s_nop 0
    buffer_load_dwordx4 v240, s[24:27], s15 offen lds
    s_add_u32 s15, s59, 40960
    s_add_u32 m0, s58, 4096
    s_nop 0
    buffer_load_dwordx4 v240, s[24:27], s15 offen lds
    s_waitcnt vmcnt(23)
    v_perm_b32 v224, v194, v192, s56
    s_waitcnt vmcnt(21)
    v_perm_b32 v225, v198, v196, s56
    s_waitcnt vmcnt(19)
    v_perm_b32 v226, v202, v200, s56
    s_waitcnt vmcnt(17)
    v_perm_b32 v227, v206, v204, s56
    ds_write_b128 v242, v[224:227] offset:0
    v_perm_b32 v228, v194, v192, s57
    v_perm_b32 v229, v198, v196, s57
    v_perm_b32 v230, v202, v200, s57
    v_perm_b32 v231, v206, v204, s57
    ds_write_b128 v242, v[228:231] offset:16
    v_perm_b32 v232, v195, v193, s56
    v_perm_b32 v233, v199, v197, s56
    v_perm_b32 v234, v203, v201, s56
    v_perm_b32 v235, v207, v205, s56
    ds_write_b128 v242, v[232:235] offset:32
    v_perm_b32 v236, v195, v193, s57
    v_perm_b32 v237, v199, v197, s57
    v_perm_b32 v238, v203, v201, s57
    v_perm_b32 v239, v207, v205, s57
    ds_write_b128 v242, v[236:239] offset:48
    buffer_load_dwordx2 v[40:41], off, s[52:55], s50 sc1
    s_waitcnt lgkmcnt(0)
    s_barrier
    ds_read_b128 v[192:195], v241 offset:0
    ds_read_b128 v[196:199], v241 offset:1040
    ds_read_b128 v[200:203], v241 offset:2080
    ds_read_b128 v[204:207], v241 offset:3120
    s_waitcnt lgkmcnt(3)
    buffer_store_dwordx4 v[192:195], v1, s[4:7], s62 offen offset:0 sc1
    s_waitcnt lgkmcnt(2)
    buffer_store_dwordx4 v[196:199], v1, s[4:7], s62 offen offset:1024 sc1
    s_waitcnt lgkmcnt(1)
    buffer_store_dwordx4 v[200:203], v1, s[4:7], s63 offen offset:0 sc1
    s_waitcnt lgkmcnt(0)
    buffer_store_dwordx4 v[204:207], v244, s[4:7], s63 offen offset:1024 sc1
    s_add_u32 s15, s59, 42240
    s_add_u32 m0, s58, 6144
    s_nop 0
    buffer_load_dwordx4 v240, s[24:27], s15 offen lds
    s_add_u32 s15, s59, s14
    s_add_u32 m0, s58, 8192
    s_nop 0
    buffer_load_dwordx4 v240, s[24:27], s15 offen lds
    s_add_u32 s58, s58, 20480
    s_cmp_ge_u32 s58, 102400
    s_cselect_b32 s58, s12, s58
    s_add_u32 s59, s59, 256
    s_sub_u32 s15, s59, 1280
    s_cmp_ge_u32 s59, s13
    s_cselect_b32 s59, s15, s59
    s_add_u32 s15, s59, 0
    s_add_u32 m0, s58, 0
    s_nop 0
    buffer_load_dwordx4 v240, s[24:27], s15 offen lds
    s_add_u32 s15, s59, 1280
    s_add_u32 m0, s58, 2048
    s_nop 0
    buffer_load_dwordx4 v240, s[24:27], s15 offen lds
    s_add_u32 s15, s59, 40960
    s_add_u32 m0, s58, 4096
    s_nop 0
    buffer_load_dwordx4 v240, s[24:27], s15 offen lds
    s_waitcnt vmcnt(25)
    v_perm_b32 v224, v210, v208, s56
    s_waitcnt vmcnt(23)
    v_perm_b32 v225, v214, v212, s56
    s_waitcnt vmcnt(21)
    v_perm_b32 v226, v218, v216, s56
    s_waitcnt vmcnt(19)
    v_perm_b32 v227, v222, v220, s56
    ds_write_b128 v243, v[224:227] offset:0
    v_perm_b32 v228, v210, v208, s57
    v_perm_b32 v229, v214, v212, s57
    v_perm_b32 v230, v218, v216, s57
    v_perm_b32 v231, v222, v220, s57
    ds_write_b128 v243, v[228:231] offset:16
    v_perm_b32 v232, v211, v209, s56
    v_perm_b32 v233, v215, v213, s56
    v_perm_b32 v234, v219, v217, s56
    v_perm_b32 v235, v223, v221, s56
    ds_write_b128 v243, v[232:235] offset:32
    v_perm_b32 v236, v211, v209, s57
    v_perm_b32 v237, v215, v213, s57
    v_perm_b32 v238, v219, v217, s57
    v_perm_b32 v239, v223, v221, s57
    ds_write_b128 v243, v[236:239] offset:48
    s_waitcnt lgkmcnt(0)
    s_barrier
    ds_read_b128 v[208:211], v241 offset:35840
    ds_read_b128 v[212:215], v241 offset:36880
    ds_read_b128 v[216:219], v241 offset:37920
    ds_read_b128 v[220:223], v241 offset:38960
    s_waitcnt lgkmcnt(3)
    buffer_store_dwordx4 v[208:211], v1, s[4:7], s64 offen offset:0 sc1
    s_waitcnt lgkmcnt(2)
    buffer_store_dwordx4 v[212:215], v1, s[4:7], s64 offen offset:1024 sc1
    s_waitcnt lgkmcnt(1)
    buffer_store_dwordx4 v[216:219], v1, s[4:7], s65 offen offset:0 sc1
    s_waitcnt lgkmcnt(0)
    buffer_store_dwordx4 v[220:223], v244, s[4:7], s65 offen offset:1024 sc1
    s_mov_b32 s51, 0x20000
    s_waitcnt vmcnt(13)
    v_readfirstlane_b32 s61, v41
    s_nop 0
    s_cmp_lg_u32 s61, 0
    s_cbranch_scc1 BT_tok
    s_nop 1
BT_tl:
    buffer_load_dwordx2 v[40:41], off, s[52:55], s50 sc1
    s_sub_u32 s51, s51, 1
    s_waitcnt vmcnt(0)
    v_readfirstlane_b32 s61, v41
    s_cbranch_scc1 BT_tok
    s_cmp_eq_u32 s61, 0
    s_cbranch_scc1 BT_tl
    s_nop 1
BT_tok:
    v_readfirstlane_b32 s60, v40
    v_mov_b32 v27, v41
    v_or_b32 v26, 1, v40
    s_or_b32 s60, s60, 15
    s_mov_b64 exec, 1
    s_waitcnt vmcnt(9)
    buffer_store_dwordx2 v[26:27], off, s[4:7], s43 sc1
    s_mov_b64 exec, -1
    s_add_u32 s15, s59, 42240
    s_add_u32 m0, s58, 6144
    s_nop 0
    buffer_load_dwordx4 v240, s[24:27], s15 offen lds
    s_add_u32 s15, s59, s14
    s_add_u32 m0, s58, 8192
    s_nop 0
    buffer_load_dwordx4 v240, s[24:27], s15 offen lds
    s_add_u32 s58, s58, 20480
    s_cmp_ge_u32 s58, 102400
    s_cselect_b32 s58, s12, s58
    s_add_u32 s59, s59, 256
    s_sub_u32 s15, s59, 1280
    s_cmp_ge_u32 s59, s13
    s_cselect_b32 s59, s15, s59
    s_add_u32 s15, s59, 0
    s_add_u32 m0, s58, 0
    s_nop 0
    buffer_load_dwordx4 v240, s[24:27], s15 offen lds
    s_add_u32 s15, s59, 1280
    s_add_u32 m0, s58, 2048
    s_nop 0
    buffer_load_dwordx4 v240, s[24:27], s15 offen lds
    s_add_u32 s15, s59, 40960
    s_add_u32 m0, s58, 4096
    s_nop 0
    buffer_load_dwordx4 v240, s[24:27], s15 offen lds
    s_add_u32 s15, s59, 42240
    s_add_u32 m0, s58, 6144
    s_nop 0
    buffer_load_dwordx4 v240, s[24:27], s15 offen lds
    s_add_u32 s15, s59, s14
    s_add_u32 m0, s58, 8192
    s_nop 0
    buffer_load_dwordx4 v240, s[24:27], s15 offen lds
    s_add_u32 s58, s58, 20480
    s_cmp_ge_u32 s58, 102400
    s_cselect_b32 s58, s12, s58
    s_add_u32 s59, s59, 256
    s_sub_u32 s15, s59, 1280
    s_cmp_ge_u32 s59, s13
    s_cselect_b32 s59, s15, s59
    s_add_u32 s15, s59, 0
    s_add_u32 m0, s58, 0
    s_nop 0
    buffer_load_dwordx4 v240, s[24:27], s15 offen lds
    s_add_u32 s15, s59, 1280
    s_add_u32 m0, s58, 2048
    s_nop 0
    buffer_load_dwordx4 v240, s[24:27], s15 offen lds
    s_add_u32 s15, s59, 40960
    s_add_u32 m0, s58, 4096
    s_nop 0
    buffer_load_dwordx4 v240, s[24:27], s15 offen lds
    s_add_u32 s15, s59, 42240
    s_add_u32 m0, s58, 6144
    s_nop 0
    buffer_load_dwordx4 v240, s[24:27], s15 offen lds
    s_add_u32 s15, s59, s14
    s_add_u32 m0, s58, 8192
    s_nop 0
    buffer_load_dwordx4 v240, s[24:27], s15 offen lds
    s_mov_b32 s59, s61
    s_sub_u32 s58, s60, 14
    v_mov_b32 v26, s58
    s_mul_i32 s24, s20, 81920
    s_mul_i32 s25, s23, 81920
    s_lshl_b32 s26, s3, 17
    s_lshl_b32 s27, s47, 14
    s_mov_b32 s27, 0
    s_add_u32 s27, s27, s26
    s_mul_i32 s48, s22, 0x20000
    s_add_u32 s48, s48, s46
    s_add_u32 s48, s48, 0x730000
    s_cmp_lt_u32 s22, 2
    s_cselect_b32 s48, s48, 0x7f000000
    v_mov_b32 v248, -1.0
    v_mov_b32 v249, -1.0
    buffer_store_dwordx2 v[248:249], v9, s[4:7], s48 offen sc1
    v_min_u32 v42, 19, v0
    s_sub_u32 s48, s43, s44
    v_lshl_add_u32 v42, v42, 12, s48
    s_lshl_b32 s49, s20, 7
    s_lshr_b32 s50, s22, 1
    s_lshl_b32 s50, s50, 6
    s_add_u32 s49, s49, s50
    s_and_b32 s50, s22, 1
    s_lshl_b32 s50, s50, 1
    s_add_u32 s49, s49, s50
    buffer_load_ushort v24, v28, s[16:19], s49 offen
    v_and_b32 v103, 7, v4
    v_lshrrev_b32 v107, 3, v4
    v_xor_b32 v102, v103, v107
    v_lshlrev_b32 v102, 7, v102
    v_lshl_add_u32 v102, v107, 10, v102
    s_lshl_b32 s48, s22, 11
    v_or_b32 v104, 0, v5
    v_xor_b32 v104, v104, v103
    v_lshl_add_u32 v104, v104, 4, v102
    v_or_b32 v105, 4, v5
    v_xor_b32 v105, v105, v103
    v_lshl_add_u32 v105, v105, 4, v102
    s_and_b32 s49, s22, 1
    s_cmp_eq_u32 s49, 1
    s_cselect_b64 vcc, -1, 0
    s_lshr_b32 s49, s22, 1
    s_mul_i32 s49, s49, 10240
    s_add_u32 s49, s49, 8192
    v_cndmask_b32 v107, v104, v105, vcc
    v_add_u32 v107, s49, v107
    v_add_u32 v104, s48, v104
    v_add_u32 v105, s48, v105
    v_and_b32 v106, 1, v5
    v_lshl_add_u32 v102, v106, 3, v102
    v_lshrrev_b32 v106, 1, v5
    v_xor_b32 v103, v103, v106
    v_xor_b32 v76, 0, v103
    v_lshl_add_u32 v76, v76, 4, v102
    v_xor_b32 v77, 2, v103
    v_lshl_add_u32 v77, v77, 4, v102
    v_xor_b32 v78, 4, v103
    v_lshl_add_u32 v78, v78, 4, v102
    v_xor_b32 v79, 6, v103
    v_lshl_add_u32 v79, v79, 4, v102
    s_lshl_b32 s14, s21, 9
    s_add_u32 s14, s14, s30
    v_and_b32 v191, 7, v0
    v_lshrrev_b32 v6, 3, v0
    v_xor_b32 v10, v191, v6
    v_lshlrev_b32 v10, 4, v10
    v_lshl_add_u32 v191, v191, 7, v10
    v_add_u32 v191, s67, v191
    v_lshl_add_u32 v10, v6, 13, v10
    v_lshrrev_b32 v6, 5, v0
    v_lshlrev_b32 v6, 12, v6
    v_lshl_add_u32 v6, v7, 4, v6
    s_add_u32 m0, s67, 0
    s_nop 0
    buffer_load_dwordx4 v10, s[8:11], s66 offen offset:0 nt lds
    s_add_u32 m0, s67, 896
    s_nop 0
    buffer_load_dwordx4 v10, s[8:11], s66 offen offset:128 nt lds
    s_add_u32 m0, s67, 1792
    s_nop 0
    buffer_load_dwordx4 v10, s[8:11], s66 offen offset:256 nt lds
    s_add_u32 m0, s67, 2688
    s_nop 0
    buffer_load_dwordx4 v10, s[8:11], s66 offen offset:384 nt lds
    s_add_u32 m0, s67, 3584
    s_nop 0
    buffer_load_dwordx4 v10, s[8:11], s66 offen offset:512 nt lds
    s_add_u32 m0, s67, 4480
    s_nop 0
    buffer_load_dwordx4 v10, s[8:11], s66 offen offset:640 nt lds
    s_add_u32 s48, s58, 1
    v_mov_b32 v26, s48
    s_waitcnt vmcnt(7)
    s_mov_b64 exec, 1
    buffer_store_dwordx2 v[26:27], off, s[4:7], s43 sc1
    s_mov_b64 exec, -1
    s_lshl_b32 s48, s22, 11
    s_barrier
    s_and_b32 s49, s21, 1
    s_mul_i32 s50, s21, 5
    s_add_u32 s52, s50, 0
    s_add_u32 s52, s52, s49
    s_lshr_b32 s53, s52, 2
    s_mul_i32 s53, s53, 10240
    s_add_u32 s53, s53, s48
    s_and_b32 s52, s52, 3
    s_lshl_b32 s52, s52, 5
    v_xor_b32 v108, s52, v76
    v_add_u32 v108, s53, v108
    ds_read_b64 v[16:17], v108
    s_add_u32 s52, s50, 1
    s_add_u32 s52, s52, s49
    s_lshr_b32 s53, s52, 2
    s_mul_i32 s53, s53, 10240
    s_add_u32 s53, s53, s48
    s_and_b32 s52, s52, 3
    s_lshl_b32 s52, s52, 5
    v_xor_b32 v109, s52, v76
    v_add_u32 v109, s53, v109
    ds_read_b64 v[18:19], v109
    s_add_u32 s52, s50, 2
    s_add_u32 s52, s52, s49
    s_lshr_b32 s53, s52, 2
    s_mul_i32 s53, s53, 10240
    s_add_u32 s53, s53, s48
    s_and_b32 s52, s52, 3
    s_lshl_b32 s52, s52, 5
    v_xor_b32 v110, s52, v76
    v_add_u32 v110, s53, v110
    ds_read_b64 v[20:21], v110
    s_add_u32 s52, s50, 3
    s_add_u32 s52, s52, s49
    s_lshr_b32 s53, s52, 2
    s_mul_i32 s53, s53, 10240
    s_add_u32 s53, s53, s48
    s_and_b32 s52, s52, 3
    s_lshl_b32 s52, s52, 5
    v_xor_b32 v111, s52, v76
    v_add_u32 v111, s53, v111
    ds_read_b64 v[22:23], v111
    s_add_u32 s52, s50, 4
    s_cmp_eq_u32 s49, 1
    s_cselect_b32 s52, s50, s52
    s_lshr_b32 s53, s52, 2
    s_mul_i32 s53, s53, 10240
    s_add_u32 s53, s53, s48
    s_and_b32 s52, s52, 3
    s_lshl_b32 s52, s52, 5
    v_xor_b32 v112, s52, v76
    v_add_u32 v112, s53, v112
    ds_read_b64 v[14:15], v112
    ds_read_b128 v[140:143], v104 offset:0
    ds_read_b128 v[144:147], v105 offset:0
    ds_read_b128 v[148:151], v104 offset:10240
    ds_read_b128 v[152:155], v105 offset:10240
    ds_read_b128 v[156:159], v104 offset:20480
    ds_read_b128 v[160:163], v105 offset:20480
    ds_read_b128 v[164:167], v104 offset:30720
    ds_read_b128 v[168:171], v105 offset:30720
    ds_read_b128 v[172:175], v104 offset:40960
    ds_read_b128 v[176:179], v105 offset:40960
    s_waitcnt lgkmcnt(9)
    v_mfma_f32_16x16x32_bf16 v[60:63], v[36:39], v[140:143], 0
    v_mfma_f32_16x16x32_bf16 v[64:67], v[140:143], v[140:143], 0
    ds_read_b128 v[140:143], v104 offset:51200
    s_waitcnt lgkmcnt(9)
    v_mfma_f32_16x16x32_bf16 v[60:63], v[36:39], v[144:147], v[60:63]
    v_mfma_f32_16x16x32_bf16 v[64:67], v[144:147], v[144:147], v[64:67]
    ds_read_b128 v[144:147], v105 offset:51200
    s_waitcnt lgkmcnt(9)
    v_mfma_f32_16x16x32_bf16 v[60:63], v[36:39], v[148:151], v[60:63]
    v_mfma_f32_16x16x32_bf16 v[64:67], v[148:151], v[148:151], v[64:67]
    v_add_u32 v113, 61440, v104
    ds_read_b128 v[148:151], v113 offset:0
    s_waitcnt lgkmcnt(9)
    v_mfma_f32_16x16x32_bf16 v[60:63], v[36:39], v[152:155], v[60:63]
    v_mfma_f32_16x16x32_bf16 v[64:67], v[152:155], v[152:155], v[64:67]
    v_add_u32 v114, 61440, v105
    ds_read_b128 v[152:155], v114 offset:0
    s_waitcnt lgkmcnt(9)
    v_mfma_f32_16x16x32_bf16 v[60:63], v[36:39], v[156:159], v[60:63]
    v_mfma_f32_16x16x32_bf16 v[64:67], v[156:159], v[156:159], v[64:67]
    ds_read_b128 v[156:159], v113 offset:10240
    s_waitcnt lgkmcnt(9)
    v_mfma_f32_16x16x32_bf16 v[60:63], v[36:39], v[160:163], v[60:63]
    v_mfma_f32_16x16x32_bf16 v[64:67], v[160:163], v[160:163], v[64:67]
    ds_read_b128 v[160:163], v114 offset:10240
    s_waitcnt lgkmcnt(9)
    v_mfma_f32_16x16x32_bf16 v[60:63], v[36:39], v[164:167], v[60:63]
    v_mfma_f32_16x16x32_bf16 v[64:67], v[164:167], v[164:167], v[64:67]
    ds_read_b128 v[164:167], v113 offset:20480
    s_waitcnt lgkmcnt(9)
    v_mfma_f32_16x16x32_bf16 v[60:63], v[36:39], v[168:171], v[60:63]
    v_mfma_f32_16x16x32_bf16 v[64:67], v[168:171], v[168:171], v[64:67]
    ds_read_b128 v[168:171], v114 offset:20480
    s_waitcnt lgkmcnt(9)
    v_mfma_f32_16x16x32_bf16 v[60:63], v[36:39], v[172:175], v[60:63]
    v_mfma_f32_16x16x32_bf16 v[64:67], v[172:175], v[172:175], v[64:67]
    ds_read_b128 v[172:175], v113 offset:30720
    s_waitcnt lgkmcnt(9)
    v_mfma_f32_16x16x32_bf16 v[60:63], v[36:39], v[176:179], v[60:63]
    v_mfma_f32_16x16x32_bf16 v[64:67], v[176:179], v[176:179], v[64:67]
    ds_read_b128 v[176:179], v114 offset:30720
    s_waitcnt lgkmcnt(9)
    v_mfma_f32_16x16x32_bf16 v[60:63], v[36:39], v[140:143], v[60:63]
    v_mfma_f32_16x16x32_bf16 v[64:67], v[140:143], v[140:143], v[64:67]
    ds_read_b128 v[140:143], v107 offset:0
    s_waitcnt lgkmcnt(9)
    v_mfma_f32_16x16x32_bf16 v[60:63], v[36:39], v[144:147], v[60:63]
    v_mfma_f32_16x16x32_bf16 v[64:67], v[144:147], v[144:147], v[64:67]
    ds_read_b128 v[144:147], v107 offset:20480
    s_waitcnt lgkmcnt(9)
    v_mfma_f32_16x16x32_bf16 v[60:63], v[36:39], v[148:151], v[60:63]
    v_mfma_f32_16x16x32_bf16 v[64:67], v[148:151], v[148:151], v[64:67]
    ds_read_b128 v[148:151], v107 offset:40960
    s_waitcnt lgkmcnt(9)
    v_mfma_f32_16x16x32_bf16 v[60:63], v[36:39], v[152:155], v[60:63]
    v_mfma_f32_16x16x32_bf16 v[64:67], v[152:155], v[152:155], v[64:67]
    v_add_u32 v115, 61440, v107
    ds_read_b128 v[152:155], v115 offset:0
    s_waitcnt lgkmcnt(9)
    v_mfma_f32_16x16x32_bf16 v[60:63], v[36:39], v[156:159], v[60:63]
    v_mfma_f32_16x16x32_bf16 v[64:67], v[156:159], v[156:159], v[64:67]
    ds_read_b128 v[156:159], v115 offset:20480
    s_waitcnt lgkmcnt(9)
    v_mfma_f32_16x16x32_bf16 v[60:63], v[36:39], v[160:163], v[60:63]
    v_mfma_f32_16x16x32_bf16 v[64:67], v[160:163], v[160:163], v[64:67]
    s_waitcnt lgkmcnt(8)
    v_mfma_f32_16x16x32_bf16 v[60:63], v[36:39], v[164:167], v[60:63]
    v_mfma_f32_16x16x32_bf16 v[64:67], v[164:167], v[164:167], v[64:67]
    s_waitcnt lgkmcnt(7)
    v_mfma_f32_16x16x32_bf16 v[60:63], v[36:39], v[168:171], v[60:63]
    v_mfma_f32_16x16x32_bf16 v[64:67], v[168:171], v[168:171], v[64:67]
    s_waitcnt lgkmcnt(6)
    v_mfma_f32_16x16x32_bf16 v[60:63], v[36:39], v[172:175], v[60:63]
    v_mfma_f32_16x16x32_bf16 v[64:67], v[172:175], v[172:175], v[64:67]
    s_waitcnt lgkmcnt(5)
    v_mfma_f32_16x16x32_bf16 v[60:63], v[36:39], v[176:179], v[60:63]
    v_mfma_f32_16x16x32_bf16 v[64:67], v[176:179], v[176:179], v[64:67]
    s_waitcnt lgkmcnt(4)
    v_mfma_f32_16x16x32_bf16 v[68:71], v[36:39], v[140:143], 0
    v_mfma_f32_16x16x32_bf16 v[72:75], v[140:143], v[140:143], 0
    s_waitcnt lgkmcnt(3)
    v_mfma_f32_16x16x32_bf16 v[68:71], v[36:39], v[144:147], v[68:71]
    v_mfma_f32_16x16x32_bf16 v[72:75], v[144:147], v[144:147], v[72:75]
    s_waitcnt lgkmcnt(2)
    v_mfma_f32_16x16x32_bf16 v[68:71], v[36:39], v[148:151], v[68:71]
    v_mfma_f32_16x16x32_bf16 v[72:75], v[148:151], v[148:151], v[72:75]
    s_waitcnt lgkmcnt(1)
    v_mfma_f32_16x16x32_bf16 v[68:71], v[36:39], v[152:155], v[68:71]
    v_mfma_f32_16x16x32_bf16 v[72:75], v[152:155], v[152:155], v[72:75]
    s_waitcnt lgkmcnt(0)
    v_mfma_f32_16x16x32_bf16 v[68:71], v[36:39], v[156:159], v[68:71]
    v_mfma_f32_16x16x32_bf16 v[72:75], v[156:159], v[156:159], v[72:75]
    buffer_load_dwordx2 v[40:41], v42, s[4:7], 0 offen sc1
    v_and_b32 v103, 3, v4
    v_cmp_eq_u32 vcc, 1, v103
    s_nop 1
    v_cndmask_b32 v64, v64, v65, vcc
    s_nop 1
    v_cndmask_b32 v72, v72, v73, vcc
    v_cmp_eq_u32 vcc, 2, v103
    s_nop 1
    v_cndmask_b32 v64, v64, v66, vcc
    v_cndmask_b32 v72, v72, v74, vcc
    v_cmp_eq_u32 vcc, 3, v103
    s_nop 1
    v_cndmask_b32 v64, v64, v67, vcc
    v_cndmask_b32 v72, v72, v75, vcc
    v_mov_b32 v61, v64
    v_mov_b32 v69, v72
    s_lshl_b32 s48, s22, 7
    s_add_u32 s48, s48, 161792
    v_lshl_add_u32 v102, v4, 3, s48
    s_mov_b32 exec_lo, 0x00f0000f
    s_mov_b32 exec_hi, 0xf0000f00
    ds_write_b64 v102, v[60:61]
    ds_write_b64 v102, v[68:69] offset:512
    s_mov_b64 exec, -1
    v_add_u32 v102, 161792, v9
    v_lshlrev_b32 v103, 3, v4
    v_add_u32 v103, 162304, v103
    s_waitcnt lgkmcnt(0)
    s_barrier
    ds_read_b64 v[60:61], v102
    ds_read_b64 v[68:69], v103 offset:0
    ds_read_b64 v[70:71], v103 offset:128
    ds_read_b64 v[72:73], v103 offset:256
    ds_read_b64 v[74:75], v103 offset:384
    ds_read_b64 v[140:141], v76 offset:0
    ds_read_b64 v[142:143], v77 offset:0
    ds_read_b64 v[144:145], v76 offset:2048
    ds_read_b64 v[146:147], v77 offset:2048
    ds_read_b64 v[148:149], v76 offset:4096
    ds_read_b64 v[150:151], v77 offset:4096
    ds_read_b64 v[152:153], v76 offset:6144
    ds_read_b64 v[154:155], v77 offset:6144
    ds_read_b64 v[156:157], v76 offset:8192
    ds_read_b64 v[158:159], v77 offset:8192
    s_waitcnt lgkmcnt(14)
    v_mul_f32 v60, 0xbacccccd, v60
    v_mul_f32 v61, 0x3acccccd, v61
    v_fma_f32 v61, -v60, v60, v61
    v_max_f32 v61, 0, v61
    v_add_f32 v61, 0x3727c5ac, v61
    v_rsq_f32 v61, v61
    ds_bpermute_b32 v180, v28, v60 offset:0
    ds_bpermute_b32 v181, v28, v61 offset:0
    ds_bpermute_b32 v182, v28, v60 offset:64
    ds_bpermute_b32 v183, v28, v61 offset:64
    ds_bpermute_b32 v184, v28, v60 offset:128
    ds_bpermute_b32 v185, v28, v61 offset:128
    ds_bpermute_b32 v186, v28, v60 offset:192
    ds_bpermute_b32 v187, v28, v61 offset:192
    s_waitcnt lgkmcnt(14)
    v_pk_add_f32 v[68:69], v[68:69], v[72:73]
    v_pk_add_f32 v[70:71], v[70:71], v[74:75]
    v_pk_add_f32 v[68:69], v[68:69], v[70:71]
    v_mul_f32 v68, 0xbacccccd, v68
    v_mul_f32 v69, 0x3acccccd, v69
    v_fma_f32 v69, -v68, v68, v69
    v_max_f32 v69, 0, v69
    v_add_f32 v69, 0x3727c5ac, v69
    v_rsq_f32 v69, v69
    v_mov_b32 v188, v68
    v_mov_b32 v189, v69
    s_mov_b32 s51, 0x20000
    s_waitcnt vmcnt(0)
    v_cmp_gt_u64 vcc, s[58:59], v[40:41]
    v_cmp_lt_u64 s[48:49], s[60:61], v[40:41]
    s_nop 0
    s_or_b64 vcc, vcc, s[48:49]
    s_cbranch_scc0 POLLD_2
    s_nop 1
POLL_1:
    buffer_load_dwordx2 v[40:41], v42, s[4:7], 0 offen sc1
    s_sub_u32 s51, s51, 1
    s_cbranch_scc1 POLLD_2X
    s_waitcnt vmcnt(0)
    v_cmp_gt_u64 vcc, s[58:59], v[40:41]
    v_cmp_lt_u64 s[48:49], s[60:61], v[40:41]
    s_nop 0
    s_or_b64 vcc, vcc, s[48:49]
    s_cbranch_scc1 POLL_1
POLLD_2X:
    s_waitcnt vmcnt(0)
POLLD_2:
    s_xor_b32 s56, s26, 0x3000000
    buffer_load_dwordx4 a[0:3], v1, s[4:7], s56 offen offset:0
    buffer_load_dwordx4 a[4:7], v1, s[4:7], s56 offen offset:1024
    buffer_load_dwordx4 a[8:11], v1, s[4:7], s56 offen offset:2048
    buffer_load_dwordx4 a[12:15], v1, s[4:7], s56 offen offset:3072
    s_sub_u32 s58, s60, 13
    v_mov_b32 v26, s58
    s_xor_b32 s56, s26, 0x3001000
    buffer_load_dwordx4 a[16:19], v1, s[4:7], s56 offen offset:0
    buffer_load_dwordx4 a[20:23], v1, s[4:7], s56 offen offset:1024
    buffer_load_dwordx4 a[24:27], v1, s[4:7], s56 offen offset:2048
    buffer_load_dwordx4 a[28:31], v1, s[4:7], s56 offen offset:3072
    s_xor_b32 s56, s26, 0x3002000
    buffer_load_dwordx4 a[32:35], v1, s[4:7], s56 offen offset:0
    buffer_load_dwordx4 a[36:39], v1, s[4:7], s56 offen offset:1024
    buffer_load_dwordx4 a[40:43], v1, s[4:7], s56 offen offset:2048
    buffer_load_dwordx4 a[44:47], v1, s[4:7], s56 offen offset:3072
    s_xor_b32 s56, s26, 0x3003000
    buffer_load_dwordx4 a[48:51], v1, s[4:7], s56 offen offset:0
    buffer_load_dwordx4 a[52:55], v1, s[4:7], s56 offen offset:1024
    s_add_u32 m0, s67, 5376
    s_nop 0
    buffer_load_dwordx4 v10, s[8:11], s66 offen offset:768 nt lds
    s_add_u32 m0, s67, 6272
    s_nop 0
    buffer_load_dwordx4 v10, s[8:11], s66 offen offset:896 nt lds
    s_cmp_eq_u32 s22, 3
    s_cselect_b32 s48, 0x0, 0
    v_add_u32 v10, s48, v1
    v_subrev_u32 v43, 20, v0
    v_min_u32 v43, 35, v43
    s_lshl_b32 s48, s21, 7
    s_add_u32 s48, s48, 0x716000
    v_lshl_add_u32 v43, v43, 10, s48
    v_cmp_le_u32 vcc, 20, v0
    s_nop 1
    v_cndmask_b32 v42, v42, v43, vcc
    s_lshl_b32 s48, s22, 8
    v_lshlrev_b32 v190, 4, v5
    v_add_u32 v190, s48, v190
    v_add_u32 v190, 160768, v190
    s_waitcnt vmcnt(15)
    v_mfma_f32_16x16x32_bf16 v[60:63], a[0:3], v[140:143], 0
    ds_read_b64 v[160:161], v78 offset:0
    ds_read_b64 v[162:163], v79 offset:0
    s_waitcnt vmcnt(14)
    v_mfma_f32_16x16x32_bf16 v[80:83], a[4:7], v[140:143], 0
    s_waitcnt vmcnt(13)
    v_mfma_f32_16x16x32_bf16 v[100:103], a[8:11], v[140:143], 0
    buffer_load_dwordx4 a[56:59], v1, s[4:7], s56 offen offset:2048
    s_waitcnt vmcnt(13)
    v_mfma_f32_16x16x32_bf16 v[120:123], a[12:15], v[140:143], 0
    v_mfma_f32_16x16x32_bf16 v[64:67], a[0:3], v[144:147], 0
    ds_read_b64 v[164:165], v78 offset:2048
    ds_read_b64 v[166:167], v79 offset:2048
    v_mfma_f32_16x16x32_bf16 v[84:87], a[4:7], v[144:147], 0
    v_mfma_f32_16x16x32_bf16 v[104:107], a[8:11], v[144:147], 0
    buffer_load_dwordx4 a[60:63], v1, s[4:7], s56 offen offset:3072
    v_mfma_f32_16x16x32_bf16 v[124:127], a[12:15], v[144:147], 0
    s_waitcnt lgkmcnt(14)
    v_mfma_f32_16x16x32_bf16 v[68:71], a[0:3], v[148:151], 0
    ds_read_b64 v[168:169], v78 offset:4096
    ds_read_b64 v[170:171], v79 offset:4096
    v_mfma_f32_16x16x32_bf16 v[88:91], a[4:7], v[148:151], 0
    v_mfma_f32_16x16x32_bf16 v[108:111], a[8:11], v[148:151], 0
    s_xor_b32 s56, s26, 0x3004000
    buffer_load_dwordx4 a[64:67], v1, s[4:7], s56 offen offset:0
    v_mfma_f32_16x16x32_bf16 v[128:131], a[12:15], v[148:151], 0
    v_mfma_f32_16x16x32_bf16 v[72:75], a[0:3], v[152:155], 0
    ds_read_b64 v[172:173], v78 offset:6144
    ds_read_b64 v[174:175], v79 offset:6144
    v_mfma_f32_16x16x32_bf16 v[92:95], a[4:7], v[152:155], 0
    v_mfma_f32_16x16x32_bf16 v[112:115], a[8:11], v[152:155], 0
    buffer_load_dwordx4 a[68:71], v1, s[4:7], s56 offen offset:1024
    v_mfma_f32_16x16x32_bf16 v[132:135], a[12:15], v[152:155], 0
    s_waitcnt lgkmcnt(14)
    v_mfma_f32_16x16x32_bf16 v[96:99], a[4:7], v[156:159], 0
    ds_read_b64 v[176:177], v78 offset:8192
    ds_read_b64 v[178:179], v79 offset:8192
    v_mfma_f32_16x16x32_bf16 v[116:119], a[8:11], v[156:159], 0
    buffer_load_dwordx4 a[72:75], v1, s[4:7], s56 offen offset:2048
    v_mfma_f32_16x16x32_bf16 v[136:139], a[12:15], v[156:159], 0
    v_mfma_f32_16x16x32_bf16 v[44:47], a[0:3], v[36:39], 0
    v_mfma_f32_16x16x32_bf16 v[48:51], a[4:7], v[36:39], 0
    v_mfma_f32_16x16x32_bf16 v[52:55], a[8:11], v[36:39], 0
    v_mfma_f32_16x16x32_bf16 v[56:59], a[12:15], v[36:39], 0
    s_waitcnt vmcnt(16) lgkmcnt(8)
    v_mfma_f32_16x16x32_bf16 v[60:63], a[16:19], v[160:163], v[60:63]
    ds_read_b64 v[140:141], v76 offset:10240
    ds_read_b64 v[142:143], v77 offset:10240
    s_waitcnt vmcnt(15)
    v_mfma_f32_16x16x32_bf16 v[80:83], a[20:23], v[160:163], v[80:83]
    s_waitcnt vmcnt(14)
    v_mfma_f32_16x16x32_bf16 v[100:103], a[24:27], v[160:163], v[100:103]
    buffer_load_dwordx4 a[76:79], v1, s[4:7], s56 offen offset:3072
    s_waitcnt vmcnt(14)
    v_mfma_f32_16x16x32_bf16 v[120:123], a[28:31], v[160:163], v[120:123]
    s_waitcnt lgkmcnt(8)
    v_mfma_f32_16x16x32_bf16 v[64:67], a[16:19], v[164:167], v[64:67]
    ds_read_b64 v[144:145], v76 offset:12288
    ds_read_b64 v[146:147], v77 offset:12288
    v_mfma_f32_16x16x32_bf16 v[84:87], a[20:23], v[164:167], v[84:87]
    v_mfma_f32_16x16x32_bf16 v[104:107], a[24:27], v[164:167], v[104:107]
    s_xor_b32 s56, s26, 0x3008000
    buffer_load_dwordx4 a[80:83], v1, s[4:7], s56 offen offset:0
    v_mfma_f32_16x16x32_bf16 v[124:127], a[28:31], v[164:167], v[124:127]
    s_waitcnt lgkmcnt(8)
    v_mfma_f32_16x16x32_bf16 v[68:71], a[16:19], v[168:171], v[68:71]
    ds_read_b64 v[148:149], v76 offset:14336
    ds_read_b64 v[150:151], v77 offset:14336
    v_mfma_f32_16x16x32_bf16 v[88:91], a[20:23], v[168:171], v[88:91]
    v_mfma_f32_16x16x32_bf16 v[108:111], a[24:27], v[168:171], v[108:111]
    buffer_load_dwordx4 a[84:87], v1, s[4:7], s56 offen offset:1024
    v_mfma_f32_16x16x32_bf16 v[128:131], a[28:31], v[168:171], v[128:131]
    s_waitcnt lgkmcnt(8)
    v_mfma_f32_16x16x32_bf16 v[72:75], a[16:19], v[172:175], v[72:75]
    ds_read_b64 v[152:153], v76 offset:16384
    ds_read_b64 v[154:155], v77 offset:16384
    v_mfma_f32_16x16x32_bf16 v[92:95], a[20:23], v[172:175], v[92:95]
    v_mfma_f32_16x16x32_bf16 v[112:115], a[24:27], v[172:175], v[112:115]
    buffer_load_dwordx4 a[88:91], v1, s[4:7], s56 offen offset:2048
    v_mfma_f32_16x16x32_bf16 v[132:135], a[28:31], v[172:175], v[132:135]
    s_waitcnt lgkmcnt(8)
    v_mfma_f32_16x16x32_bf16 v[96:99], a[20:23], v[176:179], v[96:99]
    ds_read_b64 v[156:157], v76 offset:18432
    ds_read_b64 v[158:159], v77 offset:18432
    v_mfma_f32_16x16x32_bf16 v[116:119], a[24:27], v[176:179], v[116:119]
    buffer_load_dwordx4 a[92:95], v1, s[4:7], s56 offen offset:3072
    v_mfma_f32_16x16x32_bf16 v[136:139], a[28:31], v[176:179], v[136:139]
    v_mfma_f32_16x16x32_bf16 v[44:47], a[16:19], v[36:39], v[44:47]
    v_mfma_f32_16x16x32_bf16 v[48:51], a[20:23], v[36:39], v[48:51]
    v_mfma_f32_16x16x32_bf16 v[52:55], a[24:27], v[36:39], v[52:55]
    v_mfma_f32_16x16x32_bf16 v[56:59], a[28:31], v[36:39], v[56:59]
    s_waitcnt vmcnt(17) lgkmcnt(8)
    v_mfma_f32_16x16x32_bf16 v[60:63], a[32:35], v[140:143], v[60:63]
    ds_read_b64 v[160:161], v78 offset:10240
    ds_read_b64 v[162:163], v79 offset:10240
    s_waitcnt vmcnt(16)
    v_mfma_f32_16x16x32_bf16 v[80:83], a[36:39], v[140:143], v[80:83]
    s_waitcnt vmcnt(15)
    v_mfma_f32_16x16x32_bf16 v[100:103], a[40:43], v[140:143], v[100:103]
    s_xor_b32 s56, s26, 0x3009000
    buffer_load_dwordx4 a[96:99], v1, s[4:7], s56 offen offset:0
    s_waitcnt vmcnt(15)
    v_mfma_f32_16x16x32_bf16 v[120:123], a[44:47], v[140:143], v[120:123]
    s_waitcnt lgkmcnt(8)
    v_mfma_f32_16x16x32_bf16 v[64:67], a[32:35], v[144:147], v[64:67]
    ds_read_b64 v[164:165], v78 offset:12288
    ds_read_b64 v[166:167], v79 offset:12288
    v_mfma_f32_16x16x32_bf16 v[84:87], a[36:39], v[144:147], v[84:87]
    v_mfma_f32_16x16x32_bf16 v[104:107], a[40:43], v[144:147], v[104:107]
    buffer_load_dwordx4 a[100:103], v1, s[4:7], s56 offen offset:1024
    v_mfma_f32_16x16x32_bf16 v[124:127], a[44:47], v[144:147], v[124:127]
    s_waitcnt lgkmcnt(8)
    v_mfma_f32_16x16x32_bf16 v[68:71], a[32:35], v[148:151], v[68:71]
    ds_read_b64 v[168:169], v78 offset:14336
    ds_read_b64 v[170:171], v79 offset:14336
    v_mfma_f32_16x16x32_bf16 v[88:91], a[36:39], v[148:151], v[88:91]
    v_mfma_f32_16x16x32_bf16 v[108:111], a[40:43], v[148:151], v[108:111]
    buffer_load_dwordx4 a[104:107], v1, s[4:7], s56 offen offset:2048
    v_mfma_f32_16x16x32_bf16 v[128:131], a[44:47], v[148:151], v[128:131]
    s_waitcnt lgkmcnt(8)
    v_mfma_f32_16x16x32_bf16 v[72:75], a[32:35], v[152:155], v[72:75]
    ds_read_b64 v[172:173], v78 offset:16384
    ds_read_b64 v[174:175], v79 offset:16384
    v_mfma_f32_16x16x32_bf16 v[92:95], a[36:39], v[152:155], v[92:95]
    v_mfma_f32_16x16x32_bf16 v[112:115], a[40:43], v[152:155], v[112:115]
    buffer_load_dwordx4 a[108:111], v1, s[4:7], s56 offen offset:3072
    v_mfma_f32_16x16x32_bf16 v[132:135], a[44:47], v[152:155], v[132:135]
    s_waitcnt lgkmcnt(8)
    v_mfma_f32_16x16x32_bf16 v[96:99], a[36:39], v[156:159], v[96:99]
    ds_read_b64 v[176:177], v78 offset:18432
    ds_read_b64 v[178:179], v79 offset:18432
    v_mfma_f32_16x16x32_bf16 v[116:119], a[40:43], v[156:159], v[116:119]
    s_xor_b32 s56, s26, 0x300a000
    buffer_load_dwordx4 a[112:115], v1, s[4:7], s56 offen offset:0
    v_mfma_f32_16x16x32_bf16 v[136:139], a[44:47], v[156:159], v[136:139]
    v_mfma_f32_16x16x32_bf16 v[44:47], a[32:35], v[36:39], v[44:47]
    v_mfma_f32_16x16x32_bf16 v[48:51], a[36:39], v[36:39], v[48:51]
    v_mfma_f32_16x16x32_bf16 v[52:55], a[40:43], v[36:39], v[52:55]
    v_mfma_f32_16x16x32_bf16 v[56:59], a[44:47], v[36:39], v[56:59]
    s_waitcnt vmcnt(18) lgkmcnt(8)
    v_mfma_f32_16x16x32_bf16 v[60:63], a[48:51], v[160:163], v[60:63]
    ds_read_b64 v[140:141], v76 offset:20480
    ds_read_b64 v[142:143], v77 offset:20480
    s_waitcnt vmcnt(17)
    v_mfma_f32_16x16x32_bf16 v[80:83], a[52:55], v[160:163], v[80:83]
    s_waitcnt vmcnt(14)
    v_mfma_f32_16x16x32_bf16 v[100:103], a[56:59], v[160:163], v[100:103]
    buffer_load_dwordx4 a[116:119], v1, s[4:7], s56 offen offset:1024
    s_waitcnt vmcnt(14)
    v_mfma_f32_16x16x32_bf16 v[120:123], a[60:63], v[160:163], v[120:123]
    s_waitcnt lgkmcnt(8)
    v_mfma_f32_16x16x32_bf16 v[64:67], a[48:51], v[164:167], v[64:67]
    ds_read_b64 v[144:145], v76 offset:22528
    ds_read_b64 v[146:147], v77 offset:22528
    v_mfma_f32_16x16x32_bf16 v[84:87], a[52:55], v[164:167], v[84:87]
    v_mfma_f32_16x16x32_bf16 v[104:107], a[56:59], v[164:167], v[104:107]
    buffer_load_dwordx4 a[120:123], v1, s[4:7], s56 offen offset:2048
    v_mfma_f32_16x16x32_bf16 v[124:127], a[60:63], v[164:167], v[124:127]
    s_waitcnt lgkmcnt(8)
    v_mfma_f32_16x16x32_bf16 v[68:71], a[48:51], v[168:171], v[68:71]
    ds_read_b64 v[148:149], v76 offset:24576
    ds_read_b64 v[150:151], v77 offset:24576
    v_mfma_f32_16x16x32_bf16 v[88:91], a[52:55], v[168:171], v[88:91]
    v_mfma_f32_16x16x32_bf16 v[108:111], a[56:59], v[168:171], v[108:111]
    buffer_load_dwordx4 a[124:127], v1, s[4:7], s56 offen offset:3072
    v_mfma_f32_16x16x32_bf16 v[128:131], a[60:63], v[168:171], v[128:131]
    s_waitcnt lgkmcnt(8)
    v_mfma_f32_16x16x32_bf16 v[72:75], a[48:51], v[172:175], v[72:75]
    ds_read_b64 v[152:153], v76 offset:26624
    ds_read_b64 v[154:155], v77 offset:26624
    v_mfma_f32_16x16x32_bf16 v[92:95], a[52:55], v[172:175], v[92:95]
    v_mfma_f32_16x16x32_bf16 v[112:115], a[56:59], v[172:175], v[112:115]
    s_xor_b32 s56, s26, 0x300b000
    buffer_load_dwordx4 a[128:131], v1, s[4:7], s56 offen offset:0
    v_mfma_f32_16x16x32_bf16 v[132:135], a[60:63], v[172:175], v[132:135]
    s_waitcnt lgkmcnt(8)
    v_mfma_f32_16x16x32_bf16 v[96:99], a[52:55], v[176:179], v[96:99]
    ds_read_b64 v[156:157], v76 offset:28672
    ds_read_b64 v[158:159], v77 offset:28672
    v_mfma_f32_16x16x32_bf16 v[116:119], a[56:59], v[176:179], v[116:119]
    buffer_load_dwordx4 a[132:135], v1, s[4:7], s56 offen offset:1024
    v_mfma_f32_16x16x32_bf16 v[136:139], a[60:63], v[176:179], v[136:139]
    v_mfma_f32_16x16x32_bf16 v[44:47], a[48:51], v[36:39], v[44:47]
    v_mfma_f32_16x16x32_bf16 v[48:51], a[52:55], v[36:39], v[48:51]
    v_mfma_f32_16x16x32_bf16 v[52:55], a[56:59], v[36:39], v[52:55]
    v_mfma_f32_16x16x32_bf16 v[56:59], a[60:63], v[36:39], v[56:59]
    s_waitcnt vmcnt(17) lgkmcnt(8)
    v_mfma_f32_16x16x32_bf16 v[60:63], a[64:67], v[140:143], v[60:63]
    ds_read_b64 v[160:161], v78 offset:20480
    ds_read_b64 v[162:163], v79 offset:20480
    s_waitcnt vmcnt(16)
    v_mfma_f32_16x16x32_bf16 v[80:83], a[68:71], v[140:143], v[80:83]
    s_waitcnt vmcnt(15)
    v_mfma_f32_16x16x32_bf16 v[100:103], a[72:75], v[140:143], v[100:103]
    buffer_load_dwordx4 a[136:139], v1, s[4:7], s56 offen offset:2048
    s_waitcnt vmcnt(15)
    v_mfma_f32_16x16x32_bf16 v[120:123], a[76:79], v[140:143], v[120:123]
    s_waitcnt lgkmcnt(8)
    v_mfma_f32_16x16x32_bf16 v[64:67], a[64:67], v[144:147], v[64:67]
    ds_read_b64 v[164:165], v78 offset:22528
    ds_read_b64 v[166:167], v79 offset:22528
    v_mfma_f32_16x16x32_bf16 v[84:87], a[68:71], v[144:147], v[84:87]
    v_mfma_f32_16x16x32_bf16 v[104:107], a[72:75], v[144:147], v[104:107]
    buffer_load_dwordx4 a[140:143], v1, s[4:7], s56 offen offset:3072
    v_mfma_f32_16x16x32_bf16 v[124:127], a[76:79], v[144:147], v[124:127]
    s_waitcnt lgkmcnt(8)
    v_mfma_f32_16x16x32_bf16 v[68:71], a[64:67], v[148:151], v[68:71]
    ds_read_b64 v[168:169], v78 offset:24576
    ds_read_b64 v[170:171], v79 offset:24576
    v_mfma_f32_16x16x32_bf16 v[88:91], a[68:71], v[148:151], v[88:91]
    v_mfma_f32_16x16x32_bf16 v[108:111], a[72:75], v[148:151], v[108:111]
    buffer_load_dwordx2 v[40:41], v42, s[4:7], 0 offen sc1
    v_mfma_f32_16x16x32_bf16 v[128:131], a[76:79], v[148:151], v[128:131]
    s_waitcnt lgkmcnt(8)
    v_mfma_f32_16x16x32_bf16 v[72:75], a[64:67], v[152:155], v[72:75]
    ds_read_b64 v[172:173], v78 offset:26624
    ds_read_b64 v[174:175], v79 offset:26624
    v_mfma_f32_16x16x32_bf16 v[92:95], a[68:71], v[152:155], v[92:95]
    v_mfma_f32_16x16x32_bf16 v[112:115], a[72:75], v[152:155], v[112:115]
    s_xor_b32 s56, s26, 0x300c000
    buffer_load_dwordx4 a[144:147], v1, s[4:7], s56 offen offset:0
    v_mfma_f32_16x16x32_bf16 v[132:135], a[76:79], v[152:155], v[132:135]
    s_waitcnt lgkmcnt(8)
    v_mfma_f32_16x16x32_bf16 v[96:99], a[68:71], v[156:159], v[96:99]
    ds_read_b64 v[176:177], v78 offset:28672
    ds_read_b64 v[178:179], v79 offset:28672
    v_mfma_f32_16x16x32_bf16 v[116:119], a[72:75], v[156:159], v[116:119]
    buffer_load_dwordx4 a[148:151], v1, s[4:7], s56 offen offset:1024
    v_mfma_f32_16x16x32_bf16 v[136:139], a[76:79], v[156:159], v[136:139]
    v_mfma_f32_16x16x32_bf16 v[44:47], a[64:67], v[36:39], v[44:47]
    v_mfma_f32_16x16x32_bf16 v[48:51], a[68:71], v[36:39], v[48:51]
    v_mfma_f32_16x16x32_bf16 v[52:55], a[72:75], v[36:39], v[52:55]
    v_mfma_f32_16x16x32_bf16 v[56:59], a[76:79], v[36:39], v[56:59]
    s_waitcnt vmcnt(18) lgkmcnt(8)
    v_mfma_f32_16x16x32_bf16 v[60:63], a[80:83], v[160:163], v[60:63]
    ds_read_b64 v[140:141], v76 offset:30720
    ds_read_b64 v[142:143], v77 offset:30720
    s_waitcnt vmcnt(17)
    v_mfma_f32_16x16x32_bf16 v[80:83], a[84:87], v[160:163], v[80:83]
    s_waitcnt vmcnt(16)
    v_mfma_f32_16x16x32_bf16 v[100:103], a[88:91], v[160:163], v[100:103]
    buffer_load_dwordx4 a[152:155], v1, s[4:7], s56 offen offset:2048
    s_waitcnt vmcnt(16)
    v_mfma_f32_16x16x32_bf16 v[120:123], a[92:95], v[160:163], v[120:123]
    s_waitcnt lgkmcnt(8)
    v_mfma_f32_16x16x32_bf16 v[64:67], a[80:83], v[164:167], v[64:67]
    ds_read_b64 v[144:145], v76 offset:32768
    ds_read_b64 v[146:147], v77 offset:32768
    v_mfma_f32_16x16x32_bf16 v[84:87], a[84:87], v[164:167], v[84:87]
    v_mfma_f32_16x16x32_bf16 v[104:107], a[88:91], v[164:167], v[104:107]
    buffer_load_dwordx4 a[156:159], v1, s[4:7], s56 offen offset:3072
    v_mfma_f32_16x16x32_bf16 v[124:127], a[92:95], v[164:167], v[124:127]
    s_waitcnt lgkmcnt(8)
    v_mfma_f32_16x16x32_bf16 v[68:71], a[80:83], v[168:171], v[68:71]
    ds_read_b64 v[148:149], v76 offset:34816
    ds_read_b64 v[150:151], v77 offset:34816
    v_mfma_f32_16x16x32_bf16 v[88:91], a[84:87], v[168:171], v[88:91]
    v_mfma_f32_16x16x32_bf16 v[108:111], a[88:91], v[168:171], v[108:111]
    s_xor_b32 s56, s26, 0x3010000
    buffer_load_dwordx4 a[160:163], v1, s[4:7], s56 offen offset:0
    v_mfma_f32_16x16x32_bf16 v[128:131], a[92:95], v[168:171], v[128:131]
    s_waitcnt lgkmcnt(8)
    v_mfma_f32_16x16x32_bf16 v[72:75], a[80:83], v[172:175], v[72:75]
    ds_read_b64 v[152:153], v76 offset:36864
    ds_read_b64 v[154:155], v77 offset:36864
    v_mfma_f32_16x16x32_bf16 v[92:95], a[84:87], v[172:175], v[92:95]
    v_mfma_f32_16x16x32_bf16 v[112:115], a[88:91], v[172:175], v[112:115]
    buffer_load_dwordx4 a[164:167], v1, s[4:7], s56 offen offset:1024
    v_mfma_f32_16x16x32_bf16 v[132:135], a[92:95], v[172:175], v[132:135]
    s_waitcnt lgkmcnt(8)
    v_mfma_f32_16x16x32_bf16 v[96:99], a[84:87], v[176:179], v[96:99]
    ds_read_b64 v[156:157], v76 offset:38912
    ds_read_b64 v[158:159], v77 offset:38912
    v_mfma_f32_16x16x32_bf16 v[116:119], a[88:91], v[176:179], v[116:119]
    buffer_load_dwordx4 a[168:171], v1, s[4:7], s56 offen offset:2048
    v_mfma_f32_16x16x32_bf16 v[136:139], a[92:95], v[176:179], v[136:139]
    v_mfma_f32_16x16x32_bf16 v[44:47], a[80:83], v[36:39], v[44:47]
    v_mfma_f32_16x16x32_bf16 v[48:51], a[84:87], v[36:39], v[48:51]
    v_mfma_f32_16x16x32_bf16 v[52:55], a[88:91], v[36:39], v[52:55]
    v_mfma_f32_16x16x32_bf16 v[56:59], a[92:95], v[36:39], v[56:59]
    ds_read_b128 a[64:67], v191 offset:0
    ds_read_b128 a[68:71], v191 offset:1024
    ds_read_b128 a[72:75], v191 offset:2048
    ds_read_b128 a[76:79], v191 offset:3072
    ds_read_b128 a[80:83], v191 offset:4096
    ds_read_b128 a[84:87], v191 offset:5120
    ds_read_b128 a[88:91], v191 offset:6144
    ds_read_b128 a[92:95], v191 offset:7168
    s_waitcnt vmcnt(19) lgkmcnt(14)
    v_mfma_f32_16x16x32_bf16 v[60:63], a[96:99], v[140:143], v[60:63]
    ds_read_b64 v[160:161], v78 offset:30720
    ds_read_b64 v[162:163], v79 offset:30720
    s_waitcnt vmcnt(18)
    v_mfma_f32_16x16x32_bf16 v[80:83], a[100:103], v[140:143], v[80:83]
    s_waitcnt vmcnt(17)
    v_mfma_f32_16x16x32_bf16 v[100:103], a[104:107], v[140:143], v[100:103]
    buffer_load_dwordx4 a[172:175], v1, s[4:7], s56 offen offset:3072
    s_waitcnt vmcnt(17)
    v_mfma_f32_16x16x32_bf16 v[120:123], a[108:111], v[140:143], v[120:123]
    v_mfma_f32_16x16x32_bf16 v[64:67], a[96:99], v[144:147], v[64:67]
    ds_read_b64 v[164:165], v78 offset:32768
    ds_read_b64 v[166:167], v79 offset:32768
    v_mfma_f32_16x16x32_bf16 v[84:87], a[100:103], v[144:147], v[84:87]
    v_mfma_f32_16x16x32_bf16 v[104:107], a[104:107], v[144:147], v[104:107]
    s_xor_b32 s56, s26, 0x3011000
    buffer_load_dwordx4 a[176:179], v1, s[4:7], s56 offen offset:0
    v_mfma_f32_16x16x32_bf16 v[124:127], a[108:111], v[144:147], v[124:127]
    s_waitcnt lgkmcnt(14)
    v_mfma_f32_16x16x32_bf16 v[68:71], a[96:99], v[148:151], v[68:71]
    ds_read_b64 v[168:169], v78 offset:34816
    ds_read_b64 v[170:171], v79 offset:34816
    v_mfma_f32_16x16x32_bf16 v[88:91], a[100:103], v[148:151], v[88:91]
    v_mfma_f32_16x16x32_bf16 v[108:111], a[104:107], v[148:151], v[108:111]
    buffer_load_dwordx4 a[180:183], v1, s[4:7], s56 offen offset:1024
    v_mfma_f32_16x16x32_bf16 v[128:131], a[108:111], v[148:151], v[128:131]
    v_mfma_f32_16x16x32_bf16 v[72:75], a[96:99], v[152:155], v[72:75]
    ds_read_b64 v[172:173], v78 offset:36864
    ds_read_b64 v[174:175], v79 offset:36864
    v_mfma_f32_16x16x32_bf16 v[92:95], a[100:103], v[152:155], v[92:95]
    v_mfma_f32_16x16x32_bf16 v[112:115], a[104:107], v[152:155], v[112:115]
    buffer_load_dwordx4 a[184:187], v1, s[4:7], s56 offen offset:2048
    v_mfma_f32_16x16x32_bf16 v[132:135], a[108:111], v[152:155], v[132:135]
    s_waitcnt lgkmcnt(14)
    v_mfma_f32_16x16x32_bf16 v[96:99], a[100:103], v[156:159], v[96:99]
    ds_read_b64 v[176:177], v78 offset:38912
    ds_read_b64 v[178:179], v79 offset:38912
    v_mfma_f32_16x16x32_bf16 v[116:119], a[104:107], v[156:159], v[116:119]
    buffer_load_dwordx4 a[188:191], v1, s[4:7], s56 offen offset:3072
    v_mfma_f32_16x16x32_bf16 v[136:139], a[108:111], v[156:159], v[136:139]
    v_mfma_f32_16x16x32_bf16 v[44:47], a[96:99], v[36:39], v[44:47]
    v_mfma_f32_16x16x32_bf16 v[48:51], a[100:103], v[36:39], v[48:51]
    v_mfma_f32_16x16x32_bf16 v[52:55], a[104:107], v[36:39], v[52:55]
    v_mfma_f32_16x16x32_bf16 v[56:59], a[108:111], v[36:39], v[56:59]
    s_barrier
    s_waitcnt vmcnt(20) lgkmcnt(8)
    v_mfma_f32_16x16x32_bf16 v[60:63], a[112:115], v[160:163], v[60:63]
    ds_read_b64 v[140:141], v76 offset:40960
    ds_read_b64 v[142:143], v77 offset:40960
    s_waitcnt vmcnt(19)
    v_mfma_f32_16x16x32_bf16 v[80:83], a[116:119], v[160:163], v[80:83]
    s_waitcnt vmcnt(18)
    v_mfma_f32_16x16x32_bf16 v[100:103], a[120:123], v[160:163], v[100:103]
    s_xor_b32 s56, s26, 0x3012000
    buffer_load_dwordx4 a[192:195], v1, s[4:7], s56 offen offset:0
    s_waitcnt vmcnt(18)
    v_mfma_f32_16x16x32_bf16 v[120:123], a[124:127], v[160:163], v[120:123]
    s_waitcnt lgkmcnt(8)
    v_mfma_f32_16x16x32_bf16 v[64:67], a[112:115], v[164:167], v[64:67]
    ds_read_b64 v[144:145], v76 offset:43008
    ds_read_b64 v[146:147], v77 offset:43008
    v_mfma_f32_16x16x32_bf16 v[84:87], a[116:119], v[164:167], v[84:87]
    v_mfma_f32_16x16x32_bf16 v[104:107], a[120:123], v[164:167], v[104:107]
    buffer_load_dwordx4 a[196:199], v1, s[4:7], s56 offen offset:1024
    v_mfma_f32_16x16x32_bf16 v[124:127], a[124:127], v[164:167], v[124:127]
    s_waitcnt lgkmcnt(8)
    v_mfma_f32_16x16x32_bf16 v[68:71], a[112:115], v[168:171], v[68:71]
    ds_read_b64 v[148:149], v76 offset:45056
    ds_read_b64 v[150:151], v77 offset:45056
    v_mfma_f32_16x16x32_bf16 v[88:91], a[116:119], v[168:171], v[88:91]
    v_mfma_f32_16x16x32_bf16 v[108:111], a[120:123], v[168:171], v[108:111]
    buffer_load_dwordx4 a[200:203], v1, s[4:7], s56 offen offset:2048
    v_mfma_f32_16x16x32_bf16 v[128:131], a[124:127], v[168:171], v[128:131]
    s_waitcnt lgkmcnt(8)
    v_mfma_f32_16x16x32_bf16 v[72:75], a[112:115], v[172:175], v[72:75]
    ds_read_b64 v[152:153], v76 offset:47104
    ds_read_b64 v[154:155], v77 offset:47104
    v_mfma_f32_16x16x32_bf16 v[92:95], a[116:119], v[172:175], v[92:95]
    v_mfma_f32_16x16x32_bf16 v[112:115], a[120:123], v[172:175], v[112:115]
    buffer_load_dwordx4 a[204:207], v1, s[4:7], s56 offen offset:3072
    v_mfma_f32_16x16x32_bf16 v[132:135], a[124:127], v[172:175], v[132:135]
    s_waitcnt lgkmcnt(8)
    v_mfma_f32_16x16x32_bf16 v[96:99], a[116:119], v[176:179], v[96:99]
    ds_read_b64 v[156:157], v76 offset:49152
    ds_read_b64 v[158:159], v77 offset:49152
    v_mfma_f32_16x16x32_bf16 v[116:119], a[120:123], v[176:179], v[116:119]
    s_xor_b32 s56, s26, 0x3013000
    buffer_load_dwordx4 a[208:211], v1, s[4:7], s56 offen offset:0
    v_mfma_f32_16x16x32_bf16 v[136:139], a[124:127], v[176:179], v[136:139]
    v_mfma_f32_16x16x32_bf16 v[44:47], a[112:115], v[36:39], v[44:47]
    v_mfma_f32_16x16x32_bf16 v[48:51], a[116:119], v[36:39], v[48:51]
    v_mfma_f32_16x16x32_bf16 v[52:55], a[120:123], v[36:39], v[52:55]
    v_mfma_f32_16x16x32_bf16 v[56:59], a[124:127], v[36:39], v[56:59]
    s_waitcnt vmcnt(21) lgkmcnt(8)
    v_mfma_f32_16x16x32_bf16 v[60:63], a[128:131], v[140:143], v[60:63]
    ds_read_b64 v[160:161], v78 offset:40960
    ds_read_b64 v[162:163], v79 offset:40960
    s_waitcnt vmcnt(20)
    v_mfma_f32_16x16x32_bf16 v[80:83], a[132:135], v[140:143], v[80:83]
    s_waitcnt vmcnt(19)
    v_mfma_f32_16x16x32_bf16 v[100:103], a[136:139], v[140:143], v[100:103]
    buffer_load_dwordx4 a[212:215], v1, s[4:7], s56 offen offset:1024
    s_waitcnt vmcnt(19)
    v_mfma_f32_16x16x32_bf16 v[120:123], a[140:143], v[140:143], v[120:123]
    s_waitcnt lgkmcnt(8)
    v_mfma_f32_16x16x32_bf16 v[64:67], a[128:131], v[144:147], v[64:67]
    ds_read_b64 v[164:165], v78 offset:43008
    ds_read_b64 v[166:167], v79 offset:43008
    v_mfma_f32_16x16x32_bf16 v[84:87], a[132:135], v[144:147], v[84:87]
    v_mfma_f32_16x16x32_bf16 v[104:107], a[136:139], v[144:147], v[104:107]
    buffer_load_dwordx4 a[216:219], v1, s[4:7], s56 offen offset:2048
    v_mfma_f32_16x16x32_bf16 v[124:127], a[140:143], v[144:147], v[124:127]
    s_waitcnt lgkmcnt(8)
    v_mfma_f32_16x16x32_bf16 v[68:71], a[128:131], v[148:151], v[68:71]
    ds_read_b64 v[168:169], v78 offset:45056
    ds_read_b64 v[170:171], v79 offset:45056
    v_mfma_f32_16x16x32_bf16 v[88:91], a[132:135], v[148:151], v[88:91]
    v_mfma_f32_16x16x32_bf16 v[108:111], a[136:139], v[148:151], v[108:111]
    buffer_load_dwordx4 a[220:223], v1, s[4:7], s56 offen offset:3072
    v_mfma_f32_16x16x32_bf16 v[128:131], a[140:143], v[148:151], v[128:131]
    s_waitcnt lgkmcnt(8)
    v_mfma_f32_16x16x32_bf16 v[72:75], a[128:131], v[152:155], v[72:75]
    ds_read_b64 v[172:173], v78 offset:47104
    ds_read_b64 v[174:175], v79 offset:47104
    v_mfma_f32_16x16x32_bf16 v[92:95], a[132:135], v[152:155], v[92:95]
    v_mfma_f32_16x16x32_bf16 v[112:115], a[136:139], v[152:155], v[112:115]
    s_xor_b32 s56, s26, 0x3014000
    buffer_load_dwordx4 a[224:227], v1, s[4:7], s56 offen offset:0
    v_mfma_f32_16x16x32_bf16 v[132:135], a[140:143], v[152:155], v[132:135]
    s_waitcnt lgkmcnt(8)
    v_mfma_f32_16x16x32_bf16 v[96:99], a[132:135], v[156:159], v[96:99]
    ds_read_b64 v[176:177], v78 offset:49152
    ds_read_b64 v[178:179], v79 offset:49152
    v_mfma_f32_16x16x32_bf16 v[116:119], a[136:139], v[156:159], v[116:119]
    buffer_load_dwordx4 a[228:231], v1, s[4:7], s56 offen offset:1024
    v_mfma_f32_16x16x32_bf16 v[136:139], a[140:143], v[156:159], v[136:139]
    v_mfma_f32_16x16x32_bf16 v[44:47], a[128:131], v[36:39], v[44:47]
    v_mfma_f32_16x16x32_bf16 v[48:51], a[132:135], v[36:39], v[48:51]
    v_mfma_f32_16x16x32_bf16 v[52:55], a[136:139], v[36:39], v[52:55]
    v_mfma_f32_16x16x32_bf16 v[56:59], a[140:143], v[36:39], v[56:59]
    s_mov_b32 s51, 0x20000
    s_waitcnt vmcnt(22)
    v_cmp_gt_u64 vcc, s[58:59], v[40:41]
    v_cmp_lt_u64 s[48:49], s[60:61], v[40:41]
    s_nop 0
    s_or_b64 vcc, vcc, s[48:49]
    s_cbranch_scc0 POLLD_4
    s_nop 1
POLL_3:
    buffer_load_dwordx2 v[40:41], v42, s[4:7], 0 offen sc1
    s_sub_u32 s51, s51, 1
    s_cbranch_scc1 POLLD_4X
    s_waitcnt vmcnt(0)
    v_cmp_gt_u64 vcc, s[58:59], v[40:41]
    v_cmp_lt_u64 s[48:49], s[60:61], v[40:41]
    s_nop 0
    s_or_b64 vcc, vcc, s[48:49]
    s_cbranch_scc1 POLL_3
POLLD_4X:
    s_waitcnt vmcnt(0)
POLLD_4:
    v_add_u32 v76, 51200, v76
    v_add_u32 v77, 51200, v77
    v_add_u32 v78, 51200, v78
    v_add_u32 v79, 51200, v79
    s_waitcnt vmcnt(21) lgkmcnt(8)
    v_mfma_f32_16x16x32_bf16 v[60:63], a[144:147], v[160:163], v[60:63]
    ds_read_b64 v[140:141], v76 offset:0
    ds_read_b64 v[142:143], v77 offset:0
    s_waitcnt vmcnt(20)
    v_mfma_f32_16x16x32_bf16 v[80:83], a[148:151], v[160:163], v[80:83]
    s_waitcnt vmcnt(19)
    v_mfma_f32_16x16x32_bf16 v[100:103], a[152:155], v[160:163], v[100:103]
    buffer_load_dwordx4 a[232:235], v1, s[4:7], s56 offen offset:2048
    s_waitcnt vmcnt(19)
    v_mfma_f32_16x16x32_bf16 v[120:123], a[156:159], v[160:163], v[120:123]
    s_waitcnt lgkmcnt(8)
    v_mfma_f32_16x16x32_bf16 v[64:67], a[144:147], v[164:167], v[64:67]
    ds_read_b64 v[144:145], v76 offset:2048
    ds_read_b64 v[146:147], v77 offset:2048
    v_mfma_f32_16x16x32_bf16 v[84:87], a[148:151], v[164:167], v[84:87]
    v_mfma_f32_16x16x32_bf16 v[104:107], a[152:155], v[164:167], v[104:107]
    buffer_load_dwordx4 a[236:239], v1, s[4:7], s56 offen offset:3072
    v_mfma_f32_16x16x32_bf16 v[124:127], a[156:159], v[164:167], v[124:127]
    s_waitcnt lgkmcnt(8)
    v_mfma_f32_16x16x32_bf16 v[68:71], a[144:147], v[168:171], v[68:71]
    ds_read_b64 v[148:149], v76 offset:4096
    ds_read_b64 v[150:151], v77 offset:4096
    v_mfma_f32_16x16x32_bf16 v[88:91], a[148:151], v[168:171], v[88:91]
    v_mfma_f32_16x16x32_bf16 v[108:111], a[152:155], v[168:171], v[108:111]
    s_xor_b32 s56, s26, 0x3018000
    buffer_load_dwordx4 a[240:243], v1, s[4:7], s56 offen offset:0
    v_mfma_f32_16x16x32_bf16 v[128:131], a[156:159], v[168:171], v[128:131]
    s_waitcnt lgkmcnt(8)
    v_mfma_f32_16x16x32_bf16 v[72:75], a[144:147], v[172:175], v[72:75]
    ds_read_b64 v[152:153], v76 offset:6144
    ds_read_b64 v[154:155], v77 offset:6144
    v_mfma_f32_16x16x32_bf16 v[92:95], a[148:151], v[172:175], v[92:95]
    v_mfma_f32_16x16x32_bf16 v[112:115], a[152:155], v[172:175], v[112:115]
    buffer_load_dwordx4 a[244:247], v1, s[4:7], s56 offen offset:1024
    v_mfma_f32_16x16x32_bf16 v[132:135], a[156:159], v[172:175], v[132:135]
    s_waitcnt lgkmcnt(8)
    v_mfma_f32_16x16x32_bf16 v[96:99], a[148:151], v[176:179], v[96:99]
    ds_read_b64 v[156:157], v76 offset:8192
    ds_read_b64 v[158:159], v77 offset:8192
    v_mfma_f32_16x16x32_bf16 v[116:119], a[152:155], v[176:179], v[116:119]
    buffer_load_dwordx4 a[248:251], v1, s[4:7], s56 offen offset:2048
    v_mfma_f32_16x16x32_bf16 v[136:139], a[156:159], v[176:179], v[136:139]
    v_mfma_f32_16x16x32_bf16 v[44:47], a[144:147], v[36:39], v[44:47]
    v_mfma_f32_16x16x32_bf16 v[48:51], a[148:151], v[36:39], v[48:51]
    v_mfma_f32_16x16x32_bf16 v[52:55], a[152:155], v[36:39], v[52:55]
    v_mfma_f32_16x16x32_bf16 v[56:59], a[156:159], v[36:39], v[56:59]
    s_waitcnt vmcnt(22) lgkmcnt(8)
    v_mfma_f32_16x16x32_bf16 v[60:63], a[160:163], v[140:143], v[60:63]
    ds_read_b64 v[160:161], v78 offset:0
    ds_read_b64 v[162:163], v79 offset:0
    s_waitcnt vmcnt(21)
    v_mfma_f32_16x16x32_bf16 v[80:83], a[164:167], v[140:143], v[80:83]
    s_waitcnt vmcnt(20)
    v_mfma_f32_16x16x32_bf16 v[100:103], a[168:171], v[140:143], v[100:103]
    buffer_load_dwordx4 a[252:255], v1, s[4:7], s56 offen offset:3072
    s_waitcnt vmcnt(20)
    v_mfma_f32_16x16x32_bf16 v[120:123], a[172:175], v[140:143], v[120:123]
    s_waitcnt lgkmcnt(8)
    v_mfma_f32_16x16x32_bf16 v[64:67], a[160:163], v[144:147], v[64:67]
    ds_read_b64 v[164:165], v78 offset:2048
    ds_read_b64 v[166:167], v79 offset:2048
    v_mfma_f32_16x16x32_bf16 v[84:87], a[164:167], v[144:147], v[84:87]
    v_mfma_f32_16x16x32_bf16 v[104:107], a[168:171], v[144:147], v[104:107]
    s_xor_b32 s56, s26, 0x3019000
    buffer_load_dwordx4 v[192:195], v1, s[4:7], s56 offen offset:0
    v_mfma_f32_16x16x32_bf16 v[124:127], a[172:175], v[144:147], v[124:127]
    s_waitcnt lgkmcnt(8)
    v_mfma_f32_16x16x32_bf16 v[68:71], a[160:163], v[148:151], v[68:71]
    ds_read_b64 v[168:169], v78 offset:4096
    ds_read_b64 v[170:171], v79 offset:4096
    v_mfma_f32_16x16x32_bf16 v[88:91], a[164:167], v[148:151], v[88:91]
    v_mfma_f32_16x16x32_bf16 v[108:111], a[168:171], v[148:151], v[108:111]
    buffer_load_dwordx4 v[196:199], v1, s[4:7], s56 offen offset:1024
    v_mfma_f32_16x16x32_bf16 v[128:131], a[172:175], v[148:151], v[128:131]
    s_waitcnt lgkmcnt(8)
    v_mfma_f32_16x16x32_bf16 v[72:75], a[160:163], v[152:155], v[72:75]
    ds_read_b64 v[172:173], v78 offset:6144
    ds_read_b64 v[174:175], v79 offset:6144
    v_mfma_f32_16x16x32_bf16 v[92:95], a[164:167], v[152:155], v[92:95]
    v_mfma_f32_16x16x32_bf16 v[112:115], a[168:171], v[152:155], v[112:115]
    buffer_load_dwordx4 v[200:203], v1, s[4:7], s56 offen offset:2048
    v_mfma_f32_16x16x32_bf16 v[132:135], a[172:175], v[152:155], v[132:135]
    s_waitcnt lgkmcnt(8)
    v_mfma_f32_16x16x32_bf16 v[96:99], a[164:167], v[156:159], v[96:99]
    ds_read_b64 v[176:177], v78 offset:8192
    ds_read_b64 v[178:179], v79 offset:8192
    v_mfma_f32_16x16x32_bf16 v[116:119], a[168:171], v[156:159], v[116:119]
    buffer_load_dwordx4 v[204:207], v1, s[4:7], s56 offen offset:3072
    v_mfma_f32_16x16x32_bf16 v[136:139], a[172:175], v[156:159], v[136:139]
    v_mfma_f32_16x16x32_bf16 v[44:47], a[160:163], v[36:39], v[44:47]
    v_mfma_f32_16x16x32_bf16 v[48:51], a[164:167], v[36:39], v[48:51]
    v_mfma_f32_16x16x32_bf16 v[52:55], a[168:171], v[36:39], v[52:55]
    v_mfma_f32_16x16x32_bf16 v[56:59], a[172:175], v[36:39], v[56:59]
    s_waitcnt vmcnt(23) lgkmcnt(8)
    v_mfma_f32_16x16x32_bf16 v[60:63], a[176:179], v[160:163], v[60:63]
    ds_read_b64 v[140:141], v76 offset:10240
    ds_read_b64 v[142:143], v77 offset:10240
    s_waitcnt vmcnt(22)
    v_mfma_f32_16x16x32_bf16 v[80:83], a[180:183], v[160:163], v[80:83]
    s_waitcnt vmcnt(21)
    v_mfma_f32_16x16x32_bf16 v[100:103], a[184:187], v[160:163], v[100:103]
    s_xor_b32 s56, s26, 0x301a000
    buffer_load_dwordx4 v[208:211], v1, s[4:7], s56 offen offset:0
    s_waitcnt vmcnt(21)
    v_mfma_f32_16x16x32_bf16 v[120:123], a[188:191], v[160:163], v[120:123]
    s_waitcnt lgkmcnt(8)
    v_mfma_f32_16x16x32_bf16 v[64:67], a[176:179], v[164:167], v[64:67]
    ds_read_b64 v[144:145], v76 offset:12288
    ds_read_b64 v[146:147], v77 offset:12288
    v_mfma_f32_16x16x32_bf16 v[84:87], a[180:183], v[164:167], v[84:87]
    v_mfma_f32_16x16x32_bf16 v[104:107], a[184:187], v[164:167], v[104:107]
    buffer_load_dwordx4 v[212:215], v1, s[4:7], s56 offen offset:1024
    v_mfma_f32_16x16x32_bf16 v[124:127], a[188:191], v[164:167], v[124:127]
    s_waitcnt lgkmcnt(8)
    v_mfma_f32_16x16x32_bf16 v[68:71], a[176:179], v[168:171], v[68:71]
    ds_read_b64 v[148:149], v76 offset:14336
    ds_read_b64 v[150:151], v77 offset:14336
    v_mfma_f32_16x16x32_bf16 v[88:91], a[180:183], v[168:171], v[88:91]
    v_mfma_f32_16x16x32_bf16 v[108:111], a[184:187], v[168:171], v[108:111]
    buffer_load_dwordx4 v[216:219], v1, s[4:7], s56 offen offset:2048
    v_mfma_f32_16x16x32_bf16 v[128:131], a[188:191], v[168:171], v[128:131]
    s_waitcnt lgkmcnt(8)
    v_mfma_f32_16x16x32_bf16 v[72:75], a[176:179], v[172:175], v[72:75]
    ds_read_b64 v[152:153], v76 offset:16384
    ds_read_b64 v[154:155], v77 offset:16384
    v_mfma_f32_16x16x32_bf16 v[92:95], a[180:183], v[172:175], v[92:95]
    v_mfma_f32_16x16x32_bf16 v[112:115], a[184:187], v[172:175], v[112:115]
    buffer_load_dwordx4 v[220:223], v1, s[4:7], s56 offen offset:3072
    v_mfma_f32_16x16x32_bf16 v[132:135], a[188:191], v[172:175], v[132:135]
    s_waitcnt lgkmcnt(8)
    v_mfma_f32_16x16x32_bf16 v[96:99], a[180:183], v[176:179], v[96:99]
    ds_read_b64 v[156:157], v76 offset:18432
    ds_read_b64 v[158:159], v77 offset:18432
    v_mfma_f32_16x16x32_bf16 v[116:119], a[184:187], v[176:179], v[116:119]
    s_xor_b32 s56, s26, 0x301b000
    buffer_load_dwordx4 v[224:227], v1, s[4:7], s56 offen offset:0
    v_mfma_f32_16x16x32_bf16 v[136:139], a[188:191], v[176:179], v[136:139]
    v_mfma_f32_16x16x32_bf16 v[44:47], a[176:179], v[36:39], v[44:47]
    v_mfma_f32_16x16x32_bf16 v[48:51], a[180:183], v[36:39], v[48:51]
    v_mfma_f32_16x16x32_bf16 v[52:55], a[184:187], v[36:39], v[52:55]
    v_mfma_f32_16x16x32_bf16 v[56:59], a[188:191], v[36:39], v[56:59]
    s_waitcnt vmcnt(24) lgkmcnt(8)
    v_mfma_f32_16x16x32_bf16 v[60:63], a[192:195], v[140:143], v[60:63]
    ds_read_b64 v[160:161], v78 offset:10240
    ds_read_b64 v[162:163], v79 offset:10240
    s_waitcnt vmcnt(23)
    v_mfma_f32_16x16x32_bf16 v[80:83], a[196:199], v[140:143], v[80:83]
    buffer_load_dword v43, v28, s[4:7], s34 offen sc1
    s_waitcnt vmcnt(23)
    v_mfma_f32_16x16x32_bf16 v[100:103], a[200:203], v[140:143], v[100:103]
    buffer_load_dwordx4 v[228:231], v1, s[4:7], s56 offen offset:1024
    s_waitcnt vmcnt(23)
    v_mfma_f32_16x16x32_bf16 v[120:123], a[204:207], v[140:143], v[120:123]
    s_waitcnt lgkmcnt(8)
    v_mfma_f32_16x16x32_bf16 v[64:67], a[192:195], v[144:147], v[64:67]
    ds_read_b64 v[164:165], v78 offset:12288
    ds_read_b64 v[166:167], v79 offset:12288
    v_mfma_f32_16x16x32_bf16 v[84:87], a[196:199], v[144:147], v[84:87]
    s_waitcnt vmcnt(1)
    buffer_load_dword v43, v28, s[4:7], s34 offen offset:128 sc1
    v_mfma_f32_16x16x32_bf16 v[104:107], a[200:203], v[144:147], v[104:107]
    buffer_load_dwordx4 v[232:235], v1, s[4:7], s56 offen offset:2048
    v_mfma_f32_16x16x32_bf16 v[124:127], a[204:207], v[144:147], v[124:127]
    s_waitcnt lgkmcnt(8)
    v_mfma_f32_16x16x32_bf16 v[68:71], a[192:195], v[148:151], v[68:71]
    ds_read_b64 v[168:169], v78 offset:14336
    ds_read_b64 v[170:171], v79 offset:14336
    v_mfma_f32_16x16x32_bf16 v[88:91], a[196:199], v[148:151], v[88:91]
    v_mfma_f32_16x16x32_bf16 v[108:111], a[200:203], v[148:151], v[108:111]
    buffer_load_dwordx4 v[236:239], v1, s[4:7], s56 offen offset:3072
    v_mfma_f32_16x16x32_bf16 v[128:131], a[204:207], v[148:151], v[128:131]
    s_waitcnt lgkmcnt(8)
    v_mfma_f32_16x16x32_bf16 v[72:75], a[192:195], v[152:155], v[72:75]
    ds_read_b64 v[172:173], v78 offset:16384
    ds_read_b64 v[174:175], v79 offset:16384
    v_mfma_f32_16x16x32_bf16 v[92:95], a[196:199], v[152:155], v[92:95]
    v_mfma_f32_16x16x32_bf16 v[112:115], a[200:203], v[152:155], v[112:115]
    s_xor_b32 s56, s26, 0x301c000
    buffer_load_dwordx4 v[240:243], v1, s[4:7], s56 offen offset:0
    v_mfma_f32_16x16x32_bf16 v[132:135], a[204:207], v[152:155], v[132:135]
    s_waitcnt lgkmcnt(8)
    v_mfma_f32_16x16x32_bf16 v[96:99], a[196:199], v[156:159], v[96:99]
    ds_read_b64 v[176:177], v78 offset:18432
    ds_read_b64 v[178:179], v79 offset:18432
    v_mfma_f32_16x16x32_bf16 v[116:119], a[200:203], v[156:159], v[116:119]
    buffer_load_dwordx4 v[244:247], v1, s[4:7], s56 offen offset:1024
    v_mfma_f32_16x16x32_bf16 v[136:139], a[204:207], v[156:159], v[136:139]
    v_mfma_f32_16x16x32_bf16 v[44:47], a[192:195], v[36:39], v[44:47]
    v_mfma_f32_16x16x32_bf16 v[48:51], a[196:199], v[36:39], v[48:51]
    v_mfma_f32_16x16x32_bf16 v[52:55], a[200:203], v[36:39], v[52:55]
    v_mfma_f32_16x16x32_bf16 v[56:59], a[204:207], v[36:39], v[56:59]
    s_waitcnt lgkmcnt(8)
    v_mfma_f32_16x16x32_bf16 v[60:63], a[208:211], v[160:163], v[60:63]
    ds_read_b64 v[140:141], v76 offset:20480
    ds_read_b64 v[142:143], v77 offset:20480
    v_mfma_f32_16x16x32_bf16 v[80:83], a[212:215], v[160:163], v[80:83]
    v_mfma_f32_16x16x32_bf16 v[100:103], a[216:219], v[160:163], v[100:103]
    buffer_load_dwordx4 v[248:251], v1, s[4:7], s56 offen offset:2048
    v_mfma_f32_16x16x32_bf16 v[120:123], a[220:223], v[160:163], v[120:123]
    s_waitcnt lgkmcnt(8)
    v_mfma_f32_16x16x32_bf16 v[64:67], a[208:211], v[164:167], v[64:67]
    ds_read_b64 v[144:145], v76 offset:22528
    ds_read_b64 v[146:147], v77 offset:22528
    v_mfma_f32_16x16x32_bf16 v[84:87], a[212:215], v[164:167], v[84:87]
    v_mfma_f32_16x16x32_bf16 v[104:107], a[216:219], v[164:167], v[104:107]
    buffer_load_dwordx4 v[252:255], v1, s[4:7], s56 offen offset:3072
    v_mfma_f32_16x16x32_bf16 v[124:127], a[220:223], v[164:167], v[124:127]
    s_mul_i32 s57, s22, 8192
    s_add_u32 s56, s28, 0x503000
    s_add_u32 s56, s56, s57
    s_add_u32 m0, s57, 0x19000
    s_nop 0
    buffer_load_dwordx4 v1, s[4:7], s56 offen offset:0 lds
    s_waitcnt lgkmcnt(8)
    v_mfma_f32_16x16x32_bf16 v[68:71], a[208:211], v[168:171], v[68:71]
    ds_read_b64 v[148:149], v76 offset:24576
    ds_read_b64 v[150:151], v77 offset:24576
    v_mfma_f32_16x16x32_bf16 v[88:91], a[212:215], v[168:171], v[88:91]
    v_mfma_f32_16x16x32_bf16 v[108:111], a[216:219], v[168:171], v[108:111]
    v_mfma_f32_16x16x32_bf16 v[128:131], a[220:223], v[168:171], v[128:131]
    s_waitcnt lgkmcnt(8)
    v_mfma_f32_16x16x32_bf16 v[72:75], a[208:211], v[172:175], v[72:75]
    ds_read_b64 v[152:153], v76 offset:26624
    ds_read_b64 v[154:155], v77 offset:26624
    v_mfma_f32_16x16x32_bf16 v[92:95], a[212:215], v[172:175], v[92:95]
    v_mfma_f32_16x16x32_bf16 v[112:115], a[216:219], v[172:175], v[112:115]
    s_add_u32 m0, s57, 0x19000
    s_nop 0
    buffer_load_dwordx4 v1, s[4:7], s56 offen offset:1024 lds
    v_mfma_f32_16x16x32_bf16 v[132:135], a[220:223], v[172:175], v[132:135]
    s_waitcnt lgkmcnt(8)
    v_mfma_f32_16x16x32_bf16 v[96:99], a[212:215], v[176:179], v[96:99]
    ds_read_b64 v[156:157], v76 offset:28672
    ds_read_b64 v[158:159], v77 offset:28672
    v_mfma_f32_16x16x32_bf16 v[116:119], a[216:219], v[176:179], v[116:119]
    v_mfma_f32_16x16x32_bf16 v[136:139], a[220:223], v[176:179], v[136:139]
    v_mfma_f32_16x16x32_bf16 v[44:47], a[208:211], v[36:39], v[44:47]
    v_mfma_f32_16x16x32_bf16 v[48:51], a[212:215], v[36:39], v[48:51]
    v_mfma_f32_16x16x32_bf16 v[52:55], a[216:219], v[36:39], v[52:55]
    v_mfma_f32_16x16x32_bf16 v[56:59], a[220:223], v[36:39], v[56:59]
    s_waitcnt lgkmcnt(8)
    v_mfma_f32_16x16x32_bf16 v[60:63], a[224:227], v[140:143], v[60:63]
    ds_read_b64 v[160:161], v78 offset:20480
    ds_read_b64 v[162:163], v79 offset:20480
    v_mfma_f32_16x16x32_bf16 v[80:83], a[228:231], v[140:143], v[80:83]
    v_mfma_f32_16x16x32_bf16 v[100:103], a[232:235], v[140:143], v[100:103]
    s_add_u32 m0, s57, 0x19000
    s_nop 0
    buffer_load_dwordx4 v1, s[4:7], s56 offen offset:2048 lds
    v_mfma_f32_16x16x32_bf16 v[120:123], a[236:239], v[140:143], v[120:123]
    s_waitcnt lgkmcnt(8)
    v_mfma_f32_16x16x32_bf16 v[64:67], a[224:227], v[144:147], v[64:67]
    ds_read_b64 v[164:165], v78 offset:22528
    ds_read_b64 v[166:167], v79 offset:22528
    v_mfma_f32_16x16x32_bf16 v[84:87], a[228:231], v[144:147], v[84:87]
    v_mfma_f32_16x16x32_bf16 v[104:107], a[232:235], v[144:147], v[104:107]
    v_mfma_f32_16x16x32_bf16 v[124:127], a[236:239], v[144:147], v[124:127]
    s_add_u32 m0, s57, 0x19000
    s_nop 0
    buffer_load_dwordx4 v1, s[4:7], s56 offen offset:3072 lds
    s_waitcnt lgkmcnt(8)
    v_mfma_f32_16x16x32_bf16 v[68:71], a[224:227], v[148:151], v[68:71]
    ds_read_b64 v[168:169], v78 offset:24576
    ds_read_b64 v[170:171], v79 offset:24576
    v_mfma_f32_16x16x32_bf16 v[88:91], a[228:231], v[148:151], v[88:91]
    v_mfma_f32_16x16x32_bf16 v[108:111], a[232:235], v[148:151], v[108:111]
    v_mfma_f32_16x16x32_bf16 v[128:131], a[236:239], v[148:151], v[128:131]
    s_waitcnt lgkmcnt(8)
    v_mfma_f32_16x16x32_bf16 v[72:75], a[224:227], v[152:155], v[72:75]
    ds_read_b64 v[172:173], v78 offset:26624
    ds_read_b64 v[174:175], v79 offset:26624
    v_mfma_f32_16x16x32_bf16 v[92:95], a[228:231], v[152:155], v[92:95]
    v_mfma_f32_16x16x32_bf16 v[112:115], a[232:235], v[152:155], v[112:115]
    s_add_u32 s56, s28, 0x504000
    s_add_u32 s56, s56, s57
    s_add_u32 m0, s57, 0x1a000
    s_nop 0
    buffer_load_dwordx4 v1, s[4:7], s56 offen offset:0 lds
    v_mfma_f32_16x16x32_bf16 v[132:135], a[236:239], v[152:155], v[132:135]
    s_waitcnt lgkmcnt(8)
    v_mfma_f32_16x16x32_bf16 v[96:99], a[228:231], v[156:159], v[96:99]
    ds_read_b64 v[176:177], v78 offset:28672
    ds_read_b64 v[178:179], v79 offset:28672
    v_mfma_f32_16x16x32_bf16 v[116:119], a[232:235], v[156:159], v[116:119]
    v_mfma_f32_16x16x32_bf16 v[136:139], a[236:239], v[156:159], v[136:139]
    v_mfma_f32_16x16x32_bf16 v[44:47], a[224:227], v[36:39], v[44:47]
    v_mfma_f32_16x16x32_bf16 v[48:51], a[228:231], v[36:39], v[48:51]
    v_mfma_f32_16x16x32_bf16 v[52:55], a[232:235], v[36:39], v[52:55]
    v_mfma_f32_16x16x32_bf16 v[56:59], a[236:239], v[36:39], v[56:59]
    s_barrier
    s_waitcnt lgkmcnt(8)
    v_mfma_f32_16x16x32_bf16 v[60:63], a[240:243], v[160:163], v[60:63]
    ds_read_b64 v[140:141], v76 offset:30720
    ds_read_b64 v[142:143], v77 offset:30720
    v_mfma_f32_16x16x32_bf16 v[80:83], a[244:247], v[160:163], v[80:83]
    v_mfma_f32_16x16x32_bf16 v[100:103], a[248:251], v[160:163], v[100:103]
    s_add_u32 m0, s57, 0x1a000
    s_nop 0
    buffer_load_dwordx4 v1, s[4:7], s56 offen offset:1024 lds
    v_mfma_f32_16x16x32_bf16 v[120:123], a[252:255], v[160:163], v[120:123]
    s_waitcnt lgkmcnt(8)
    v_mfma_f32_16x16x32_bf16 v[64:67], a[240:243], v[164:167], v[64:67]
    ds_read_b64 v[144:145], v76 offset:32768
    ds_read_b64 v[146:147], v77 offset:32768
    v_mfma_f32_16x16x32_bf16 v[84:87], a[244:247], v[164:167], v[84:87]
    v_mfma_f32_16x16x32_bf16 v[104:107], a[248:251], v[164:167], v[104:107]
    v_mfma_f32_16x16x32_bf16 v[124:127], a[252:255], v[164:167], v[124:127]
    s_add_u32 m0, s57, 0x1a000
    s_nop 0
    buffer_load_dwordx4 v1, s[4:7], s56 offen offset:2048 lds
    s_waitcnt lgkmcnt(8)
    v_mfma_f32_16x16x32_bf16 v[68:71], a[240:243], v[168:171], v[68:71]
    ds_read_b64 v[148:149], v76 offset:34816
    ds_read_b64 v[150:151], v77 offset:34816
    v_mfma_f32_16x16x32_bf16 v[88:91], a[244:247], v[168:171], v[88:91]
    v_mfma_f32_16x16x32_bf16 v[108:111], a[248:251], v[168:171], v[108:111]
    v_mfma_f32_16x16x32_bf16 v[128:131], a[252:255], v[168:171], v[128:131]
    s_waitcnt lgkmcnt(8)
    v_mfma_f32_16x16x32_bf16 v[72:75], a[240:243], v[172:175], v[72:75]
    ds_read_b64 v[152:153], v76 offset:36864
    ds_read_b64 v[154:155], v77 offset:36864
    v_mfma_f32_16x16x32_bf16 v[92:95], a[244:247], v[172:175], v[92:95]
    v_mfma_f32_16x16x32_bf16 v[112:115], a[248:251], v[172:175], v[112:115]
    s_add_u32 m0, s57, 0x1a000
    s_nop 0
    buffer_load_dwordx4 v1, s[4:7], s56 offen offset:3072 lds
    v_mfma_f32_16x16x32_bf16 v[132:135], a[252:255], v[172:175], v[132:135]
    s_waitcnt lgkmcnt(8)
    v_mfma_f32_16x16x32_bf16 v[96:99], a[244:247], v[176:179], v[96:99]
    ds_read_b64 v[156:157], v76 offset:38912
    ds_read_b64 v[158:159], v77 offset:38912
    v_mfma_f32_16x16x32_bf16 v[116:119], a[248:251], v[176:179], v[116:119]
    v_mfma_f32_16x16x32_bf16 v[136:139], a[252:255], v[176:179], v[136:139]
    v_mfma_f32_16x16x32_bf16 v[44:47], a[240:243], v[36:39], v[44:47]
    v_mfma_f32_16x16x32_bf16 v[48:51], a[244:247], v[36:39], v[48:51]
    v_mfma_f32_16x16x32_bf16 v[52:55], a[248:251], v[36:39], v[52:55]
    v_mfma_f32_16x16x32_bf16 v[56:59], a[252:255], v[36:39], v[56:59]
    s_waitcnt lgkmcnt(8)
    v_mfma_f32_16x16x32_bf16 v[60:63], v[192:195], v[140:143], v[60:63]
    ds_read_b64 v[160:161], v78 offset:30720
    ds_read_b64 v[162:163], v79 offset:30720
    v_mfma_f32_16x16x32_bf16 v[80:83], v[196:199], v[140:143], v[80:83]
    s_add_u32 s15, s14, 0x2500000
    buffer_store_dwordx4 a[64:67], v6, s[4:7], s15 offen sc1
    v_mfma_f32_16x16x32_bf16 v[100:103], v[200:203], v[140:143], v[100:103]
    s_mul_i32 s57, s22, 8192
    s_add_u32 s56, s28, 0x50b000
    s_add_u32 s56, s56, s57
    s_add_u32 m0, s57, 0x0
    s_nop 0
    buffer_load_dwordx4 v1, s[4:7], s56 offen offset:0 lds
    v_mfma_f32_16x16x32_bf16 v[120:123], v[204:207], v[140:143], v[120:123]
    s_waitcnt lgkmcnt(8)
    v_mfma_f32_16x16x32_bf16 v[64:67], v[192:195], v[144:147], v[64:67]
    ds_read_b64 v[164:165], v78 offset:32768
    ds_read_b64 v[166:167], v79 offset:32768
    v_mfma_f32_16x16x32_bf16 v[84:87], v[196:199], v[144:147], v[84:87]
    s_add_u32 s15, s14, 0x2502000
    buffer_store_dwordx4 a[68:71], v6, s[4:7], s15 offen sc1
    v_mfma_f32_16x16x32_bf16 v[104:107], v[200:203], v[144:147], v[104:107]
    v_mfma_f32_16x16x32_bf16 v[124:127], v[204:207], v[144:147], v[124:127]
    s_add_u32 m0, s57, 0x0
    s_nop 0
    buffer_load_dwordx4 v1, s[4:7], s56 offen offset:1024 lds
    s_waitcnt lgkmcnt(8)
    v_mfma_f32_16x16x32_bf16 v[68:71], v[192:195], v[148:151], v[68:71]
    ds_read_b64 v[168:169], v78 offset:34816
    ds_read_b64 v[170:171], v79 offset:34816
    v_mfma_f32_16x16x32_bf16 v[88:91], v[196:199], v[148:151], v[88:91]
    s_add_u32 s15, s14, 0x2504000
    buffer_store_dwordx4 a[72:75], v6, s[4:7], s15 offen sc1
    v_mfma_f32_16x16x32_bf16 v[108:111], v[200:203], v[148:151], v[108:111]
    v_mfma_f32_16x16x32_bf16 v[128:131], v[204:207], v[148:151], v[128:131]
    s_waitcnt lgkmcnt(8)
    v_mfma_f32_16x16x32_bf16 v[72:75], v[192:195], v[152:155], v[72:75]
    ds_read_b64 v[172:173], v78 offset:36864
    ds_read_b64 v[174:175], v79 offset:36864
    v_mfma_f32_16x16x32_bf16 v[92:95], v[196:199], v[152:155], v[92:95]
    s_add_u32 s15, s14, 0x2506000
    buffer_store_dwordx4 a[76:79], v6, s[4:7], s15 offen sc1
    v_mfma_f32_16x16x32_bf16 v[112:115], v[200:203], v[152:155], v[112:115]
    s_add_u32 m0, s57, 0x0
    s_nop 0
    buffer_load_dwordx4 v1, s[4:7], s56 offen offset:2048 lds
    v_mfma_f32_16x16x32_bf16 v[132:135], v[204:207], v[152:155], v[132:135]
    s_waitcnt lgkmcnt(8)
    v_mfma_f32_16x16x32_bf16 v[96:99], v[196:199], v[156:159], v[96:99]
    ds_read_b64 v[176:177], v78 offset:38912
    ds_read_b64 v[178:179], v79 offset:38912
    v_mfma_f32_16x16x32_bf16 v[116:119], v[200:203], v[156:159], v[116:119]
    v_mfma_f32_16x16x32_bf16 v[136:139], v[204:207], v[156:159], v[136:139]
    v_mfma_f32_16x16x32_bf16 v[44:47], v[192:195], v[36:39], v[44:47]
    v_mfma_f32_16x16x32_bf16 v[48:51], v[196:199], v[36:39], v[48:51]
    v_mfma_f32_16x16x32_bf16 v[52:55], v[200:203], v[36:39], v[52:55]
    v_mfma_f32_16x16x32_bf16 v[56:59], v[204:207], v[36:39], v[56:59]
    s_waitcnt lgkmcnt(8)
    v_mfma_f32_16x16x32_bf16 v[60:63], v[208:211], v[160:163], v[60:63]
    ds_read_b64 v[140:141], v76 offset:40960
    ds_read_b64 v[142:143], v77 offset:40960
    v_mfma_f32_16x16x32_bf16 v[80:83], v[212:215], v[160:163], v[80:83]
    s_add_u32 s15, s14, 0x2508000
    buffer_store_dwordx4 a[80:83], v6, s[4:7], s15 offen sc1
    v_mfma_f32_16x16x32_bf16 v[100:103], v[216:219], v[160:163], v[100:103]
    s_add_u32 m0, s57, 0x0
    s_nop 0
    buffer_load_dwordx4 v1, s[4:7], s56 offen offset:3072 lds
    v_mfma_f32_16x16x32_bf16 v[120:123], v[220:223], v[160:163], v[120:123]
    s_waitcnt lgkmcnt(8)
    v_mfma_f32_16x16x32_bf16 v[64:67], v[208:211], v[164:167], v[64:67]
    ds_read_b64 v[144:145], v76 offset:43008
    ds_read_b64 v[146:147], v77 offset:43008
    v_mfma_f32_16x16x32_bf16 v[84:87], v[212:215], v[164:167], v[84:87]
    s_add_u32 s15, s14, 0x250a000
    buffer_store_dwordx4 a[84:87], v6, s[4:7], s15 offen sc1
    v_mfma_f32_16x16x32_bf16 v[104:107], v[216:219], v[164:167], v[104:107]
    v_mfma_f32_16x16x32_bf16 v[124:127], v[220:223], v[164:167], v[124:127]
    s_add_u32 s56, s28, 0x50c000
    s_add_u32 s56, s56, s57
    s_add_u32 m0, s57, 0x1000
    s_nop 0
    buffer_load_dwordx4 v1, s[4:7], s56 offen offset:0 lds
    s_waitcnt lgkmcnt(8)
    v_mfma_f32_16x16x32_bf16 v[68:71], v[208:211], v[168:171], v[68:71]
    ds_read_b64 v[148:149], v76 offset:45056
    ds_read_b64 v[150:151], v77 offset:45056
    v_mfma_f32_16x16x32_bf16 v[88:91], v[212:215], v[168:171], v[88:91]
    s_add_u32 s15, s14, 0x250c000
    buffer_store_dwordx4 a[88:91], v6, s[4:7], s15 offen sc1
    v_mfma_f32_16x16x32_bf16 v[108:111], v[216:219], v[168:171], v[108:111]
    v_mfma_f32_16x16x32_bf16 v[128:131], v[220:223], v[168:171], v[128:131]
    s_waitcnt lgkmcnt(8)
    v_mfma_f32_16x16x32_bf16 v[72:75], v[208:211], v[172:175], v[72:75]
    ds_read_b64 v[152:153], v76 offset:47104
    ds_read_b64 v[154:155], v77 offset:47104
    v_mfma_f32_16x16x32_bf16 v[92:95], v[212:215], v[172:175], v[92:95]
    s_add_u32 s15, s14, 0x250e000
    buffer_store_dwordx4 a[92:95], v6, s[4:7], s15 offen sc1
    v_mfma_f32_16x16x32_bf16 v[112:115], v[216:219], v[172:175], v[112:115]
    s_add_u32 m0, s57, 0x1000
    s_nop 0
    buffer_load_dwordx4 v1, s[4:7], s56 offen offset:1024 lds
    v_mfma_f32_16x16x32_bf16 v[132:135], v[220:223], v[172:175], v[132:135]
    s_waitcnt lgkmcnt(8)
    v_mfma_f32_16x16x32_bf16 v[96:99], v[212:215], v[176:179], v[96:99]
    ds_read_b64 v[156:157], v76 offset:49152
    ds_read_b64 v[158:159], v77 offset:49152
    v_mfma_f32_16x16x32_bf16 v[116:119], v[216:219], v[176:179], v[116:119]
    v_mfma_f32_16x16x32_bf16 v[136:139], v[220:223], v[176:179], v[136:139]
    v_mfma_f32_16x16x32_bf16 v[44:47], v[208:211], v[36:39], v[44:47]
    v_mfma_f32_16x16x32_bf16 v[48:51], v[212:215], v[36:39], v[48:51]
    v_mfma_f32_16x16x32_bf16 v[52:55], v[216:219], v[36:39], v[52:55]
    v_mfma_f32_16x16x32_bf16 v[56:59], v[220:223], v[36:39], v[56:59]
    s_waitcnt lgkmcnt(8)
    v_mfma_f32_16x16x32_bf16 v[60:63], v[224:227], v[140:143], v[60:63]
    ds_read_b64 v[160:161], v78 offset:40960
    ds_read_b64 v[162:163], v79 offset:40960
    s_waitcnt vmcnt(29)
    v_mfma_f32_16x16x32_bf16 v[80:83], v[228:231], v[140:143], v[80:83]
    s_waitcnt vmcnt(27)
    v_mfma_f32_16x16x32_bf16 v[100:103], v[232:235], v[140:143], v[100:103]
    s_add_u32 m0, s57, 0x1000
    s_nop 0
    buffer_load_dwordx4 v1, s[4:7], s56 offen offset:2048 lds
    s_waitcnt vmcnt(27)
    v_mfma_f32_16x16x32_bf16 v[120:123], v[236:239], v[140:143], v[120:123]
    s_waitcnt lgkmcnt(8)
    v_mfma_f32_16x16x32_bf16 v[64:67], v[224:227], v[144:147], v[64:67]
    ds_read_b64 v[164:165], v78 offset:43008
    ds_read_b64 v[166:167], v79 offset:43008
    v_mfma_f32_16x16x32_bf16 v[84:87], v[228:231], v[144:147], v[84:87]
    v_mfma_f32_16x16x32_bf16 v[104:107], v[232:235], v[144:147], v[104:107]
    v_mfma_f32_16x16x32_bf16 v[124:127], v[236:239], v[144:147], v[124:127]
    s_add_u32 m0, s57, 0x1000
    s_nop 0
    buffer_load_dwordx4 v1, s[4:7], s56 offen offset:3072 lds
    s_waitcnt lgkmcnt(8)
    v_mfma_f32_16x16x32_bf16 v[68:71], v[224:227], v[148:151], v[68:71]
    ds_read_b64 v[168:169], v78 offset:45056
    ds_read_b64 v[170:171], v79 offset:45056
    v_mfma_f32_16x16x32_bf16 v[88:91], v[228:231], v[148:151], v[88:91]
    v_mfma_f32_16x16x32_bf16 v[108:111], v[232:235], v[148:151], v[108:111]
    v_mfma_f32_16x16x32_bf16 v[128:131], v[236:239], v[148:151], v[128:131]
    s_waitcnt lgkmcnt(8)
    v_mfma_f32_16x16x32_bf16 v[72:75], v[224:227], v[152:155], v[72:75]
    ds_read_b64 v[172:173], v78 offset:47104
    ds_read_b64 v[174:175], v79 offset:47104
    v_mfma_f32_16x16x32_bf16 v[92:95], v[228:231], v[152:155], v[92:95]
    v_mfma_f32_16x16x32_bf16 v[112:115], v[232:235], v[152:155], v[112:115]
    s_mul_i32 s57, s22, 9216
    s_add_u32 s56, s28, 0x513000
    s_add_u32 s56, s56, s57
    s_add_u32 m0, s57, 0x8000
    s_nop 0
    buffer_load_dwordx4 v1, s[4:7], s56 offen offset:0 lds
    v_mfma_f32_16x16x32_bf16 v[132:135], v[236:239], v[152:155], v[132:135]
    s_waitcnt lgkmcnt(8)
    v_mfma_f32_16x16x32_bf16 v[96:99], v[228:231], v[156:159], v[96:99]
    ds_read_b64 v[176:177], v78 offset:49152
    ds_read_b64 v[178:179], v79 offset:49152
    v_mfma_f32_16x16x32_bf16 v[116:119], v[232:235], v[156:159], v[116:119]
    v_mfma_f32_16x16x32_bf16 v[136:139], v[236:239], v[156:159], v[136:139]
    v_mfma_f32_16x16x32_bf16 v[44:47], v[224:227], v[36:39], v[44:47]
    v_mfma_f32_16x16x32_bf16 v[48:51], v[228:231], v[36:39], v[48:51]
    v_mfma_f32_16x16x32_bf16 v[52:55], v[232:235], v[36:39], v[52:55]
    v_mfma_f32_16x16x32_bf16 v[56:59], v[236:239], v[36:39], v[56:59]
    s_waitcnt vmcnt(28) lgkmcnt(8)
    v_mfma_f32_16x16x32_bf16 v[60:63], v[240:243], v[160:163], v[60:63]
    s_waitcnt vmcnt(27)
    v_mfma_f32_16x16x32_bf16 v[80:83], v[244:247], v[160:163], v[80:83]
    s_waitcnt vmcnt(26)
    v_mfma_f32_16x16x32_bf16 v[100:103], v[248:251], v[160:163], v[100:103]
    s_add_u32 m0, s57, 0x8000
    s_nop 0
    buffer_load_dwordx4 v1, s[4:7], s56 offen offset:1024 lds
    s_waitcnt vmcnt(26)
    v_mfma_f32_16x16x32_bf16 v[120:123], v[252:255], v[160:163], v[120:123]
    s_waitcnt lgkmcnt(6)
    v_mfma_f32_16x16x32_bf16 v[64:67], v[240:243], v[164:167], v[64:67]
    v_mfma_f32_16x16x32_bf16 v[84:87], v[244:247], v[164:167], v[84:87]
    v_mfma_f32_16x16x32_bf16 v[104:107], v[248:251], v[164:167], v[104:107]
    v_mfma_f32_16x16x32_bf16 v[124:127], v[252:255], v[164:167], v[124:127]
    s_add_u32 m0, s57, 0x8000
    s_nop 0
    buffer_load_dwordx4 v1, s[4:7], s56 offen offset:2048 lds
    s_waitcnt lgkmcnt(4)
    v_mfma_f32_16x16x32_bf16 v[68:71], v[240:243], v[168:171], v[68:71]
    v_mfma_f32_16x16x32_bf16 v[88:91], v[244:247], v[168:171], v[88:91]
    v_mfma_f32_16x16x32_bf16 v[108:111], v[248:251], v[168:171], v[108:111]
    v_mfma_f32_16x16x32_bf16 v[128:131], v[252:255], v[168:171], v[128:131]
    s_waitcnt lgkmcnt(2)
    v_mfma_f32_16x16x32_bf16 v[72:75], v[240:243], v[172:175], v[72:75]
    v_mfma_f32_16x16x32_bf16 v[92:95], v[244:247], v[172:175], v[92:95]
    v_mfma_f32_16x16x32_bf16 v[112:115], v[248:251], v[172:175], v[112:115]
    s_add_u32 m0, s57, 0x8000
    s_nop 0
    buffer_load_dwordx4 v1, s[4:7], s56 offen offset:3072 lds
    v_mfma_f32_16x16x32_bf16 v[132:135], v[252:255], v[172:175], v[132:135]
    s_waitcnt lgkmcnt(0)
    v_mfma_f32_16x16x32_bf16 v[96:99], v[244:247], v[176:179], v[96:99]
    v_mfma_f32_16x16x32_bf16 v[116:119], v[248:251], v[176:179], v[116:119]
    v_mfma_f32_16x16x32_bf16 v[136:139], v[252:255], v[176:179], v[136:139]
    v_mfma_f32_16x16x32_bf16 v[44:47], v[240:243], v[36:39], v[44:47]
    v_mfma_f32_16x16x32_bf16 v[48:51], v[244:247], v[36:39], v[48:51]
    v_mfma_f32_16x16x32_bf16 v[52:55], v[248:251], v[36:39], v[52:55]
    v_mfma_f32_16x16x32_bf16 v[56:59], v[252:255], v[36:39], v[56:59]
    s_nop 4
    ds_write_b128 v190, v[44:47] offset:0
    ds_write_b128 v190, v[48:51] offset:64
    ds_write_b128 v190, v[52:55] offset:128
    ds_write_b128 v190, v[56:59] offset:192
    v_pk_fma_f32 v[116:117], v[52:53], v[188:189], v[116:117] op_sel_hi:[1,0,1]
    s_add_u32 s56, s28, 0x514000
    s_add_u32 s56, s56, s57
    s_add_u32 m0, s57, 0x9000
    s_nop 0
    buffer_load_dwordx4 v1, s[4:7], s56 offen offset:0 lds
    v_pk_fma_f32 v[118:119], v[54:55], v[188:189], v[118:119] op_sel_hi:[1,0,1]
    v_pk_mul_f32 v[116:117], v[116:117], v[188:189] op_sel:[0,1]
    v_pk_mul_f32 v[118:119], v[118:119], v[188:189] op_sel:[0,1]
    v_cvt_pk_bf16_f32 v176, v116, v117
    v_cvt_pk_bf16_f32 v177, v118, v119
    ds_write_b64 v29, v[176:177] offset:3072
    v_pk_fma_f32 v[136:137], v[56:57], v[188:189], v[136:137] op_sel_hi:[1,0,1]
    v_pk_fma_f32 v[138:139], v[58:59], v[188:189], v[138:139] op_sel_hi:[1,0,1]
    v_pk_mul_f32 v[136:137], v[136:137], v[188:189] op_sel:[0,1]
    v_pk_mul_f32 v[138:139], v[138:139], v[188:189] op_sel:[0,1]
    v_cvt_pk_bf16_f32 v174, v136, v137
    v_cvt_pk_bf16_f32 v175, v138, v139
    ds_write_b64 v30, v[174:175] offset:3072
    s_add_u32 m0, s57, 0x9000
    s_nop 0
    buffer_load_dwordx4 v1, s[4:7], s56 offen offset:1024 lds
    v_pk_fma_f32 v[96:97], v[48:49], v[188:189], v[96:97] op_sel_hi:[1,0,1]
    v_pk_fma_f32 v[98:99], v[50:51], v[188:189], v[98:99] op_sel_hi:[1,0,1]
    v_pk_mul_f32 v[96:97], v[96:97], v[188:189] op_sel:[0,1]
    v_pk_mul_f32 v[98:99], v[98:99], v[188:189] op_sel:[0,1]
    v_cvt_pk_bf16_f32 v172, v96, v97
    v_cvt_pk_bf16_f32 v173, v98, v99
    v_pk_fma_f32 v[100:101], v[52:53], v[180:181], v[100:101] op_sel_hi:[1,0,1]
    v_pk_fma_f32 v[102:103], v[54:55], v[180:181], v[102:103] op_sel_hi:[1,0,1]
    v_pk_mul_f32 v[100:101], v[100:101], v[180:181] op_sel:[0,1]
    v_pk_mul_f32 v[102:103], v[102:103], v[180:181] op_sel:[0,1]
    v_cvt_pk_bf16_f32 v176, v100, v101
    v_cvt_pk_bf16_f32 v177, v102, v103
    s_add_u32 m0, s57, 0x9000
    s_nop 0
    buffer_load_dwordx4 v1, s[4:7], s56 offen offset:2048 lds
    ds_write_b64 v29, v[176:177] offset:0
    v_and_b32 v142, v35, v176
    v_and_b32 v143, v35, v177
    v_pk_fma_f32 v[120:121], v[56:57], v[180:181], v[120:121] op_sel_hi:[1,0,1]
    v_pk_fma_f32 v[122:123], v[58:59], v[180:181], v[122:123] op_sel_hi:[1,0,1]
    v_pk_mul_f32 v[120:121], v[120:121], v[180:181] op_sel:[0,1]
    v_pk_mul_f32 v[122:123], v[122:123], v[180:181] op_sel:[0,1]
    v_cvt_pk_bf16_f32 v158, v120, v121
    v_cvt_pk_bf16_f32 v159, v122, v123
    ds_write_b64 v30, v[158:159] offset:0
    v_pk_fma_f32 v[80:81], v[48:49], v[180:181], v[80:81] op_sel_hi:[1,0,1]
    v_pk_fma_f32 v[82:83], v[50:51], v[180:181], v[82:83] op_sel_hi:[1,0,1]
    v_pk_mul_f32 v[80:81], v[80:81], v[180:181] op_sel:[0,1]
    s_add_u32 m0, s57, 0x9000
    s_nop 0
    buffer_load_dwordx4 v1, s[4:7], s56 offen offset:3072 lds
    v_pk_mul_f32 v[82:83], v[82:83], v[180:181] op_sel:[0,1]
    v_cvt_pk_bf16_f32 v156, v80, v81
    v_cvt_pk_bf16_f32 v157, v82, v83
    v_pk_fma_f32 v[60:61], v[44:45], v[180:181], v[60:61] op_sel_hi:[1,0,1]
    v_pk_fma_f32 v[62:63], v[46:47], v[180:181], v[62:63] op_sel_hi:[1,0,1]
    v_pk_mul_f32 v[60:61], v[60:61], v[180:181] op_sel:[0,1]
    v_pk_mul_f32 v[62:63], v[62:63], v[180:181] op_sel:[0,1]
    v_cvt_pk_bf16_f32 v140, v60, v61
    v_cvt_pk_bf16_f32 v141, v62, v63
    v_pk_fma_f32 v[104:105], v[52:53], v[182:183], v[104:105] op_sel_hi:[1,0,1]
    v_pk_fma_f32 v[106:107], v[54:55], v[182:183], v[106:107] op_sel_hi:[1,0,1]
    v_pk_mul_f32 v[104:105], v[104:105], v[182:183] op_sel:[0,1]
    v_pk_mul_f32 v[106:107], v[106:107], v[182:183] op_sel:[0,1]
    s_add_u32 s56, s28, 0x515000
    s_add_u32 s56, s56, s57
    s_add_u32 m0, s57, 0xa000
    s_nop 0
    buffer_load_dwordx4 v1, s[4:7], s56 offen offset:0 lds
    v_cvt_pk_bf16_f32 v178, v104, v105
    v_cvt_pk_bf16_f32 v179, v106, v107
    ds_write_b64 v29, v[178:179] offset:768
    v_and_b32 v146, v35, v178
    v_and_b32 v147, v35, v179
    v_pk_fma_f32 v[124:125], v[56:57], v[182:183], v[124:125] op_sel_hi:[1,0,1]
    v_pk_fma_f32 v[126:127], v[58:59], v[182:183], v[126:127] op_sel_hi:[1,0,1]
    v_pk_mul_f32 v[124:125], v[124:125], v[182:183] op_sel:[0,1]
    v_pk_mul_f32 v[126:127], v[126:127], v[182:183] op_sel:[0,1]
    v_cvt_pk_bf16_f32 v162, v124, v125
    v_cvt_pk_bf16_f32 v163, v126, v127
    ds_write_b64 v30, v[162:163] offset:768
    v_pk_fma_f32 v[84:85], v[48:49], v[182:183], v[84:85] op_sel_hi:[1,0,1]
    s_xor_b32 s56, s27, 0x3400000
    buffer_load_dwordx4 a[0:3], v1, s[4:7], s56 offen offset:0
    v_pk_fma_f32 v[86:87], v[50:51], v[182:183], v[86:87] op_sel_hi:[1,0,1]
    v_pk_mul_f32 v[84:85], v[84:85], v[182:183] op_sel:[0,1]
    v_pk_mul_f32 v[86:87], v[86:87], v[182:183] op_sel:[0,1]
    v_cvt_pk_bf16_f32 v160, v84, v85
    v_cvt_pk_bf16_f32 v161, v86, v87
    v_pk_fma_f32 v[64:65], v[44:45], v[182:183], v[64:65] op_sel_hi:[1,0,1]
    v_pk_fma_f32 v[66:67], v[46:47], v[182:183], v[66:67] op_sel_hi:[1,0,1]
    v_pk_mul_f32 v[64:65], v[64:65], v[182:183] op_sel:[0,1]
    v_pk_mul_f32 v[66:67], v[66:67], v[182:183] op_sel:[0,1]
    v_cvt_pk_bf16_f32 v144, v64, v65
    v_cvt_pk_bf16_f32 v145, v66, v67
    v_pk_fma_f32 v[108:109], v[52:53], v[184:185], v[108:109] op_sel_hi:[1,0,1]
    v_pk_fma_f32 v[110:111], v[54:55], v[184:185], v[110:111] op_sel_hi:[1,0,1]
    buffer_load_dwordx4 a[4:7], v10, s[4:7], s56 offen offset:1024
    v_pk_mul_f32 v[108:109], v[108:109], v[184:185] op_sel:[0,1]
    v_pk_mul_f32 v[110:111], v[110:111], v[184:185] op_sel:[0,1]
    v_cvt_pk_bf16_f32 v176, v108, v109
    v_cvt_pk_bf16_f32 v177, v110, v111
    ds_write_b64 v29, v[176:177] offset:1536
    v_and_b32 v150, v35, v176
    v_and_b32 v151, v35, v177
    v_pk_fma_f32 v[128:129], v[56:57], v[184:185], v[128:129] op_sel_hi:[1,0,1]
    v_pk_fma_f32 v[130:131], v[58:59], v[184:185], v[130:131] op_sel_hi:[1,0,1]
    v_pk_mul_f32 v[128:129], v[128:129], v[184:185] op_sel:[0,1]
    v_pk_mul_f32 v[130:131], v[130:131], v[184:185] op_sel:[0,1]
    v_cvt_pk_bf16_f32 v166, v128, v129
    v_cvt_pk_bf16_f32 v167, v130, v131
    ds_write_b64 v30, v[166:167] offset:1536
    buffer_load_dwordx4 a[8:11], v1, s[4:7], s56 offen offset:2048
    v_pk_fma_f32 v[88:89], v[48:49], v[184:185], v[88:89] op_sel_hi:[1,0,1]
    v_pk_fma_f32 v[90:91], v[50:51], v[184:185], v[90:91] op_sel_hi:[1,0,1]
    v_pk_mul_f32 v[88:89], v[88:89], v[184:185] op_sel:[0,1]
    v_pk_mul_f32 v[90:91], v[90:91], v[184:185] op_sel:[0,1]
    v_cvt_pk_bf16_f32 v164, v88, v89
    v_cvt_pk_bf16_f32 v165, v90, v91
    v_pk_fma_f32 v[68:69], v[44:45], v[184:185], v[68:69] op_sel_hi:[1,0,1]
    v_pk_fma_f32 v[70:71], v[46:47], v[184:185], v[70:71] op_sel_hi:[1,0,1]
    v_pk_mul_f32 v[68:69], v[68:69], v[184:185] op_sel:[0,1]
    v_pk_mul_f32 v[70:71], v[70:71], v[184:185] op_sel:[0,1]
    v_cvt_pk_bf16_f32 v148, v68, v69
    v_cvt_pk_bf16_f32 v149, v70, v71
    v_pk_fma_f32 v[112:113], v[52:53], v[186:187], v[112:113] op_sel_hi:[1,0,1]
    buffer_load_dwordx4 a[12:15], v10, s[4:7], s56 offen offset:3072
    v_pk_fma_f32 v[114:115], v[54:55], v[186:187], v[114:115] op_sel_hi:[1,0,1]
    v_pk_mul_f32 v[112:113], v[112:113], v[186:187] op_sel:[0,1]
    v_pk_mul_f32 v[114:115], v[114:115], v[186:187] op_sel:[0,1]
    v_cvt_pk_bf16_f32 v178, v112, v113
    v_cvt_pk_bf16_f32 v179, v114, v115
    ds_write_b64 v29, v[178:179] offset:2304
    v_and_b32 v154, v35, v178
    v_and_b32 v155, v35, v179
    v_pk_fma_f32 v[132:133], v[56:57], v[186:187], v[132:133] op_sel_hi:[1,0,1]
    v_pk_fma_f32 v[134:135], v[58:59], v[186:187], v[134:135] op_sel_hi:[1,0,1]
    v_pk_mul_f32 v[132:133], v[132:133], v[186:187] op_sel:[0,1]
    v_pk_mul_f32 v[134:135], v[134:135], v[186:187] op_sel:[0,1]
    v_cvt_pk_bf16_f32 v170, v132, v133
    v_cvt_pk_bf16_f32 v171, v134, v135
    s_xor_b32 s56, s27, 0x3401000
    buffer_load_dwordx4 a[16:19], v1, s[4:7], s56 offen offset:0
    ds_write_b64 v30, v[170:171] offset:2304
    v_pk_fma_f32 v[92:93], v[48:49], v[186:187], v[92:93] op_sel_hi:[1,0,1]
    v_pk_fma_f32 v[94:95], v[50:51], v[186:187], v[94:95] op_sel_hi:[1,0,1]
    v_pk_mul_f32 v[92:93], v[92:93], v[186:187] op_sel:[0,1]
    v_pk_mul_f32 v[94:95], v[94:95], v[186:187] op_sel:[0,1]
    v_cvt_pk_bf16_f32 v168, v92, v93
    v_cvt_pk_bf16_f32 v169, v94, v95
    v_pk_fma_f32 v[72:73], v[44:45], v[186:187], v[72:73] op_sel_hi:[1,0,1]
    v_pk_fma_f32 v[74:75], v[46:47], v[186:187], v[74:75] op_sel_hi:[1,0,1]
    v_pk_mul_f32 v[72:73], v[72:73], v[186:187] op_sel:[0,1]
    v_pk_mul_f32 v[74:75], v[74:75], v[186:187] op_sel:[0,1]
    v_cvt_pk_bf16_f32 v152, v72, v73
    v_cvt_pk_bf16_f32 v153, v74, v75
    buffer_load_dwordx4 a[20:23], v10, s[4:7], s56 offen offset:1024
    ds_read_b128 v[60:63], v3 offset:54272
    ds_read_b128 v[64:67], v3 offset:55296
    ds_read_b128 v[68:71], v3 offset:56320
    ds_read_b128 v[72:75], v3 offset:57344
    ds_read_b64_tr_b16 v[108:109], v31 offset:3072
    ds_read_b64_tr_b16 v[110:111], v31 offset:0
    ds_read_b64_tr_b16 v[112:113], v32 offset:3072
    ds_read_b64_tr_b16 v[114:115], v32 offset:0
    ds_read_b64_tr_b16 v[116:117], v31 offset:3072
    ds_read_b64_tr_b16 v[118:119], v31 offset:768
    ds_read_b64_tr_b16 v[120:121], v32 offset:3072
    ds_read_b64_tr_b16 v[122:123], v32 offset:768
    ds_read_b64_tr_b16 v[124:125], v31 offset:0
    ds_read_b64_tr_b16 v[126:127], v31 offset:1536
    ds_read_b64_tr_b16 v[128:129], v32 offset:0
    buffer_load_dwordx4 a[24:27], v1, s[4:7], s56 offen offset:2048
    ds_read_b64_tr_b16 v[130:131], v32 offset:1536
    ds_read_b64_tr_b16 v[132:133], v31 offset:768
    ds_read_b64_tr_b16 v[134:135], v31 offset:2304
    ds_read_b64_tr_b16 v[136:137], v32 offset:768
    ds_read_b64_tr_b16 v[138:139], v32 offset:2304
    s_waitcnt lgkmcnt(14)
    v_mfma_f32_16x16x32_bf16 v[76:79], v[172:175], v[140:143], v[68:71]
    v_mfma_f32_16x16x32_bf16 v[80:83], v[156:159], v[140:143], v[60:63]
    v_mfma_f32_16x16x32_bf16 v[84:87], v[172:175], v[144:147], v[72:75]
    v_mfma_f32_16x16x32_bf16 v[88:91], v[160:163], v[144:147], v[60:63]
    buffer_load_dwordx4 a[28:31], v10, s[4:7], s56 offen offset:3072
    v_mfma_f32_16x16x32_bf16 v[92:95], v[156:159], v[148:151], v[64:67]
    v_mfma_f32_16x16x32_bf16 v[96:99], v[164:167], v[148:151], v[60:63]
    v_mfma_f32_16x16x32_bf16 v[100:103], v[160:163], v[152:155], v[64:67]
    v_mfma_f32_16x16x32_bf16 v[104:107], v[168:171], v[152:155], v[60:63]
    s_mov_b32 s52, 0x3ea52b5c
    v_max3_f32 v44, v76, v77, v78
    s_xor_b32 s56, s27, 0x3402000
    buffer_load_dwordx4 a[32:35], v1, s[4:7], s56 offen offset:0
    v_max3_f32 v48, v79, v80, v81
    v_max3_f32 v44, v44, v82, v83
    v_max_f32 v44, v44, v48
    v_max3_f32 v45, v84, v85, v86
    v_max3_f32 v49, v87, v88, v89
    v_max3_f32 v45, v45, v90, v91
    v_max_f32 v45, v45, v49
    v_max3_f32 v46, v92, v93, v94
    v_max3_f32 v50, v95, v96, v97
    v_max3_f32 v46, v46, v98, v99
    v_max_f32 v46, v46, v50
    v_max3_f32 v47, v100, v101, v102
    v_max3_f32 v51, v103, v104, v105
    v_max3_f32 v47, v47, v106, v107
    buffer_load_dwordx4 a[36:39], v10, s[4:7], s56 offen offset:1024
    v_max_f32 v47, v47, v51
    v_mov_b32 v48, v44
    v_mov_b32 v49, v45
    v_mov_b32 v50, v46
    v_mov_b32 v51, v47
    v_permlane32_swap_b32 v44, v48
    v_permlane32_swap_b32 v45, v49
    v_permlane32_swap_b32 v46, v50
    v_permlane32_swap_b32 v47, v51
    v_max_f32 v44, v44, v48
    v_max_f32 v45, v45, v49
    v_max_f32 v46, v46, v50
    v_max_f32 v47, v47, v51
    v_mov_b32 v48, v44
    s_xor_b32 s56, s27, 0x3404000
    buffer_load_dwordx4 a[40:43], v1, s[4:7], s56 offen offset:0
    v_mov_b32 v49, v45
    v_mov_b32 v50, v46
    v_mov_b32 v51, v47
    v_permlane16_swap_b32 v44, v48
    v_permlane16_swap_b32 v45, v49
    v_permlane16_swap_b32 v46, v50
    v_permlane16_swap_b32 v47, v51
    v_max_f32 v44, v44, v48
    v_max_f32 v45, v45, v49
    v_max_f32 v46, v46, v50
    v_max_f32 v47, v47, v51
    v_mul_f32 v44, s52, v44
    v_mul_f32 v45, s52, v45
    v_mul_f32 v46, s52, v46
    buffer_load_dwordx4 a[44:47], v10, s[4:7], s56 offen offset:1024
    v_mul_f32 v47, s52, v47
    v_fma_f32 v76, v76, s52, -v44
    v_fma_f32 v77, v77, s52, -v44
    v_fma_f32 v78, v78, s52, -v44
    v_fma_f32 v79, v79, s52, -v44
    v_fma_f32 v80, v80, s52, -v44
    v_fma_f32 v81, v81, s52, -v44
    v_fma_f32 v82, v82, s52, -v44
    v_fma_f32 v83, v83, s52, -v44
    v_exp_f32 v76, v76
    v_exp_f32 v77, v77
    v_exp_f32 v78, v78
    buffer_load_dwordx4 a[48:51], v1, s[4:7], s56 offen offset:2048
    v_exp_f32 v79, v79
    v_exp_f32 v80, v80
    v_exp_f32 v81, v81
    v_exp_f32 v82, v82
    v_exp_f32 v83, v83
    v_cvt_pk_bf16_f32 v140, v76, v77
    v_cvt_pk_bf16_f32 v141, v78, v79
    v_cvt_pk_bf16_f32 v142, v80, v81
    v_cvt_pk_bf16_f32 v143, v82, v83
    s_nop 1
    v_mfma_f32_16x16x32_bf16 v[164:167], v[36:39], v[140:143], 0
    buffer_load_dwordx4 a[52:55], v10, s[4:7], s56 offen offset:3072
    v_mfma_f32_16x16x32_bf16 v[156:159], v[108:111], v[140:143], 0
    s_waitcnt lgkmcnt(12)
    v_mfma_f32_16x16x32_bf16 v[160:163], v[112:115], v[140:143], 0
    v_fma_f32 v84, v84, s52, -v45
    v_fma_f32 v85, v85, s52, -v45
    v_fma_f32 v86, v86, s52, -v45
    v_fma_f32 v87, v87, s52, -v45
    v_fma_f32 v88, v88, s52, -v45
    v_fma_f32 v89, v89, s52, -v45
    v_fma_f32 v90, v90, s52, -v45
    v_fma_f32 v91, v91, s52, -v45
    v_exp_f32 v84, v84
    s_xor_b32 s56, s27, 0x3405000
    buffer_load_dwordx4 a[56:59], v1, s[4:7], s56 offen offset:0
    v_exp_f32 v85, v85
    v_exp_f32 v86, v86
    v_exp_f32 v87, v87
    v_exp_f32 v88, v88
    v_exp_f32 v89, v89
    v_exp_f32 v90, v90
    v_exp_f32 v91, v91
    buffer_load_dwordx4 a[60:63], v10, s[4:7], s56 offen offset:1024
    v_cvt_pk_bf16_f32 v144, v84, v85
    v_cvt_pk_bf16_f32 v145, v86, v87
    v_cvt_pk_bf16_f32 v146, v88, v89
    v_cvt_pk_bf16_f32 v147, v90, v91
    s_nop 1
    v_mfma_f32_16x16x32_bf16 v[176:179], v[36:39], v[144:147], 0
    s_waitcnt lgkmcnt(10)
    v_mfma_f32_16x16x32_bf16 v[168:171], v[116:119], v[144:147], 0
    s_waitcnt lgkmcnt(8)
    v_mfma_f32_16x16x32_bf16 v[172:175], v[120:123], v[144:147], 0
    v_rcp_f32 v164, v164
    buffer_load_dwordx4 a[64:67], v1, s[4:7], s56 offen offset:2048
    v_pk_mul_f32 v[156:157], v[156:157], v[164:165] op_sel_hi:[1,0]
    v_pk_mul_f32 v[158:159], v[158:159], v[164:165] op_sel_hi:[1,0]
    v_pk_mul_f32 v[160:161], v[160:161], v[164:165] op_sel_hi:[1,0]
    v_pk_mul_f32 v[162:163], v[162:163], v[164:165] op_sel_hi:[1,0]
    v_cvt_pk_bf16_f32 v156, v156, v157
    v_cvt_pk_bf16_f32 v157, v158, v159
    v_cvt_pk_bf16_f32 v158, v160, v161
    v_cvt_pk_bf16_f32 v159, v162, v163
    s_add_u32 s48, s24, 0x1100000
    buffer_store_dwordx4 v[156:159], v11, s[4:7], s48 offen offset:0 sc1
    buffer_store_dwordx2 v[156:157], v12, s[4:7], s48 offen offset:0 sc1
    v_fma_f32 v92, v92, s52, -v46
    v_fma_f32 v93, v93, s52, -v46
    v_fma_f32 v94, v94, s52, -v46
    v_fma_f32 v95, v95, s52, -v46
    v_fma_f32 v96, v96, s52, -v46
    v_fma_f32 v97, v97, s52, -v46
    v_fma_f32 v98, v98, s52, -v46
    v_fma_f32 v99, v99, s52, -v46
    v_exp_f32 v92, v92
    v_exp_f32 v93, v93
    v_exp_f32 v94, v94
    v_exp_f32 v95, v95
    v_exp_f32 v96, v96
    v_exp_f32 v97, v97
    v_exp_f32 v98, v98
    v_exp_f32 v99, v99
    v_cvt_pk_bf16_f32 v148, v92, v93
    v_cvt_pk_bf16_f32 v149, v94, v95
    v_cvt_pk_bf16_f32 v150, v96, v97
    v_cvt_pk_bf16_f32 v151, v98, v99
    s_nop 1
    v_mfma_f32_16x16x32_bf16 v[188:191], v[36:39], v[148:151], 0
    s_waitcnt lgkmcnt(6)
    v_mfma_f32_16x16x32_bf16 v[180:183], v[124:127], v[148:151], 0
    s_waitcnt lgkmcnt(4)
    v_mfma_f32_16x16x32_bf16 v[184:187], v[128:131], v[148:151], 0
    v_rcp_f32 v176, v176
    s_nop 0
    v_pk_mul_f32 v[168:169], v[168:169], v[176:177] op_sel_hi:[1,0]
    v_pk_mul_f32 v[170:171], v[170:171], v[176:177] op_sel_hi:[1,0]
    v_pk_mul_f32 v[172:173], v[172:173], v[176:177] op_sel_hi:[1,0]
    v_pk_mul_f32 v[174:175], v[174:175], v[176:177] op_sel_hi:[1,0]
    v_cvt_pk_bf16_f32 v168, v168, v169
    v_cvt_pk_bf16_f32 v169, v170, v171
    v_cvt_pk_bf16_f32 v170, v172, v173
    v_cvt_pk_bf16_f32 v171, v174, v175
    s_add_u32 s48, s24, 0x1105000
    buffer_store_dwordx4 v[168:171], v11, s[4:7], s48 offen offset:0 sc1
    buffer_store_dwordx2 v[168:169], v12, s[4:7], s48 offen offset:0 sc1
    v_fma_f32 v100, v100, s52, -v47
    v_fma_f32 v101, v101, s52, -v47
    v_fma_f32 v102, v102, s52, -v47
    v_fma_f32 v103, v103, s52, -v47
    v_fma_f32 v104, v104, s52, -v47
    v_fma_f32 v105, v105, s52, -v47
    v_fma_f32 v106, v106, s52, -v47
    v_fma_f32 v107, v107, s52, -v47
    v_exp_f32 v100, v100
    v_exp_f32 v101, v101
    v_exp_f32 v102, v102
    v_exp_f32 v103, v103
    v_exp_f32 v104, v104
    v_exp_f32 v105, v105
    v_exp_f32 v106, v106
    v_exp_f32 v107, v107
    v_cvt_pk_bf16_f32 v152, v100, v101
    v_cvt_pk_bf16_f32 v153, v102, v103
    v_cvt_pk_bf16_f32 v154, v104, v105
    v_cvt_pk_bf16_f32 v155, v106, v107
    s_nop 1
    v_mfma_f32_16x16x32_bf16 v[68:71], v[36:39], v[152:155], 0
    s_waitcnt lgkmcnt(2)
    v_mfma_f32_16x16x32_bf16 v[60:63], v[132:135], v[152:155], 0
    s_waitcnt lgkmcnt(0)
    v_mfma_f32_16x16x32_bf16 v[64:67], v[136:139], v[152:155], 0
    v_rcp_f32 v188, v188
    s_nop 0
    v_pk_mul_f32 v[180:181], v[180:181], v[188:189] op_sel_hi:[1,0]
    v_pk_mul_f32 v[182:183], v[182:183], v[188:189] op_sel_hi:[1,0]
    v_pk_mul_f32 v[184:185], v[184:185], v[188:189] op_sel_hi:[1,0]
    v_pk_mul_f32 v[186:187], v[186:187], v[188:189] op_sel_hi:[1,0]
    v_cvt_pk_bf16_f32 v180, v180, v181
    v_cvt_pk_bf16_f32 v181, v182, v183
    v_cvt_pk_bf16_f32 v182, v184, v185
    v_cvt_pk_bf16_f32 v183, v186, v187
    s_add_u32 s48, s24, 0x110a000
    buffer_store_dwordx4 v[180:183], v11, s[4:7], s48 offen offset:0 sc1
    buffer_store_dwordx2 v[180:181], v12, s[4:7], s48 offen offset:0 sc1
    v_rcp_f32 v68, v68
    s_nop 0
    v_pk_mul_f32 v[60:61], v[60:61], v[68:69] op_sel_hi:[1,0]
    v_pk_mul_f32 v[62:63], v[62:63], v[68:69] op_sel_hi:[1,0]
    v_pk_mul_f32 v[64:65], v[64:65], v[68:69] op_sel_hi:[1,0]
    v_pk_mul_f32 v[66:67], v[66:67], v[68:69] op_sel_hi:[1,0]
    v_cvt_pk_bf16_f32 v60, v60, v61
    v_cvt_pk_bf16_f32 v61, v62, v63
    v_cvt_pk_bf16_f32 v62, v64, v65
    v_cvt_pk_bf16_f32 v63, v66, v67
    s_add_u32 s48, s24, 0x110f000
    buffer_store_dwordx4 v[60:63], v11, s[4:7], s48 offen offset:0 sc1
    buffer_store_dwordx2 v[60:61], v12, s[4:7], s48 offen offset:0 sc1
    buffer_load_dwordx4 a[68:71], v10, s[4:7], s56 offen offset:3072
    s_xor_b32 s56, s27, 0x3406000
    buffer_load_dwordx4 a[72:75], v1, s[4:7], s56 offen offset:0
    buffer_load_dwordx4 a[76:79], v10, s[4:7], s56 offen offset:1024
    s_xor_b32 s56, s27, 0x3408000
    buffer_load_dwordx4 a[80:83], v1, s[4:7], s56 offen offset:0
    buffer_load_dwordx4 a[84:87], v10, s[4:7], s56 offen offset:1024
    buffer_load_dwordx4 a[88:91], v1, s[4:7], s56 offen offset:2048
    buffer_load_dwordx4 a[92:95], v10, s[4:7], s56 offen offset:3072
    s_xor_b32 s56, s27, 0x3409000
    buffer_load_dwordx4 a[96:99], v1, s[4:7], s56 offen offset:0
    s_sub_u32 s58, s60, 12
    v_mov_b32 v26, s58
    s_mov_b64 exec, 1
    s_waitcnt vmcnt(8)
    buffer_store_dwordx2 v[26:27], off, s[4:7], s35
    s_mov_b64 exec, -1
    s_barrier
    buffer_load_dwordx4 a[100:103], v10, s[4:7], s56 offen offset:1024
    buffer_load_dwordx4 a[104:107], v1, s[4:7], s56 offen offset:2048
    v_lshlrev_b32 v140, 16, v16
    v_and_b32 v141, 0xffff0000, v16
    v_lshlrev_b32 v142, 16, v17
    v_and_b32 v143, 0xffff0000, v17
    v_lshlrev_b32 v144, 16, v18
    v_and_b32 v145, 0xffff0000, v18
    v_lshlrev_b32 v146, 16, v19
    v_and_b32 v147, 0xffff0000, v19
    v_lshlrev_b32 v148, 16, v20
    v_and_b32 v149, 0xffff0000, v20
    v_lshlrev_b32 v150, 16, v21
    v_and_b32 v151, 0xffff0000, v21
    v_lshlrev_b32 v152, 16, v22
    v_and_b32 v153, 0xffff0000, v22
    v_lshlrev_b32 v154, 16, v23
    v_and_b32 v155, 0xffff0000, v23
    v_lshlrev_b32 v156, 16, v14
    v_and_b32 v157, 0xffff0000, v14
    v_lshlrev_b32 v158, 16, v15
    v_and_b32 v159, 0xffff0000, v15
    s_mov_b32 s50, 0
    s_add_u32 s62, s22, 0
    s_mul_i32 s48, s62, 13
    s_lshr_b32 s48, s48, 6
    s_xor_b32 s49, s48, s50
    s_sub_u32 s49, s49, s48
    s_mul_i32 s49, s49, 5
    s_add_u32 s62, s62, s49
    s_lshl_b32 s62, s62, 12
    s_add_u32 s62, s62, s24
    s_add_u32 s63, s22, 4
    s_mul_i32 s48, s63, 13
    s_lshr_b32 s48, s48, 6
    s_xor_b32 s49, s48, s50
    s_sub_u32 s49, s49, s48
    s_mul_i32 s49, s49, 5
    s_add_u32 s63, s63, s49
    s_lshl_b32 s63, s63, 12
    s_add_u32 s63, s63, s24
    s_add_u32 s64, s22, 8
    s_mul_i32 s48, s64, 13
    s_lshr_b32 s48, s48, 6
    s_xor_b32 s49, s48, s50
    s_sub_u32 s49, s49, s48
    s_mul_i32 s49, s49, 5
    s_add_u32 s64, s64, s49
    s_lshl_b32 s64, s64, 12
    s_add_u32 s64, s64, s24
    s_add_u32 s65, s22, 12
    s_mul_i32 s48, s65, 13
    s_lshr_b32 s48, s48, 6
    s_xor_b32 s49, s48, s50
    s_sub_u32 s49, s49, s48
    s_mul_i32 s49, s49, 5
    s_add_u32 s65, s65, s49
    s_lshl_b32 s65, s65, 12
    s_add_u32 s65, s65, s24
    s_add_u32 s66, s22, 16
    s_mul_i32 s48, s66, 13
    s_lshr_b32 s48, s48, 6
    s_xor_b32 s49, s48, s50
    s_sub_u32 s49, s49, s48
    s_mul_i32 s49, s49, 5
    s_add_u32 s66, s66, s49
    s_lshl_b32 s66, s66, 12
    s_add_u32 s66, s66, s24
    s_lshl_b32 s48, s50, 15
    s_add_u32 s26, s26, s48
    s_mov_b32 s47, 0
    s_lshl_b32 s48, s47, 14
    s_add_u32 s30, s30, s48
    s_add_u32 s30, s30, 0x2500000
    s_lshl_b32 s48, s47, 12
    s_add_u32 s38, s38, s48
    ds_read_b128 v[160:163], v3 offset:0
    ds_read_b128 v[164:167], v3 offset:1024
    ds_read_b128 v[168:171], v3 offset:2048
    ds_read_b128 v[172:175], v3 offset:3072
    ds_read_b128 v[176:179], v3 offset:4096
    ds_read_b128 v[180:183], v3 offset:5120
    ds_read_b128 v[184:187], v3 offset:6144
    ds_read_b128 v[188:191], v3 offset:7168
    v_lshlrev_b32 v43, 7, v7
    v_add_u32 v43, s42, v43
    v_lshl_add_u32 v42, v7, 3, s34
    buffer_load_dwordx2 v[40:41], v42, s[4:7], 0 offen sc1
    s_mov_b32 s51, 0x20000
    s_mov_b64 exec, 1
    buffer_store_dwordx2 v[26:27], off, s[4:7], s43 sc1
    s_mov_b64 exec, -1
    s_lshr_b32 s50, s2, 3
    s_lshl_b32 s50, s50, 2
    s_add_u32 s50, s50, s22
    s_lshl_b32 s50, s50, 10
    v_add_u32 v60, s50, v1
    v_min_u32 v60, MK_codeend-CPF_7-32, v60
    s_getpc_b64 s[48:49]
CPF_7:
    global_load_dword v60, v60, s[48:49]
    buffer_load_dwordx4 a[108:111], v10, s[4:7], s56 offen offset:3072
    s_xor_b32 s56, s27, 0x340a000
    buffer_load_dwordx4 a[112:115], v1, s[4:7], s56 offen offset:0
    buffer_load_dwordx4 a[116:119], v10, s[4:7], s56 offen offset:1024
    s_xor_b32 s56, s27, 0x340c000
    buffer_load_dwordx4 a[120:123], v1, s[4:7], s56 offen offset:0
    buffer_load_dwordx4 a[124:127], v10, s[4:7], s56 offen offset:1024
    buffer_load_dwordx4 a[128:131], v1, s[4:7], s56 offen offset:2048
    buffer_load_dwordx4 a[132:135], v10, s[4:7], s56 offen offset:3072
    s_xor_b32 s56, s27, 0x340d000
    buffer_load_dwordx4 a[136:139], v1, s[4:7], s56 offen offset:0
    s_waitcnt vmcnt(10)
    v_cmp_gt_u64 vcc, s[58:59], v[40:41]
    v_cmp_lt_u64 s[48:49], s[60:61], v[40:41]
    s_nop 0
    s_or_b64 vcc, vcc, s[48:49]
    s_cbranch_scc0 POLLD_6
    s_nop 1
POLL_5:
    buffer_load_dwordx2 v[40:41], v42, s[4:7], 0 offen sc1
    s_sub_u32 s51, s51, 1
    s_cbranch_scc1 POLLD_6X
    s_cmp_eq_u32 s51, 0x1ffd8
    s_cselect_b64 vcc, -1, 0
    v_cndmask_b32 v42, v42, v43, vcc
    s_waitcnt vmcnt(0)
    v_cmp_gt_u64 vcc, s[58:59], v[40:41]
    v_cmp_lt_u64 s[48:49], s[60:61], v[40:41]
    s_nop 0
    s_or_b64 vcc, vcc, s[48:49]
    s_cbranch_scc1 POLL_5
POLLD_6X:
    s_waitcnt vmcnt(0)
POLLD_6:
    s_add_u32 s48, s31, 0x1100000
    buffer_load_dwordx4 v[60:63], v1, s[4:7], s48 offen offset:0 sc1
    buffer_load_dwordx4 v[64:67], v1, s[4:7], s48 offen offset:1024 sc1
    buffer_load_dwordx4 v[68:71], v1, s[4:7], s48 offen offset:2048 sc1
    buffer_load_dwordx4 v[72:75], v1, s[4:7], s48 offen offset:3072 sc1
    s_add_u32 s48, s31, 0x1101000
    buffer_load_dwordx4 v[76:79], v1, s[4:7], s48 offen offset:0 sc1
    buffer_load_dwordx4 v[80:83], v1, s[4:7], s48 offen offset:1024 sc1
    buffer_load_dwordx4 v[84:87], v1, s[4:7], s48 offen offset:2048 sc1
    buffer_load_dwordx4 v[88:91], v1, s[4:7], s48 offen offset:3072 sc1
    s_add_u32 s48, s31, 0x1102000
    buffer_load_dwordx4 v[92:95], v1, s[4:7], s48 offen offset:0 sc1
    buffer_load_dwordx4 v[96:99], v1, s[4:7], s48 offen offset:1024 sc1
    buffer_load_dwordx4 v[100:103], v1, s[4:7], s48 offen offset:2048 sc1
    buffer_load_dwordx4 v[104:107], v1, s[4:7], s48 offen offset:3072 sc1
    s_add_u32 s48, s31, 0x1103000
    buffer_load_dwordx4 v[108:111], v1, s[4:7], s48 offen offset:0 sc1
    buffer_load_dwordx4 v[112:115], v1, s[4:7], s48 offen offset:1024 sc1
    buffer_load_dwordx4 v[116:119], v1, s[4:7], s48 offen offset:2048 sc1
    buffer_load_dwordx4 v[120:123], v1, s[4:7], s48 offen offset:3072 sc1
    s_add_u32 s48, s31, 0x1104000
    buffer_load_dwordx2 v[124:125], v25, s[4:7], s48 offen offset:0 sc1
    buffer_load_dwordx2 v[126:127], v25, s[4:7], s48 offen offset:128 sc1
    buffer_load_dwordx2 v[128:129], v25, s[4:7], s48 offen offset:1024 sc1
    buffer_load_dwordx2 v[130:131], v25, s[4:7], s48 offen offset:1152 sc1
    buffer_load_dwordx2 v[132:133], v25, s[4:7], s48 offen offset:2048 sc1
    buffer_load_dwordx2 v[134:135], v25, s[4:7], s48 offen offset:2176 sc1
    buffer_load_dwordx2 v[136:137], v25, s[4:7], s48 offen offset:3072 sc1
    buffer_load_dwordx2 v[138:139], v25, s[4:7], s48 offen offset:3200 sc1
    s_waitcnt vmcnt(23) lgkmcnt(7)
    v_mfma_f32_16x16x32_bf16 v[140:143], v[160:163], v[60:63], v[140:143]
    ds_read_b128 v[160:163], v3 offset:8192
    s_waitcnt lgkmcnt(7)
    v_mfma_f32_16x16x32_bf16 v[144:147], v[164:167], v[60:63], v[144:147]
    ds_read_b128 v[164:167], v3 offset:9216
    s_waitcnt lgkmcnt(7)
    v_mfma_f32_16x16x32_bf16 v[148:151], v[168:171], v[60:63], v[148:151]
    ds_read_b128 v[168:171], v3 offset:10240
    s_waitcnt lgkmcnt(7)
    v_mfma_f32_16x16x32_bf16 v[152:155], v[172:175], v[60:63], v[152:155]
    ds_read_b128 v[172:175], v3 offset:11264
    s_waitcnt lgkmcnt(7)
    v_mfma_f32_16x16x32_bf16 v[156:159], v[176:179], v[60:63], v[156:159]
    ds_read_b128 v[176:179], v3 offset:12288
    s_waitcnt vmcnt(22) lgkmcnt(7)
    v_mfma_f32_16x16x32_bf16 v[140:143], v[180:183], v[64:67], v[140:143]
    ds_read_b128 v[180:183], v3 offset:13312
    s_waitcnt lgkmcnt(7)
    v_mfma_f32_16x16x32_bf16 v[144:147], v[184:187], v[64:67], v[144:147]
    ds_read_b128 v[184:187], v3 offset:14336
    s_waitcnt lgkmcnt(7)
    v_mfma_f32_16x16x32_bf16 v[148:151], v[188:191], v[64:67], v[148:151]
    ds_read_b128 v[188:191], v3 offset:15360
    s_waitcnt lgkmcnt(7)
    v_mfma_f32_16x16x32_bf16 v[152:155], v[160:163], v[64:67], v[152:155]
    buffer_load_dwordx4 a[140:143], v10, s[4:7], s56 offen offset:1024
    ds_read_b128 v[160:163], v3 offset:16384
    s_waitcnt lgkmcnt(7)
    v_mfma_f32_16x16x32_bf16 v[156:159], v[164:167], v[64:67], v[156:159]
    ds_read_b128 v[164:167], v3 offset:17408
    s_waitcnt vmcnt(22) lgkmcnt(7)
    v_mfma_f32_16x16x32_bf16 v[140:143], v[168:171], v[68:71], v[140:143]
    ds_read_b128 v[168:171], v3 offset:18432
    s_waitcnt lgkmcnt(7)
    v_mfma_f32_16x16x32_bf16 v[144:147], v[172:175], v[68:71], v[144:147]
    ds_read_b128 v[172:175], v3 offset:19456
    s_waitcnt lgkmcnt(7)
    v_mfma_f32_16x16x32_bf16 v[148:151], v[176:179], v[68:71], v[148:151]
    ds_read_b128 v[176:179], v3 offset:20480
    s_waitcnt lgkmcnt(7)
    v_mfma_f32_16x16x32_bf16 v[152:155], v[180:183], v[68:71], v[152:155]
    buffer_load_dwordx4 a[144:147], v1, s[4:7], s56 offen offset:2048
    ds_read_b128 v[180:183], v3 offset:21504
    s_waitcnt lgkmcnt(7)
    v_mfma_f32_16x16x32_bf16 v[156:159], v[184:187], v[68:71], v[156:159]
    ds_read_b128 v[184:187], v3 offset:22528
    s_waitcnt vmcnt(22) lgkmcnt(7)
    v_mfma_f32_16x16x32_bf16 v[140:143], v[188:191], v[72:75], v[140:143]
    ds_read_b128 v[188:191], v3 offset:23552
    s_waitcnt lgkmcnt(7)
    v_mfma_f32_16x16x32_bf16 v[144:147], v[160:163], v[72:75], v[144:147]
    ds_read_b128 v[160:163], v3 offset:24576
    s_waitcnt lgkmcnt(7)
    v_mfma_f32_16x16x32_bf16 v[148:151], v[164:167], v[72:75], v[148:151]
    ds_read_b128 v[164:167], v3 offset:25600
    s_waitcnt lgkmcnt(7)
    v_mfma_f32_16x16x32_bf16 v[152:155], v[168:171], v[72:75], v[152:155]
    buffer_load_dwordx4 a[148:151], v10, s[4:7], s56 offen offset:3072
    ds_read_b128 v[168:171], v3 offset:26624
    s_waitcnt lgkmcnt(7)
    v_mfma_f32_16x16x32_bf16 v[156:159], v[172:175], v[72:75], v[156:159]
    ds_read_b128 v[172:175], v3 offset:27648
    s_waitcnt vmcnt(22) lgkmcnt(7)
    v_mfma_f32_16x16x32_bf16 v[140:143], v[176:179], v[76:79], v[140:143]
    ds_read_b128 v[176:179], v3 offset:28672
    s_waitcnt lgkmcnt(7)
    v_mfma_f32_16x16x32_bf16 v[144:147], v[180:183], v[76:79], v[144:147]
    ds_read_b128 v[180:183], v3 offset:29696
    s_waitcnt lgkmcnt(7)
    v_mfma_f32_16x16x32_bf16 v[148:151], v[184:187], v[76:79], v[148:151]
    ds_read_b128 v[184:187], v3 offset:30720
    s_waitcnt lgkmcnt(7)
    v_mfma_f32_16x16x32_bf16 v[152:155], v[188:191], v[76:79], v[152:155]
    s_xor_b32 s56, s27, 0x340e000
    buffer_load_dwordx4 a[152:155], v1, s[4:7], s56 offen offset:0
    ds_read_b128 v[188:191], v3 offset:31744
    s_waitcnt lgkmcnt(7)
    v_mfma_f32_16x16x32_bf16 v[156:159], v[160:163], v[76:79], v[156:159]
    ds_read_b128 v[160:163], v1 offset:0
    s_waitcnt vmcnt(22) lgkmcnt(7)
    v_mfma_f32_16x16x32_bf16 v[140:143], v[164:167], v[80:83], v[140:143]
    ds_read_b128 v[164:167], v1 offset:1024
    s_waitcnt lgkmcnt(7)
    v_mfma_f32_16x16x32_bf16 v[144:147], v[168:171], v[80:83], v[144:147]
    ds_read_b128 v[168:171], v1 offset:2048
    s_waitcnt lgkmcnt(7)
    v_mfma_f32_16x16x32_bf16 v[148:151], v[172:175], v[80:83], v[148:151]
    ds_read_b128 v[172:175], v1 offset:3072
    s_waitcnt lgkmcnt(7)
    v_mfma_f32_16x16x32_bf16 v[152:155], v[176:179], v[80:83], v[152:155]
    buffer_load_dwordx4 a[156:159], v10, s[4:7], s56 offen offset:1024
    ds_read_b128 v[176:179], v1 offset:4096
    s_waitcnt lgkmcnt(7)
    v_mfma_f32_16x16x32_bf16 v[156:159], v[180:183], v[80:83], v[156:159]
    ds_read_b128 v[180:183], v1 offset:5120
    s_waitcnt vmcnt(22) lgkmcnt(7)
    v_mfma_f32_16x16x32_bf16 v[140:143], v[184:187], v[84:87], v[140:143]
    ds_read_b128 v[184:187], v1 offset:6144
    s_waitcnt lgkmcnt(7)
    v_mfma_f32_16x16x32_bf16 v[144:147], v[188:191], v[84:87], v[144:147]
    ds_read_b128 v[188:191], v1 offset:7168
    s_waitcnt lgkmcnt(7)
    v_mfma_f32_16x16x32_bf16 v[148:151], v[160:163], v[84:87], v[148:151]
    ds_read_b128 v[160:163], v1 offset:8192
    s_waitcnt lgkmcnt(7)
    v_mfma_f32_16x16x32_bf16 v[152:155], v[164:167], v[84:87], v[152:155]
    s_xor_b32 s56, s27, 0x3410000
    buffer_load_dwordx4 a[160:163], v1, s[4:7], s56 offen offset:0
    ds_read_b128 v[164:167], v1 offset:9216
    s_waitcnt lgkmcnt(7)
    v_mfma_f32_16x16x32_bf16 v[156:159], v[168:171], v[84:87], v[156:159]
    ds_read_b128 v[168:171], v1 offset:10240
    s_waitcnt vmcnt(22) lgkmcnt(7)
    v_mfma_f32_16x16x32_bf16 v[140:143], v[172:175], v[88:91], v[140:143]
    ds_read_b128 v[172:175], v1 offset:11264
    s_waitcnt lgkmcnt(7)
    v_mfma_f32_16x16x32_bf16 v[144:147], v[176:179], v[88:91], v[144:147]
    ds_read_b128 v[176:179], v1 offset:12288
    s_waitcnt lgkmcnt(7)
    v_mfma_f32_16x16x32_bf16 v[148:151], v[180:183], v[88:91], v[148:151]
    ds_read_b128 v[180:183], v1 offset:13312
    s_waitcnt lgkmcnt(7)
    v_mfma_f32_16x16x32_bf16 v[152:155], v[184:187], v[88:91], v[152:155]
    buffer_load_dwordx4 a[164:167], v10, s[4:7], s56 offen offset:1024
    ds_read_b128 v[184:187], v1 offset:14336
    s_waitcnt lgkmcnt(7)
    v_mfma_f32_16x16x32_bf16 v[156:159], v[188:191], v[88:91], v[156:159]
    ds_read_b128 v[188:191], v1 offset:15360
    s_waitcnt vmcnt(22) lgkmcnt(7)
    v_mfma_f32_16x16x32_bf16 v[140:143], v[160:163], v[92:95], v[140:143]
    ds_read_b128 v[160:163], v1 offset:16384
    s_waitcnt lgkmcnt(7)
    v_mfma_f32_16x16x32_bf16 v[144:147], v[164:167], v[92:95], v[144:147]
    ds_read_b128 v[164:167], v1 offset:17408
    s_waitcnt lgkmcnt(7)
    v_mfma_f32_16x16x32_bf16 v[148:151], v[168:171], v[92:95], v[148:151]
    ds_read_b128 v[168:171], v1 offset:18432
    s_waitcnt lgkmcnt(7)
    v_mfma_f32_16x16x32_bf16 v[152:155], v[172:175], v[92:95], v[152:155]
    buffer_load_dwordx4 a[168:171], v1, s[4:7], s56 offen offset:2048
    ds_read_b128 v[172:175], v1 offset:19456
    s_waitcnt lgkmcnt(7)
    v_mfma_f32_16x16x32_bf16 v[156:159], v[176:179], v[92:95], v[156:159]
    ds_read_b128 v[176:179], v1 offset:20480
    s_waitcnt vmcnt(22) lgkmcnt(7)
    v_mfma_f32_16x16x32_bf16 v[140:143], v[180:183], v[96:99], v[140:143]
    ds_read_b128 v[180:183], v1 offset:21504
    s_waitcnt lgkmcnt(7)
    v_mfma_f32_16x16x32_bf16 v[144:147], v[184:187], v[96:99], v[144:147]
    ds_read_b128 v[184:187], v1 offset:22528
    s_waitcnt lgkmcnt(7)
    v_mfma_f32_16x16x32_bf16 v[148:151], v[188:191], v[96:99], v[148:151]
    ds_read_b128 v[188:191], v1 offset:23552
    s_waitcnt lgkmcnt(7)
    v_mfma_f32_16x16x32_bf16 v[152:155], v[160:163], v[96:99], v[152:155]
    buffer_load_dwordx4 a[172:175], v10, s[4:7], s56 offen offset:3072
    ds_read_b128 v[160:163], v1 offset:24576
    s_waitcnt lgkmcnt(7)
    v_mfma_f32_16x16x32_bf16 v[156:159], v[164:167], v[96:99], v[156:159]
    ds_read_b128 v[164:167], v1 offset:25600
    s_waitcnt vmcnt(22) lgkmcnt(7)
    v_mfma_f32_16x16x32_bf16 v[140:143], v[168:171], v[100:103], v[140:143]
    ds_read_b128 v[168:171], v1 offset:26624
    s_waitcnt lgkmcnt(7)
    v_mfma_f32_16x16x32_bf16 v[144:147], v[172:175], v[100:103], v[144:147]
    ds_read_b128 v[172:175], v1 offset:27648
    s_waitcnt lgkmcnt(7)
    v_mfma_f32_16x16x32_bf16 v[148:151], v[176:179], v[100:103], v[148:151]
    ds_read_b128 v[176:179], v1 offset:28672
    s_waitcnt lgkmcnt(7)
    v_mfma_f32_16x16x32_bf16 v[152:155], v[180:183], v[100:103], v[152:155]
    s_xor_b32 s56, s27, 0x3411000
    buffer_load_dwordx4 a[176:179], v1, s[4:7], s56 offen offset:0
    ds_read_b128 v[180:183], v1 offset:29696
    s_waitcnt lgkmcnt(7)
    v_mfma_f32_16x16x32_bf16 v[156:159], v[184:187], v[100:103], v[156:159]
    ds_read_b128 v[184:187], v1 offset:30720
    s_waitcnt vmcnt(22) lgkmcnt(7)
    v_mfma_f32_16x16x32_bf16 v[140:143], v[188:191], v[104:107], v[140:143]
    ds_read_b128 v[188:191], v1 offset:31744
    s_waitcnt lgkmcnt(7)
    v_mfma_f32_16x16x32_bf16 v[144:147], v[160:163], v[104:107], v[144:147]
    ds_read_b128 v[160:163], v1 offset:32768
    s_waitcnt lgkmcnt(7)
    v_mfma_f32_16x16x32_bf16 v[148:151], v[164:167], v[104:107], v[148:151]
    ds_read_b128 v[164:167], v1 offset:33792
    s_waitcnt lgkmcnt(7)
    v_mfma_f32_16x16x32_bf16 v[152:155], v[168:171], v[104:107], v[152:155]
    buffer_load_dwordx4 a[180:183], v10, s[4:7], s56 offen offset:1024
    ds_read_b128 v[168:171], v1 offset:34816
    s_waitcnt lgkmcnt(7)
    v_mfma_f32_16x16x32_bf16 v[156:159], v[172:175], v[104:107], v[156:159]
    ds_read_b128 v[172:175], v1 offset:35840
    s_waitcnt vmcnt(22) lgkmcnt(7)
    v_mfma_f32_16x16x32_bf16 v[140:143], v[176:179], v[108:111], v[140:143]
    ds_read_b128 v[176:179], v1 offset:36864
    s_waitcnt lgkmcnt(7)
    v_mfma_f32_16x16x32_bf16 v[144:147], v[180:183], v[108:111], v[144:147]
    ds_read_b128 v[180:183], v1 offset:37888
    s_waitcnt lgkmcnt(7)
    v_mfma_f32_16x16x32_bf16 v[148:151], v[184:187], v[108:111], v[148:151]
    ds_read_b128 v[184:187], v1 offset:38912
    s_waitcnt lgkmcnt(7)
    v_mfma_f32_16x16x32_bf16 v[152:155], v[188:191], v[108:111], v[152:155]
    buffer_load_dwordx4 a[184:187], v1, s[4:7], s56 offen offset:2048
    ds_read_b128 v[188:191], v1 offset:39936
    s_waitcnt lgkmcnt(7)
    v_mfma_f32_16x16x32_bf16 v[156:159], v[160:163], v[108:111], v[156:159]
    ds_read_b128 v[160:163], v1 offset:40960
    s_waitcnt vmcnt(22) lgkmcnt(7)
    v_mfma_f32_16x16x32_bf16 v[140:143], v[164:167], v[112:115], v[140:143]
    ds_read_b128 v[164:167], v1 offset:41984
    s_waitcnt lgkmcnt(7)
    v_mfma_f32_16x16x32_bf16 v[144:147], v[168:171], v[112:115], v[144:147]
    ds_read_b128 v[168:171], v1 offset:43008
    s_waitcnt lgkmcnt(7)
    v_mfma_f32_16x16x32_bf16 v[148:151], v[172:175], v[112:115], v[148:151]
    ds_read_b128 v[172:175], v1 offset:44032
    s_waitcnt lgkmcnt(7)
    v_mfma_f32_16x16x32_bf16 v[152:155], v[176:179], v[112:115], v[152:155]
    buffer_load_dwordx4 a[188:191], v10, s[4:7], s56 offen offset:3072
    ds_read_b128 v[176:179], v1 offset:45056
    s_waitcnt lgkmcnt(7)
    v_mfma_f32_16x16x32_bf16 v[156:159], v[180:183], v[112:115], v[156:159]
    ds_read_b128 v[180:183], v1 offset:46080
    s_waitcnt vmcnt(22) lgkmcnt(7)
    v_mfma_f32_16x16x32_bf16 v[140:143], v[184:187], v[116:119], v[140:143]
    ds_read_b128 v[184:187], v1 offset:47104
    s_waitcnt lgkmcnt(7)
    v_mfma_f32_16x16x32_bf16 v[144:147], v[188:191], v[116:119], v[144:147]
    ds_read_b128 v[188:191], v1 offset:48128
    s_waitcnt lgkmcnt(7)
    v_mfma_f32_16x16x32_bf16 v[148:151], v[160:163], v[116:119], v[148:151]
    ds_read_b128 v[160:163], v1 offset:49152
    s_waitcnt lgkmcnt(7)
    v_mfma_f32_16x16x32_bf16 v[152:155], v[164:167], v[116:119], v[152:155]
    ds_read_b128 v[164:167], v1 offset:50176
    s_waitcnt lgkmcnt(7)
    v_mfma_f32_16x16x32_bf16 v[156:159], v[168:171], v[116:119], v[156:159]
    ds_read_b128 v[168:171], v2 offset:0
    s_waitcnt vmcnt(21) lgkmcnt(7)
    v_mfma_f32_16x16x32_bf16 v[140:143], v[172:175], v[120:123], v[140:143]
    ds_read_b128 v[172:175], v2 offset:1024
    s_waitcnt lgkmcnt(7)
    v_mfma_f32_16x16x32_bf16 v[144:147], v[176:179], v[120:123], v[144:147]
    ds_read_b128 v[176:179], v2 offset:2048
    s_waitcnt lgkmcnt(7)
    v_mfma_f32_16x16x32_bf16 v[148:151], v[180:183], v[120:123], v[148:151]
    ds_read_b128 v[180:183], v2 offset:3072
    s_waitcnt lgkmcnt(7)
    v_mfma_f32_16x16x32_bf16 v[152:155], v[184:187], v[120:123], v[152:155]
    ds_read_b128 v[184:187], v2 offset:4096
    s_waitcnt lgkmcnt(7)
    v_mfma_f32_16x16x32_bf16 v[156:159], v[188:191], v[120:123], v[156:159]
    ds_read_b128 v[188:191], v2 offset:5120
    s_waitcnt vmcnt(19) lgkmcnt(7)
    v_mfma_f32_16x16x32_bf16 v[140:143], v[160:163], v[124:127], v[140:143]
    ds_read_b128 v[160:163], v2 offset:6144
    s_waitcnt lgkmcnt(7)
    v_mfma_f32_16x16x32_bf16 v[144:147], v[164:167], v[124:127], v[144:147]
    ds_read_b128 v[164:167], v2 offset:7168
    s_waitcnt lgkmcnt(7)
    v_mfma_f32_16x16x32_bf16 v[148:151], v[168:171], v[124:127], v[148:151]
    ds_read_b128 v[168:171], v2 offset:8192
    s_waitcnt lgkmcnt(7)
    v_mfma_f32_16x16x32_bf16 v[152:155], v[172:175], v[124:127], v[152:155]
    ds_read_b128 v[172:175], v2 offset:9216
    s_waitcnt lgkmcnt(7)
    v_mfma_f32_16x16x32_bf16 v[156:159], v[176:179], v[124:127], v[156:159]
    ds_read_b128 v[176:179], v2 offset:10240
    s_waitcnt vmcnt(17) lgkmcnt(7)
    v_mfma_f32_16x16x32_bf16 v[140:143], v[180:183], v[128:131], v[140:143]
    ds_read_b128 v[180:183], v2 offset:11264
    s_waitcnt lgkmcnt(7)
    v_mfma_f32_16x16x32_bf16 v[144:147], v[184:187], v[128:131], v[144:147]
    ds_read_b128 v[184:187], v2 offset:12288
    s_waitcnt lgkmcnt(7)
    v_mfma_f32_16x16x32_bf16 v[148:151], v[188:191], v[128:131], v[148:151]
    ds_read_b128 v[188:191], v2 offset:13312
    s_waitcnt lgkmcnt(7)
    v_mfma_f32_16x16x32_bf16 v[152:155], v[160:163], v[128:131], v[152:155]
    ds_read_b128 v[160:163], v2 offset:14336
    s_waitcnt lgkmcnt(7)
    v_mfma_f32_16x16x32_bf16 v[156:159], v[164:167], v[128:131], v[156:159]
    ds_read_b128 v[164:167], v2 offset:15360
    s_waitcnt vmcnt(15) lgkmcnt(7)
    v_mfma_f32_16x16x32_bf16 v[140:143], v[168:171], v[132:135], v[140:143]
    ds_read_b128 v[168:171], v2 offset:16384
    s_waitcnt lgkmcnt(7)
    v_mfma_f32_16x16x32_bf16 v[144:147], v[172:175], v[132:135], v[144:147]
    ds_read_b128 v[172:175], v2 offset:17408
    s_waitcnt lgkmcnt(7)
    v_mfma_f32_16x16x32_bf16 v[148:151], v[176:179], v[132:135], v[148:151]
    s_waitcnt lgkmcnt(6)
    v_mfma_f32_16x16x32_bf16 v[152:155], v[180:183], v[132:135], v[152:155]
    s_waitcnt lgkmcnt(5)
    v_mfma_f32_16x16x32_bf16 v[156:159], v[184:187], v[132:135], v[156:159]
    s_waitcnt vmcnt(13) lgkmcnt(4)
    v_mfma_f32_16x16x32_bf16 v[140:143], v[188:191], v[136:139], v[140:143]
    s_waitcnt lgkmcnt(3)
    v_mfma_f32_16x16x32_bf16 v[144:147], v[160:163], v[136:139], v[144:147]
    s_waitcnt lgkmcnt(2)
    v_mfma_f32_16x16x32_bf16 v[148:151], v[164:167], v[136:139], v[148:151]
    s_waitcnt lgkmcnt(1)
    v_mfma_f32_16x16x32_bf16 v[152:155], v[168:171], v[136:139], v[152:155]
    s_waitcnt lgkmcnt(0)
    v_mfma_f32_16x16x32_bf16 v[156:159], v[172:175], v[136:139], v[156:159]
    v_cvt_pk_bf16_f32 v16, v140, v141
    v_cvt_pk_bf16_f32 v17, v142, v143
    v_cvt_pk_bf16_f32 v18, v144, v145
    v_cvt_pk_bf16_f32 v19, v146, v147
    v_cvt_pk_bf16_f32 v20, v148, v149
    v_cvt_pk_bf16_f32 v21, v150, v151
    v_cvt_pk_bf16_f32 v22, v152, v153
    v_cvt_pk_bf16_f32 v23, v154, v155
    v_cvt_pk_bf16_f32 v14, v156, v157
    v_cvt_pk_bf16_f32 v15, v158, v159
    s_add_u32 s48, s32, 0x980000
    buffer_store_dwordx4 v[16:19], v1, s[4:7], s48 offen offset:0 sc1
    s_add_u32 s49, s32, 0x981000
    buffer_store_dwordx4 v[20:23], v1, s[4:7], s49 offen offset:0 sc1
    s_add_u32 s50, s33, 0x980000
    buffer_store_dwordx2 v[14:15], v9, s[4:7], s50 offen offset:0 sc1
    v_dot2_f32_bf16 v140, v14, v36, 0
    v_dot2_f32_bf16 v142, v14, v14, 0
    v_dot2_f32_bf16 v141, v15, v36, 0
    v_dot2_f32_bf16 v143, v15, v15, 0
    v_dot2_f32_bf16 v140, v16, v36, v140
    v_dot2_f32_bf16 v142, v16, v16, v142
    v_dot2_f32_bf16 v141, v17, v36, v141
    v_dot2_f32_bf16 v143, v17, v17, v143
    v_dot2_f32_bf16 v140, v18, v36, v140
    v_dot2_f32_bf16 v142, v18, v18, v142
    v_dot2_f32_bf16 v141, v19, v36, v141
    v_dot2_f32_bf16 v143, v19, v19, v143
    v_dot2_f32_bf16 v140, v20, v36, v140
    v_dot2_f32_bf16 v142, v20, v20, v142
    v_dot2_f32_bf16 v141, v21, v36, v141
    v_dot2_f32_bf16 v143, v21, v21, v143
    v_dot2_f32_bf16 v140, v22, v36, v140
    v_dot2_f32_bf16 v142, v22, v22, v142
    v_dot2_f32_bf16 v141, v23, v36, v141
    v_dot2_f32_bf16 v143, v23, v23, v143
    s_nop 1
    v_add_f32 v140, v140, v141
    v_add_f32 v141, v142, v143
    s_nop 1
    v_permlane32_swap_b32 v140, v141
    v_add_f32 v140, v140, v141
    v_mov_b32 v141, v140
    s_nop 1
    v_permlane16_swap_b32 v140, v141
    v_add_f32 v140, v140, v141
    s_add_u32 s48, s46, 0x790000
    buffer_store_dword v140, v13, s[4:7], s48 offen offset:0 sc1
    s_xor_b32 s56, s27, 0x3412000
    buffer_load_dwordx4 a[192:195], v1, s[4:7], s56 offen offset:0
    buffer_load_dwordx4 a[196:199], v10, s[4:7], s56 offen offset:1024
    s_xor_b32 s56, s27, 0x3414000
    buffer_load_dwordx4 a[200:203], v1, s[4:7], s56 offen offset:0
    buffer_load_dwordx4 a[204:207], v10, s[4:7], s56 offen offset:1024
    buffer_load_dwordx4 a[208:211], v1, s[4:7], s56 offen offset:2048
    buffer_load_dwordx4 a[212:215], v10, s[4:7], s56 offen offset:3072
    s_xor_b32 s56, s27, 0x3415000
    buffer_load_dwordx4 a[216:219], v1, s[4:7], s56 offen offset:0
    buffer_load_dwordx4 a[220:223], v10, s[4:7], s56 offen offset:1024
    s_sub_u32 s58, s60, 11
    v_mov_b32 v26, s58
    s_mov_b64 exec, 1
    s_waitcnt vmcnt(8)
    buffer_store_dwordx2 v[26:27], off, s[4:7], s35
    s_mov_b64 exec, -1
    s_barrier
    buffer_load_dwordx4 a[224:227], v1, s[4:7], s56 offen offset:2048
    buffer_load_dwordx4 a[228:231], v10, s[4:7], s56 offen offset:3072
    v_lshrrev_b32 v188, 3, v4
    v_and_b32 v6, 7, v4
    v_lshlrev_b32 v6, 4, v6
    v_lshl_add_u32 v6, v188, 9, v6
    v_lshl_add_u32 v6, v5, 7, v6
    s_lshl_b32 s48, s22, 8
    v_lshlrev_b32 v188, 4, v5
    v_add_u32 v188, s48, v188
    v_add_u32 v188, 161792, v188
    v_mfma_f32_16x16x32_bf16 v[124:127], a[0:3], v[36:39], 0
    v_mfma_f32_16x16x32_bf16 v[128:131], a[4:7], v[36:39], 0
    v_mfma_f32_16x16x32_bf16 v[124:127], a[8:11], v[36:39], v[124:127]
    v_mfma_f32_16x16x32_bf16 v[128:131], a[12:15], v[36:39], v[128:131]
    v_mfma_f32_16x16x32_bf16 v[124:127], a[16:19], v[36:39], v[124:127]
    v_mfma_f32_16x16x32_bf16 v[128:131], a[20:23], v[36:39], v[128:131]
    v_mfma_f32_16x16x32_bf16 v[124:127], a[24:27], v[36:39], v[124:127]
    v_mfma_f32_16x16x32_bf16 v[128:131], a[28:31], v[36:39], v[128:131]
    v_mfma_f32_16x16x32_bf16 v[124:127], a[32:35], v[36:39], v[124:127]
    v_mfma_f32_16x16x32_bf16 v[128:131], a[36:39], v[36:39], v[128:131]
    v_mfma_f32_16x16x32_bf16 v[124:127], a[40:43], v[36:39], v[124:127]
    v_mfma_f32_16x16x32_bf16 v[128:131], a[44:47], v[36:39], v[128:131]
    v_mfma_f32_16x16x32_bf16 v[124:127], a[48:51], v[36:39], v[124:127]
    v_mfma_f32_16x16x32_bf16 v[128:131], a[52:55], v[36:39], v[128:131]
    v_mfma_f32_16x16x32_bf16 v[124:127], a[56:59], v[36:39], v[124:127]
    v_mfma_f32_16x16x32_bf16 v[128:131], a[60:63], v[36:39], v[128:131]
    v_mfma_f32_16x16x32_bf16 v[124:127], a[64:67], v[36:39], v[124:127]
    v_mfma_f32_16x16x32_bf16 v[128:131], a[68:71], v[36:39], v[128:131]
    v_mfma_f32_16x16x32_bf16 v[124:127], a[72:75], v[36:39], v[124:127]
    v_mfma_f32_16x16x32_bf16 v[128:131], a[76:79], v[36:39], v[128:131]
    v_mfma_f32_16x16x32_bf16 v[124:127], a[80:83], v[36:39], v[124:127]
    v_mfma_f32_16x16x32_bf16 v[128:131], a[84:87], v[36:39], v[128:131]
    v_mfma_f32_16x16x32_bf16 v[124:127], a[88:91], v[36:39], v[124:127]
    v_mfma_f32_16x16x32_bf16 v[128:131], a[92:95], v[36:39], v[128:131]
    v_mfma_f32_16x16x32_bf16 v[124:127], a[96:99], v[36:39], v[124:127]
    v_mfma_f32_16x16x32_bf16 v[128:131], a[100:103], v[36:39], v[128:131]
    v_mfma_f32_16x16x32_bf16 v[124:127], a[104:107], v[36:39], v[124:127]
    v_mfma_f32_16x16x32_bf16 v[128:131], a[108:111], v[36:39], v[128:131]
    v_mfma_f32_16x16x32_bf16 v[124:127], a[112:115], v[36:39], v[124:127]
    v_mfma_f32_16x16x32_bf16 v[128:131], a[116:119], v[36:39], v[128:131]
    v_mfma_f32_16x16x32_bf16 v[124:127], a[120:123], v[36:39], v[124:127]
    v_mfma_f32_16x16x32_bf16 v[128:131], a[124:127], v[36:39], v[128:131]
    v_mfma_f32_16x16x32_bf16 v[124:127], a[128:131], v[36:39], v[124:127]
    v_mfma_f32_16x16x32_bf16 v[128:131], a[132:135], v[36:39], v[128:131]
    v_mfma_f32_16x16x32_bf16 v[124:127], a[136:139], v[36:39], v[124:127]
    v_mfma_f32_16x16x32_bf16 v[128:131], a[140:143], v[36:39], v[128:131]
    v_mfma_f32_16x16x32_bf16 v[124:127], a[144:147], v[36:39], v[124:127]
    v_mfma_f32_16x16x32_bf16 v[128:131], a[148:151], v[36:39], v[128:131]
    v_mfma_f32_16x16x32_bf16 v[124:127], a[152:155], v[36:39], v[124:127]
    v_mfma_f32_16x16x32_bf16 v[128:131], a[156:159], v[36:39], v[128:131]
    s_lshl_b32 s54, s22, 12
    s_mov_b32 s52, 0xbdd2d3e8
    s_mov_b32 s53, 0xc0135761
    v_lshlrev_b32 v43, 7, v7
    v_add_u32 v43, s42, v43
    v_lshl_add_u32 v42, v7, 3, s34
    buffer_load_dwordx2 v[40:41], v42, s[4:7], 0 offen sc1
    s_mov_b32 s51, 0x20000
    s_mov_b64 exec, 1
    buffer_store_dwordx2 v[26:27], off, s[4:7], s43 sc1
    s_mov_b64 exec, -1
    s_xor_b32 s56, s27, 0x3416000
    buffer_load_dwordx4 a[232:235], v1, s[4:7], s56 offen offset:0
    buffer_load_dwordx4 a[236:239], v10, s[4:7], s56 offen offset:1024
    s_xor_b32 s56, s27, 0x3418000
    buffer_load_dwordx4 a[240:243], v1, s[4:7], s56 offen offset:0
    buffer_load_dwordx4 a[244:247], v10, s[4:7], s56 offen offset:1024
    buffer_load_dwordx4 a[248:251], v1, s[4:7], s56 offen offset:2048
    buffer_load_dwordx4 a[252:255], v10, s[4:7], s56 offen offset:3072
    s_xor_b32 s56, s27, 0x3419000
    buffer_load_dwordx4 v[192:195], v1, s[4:7], s56 offen offset:0
    buffer_load_dwordx4 v[196:199], v10, s[4:7], s56 offen offset:1024
    s_waitcnt vmcnt(9)
    v_cmp_gt_u64 vcc, s[58:59], v[40:41]
    v_cmp_lt_u64 s[48:49], s[60:61], v[40:41]
    s_nop 0
    s_or_b64 vcc, vcc, s[48:49]
    s_cbranch_scc0 POLLD_9
    s_nop 1
POLL_8:
    buffer_load_dwordx2 v[40:41], v42, s[4:7], 0 offen sc1
    s_sub_u32 s51, s51, 1
    s_cbranch_scc1 POLLD_9X
    s_cmp_eq_u32 s51, 0x1ffd8
    s_cselect_b64 vcc, -1, 0
    v_cndmask_b32 v42, v42, v43, vcc
    s_waitcnt vmcnt(0)
    v_cmp_gt_u64 vcc, s[58:59], v[40:41]
    v_cmp_lt_u64 s[48:49], s[60:61], v[40:41]
    s_nop 0
    s_or_b64 vcc, vcc, s[48:49]
    s_cbranch_scc1 POLL_8
POLLD_9X:
    s_waitcnt vmcnt(0)
POLLD_9:
    s_add_u32 s49, s62, 0x980000
    s_add_u32 m0, s54, 0x0
    s_nop 0
    buffer_load_dwordx4 v1, s[4:7], s49 offen offset:0 sc1 lds
    buffer_load_dwordx4 v1, s[4:7], s49 offen offset:1024 sc1 lds
    buffer_load_dwordx4 v1, s[4:7], s49 offen offset:2048 sc1 lds
    buffer_load_dwordx4 v1, s[4:7], s49 offen offset:3072 sc1 lds
    s_add_u32 s49, s63, 0x980000
    s_add_u32 m0, s54, 0x4000
    s_nop 0
    buffer_load_dwordx4 v1, s[4:7], s49 offen offset:0 sc1 lds
    buffer_load_dwordx4 v1, s[4:7], s49 offen offset:1024 sc1 lds
    buffer_load_dwordx4 v1, s[4:7], s49 offen offset:2048 sc1 lds
    buffer_load_dwordx4 v1, s[4:7], s49 offen offset:3072 sc1 lds
    s_add_u32 s49, s64, 0x980000
    s_add_u32 m0, s54, 0x8000
    s_nop 0
    buffer_load_dwordx4 v1, s[4:7], s49 offen offset:0 sc1 lds
    buffer_load_dwordx4 v1, s[4:7], s49 offen offset:1024 sc1 lds
    buffer_load_dwordx4 v1, s[4:7], s49 offen offset:2048 sc1 lds
    buffer_load_dwordx4 v1, s[4:7], s49 offen offset:3072 sc1 lds
    s_add_u32 s49, s65, 0x980000
    s_add_u32 m0, s54, 0xc000
    s_nop 0
    buffer_load_dwordx4 v1, s[4:7], s49 offen offset:0 sc1 lds
    buffer_load_dwordx4 v1, s[4:7], s49 offen offset:1024 sc1 lds
    buffer_load_dwordx4 v1, s[4:7], s49 offen offset:2048 sc1 lds
    buffer_load_dwordx4 v1, s[4:7], s49 offen offset:3072 sc1 lds
    s_add_u32 s49, s66, 0x980000
    s_add_u32 m0, s54, 0x10000
    s_nop 0
    buffer_load_dwordx4 v1, s[4:7], s49 offen offset:0 sc1 lds
    buffer_load_dwordx4 v1, s[4:7], s49 offen offset:1024 sc1 lds
    buffer_load_dwordx4 v1, s[4:7], s49 offen offset:2048 sc1 lds
    buffer_load_dwordx4 v1, s[4:7], s49 offen offset:3072 sc1 lds
    s_waitcnt vmcnt(16)
    s_barrier
    ds_read_b128 v[140:143], v1 offset:0
    ds_read_b128 v[144:147], v1 offset:1024
    ds_read_b128 v[148:151], v1 offset:2048
    ds_read_b128 v[152:155], v1 offset:3072
    s_waitcnt lgkmcnt(3)
    v_mfma_f32_16x16x32_bf16 v[60:63], a[0:3], v[140:143], 0
    ds_read_b128 v[156:159], v1 offset:4096
    v_mfma_f32_16x16x32_bf16 v[76:79], a[4:7], v[140:143], 0
    s_waitcnt lgkmcnt(3)
    v_mfma_f32_16x16x32_bf16 v[64:67], a[0:3], v[144:147], 0
    ds_read_b128 v[160:163], v1 offset:5120
    v_mfma_f32_16x16x32_bf16 v[80:83], a[4:7], v[144:147], 0
    s_waitcnt lgkmcnt(3)
    v_mfma_f32_16x16x32_bf16 v[68:71], a[0:3], v[148:151], 0
    ds_read_b128 v[164:167], v1 offset:6144
    v_mfma_f32_16x16x32_bf16 v[84:87], a[4:7], v[148:151], 0
    s_waitcnt lgkmcnt(3)
    v_mfma_f32_16x16x32_bf16 v[72:75], a[0:3], v[152:155], 0
    ds_read_b128 v[168:171], v1 offset:7168
    v_mfma_f32_16x16x32_bf16 v[88:91], a[4:7], v[152:155], 0
    s_waitcnt lgkmcnt(3)
    v_mfma_f32_16x16x32_bf16 v[60:63], a[8:11], v[156:159], v[60:63]
    ds_read_b64 v[140:141], v9 offset:8192
    ds_read_b64 v[142:143], v9 offset:8704
    v_mfma_f32_16x16x32_bf16 v[76:79], a[12:15], v[156:159], v[76:79]
    s_add_u32 s48, s44, 0x790000
    buffer_load_dwordx2 v[92:93], v9, s[4:7], s48 offen offset:0 sc1
    s_waitcnt lgkmcnt(4)
    v_mfma_f32_16x16x32_bf16 v[64:67], a[8:11], v[160:163], v[64:67]
    ds_read_b64 v[144:145], v9 offset:9216
    ds_read_b64 v[146:147], v9 offset:9728
    v_mfma_f32_16x16x32_bf16 v[80:83], a[12:15], v[160:163], v[80:83]
    buffer_load_dwordx2 v[94:95], v9, s[4:7], s48 offen offset:512 sc1
    buffer_load_dwordx2 v[96:97], v9, s[4:7], s48 offen offset:1024 sc1
    s_waitcnt lgkmcnt(5)
    v_mfma_f32_16x16x32_bf16 v[68:71], a[8:11], v[164:167], v[68:71]
    ds_read_b64 v[148:149], v9 offset:10240
    ds_read_b64 v[150:151], v9 offset:10752
    v_mfma_f32_16x16x32_bf16 v[84:87], a[12:15], v[164:167], v[84:87]
    buffer_load_dwordx2 v[98:99], v9, s[4:7], s48 offen offset:1536 sc1
    buffer_load_dwordx2 v[100:101], v9, s[4:7], s48 offen offset:2048 sc1
    s_waitcnt lgkmcnt(6)
    v_mfma_f32_16x16x32_bf16 v[72:75], a[8:11], v[168:171], v[72:75]
    ds_read_b64 v[152:153], v9 offset:11264
    ds_read_b64 v[154:155], v9 offset:11776
    v_mfma_f32_16x16x32_bf16 v[88:91], a[12:15], v[168:171], v[88:91]
    buffer_load_dwordx2 v[102:103], v9, s[4:7], s48 offen offset:2560 sc1
    buffer_load_dwordx2 v[104:105], v9, s[4:7], s48 offen offset:3072 sc1
    s_waitcnt lgkmcnt(6)
    v_mfma_f32_16x16x32_bf16 v[60:63], a[16:19], v[140:143], v[60:63]
    ds_read_b128 v[156:159], v1 offset:12288
    v_mfma_f32_16x16x32_bf16 v[76:79], a[20:23], v[140:143], v[76:79]
    buffer_load_dwordx2 v[106:107], v9, s[4:7], s48 offen offset:3584 sc1
    s_waitcnt lgkmcnt(5)
    v_mfma_f32_16x16x32_bf16 v[64:67], a[16:19], v[144:147], v[64:67]
    ds_read_b128 v[160:163], v1 offset:13312
    v_mfma_f32_16x16x32_bf16 v[80:83], a[20:23], v[144:147], v[80:83]
    s_waitcnt lgkmcnt(4)
    v_mfma_f32_16x16x32_bf16 v[68:71], a[16:19], v[148:151], v[68:71]
    ds_read_b128 v[164:167], v1 offset:14336
    v_mfma_f32_16x16x32_bf16 v[84:87], a[20:23], v[148:151], v[84:87]
    s_waitcnt lgkmcnt(3)
    v_mfma_f32_16x16x32_bf16 v[72:75], a[16:19], v[152:155], v[72:75]
    ds_read_b128 v[168:171], v1 offset:15360
    v_mfma_f32_16x16x32_bf16 v[88:91], a[20:23], v[152:155], v[88:91]
    s_waitcnt vmcnt(20)
    s_barrier
    s_waitcnt lgkmcnt(3)
    v_mfma_f32_16x16x32_bf16 v[60:63], a[24:27], v[156:159], v[60:63]
    ds_read_b128 v[140:143], v1 offset:16384
    v_mfma_f32_16x16x32_bf16 v[76:79], a[28:31], v[156:159], v[76:79]
    s_waitcnt lgkmcnt(3)
    v_mfma_f32_16x16x32_bf16 v[64:67], a[24:27], v[160:163], v[64:67]
    buffer_load_dwordx4 v[200:203], v1, s[4:7], s56 offen offset:2048
    ds_read_b128 v[144:147], v1 offset:17408
    v_mfma_f32_16x16x32_bf16 v[80:83], a[28:31], v[160:163], v[80:83]
    s_waitcnt lgkmcnt(3)
    v_mfma_f32_16x16x32_bf16 v[68:71], a[24:27], v[164:167], v[68:71]
    ds_read_b128 v[148:151], v1 offset:18432
    v_mfma_f32_16x16x32_bf16 v[84:87], a[28:31], v[164:167], v[84:87]
    s_waitcnt lgkmcnt(3)
    v_mfma_f32_16x16x32_bf16 v[72:75], a[24:27], v[168:171], v[72:75]
    ds_read_b128 v[152:155], v1 offset:19456
    v_mfma_f32_16x16x32_bf16 v[88:91], a[28:31], v[168:171], v[88:91]
    buffer_load_dwordx4 v[204:207], v10, s[4:7], s56 offen offset:3072
    s_waitcnt lgkmcnt(3)
    v_mfma_f32_16x16x32_bf16 v[60:63], a[32:35], v[140:143], v[60:63]
    ds_read_b128 v[156:159], v1 offset:20480
    v_mfma_f32_16x16x32_bf16 v[76:79], a[36:39], v[140:143], v[76:79]
    s_waitcnt lgkmcnt(3)
    v_mfma_f32_16x16x32_bf16 v[64:67], a[32:35], v[144:147], v[64:67]
    ds_read_b128 v[160:163], v1 offset:21504
    v_mfma_f32_16x16x32_bf16 v[80:83], a[36:39], v[144:147], v[80:83]
    s_waitcnt lgkmcnt(3)
    v_mfma_f32_16x16x32_bf16 v[68:71], a[32:35], v[148:151], v[68:71]
    s_xor_b32 s56, s27, 0x341a000
    buffer_load_dwordx4 v[208:211], v1, s[4:7], s56 offen offset:0
    ds_read_b128 v[164:167], v1 offset:22528
    v_mfma_f32_16x16x32_bf16 v[84:87], a[36:39], v[148:151], v[84:87]
    s_waitcnt lgkmcnt(3)
    v_mfma_f32_16x16x32_bf16 v[72:75], a[32:35], v[152:155], v[72:75]
    ds_read_b128 v[168:171], v1 offset:23552
    v_mfma_f32_16x16x32_bf16 v[88:91], a[36:39], v[152:155], v[88:91]
    s_waitcnt lgkmcnt(3)
    v_mfma_f32_16x16x32_bf16 v[60:63], a[40:43], v[156:159], v[60:63]
    ds_read_b128 v[140:143], v1 offset:24576
    v_mfma_f32_16x16x32_bf16 v[76:79], a[44:47], v[156:159], v[76:79]
    buffer_load_dwordx4 v[212:215], v10, s[4:7], s56 offen offset:1024
    s_waitcnt lgkmcnt(3)
    v_mfma_f32_16x16x32_bf16 v[64:67], a[40:43], v[160:163], v[64:67]
    ds_read_b128 v[144:147], v1 offset:25600
    v_mfma_f32_16x16x32_bf16 v[80:83], a[44:47], v[160:163], v[80:83]
    s_waitcnt lgkmcnt(3)
    v_mfma_f32_16x16x32_bf16 v[68:71], a[40:43], v[164:167], v[68:71]
    ds_read_b128 v[148:151], v1 offset:26624
    v_mfma_f32_16x16x32_bf16 v[84:87], a[44:47], v[164:167], v[84:87]
    s_waitcnt lgkmcnt(3)
    v_mfma_f32_16x16x32_bf16 v[72:75], a[40:43], v[168:171], v[72:75]
    s_xor_b32 s56, s27, 0x341c000
    buffer_load_dwordx4 v[216:219], v1, s[4:7], s56 offen offset:0
    ds_read_b128 v[152:155], v1 offset:27648
    v_mfma_f32_16x16x32_bf16 v[88:91], a[44:47], v[168:171], v[88:91]
    s_waitcnt lgkmcnt(3)
    v_mfma_f32_16x16x32_bf16 v[60:63], a[48:51], v[140:143], v[60:63]
    ds_read_b64 v[156:157], v9 offset:28672
    ds_read_b64 v[158:159], v9 offset:29184
    v_mfma_f32_16x16x32_bf16 v[76:79], a[52:55], v[140:143], v[76:79]
    s_waitcnt lgkmcnt(4)
    v_mfma_f32_16x16x32_bf16 v[64:67], a[48:51], v[144:147], v[64:67]
    ds_read_b64 v[160:161], v9 offset:29696
    ds_read_b64 v[162:163], v9 offset:30208
    buffer_load_dwordx4 v[220:223], v10, s[4:7], s56 offen offset:1024
    v_mfma_f32_16x16x32_bf16 v[80:83], a[52:55], v[144:147], v[80:83]
    s_waitcnt lgkmcnt(5)
    v_mfma_f32_16x16x32_bf16 v[68:71], a[48:51], v[148:151], v[68:71]
    ds_read_b64 v[164:165], v9 offset:30720
    ds_read_b64 v[166:167], v9 offset:31232
    v_mfma_f32_16x16x32_bf16 v[84:87], a[52:55], v[148:151], v[84:87]
    s_waitcnt lgkmcnt(6)
    v_mfma_f32_16x16x32_bf16 v[72:75], a[48:51], v[152:155], v[72:75]
    ds_read_b64 v[168:169], v9 offset:31744
    ds_read_b64 v[170:171], v9 offset:32256
    buffer_load_dwordx4 v[224:227], v1, s[4:7], s56 offen offset:2048
    v_mfma_f32_16x16x32_bf16 v[88:91], a[52:55], v[152:155], v[88:91]
    s_waitcnt vmcnt(23)
    s_barrier
    s_waitcnt lgkmcnt(6)
    v_mfma_f32_16x16x32_bf16 v[60:63], a[56:59], v[156:159], v[60:63]
    ds_read_b128 v[140:143], v1 offset:32768
    v_mfma_f32_16x16x32_bf16 v[76:79], a[60:63], v[156:159], v[76:79]
    s_waitcnt lgkmcnt(5)
    v_mfma_f32_16x16x32_bf16 v[64:67], a[56:59], v[160:163], v[64:67]
    ds_read_b128 v[144:147], v1 offset:33792
    v_mfma_f32_16x16x32_bf16 v[80:83], a[60:63], v[160:163], v[80:83]
    buffer_load_dwordx4 v[228:231], v10, s[4:7], s56 offen offset:3072
    s_waitcnt lgkmcnt(4)
    v_mfma_f32_16x16x32_bf16 v[68:71], a[56:59], v[164:167], v[68:71]
    ds_read_b128 v[148:151], v1 offset:34816
    v_mfma_f32_16x16x32_bf16 v[84:87], a[60:63], v[164:167], v[84:87]
    s_waitcnt lgkmcnt(3)
    v_mfma_f32_16x16x32_bf16 v[72:75], a[56:59], v[168:171], v[72:75]
    ds_read_b128 v[152:155], v1 offset:35840
    v_mfma_f32_16x16x32_bf16 v[88:91], a[60:63], v[168:171], v[88:91]
    s_waitcnt lgkmcnt(3)
    v_mfma_f32_16x16x32_bf16 v[60:63], a[64:67], v[140:143], v[60:63]
    s_xor_b32 s56, s27, 0x341d000
    buffer_load_dwordx4 v[232:235], v1, s[4:7], s56 offen offset:0
    ds_read_b128 v[156:159], v1 offset:36864
    v_mfma_f32_16x16x32_bf16 v[76:79], a[68:71], v[140:143], v[76:79]
    s_waitcnt lgkmcnt(3)
    v_mfma_f32_16x16x32_bf16 v[64:67], a[64:67], v[144:147], v[64:67]
    ds_read_b128 v[160:163], v1 offset:37888
    v_mfma_f32_16x16x32_bf16 v[80:83], a[68:71], v[144:147], v[80:83]
    s_waitcnt lgkmcnt(3)
    v_mfma_f32_16x16x32_bf16 v[68:71], a[64:67], v[148:151], v[68:71]
    ds_read_b128 v[164:167], v1 offset:38912
    v_mfma_f32_16x16x32_bf16 v[84:87], a[68:71], v[148:151], v[84:87]
    buffer_load_dwordx4 v[236:239], v10, s[4:7], s56 offen offset:1024
    s_waitcnt lgkmcnt(3)
    v_mfma_f32_16x16x32_bf16 v[72:75], a[64:67], v[152:155], v[72:75]
    ds_read_b128 v[168:171], v1 offset:39936
    v_mfma_f32_16x16x32_bf16 v[88:91], a[68:71], v[152:155], v[88:91]
    s_waitcnt lgkmcnt(3)
    v_mfma_f32_16x16x32_bf16 v[60:63], a[72:75], v[156:159], v[60:63]
    ds_read_b128 v[140:143], v1 offset:40960
    v_mfma_f32_16x16x32_bf16 v[76:79], a[76:79], v[156:159], v[76:79]
    s_waitcnt lgkmcnt(3)
    v_mfma_f32_16x16x32_bf16 v[64:67], a[72:75], v[160:163], v[64:67]
    buffer_load_dwordx4 v[240:243], v1, s[4:7], s56 offen offset:2048
    ds_read_b128 v[144:147], v1 offset:41984
    v_mfma_f32_16x16x32_bf16 v[80:83], a[76:79], v[160:163], v[80:83]
    s_waitcnt lgkmcnt(3)
    v_mfma_f32_16x16x32_bf16 v[68:71], a[72:75], v[164:167], v[68:71]
    ds_read_b128 v[148:151], v1 offset:43008
    v_mfma_f32_16x16x32_bf16 v[84:87], a[76:79], v[164:167], v[84:87]
    s_waitcnt lgkmcnt(3)
    v_mfma_f32_16x16x32_bf16 v[72:75], a[72:75], v[168:171], v[72:75]
    ds_read_b128 v[152:155], v1 offset:44032
    v_mfma_f32_16x16x32_bf16 v[88:91], a[76:79], v[168:171], v[88:91]
    buffer_load_dwordx4 v[244:247], v10, s[4:7], s56 offen offset:3072
    s_waitcnt lgkmcnt(3)
    v_mfma_f32_16x16x32_bf16 v[60:63], a[80:83], v[140:143], v[60:63]
    ds_read_b128 v[156:159], v1 offset:45056
    v_mfma_f32_16x16x32_bf16 v[76:79], a[84:87], v[140:143], v[76:79]
    s_waitcnt lgkmcnt(3)
    v_mfma_f32_16x16x32_bf16 v[64:67], a[80:83], v[144:147], v[64:67]
    ds_read_b128 v[160:163], v1 offset:46080
    v_mfma_f32_16x16x32_bf16 v[80:83], a[84:87], v[144:147], v[80:83]
    s_waitcnt lgkmcnt(3)
    v_mfma_f32_16x16x32_bf16 v[68:71], a[80:83], v[148:151], v[68:71]
    s_xor_b32 s56, s27, 0x341e000
    buffer_load_dwordx4 v[248:251], v1, s[4:7], s56 offen offset:0
    ds_read_b128 v[164:167], v1 offset:47104
    v_mfma_f32_16x16x32_bf16 v[84:87], a[84:87], v[148:151], v[84:87]
    s_waitcnt lgkmcnt(3)
    v_mfma_f32_16x16x32_bf16 v[72:75], a[80:83], v[152:155], v[72:75]
    ds_read_b128 v[168:171], v1 offset:48128
    v_mfma_f32_16x16x32_bf16 v[88:91], a[84:87], v[152:155], v[88:91]
    s_waitcnt vmcnt(25)
    s_barrier
    s_waitcnt lgkmcnt(3)
    v_mfma_f32_16x16x32_bf16 v[60:63], a[88:91], v[156:159], v[60:63]
    ds_read_b64 v[140:141], v9 offset:49152
    ds_read_b64 v[142:143], v9 offset:49664
    buffer_load_dwordx4 v[252:255], v10, s[4:7], s56 offen offset:1024
    v_mfma_f32_16x16x32_bf16 v[76:79], a[92:95], v[156:159], v[76:79]
    s_waitcnt vmcnt(17)
    v_add_f32 v92, v92, v100
    v_add_f32 v93, v93, v101
    s_waitcnt lgkmcnt(4)
    v_mfma_f32_16x16x32_bf16 v[64:67], a[88:91], v[160:163], v[64:67]
    ds_read_b64 v[144:145], v9 offset:50176
    ds_read_b64 v[146:147], v9 offset:50688
    v_mfma_f32_16x16x32_bf16 v[80:83], a[92:95], v[160:163], v[80:83]
    s_waitcnt vmcnt(16)
    v_add_f32 v94, v94, v102
    v_add_f32 v95, v95, v103
    s_waitcnt lgkmcnt(5)
    v_mfma_f32_16x16x32_bf16 v[68:71], a[88:91], v[164:167], v[68:71]
    ds_read_b64 v[148:149], v8 offset:0
    ds_read_b64 v[150:151], v8 offset:512
    s_mul_i32 s57, s22, 14336
    s_min_u32 s57, s57, 41984
    s_add_u32 s56, s29, 0x5e1000
    s_add_u32 s56, s56, s57
    s_add_u32 m0, s57, 0x14000
    s_nop 0
    buffer_load_dwordx4 v1, s[4:7], s56 offen offset:0 lds
    v_mfma_f32_16x16x32_bf16 v[84:87], a[92:95], v[164:167], v[84:87]
    s_waitcnt vmcnt(16)
    v_add_f32 v96, v96, v104
    v_add_f32 v97, v97, v105
    s_waitcnt lgkmcnt(6)
    v_mfma_f32_16x16x32_bf16 v[72:75], a[88:91], v[168:171], v[72:75]
    ds_read_b64 v[152:153], v8 offset:1024
    ds_read_b64 v[154:155], v8 offset:1536
    v_mfma_f32_16x16x32_bf16 v[88:91], a[92:95], v[168:171], v[88:91]
    s_waitcnt vmcnt(15)
    v_add_f32 v98, v98, v106
    v_add_f32 v99, v99, v107
    s_waitcnt lgkmcnt(6)
    v_mfma_f32_16x16x32_bf16 v[60:63], a[96:99], v[140:143], v[60:63]
    s_add_u32 m0, s57, 0x14000
    s_nop 0
    buffer_load_dwordx4 v1, s[4:7], s56 offen offset:1024 lds
    ds_read_b128 v[156:159], v2 offset:2048
    v_mfma_f32_16x16x32_bf16 v[76:79], a[100:103], v[140:143], v[76:79]
    v_add_f32 v92, v92, v96
    v_add_f32 v93, v93, v97
    s_waitcnt lgkmcnt(5)
    v_mfma_f32_16x16x32_bf16 v[64:67], a[96:99], v[144:147], v[64:67]
    ds_read_b128 v[160:163], v2 offset:3072
    v_mfma_f32_16x16x32_bf16 v[80:83], a[100:103], v[144:147], v[80:83]
    v_add_f32 v94, v94, v98
    v_add_f32 v95, v95, v99
    s_waitcnt lgkmcnt(4)
    v_mfma_f32_16x16x32_bf16 v[68:71], a[96:99], v[148:151], v[68:71]
    ds_read_b128 v[164:167], v2 offset:4096
    v_mfma_f32_16x16x32_bf16 v[84:87], a[100:103], v[148:151], v[84:87]
    s_add_u32 m0, s57, 0x14000
    s_nop 0
    buffer_load_dwordx4 v1, s[4:7], s56 offen offset:2048 lds
    v_add_f32 v92, v92, v94
    v_add_f32 v93, v93, v95
    s_waitcnt lgkmcnt(3)
    v_mfma_f32_16x16x32_bf16 v[72:75], a[96:99], v[152:155], v[72:75]
    ds_read_b128 v[168:171], v2 offset:5120
    v_mfma_f32_16x16x32_bf16 v[88:91], a[100:103], v[152:155], v[88:91]
    v_mul_f32 v92, 0xbacccccd, v92
    v_mul_f32 v93, 0x3acccccd, v93
    s_waitcnt lgkmcnt(3)
    v_mfma_f32_16x16x32_bf16 v[60:63], a[104:107], v[156:159], v[60:63]
    ds_read_b128 v[140:143], v2 offset:6144
    v_mfma_f32_16x16x32_bf16 v[76:79], a[108:111], v[156:159], v[76:79]
    s_add_u32 m0, s57, 0x14000
    s_nop 0
    buffer_load_dwordx4 v1, s[4:7], s56 offen offset:3072 lds
    v_fma_f32 v93, -v92, v92, v93
    v_max_f32 v93, 0, v93
    s_waitcnt lgkmcnt(3)
    v_mfma_f32_16x16x32_bf16 v[64:67], a[104:107], v[160:163], v[64:67]
    ds_read_b128 v[144:147], v2 offset:7168
    v_mfma_f32_16x16x32_bf16 v[80:83], a[108:111], v[160:163], v[80:83]
    v_add_f32 v93, 0x3727c5ac, v93
    v_rsq_f32 v93, v93
    s_waitcnt lgkmcnt(3)
    v_mfma_f32_16x16x32_bf16 v[68:71], a[104:107], v[164:167], v[68:71]
    ds_read_b128 v[148:151], v2 offset:8192
    v_mfma_f32_16x16x32_bf16 v[84:87], a[108:111], v[164:167], v[84:87]
    s_add_u32 s56, s29, 0x5e2000
    s_add_u32 s56, s56, s57
    s_add_u32 m0, s57, 0x15000
    s_nop 0
    buffer_load_dwordx4 v1, s[4:7], s56 offen offset:0 lds
    ds_bpermute_b32 v52, v28, v92 offset:0
    ds_bpermute_b32 v53, v28, v93 offset:0
    s_waitcnt lgkmcnt(5)
    v_mfma_f32_16x16x32_bf16 v[72:75], a[104:107], v[168:171], v[72:75]
    ds_read_b128 v[152:155], v2 offset:9216
    v_mfma_f32_16x16x32_bf16 v[88:91], a[108:111], v[168:171], v[88:91]
    ds_bpermute_b32 v54, v28, v92 offset:64
    ds_bpermute_b32 v55, v28, v93 offset:64
    s_waitcnt lgkmcnt(7)
    v_mfma_f32_16x16x32_bf16 v[60:63], a[112:115], v[140:143], v[60:63]
    ds_read_b128 v[156:159], v2 offset:10240
    v_mfma_f32_16x16x32_bf16 v[76:79], a[116:119], v[140:143], v[76:79]
    s_add_u32 m0, s57, 0x15000
    s_nop 0
    buffer_load_dwordx4 v1, s[4:7], s56 offen offset:1024 lds
    ds_bpermute_b32 v56, v28, v92 offset:128
    ds_bpermute_b32 v57, v28, v93 offset:128
    s_waitcnt lgkmcnt(9)
    v_mfma_f32_16x16x32_bf16 v[64:67], a[112:115], v[144:147], v[64:67]
    ds_read_b128 v[160:163], v2 offset:11264
    v_mfma_f32_16x16x32_bf16 v[80:83], a[116:119], v[144:147], v[80:83]
    ds_bpermute_b32 v58, v28, v92 offset:192
    ds_bpermute_b32 v59, v28, v93 offset:192
    s_waitcnt lgkmcnt(11)
    v_mfma_f32_16x16x32_bf16 v[68:71], a[112:115], v[148:151], v[68:71]
    ds_read_b128 v[164:167], v2 offset:12288
    v_mfma_f32_16x16x32_bf16 v[84:87], a[116:119], v[148:151], v[84:87]
    s_add_u32 m0, s57, 0x15000
    s_nop 0
    buffer_load_dwordx4 v1, s[4:7], s56 offen offset:2048 lds
    s_waitcnt lgkmcnt(9)
    v_mfma_f32_16x16x32_bf16 v[72:75], a[112:115], v[152:155], v[72:75]
    ds_read_b128 v[168:171], v2 offset:13312
    v_mfma_f32_16x16x32_bf16 v[88:91], a[116:119], v[152:155], v[88:91]
    s_barrier
    s_waitcnt lgkmcnt(7)
    v_mfma_f32_16x16x32_bf16 v[60:63], a[120:123], v[156:159], v[60:63]
    ds_read_b128 v[140:143], v2 offset:14336
    v_mfma_f32_16x16x32_bf16 v[76:79], a[124:127], v[156:159], v[76:79]
    s_waitcnt lgkmcnt(5)
    v_mfma_f32_16x16x32_bf16 v[64:67], a[120:123], v[160:163], v[64:67]
    s_add_u32 m0, s57, 0x15000
    s_nop 0
    buffer_load_dwordx4 v1, s[4:7], s56 offen offset:3072 lds
    ds_read_b128 v[144:147], v2 offset:15360
    v_mfma_f32_16x16x32_bf16 v[80:83], a[124:127], v[160:163], v[80:83]
    s_waitcnt lgkmcnt(3)
    v_mfma_f32_16x16x32_bf16 v[68:71], a[120:123], v[164:167], v[68:71]
    ds_read_b128 v[148:151], v2 offset:16384
    v_mfma_f32_16x16x32_bf16 v[84:87], a[124:127], v[164:167], v[84:87]
    s_waitcnt lgkmcnt(3)
    v_mfma_f32_16x16x32_bf16 v[72:75], a[120:123], v[168:171], v[72:75]
    ds_read_b128 v[152:155], v2 offset:17408
    v_mfma_f32_16x16x32_bf16 v[88:91], a[124:127], v[168:171], v[88:91]
    s_add_u32 s56, s29, 0x5e3000
    s_add_u32 s56, s56, s57
    s_add_u32 m0, s57, 0x16000
    s_nop 0
    buffer_load_dwordx4 v1, s[4:7], s56 offen offset:0 lds
    s_waitcnt lgkmcnt(3)
    v_mfma_f32_16x16x32_bf16 v[60:63], a[128:131], v[140:143], v[60:63]
    ds_read_b64 v[156:157], v8 offset:18432
    ds_read_b64 v[158:159], v8 offset:18944
    v_mfma_f32_16x16x32_bf16 v[76:79], a[132:135], v[140:143], v[76:79]
    s_waitcnt lgkmcnt(4)
    v_mfma_f32_16x16x32_bf16 v[64:67], a[128:131], v[144:147], v[64:67]
    ds_read_b64 v[160:161], v8 offset:19456
    ds_read_b64 v[162:163], v8 offset:19968
    v_mfma_f32_16x16x32_bf16 v[80:83], a[132:135], v[144:147], v[80:83]
    s_add_u32 m0, s57, 0x16000
    s_nop 0
    buffer_load_dwordx4 v1, s[4:7], s56 offen offset:1024 lds
    s_waitcnt lgkmcnt(5)
    v_mfma_f32_16x16x32_bf16 v[68:71], a[128:131], v[148:151], v[68:71]
    ds_read_b64 v[164:165], v8 offset:20480
    ds_read_b64 v[166:167], v8 offset:20992
    v_mfma_f32_16x16x32_bf16 v[84:87], a[132:135], v[148:151], v[84:87]
    s_waitcnt lgkmcnt(6)
    v_mfma_f32_16x16x32_bf16 v[72:75], a[128:131], v[152:155], v[72:75]
    ds_read_b64 v[168:169], v8 offset:21504
    ds_read_b64 v[170:171], v8 offset:22016
    v_mfma_f32_16x16x32_bf16 v[88:91], a[132:135], v[152:155], v[88:91]
    s_waitcnt lgkmcnt(6)
    v_mfma_f32_16x16x32_bf16 v[60:63], a[136:139], v[156:159], v[60:63]
    s_add_u32 m0, s57, 0x16000
    s_nop 0
    buffer_load_dwordx4 v1, s[4:7], s56 offen offset:2048 lds
    ds_read_b128 v[140:143], v2 offset:22528
    v_mfma_f32_16x16x32_bf16 v[76:79], a[140:143], v[156:159], v[76:79]
    s_waitcnt lgkmcnt(5)
    v_mfma_f32_16x16x32_bf16 v[64:67], a[136:139], v[160:163], v[64:67]
    ds_read_b128 v[144:147], v2 offset:23552
    v_mfma_f32_16x16x32_bf16 v[80:83], a[140:143], v[160:163], v[80:83]
    s_waitcnt lgkmcnt(4)
    v_mfma_f32_16x16x32_bf16 v[68:71], a[136:139], v[164:167], v[68:71]
    ds_read_b128 v[148:151], v2 offset:24576
    v_mfma_f32_16x16x32_bf16 v[84:87], a[140:143], v[164:167], v[84:87]
    s_add_u32 m0, s57, 0x16000
    s_nop 0
    buffer_load_dwordx4 v1, s[4:7], s56 offen offset:3072 lds
    s_waitcnt lgkmcnt(3)
    v_mfma_f32_16x16x32_bf16 v[72:75], a[136:139], v[168:171], v[72:75]
    ds_read_b128 v[152:155], v2 offset:25600
    v_mfma_f32_16x16x32_bf16 v[88:91], a[140:143], v[168:171], v[88:91]
    s_waitcnt lgkmcnt(3)
    v_mfma_f32_16x16x32_bf16 v[60:63], a[144:147], v[140:143], v[60:63]
    ds_read_b128 v[156:159], v2 offset:26624
    v_mfma_f32_16x16x32_bf16 v[76:79], a[148:151], v[140:143], v[76:79]
    s_waitcnt lgkmcnt(3)
    v_mfma_f32_16x16x32_bf16 v[64:67], a[144:147], v[144:147], v[64:67]
    s_add_u32 s56, s29, 0x5e4000
    s_add_u32 s56, s56, s57
    s_add_u32 m0, s57, 0x17000
    s_nop 0
    buffer_load_dwordx4 v1, s[4:7], s56 offen offset:0 lds
    ds_read_b128 v[160:163], v2 offset:27648
    v_mfma_f32_16x16x32_bf16 v[80:83], a[148:151], v[144:147], v[80:83]
    s_waitcnt lgkmcnt(3)
    v_mfma_f32_16x16x32_bf16 v[68:71], a[144:147], v[148:151], v[68:71]
    ds_read_b128 v[164:167], v2 offset:28672
    v_mfma_f32_16x16x32_bf16 v[84:87], a[148:151], v[148:151], v[84:87]
    s_waitcnt lgkmcnt(3)
    v_mfma_f32_16x16x32_bf16 v[72:75], a[144:147], v[152:155], v[72:75]
    s_add_u32 m0, s57, 0x17000
    s_nop 0
    buffer_load_dwordx4 v1, s[4:7], s56 offen offset:1024 lds
    ds_read_b128 v[168:171], v2 offset:29696
    v_mfma_f32_16x16x32_bf16 v[88:91], a[148:151], v[152:155], v[88:91]
    s_waitcnt lgkmcnt(3)
    v_mfma_f32_16x16x32_bf16 v[60:63], a[152:155], v[156:159], v[60:63]
    v_mfma_f32_16x16x32_bf16 v[76:79], a[156:159], v[156:159], v[76:79]
    s_waitcnt lgkmcnt(2)
    v_mfma_f32_16x16x32_bf16 v[64:67], a[152:155], v[160:163], v[64:67]
    v_mfma_f32_16x16x32_bf16 v[80:83], a[156:159], v[160:163], v[80:83]
    s_xor_b32 s56, s30, 0x0
    buffer_load_dwordx4 a[0:3], v6, s[4:7], s56 offen offset:0
    s_waitcnt lgkmcnt(1)
    v_mfma_f32_16x16x32_bf16 v[68:71], a[152:155], v[164:167], v[68:71]
    v_mfma_f32_16x16x32_bf16 v[84:87], a[156:159], v[164:167], v[84:87]
    s_waitcnt lgkmcnt(0)
    v_mfma_f32_16x16x32_bf16 v[72:75], a[152:155], v[168:171], v[72:75]
    v_mfma_f32_16x16x32_bf16 v[88:91], a[156:159], v[168:171], v[88:91]
    v_pk_fma_f32 v[60:61], v[124:125], v[52:53], v[60:61] op_sel_hi:[1,0,1]
    buffer_load_dwordx4 a[4:7], v6, s[4:7], s56 offen offset:1024
    v_pk_fma_f32 v[62:63], v[126:127], v[52:53], v[62:63] op_sel_hi:[1,0,1]
    v_pk_mul_f32 v[60:61], v[60:61], v[52:53] op_sel:[0,1]
    v_pk_mul_f32 v[62:63], v[62:63], v[52:53] op_sel:[0,1]
    v_pk_mul_f32 v[180:181], v[60:61], v[60:61]
    v_pk_mul_f32 v[182:183], v[62:63], v[62:63]
    v_pk_fma_f32 v[180:181], v[180:181], s[52:53], s[52:53] op_sel:[0,0,1] op_sel_hi:[1,0,1]
    v_pk_fma_f32 v[182:183], v[182:183], s[52:53], s[52:53] op_sel:[0,0,1] op_sel_hi:[1,0,1]
    v_pk_mul_f32 v[180:181], v[180:181], v[60:61]
    v_pk_mul_f32 v[182:183], v[182:183], v[62:63]
    v_exp_f32 v180, v180
    v_exp_f32 v181, v181
    buffer_load_dwordx4 a[8:11], v6, s[4:7], s56 offen offset:2048
    v_exp_f32 v182, v182
    v_exp_f32 v183, v183
    v_pk_add_f32 v[180:181], v[180:181], 1.0 op_sel_hi:[1,0]
    v_pk_add_f32 v[182:183], v[182:183], 1.0 op_sel_hi:[1,0]
    v_rcp_f32 v180, v180
    v_rcp_f32 v181, v181
    v_rcp_f32 v182, v182
    v_rcp_f32 v183, v183
    buffer_load_dwordx4 a[12:15], v6, s[4:7], s56 offen offset:3072
    v_pk_mul_f32 v[60:61], v[60:61], v[180:181]
    v_pk_mul_f32 v[62:63], v[62:63], v[182:183]
    v_pk_fma_f32 v[76:77], v[128:129], v[52:53], v[76:77] op_sel_hi:[1,0,1]
    v_pk_fma_f32 v[78:79], v[130:131], v[52:53], v[78:79] op_sel_hi:[1,0,1]
    v_pk_mul_f32 v[76:77], v[76:77], v[52:53] op_sel:[0,1]
    v_pk_mul_f32 v[78:79], v[78:79], v[52:53] op_sel:[0,1]
    v_pk_mul_f32 v[184:185], v[76:77], v[76:77]
    v_pk_mul_f32 v[186:187], v[78:79], v[78:79]
    v_pk_fma_f32 v[184:185], v[184:185], s[52:53], s[52:53] op_sel:[0,0,1] op_sel_hi:[1,0,1]
    v_pk_fma_f32 v[186:187], v[186:187], s[52:53], s[52:53] op_sel:[0,0,1] op_sel_hi:[1,0,1]
    v_pk_mul_f32 v[184:185], v[184:185], v[76:77]
    v_pk_mul_f32 v[186:187], v[186:187], v[78:79]
    v_exp_f32 v184, v184
    s_xor_b32 s56, s30, 0x1000
    buffer_load_dwordx4 a[16:19], v6, s[4:7], s56 offen offset:0
    v_exp_f32 v185, v185
    v_exp_f32 v186, v186
    v_exp_f32 v187, v187
    v_pk_add_f32 v[184:185], v[184:185], 1.0 op_sel_hi:[1,0]
    v_pk_add_f32 v[186:187], v[186:187], 1.0 op_sel_hi:[1,0]
    v_rcp_f32 v184, v184
    v_rcp_f32 v185, v185
    v_rcp_f32 v186, v186
    buffer_load_dwordx4 a[20:23], v6, s[4:7], s56 offen offset:1024
    v_rcp_f32 v187, v187
    v_pk_mul_f32 v[76:77], v[76:77], v[184:185]
    v_pk_mul_f32 v[78:79], v[78:79], v[186:187]
    v_pk_add_f32 v[140:141], v[60:61], v[62:63]
    v_pk_mul_f32 v[142:143], v[60:61], v[60:61]
    v_pk_add_f32 v[140:141], v[140:141], v[76:77]
    v_pk_fma_f32 v[142:143], v[62:63], v[62:63], v[142:143]
    v_pk_add_f32 v[140:141], v[140:141], v[78:79]
    v_pk_fma_f32 v[142:143], v[76:77], v[76:77], v[142:143]
    v_pk_fma_f32 v[142:143], v[78:79], v[78:79], v[142:143]
    v_add_f32 v140, v140, v141
    v_add_f32 v141, v142, v143
    buffer_load_dwordx4 a[24:27], v6, s[4:7], s56 offen offset:2048
    v_pk_fma_f32 v[64:65], v[124:125], v[54:55], v[64:65] op_sel_hi:[1,0,1]
    v_pk_fma_f32 v[66:67], v[126:127], v[54:55], v[66:67] op_sel_hi:[1,0,1]
    v_pk_mul_f32 v[64:65], v[64:65], v[54:55] op_sel:[0,1]
    v_pk_mul_f32 v[66:67], v[66:67], v[54:55] op_sel:[0,1]
    v_pk_mul_f32 v[180:181], v[64:65], v[64:65]
    v_pk_mul_f32 v[182:183], v[66:67], v[66:67]
    v_pk_fma_f32 v[180:181], v[180:181], s[52:53], s[52:53] op_sel:[0,0,1] op_sel_hi:[1,0,1]
    v_pk_fma_f32 v[182:183], v[182:183], s[52:53], s[52:53] op_sel:[0,0,1] op_sel_hi:[1,0,1]
    v_pk_mul_f32 v[180:181], v[180:181], v[64:65]
    v_pk_mul_f32 v[182:183], v[182:183], v[66:67]
    v_exp_f32 v180, v180
    v_exp_f32 v181, v181
    buffer_load_dwordx4 a[28:31], v6, s[4:7], s56 offen offset:3072
    v_exp_f32 v182, v182
    v_exp_f32 v183, v183
    v_pk_add_f32 v[180:181], v[180:181], 1.0 op_sel_hi:[1,0]
    v_pk_add_f32 v[182:183], v[182:183], 1.0 op_sel_hi:[1,0]
    v_rcp_f32 v180, v180
    v_rcp_f32 v181, v181
    v_rcp_f32 v182, v182
    v_rcp_f32 v183, v183
    v_pk_mul_f32 v[64:65], v[64:65], v[180:181]
    s_xor_b32 s56, s30, 0x2000
    buffer_load_dwordx4 a[32:35], v6, s[4:7], s56 offen offset:0
    v_pk_mul_f32 v[66:67], v[66:67], v[182:183]
    v_pk_fma_f32 v[80:81], v[128:129], v[54:55], v[80:81] op_sel_hi:[1,0,1]
    v_pk_fma_f32 v[82:83], v[130:131], v[54:55], v[82:83] op_sel_hi:[1,0,1]
    v_pk_mul_f32 v[80:81], v[80:81], v[54:55] op_sel:[0,1]
    v_pk_mul_f32 v[82:83], v[82:83], v[54:55] op_sel:[0,1]
    v_pk_mul_f32 v[184:185], v[80:81], v[80:81]
    v_pk_mul_f32 v[186:187], v[82:83], v[82:83]
    v_pk_fma_f32 v[184:185], v[184:185], s[52:53], s[52:53] op_sel:[0,0,1] op_sel_hi:[1,0,1]
    v_pk_fma_f32 v[186:187], v[186:187], s[52:53], s[52:53] op_sel:[0,0,1] op_sel_hi:[1,0,1]
    v_pk_mul_f32 v[184:185], v[184:185], v[80:81]
    v_pk_mul_f32 v[186:187], v[186:187], v[82:83]
    v_exp_f32 v184, v184
    buffer_load_dwordx4 a[36:39], v6, s[4:7], s56 offen offset:1024
    v_exp_f32 v185, v185
    v_exp_f32 v186, v186
    v_exp_f32 v187, v187
    v_pk_add_f32 v[184:185], v[184:185], 1.0 op_sel_hi:[1,0]
    v_pk_add_f32 v[186:187], v[186:187], 1.0 op_sel_hi:[1,0]
    v_rcp_f32 v184, v184
    v_rcp_f32 v185, v185
    v_rcp_f32 v186, v186
    buffer_load_dwordx4 a[40:43], v6, s[4:7], s56 offen offset:2048
    v_rcp_f32 v187, v187
    v_pk_mul_f32 v[80:81], v[80:81], v[184:185]
    v_pk_mul_f32 v[82:83], v[82:83], v[186:187]
    v_pk_add_f32 v[144:145], v[64:65], v[66:67]
    v_pk_mul_f32 v[146:147], v[64:65], v[64:65]
    v_pk_add_f32 v[144:145], v[144:145], v[80:81]
    v_pk_fma_f32 v[146:147], v[66:67], v[66:67], v[146:147]
    v_pk_add_f32 v[144:145], v[144:145], v[82:83]
    v_pk_fma_f32 v[146:147], v[80:81], v[80:81], v[146:147]
    v_pk_fma_f32 v[146:147], v[82:83], v[82:83], v[146:147]
    v_add_f32 v144, v144, v145
    v_add_f32 v145, v146, v147
    v_pk_fma_f32 v[68:69], v[124:125], v[56:57], v[68:69] op_sel_hi:[1,0,1]
    buffer_load_dwordx4 a[44:47], v6, s[4:7], s56 offen offset:3072
    v_pk_fma_f32 v[70:71], v[126:127], v[56:57], v[70:71] op_sel_hi:[1,0,1]
    v_pk_mul_f32 v[68:69], v[68:69], v[56:57] op_sel:[0,1]
    v_pk_mul_f32 v[70:71], v[70:71], v[56:57] op_sel:[0,1]
    v_pk_mul_f32 v[180:181], v[68:69], v[68:69]
    v_pk_mul_f32 v[182:183], v[70:71], v[70:71]
    v_pk_fma_f32 v[180:181], v[180:181], s[52:53], s[52:53] op_sel:[0,0,1] op_sel_hi:[1,0,1]
    v_pk_fma_f32 v[182:183], v[182:183], s[52:53], s[52:53] op_sel:[0,0,1] op_sel_hi:[1,0,1]
    v_pk_mul_f32 v[180:181], v[180:181], v[68:69]
    v_pk_mul_f32 v[182:183], v[182:183], v[70:71]
    v_exp_f32 v180, v180
    v_exp_f32 v181, v181
    v_exp_f32 v182, v182
    s_xor_b32 s56, s30, 0x3000
    buffer_load_dwordx4 a[48:51], v6, s[4:7], s56 offen offset:0
    v_exp_f32 v183, v183
    v_pk_add_f32 v[180:181], v[180:181], 1.0 op_sel_hi:[1,0]
    v_pk_add_f32 v[182:183], v[182:183], 1.0 op_sel_hi:[1,0]
    v_rcp_f32 v180, v180
    v_rcp_f32 v181, v181
    v_rcp_f32 v182, v182
    v_rcp_f32 v183, v183
    v_pk_mul_f32 v[68:69], v[68:69], v[180:181]
    buffer_load_dwordx4 a[52:55], v6, s[4:7], s56 offen offset:1024
    v_pk_mul_f32 v[70:71], v[70:71], v[182:183]
    v_pk_fma_f32 v[84:85], v[128:129], v[56:57], v[84:85] op_sel_hi:[1,0,1]
    v_pk_fma_f32 v[86:87], v[130:131], v[56:57], v[86:87] op_sel_hi:[1,0,1]
    v_pk_mul_f32 v[84:85], v[84:85], v[56:57] op_sel:[0,1]
    v_pk_mul_f32 v[86:87], v[86:87], v[56:57] op_sel:[0,1]
    v_pk_mul_f32 v[184:185], v[84:85], v[84:85]
    v_pk_mul_f32 v[186:187], v[86:87], v[86:87]
    v_pk_fma_f32 v[184:185], v[184:185], s[52:53], s[52:53] op_sel:[0,0,1] op_sel_hi:[1,0,1]
    v_pk_fma_f32 v[186:187], v[186:187], s[52:53], s[52:53] op_sel:[0,0,1] op_sel_hi:[1,0,1]
    v_pk_mul_f32 v[184:185], v[184:185], v[84:85]
    v_pk_mul_f32 v[186:187], v[186:187], v[86:87]
    v_exp_f32 v184, v184
    v_exp_f32 v185, v185
    buffer_load_dwordx4 a[56:59], v6, s[4:7], s56 offen offset:2048
    v_exp_f32 v186, v186
    v_exp_f32 v187, v187
    v_pk_add_f32 v[184:185], v[184:185], 1.0 op_sel_hi:[1,0]
    v_pk_add_f32 v[186:187], v[186:187], 1.0 op_sel_hi:[1,0]
    v_rcp_f32 v184, v184
    v_rcp_f32 v185, v185
    v_rcp_f32 v186, v186
    v_rcp_f32 v187, v187
    buffer_load_dwordx4 a[60:63], v6, s[4:7], s56 offen offset:3072
    v_pk_mul_f32 v[84:85], v[84:85], v[184:185]
    v_pk_mul_f32 v[86:87], v[86:87], v[186:187]
    v_pk_add_f32 v[148:149], v[68:69], v[70:71]
    v_pk_mul_f32 v[150:151], v[68:69], v[68:69]
    v_pk_add_f32 v[148:149], v[148:149], v[84:85]
    v_pk_fma_f32 v[150:151], v[70:71], v[70:71], v[150:151]
    v_pk_add_f32 v[148:149], v[148:149], v[86:87]
    v_pk_fma_f32 v[150:151], v[84:85], v[84:85], v[150:151]
    v_pk_fma_f32 v[150:151], v[86:87], v[86:87], v[150:151]
    v_add_f32 v148, v148, v149
    v_add_f32 v149, v150, v151
    v_pk_fma_f32 v[72:73], v[124:125], v[58:59], v[72:73] op_sel_hi:[1,0,1]
    v_pk_fma_f32 v[74:75], v[126:127], v[58:59], v[74:75] op_sel_hi:[1,0,1]
    s_xor_b32 s56, s30, 0x4000
    buffer_load_dwordx4 a[64:67], v6, s[4:7], s56 offen offset:0
    v_pk_mul_f32 v[72:73], v[72:73], v[58:59] op_sel:[0,1]
    v_pk_mul_f32 v[74:75], v[74:75], v[58:59] op_sel:[0,1]
    v_pk_mul_f32 v[180:181], v[72:73], v[72:73]
    v_pk_mul_f32 v[182:183], v[74:75], v[74:75]
    v_pk_fma_f32 v[180:181], v[180:181], s[52:53], s[52:53] op_sel:[0,0,1] op_sel_hi:[1,0,1]
    v_pk_fma_f32 v[182:183], v[182:183], s[52:53], s[52:53] op_sel:[0,0,1] op_sel_hi:[1,0,1]
    v_pk_mul_f32 v[180:181], v[180:181], v[72:73]
    v_pk_mul_f32 v[182:183], v[182:183], v[74:75]
    v_exp_f32 v180, v180
    v_exp_f32 v181, v181
    v_exp_f32 v182, v182
    buffer_load_dwordx4 a[68:71], v6, s[4:7], s56 offen offset:1024
    v_exp_f32 v183, v183
    v_pk_add_f32 v[180:181], v[180:181], 1.0 op_sel_hi:[1,0]
    v_pk_add_f32 v[182:183], v[182:183], 1.0 op_sel_hi:[1,0]
    v_rcp_f32 v180, v180
    v_rcp_f32 v181, v181
    v_rcp_f32 v182, v182
    v_rcp_f32 v183, v183
    v_pk_mul_f32 v[72:73], v[72:73], v[180:181]
    v_pk_mul_f32 v[74:75], v[74:75], v[182:183]
    buffer_load_dwordx4 a[72:75], v6, s[4:7], s56 offen offset:2048
    v_pk_fma_f32 v[88:89], v[128:129], v[58:59], v[88:89] op_sel_hi:[1,0,1]
    v_pk_fma_f32 v[90:91], v[130:131], v[58:59], v[90:91] op_sel_hi:[1,0,1]
    v_pk_mul_f32 v[88:89], v[88:89], v[58:59] op_sel:[0,1]
    v_pk_mul_f32 v[90:91], v[90:91], v[58:59] op_sel:[0,1]
    v_pk_mul_f32 v[184:185], v[88:89], v[88:89]
    v_pk_mul_f32 v[186:187], v[90:91], v[90:91]
    v_pk_fma_f32 v[184:185], v[184:185], s[52:53], s[52:53] op_sel:[0,0,1] op_sel_hi:[1,0,1]
    v_pk_fma_f32 v[186:187], v[186:187], s[52:53], s[52:53] op_sel:[0,0,1] op_sel_hi:[1,0,1]
    v_pk_mul_f32 v[184:185], v[184:185], v[88:89]
    v_pk_mul_f32 v[186:187], v[186:187], v[90:91]
    v_exp_f32 v184, v184
    v_exp_f32 v185, v185
    buffer_load_dwordx4 a[76:79], v6, s[4:7], s56 offen offset:3072
    v_exp_f32 v186, v186
    v_exp_f32 v187, v187
    v_pk_add_f32 v[184:185], v[184:185], 1.0 op_sel_hi:[1,0]
    v_pk_add_f32 v[186:187], v[186:187], 1.0 op_sel_hi:[1,0]
    v_rcp_f32 v184, v184
    v_rcp_f32 v185, v185
    v_rcp_f32 v186, v186
    v_rcp_f32 v187, v187
    s_xor_b32 s56, s30, 0x5000
    buffer_load_dwordx4 a[80:83], v6, s[4:7], s56 offen offset:0
    v_pk_mul_f32 v[88:89], v[88:89], v[184:185]
    v_pk_mul_f32 v[90:91], v[90:91], v[186:187]
    v_pk_add_f32 v[152:153], v[72:73], v[74:75]
    v_pk_mul_f32 v[154:155], v[72:73], v[72:73]
    v_pk_add_f32 v[152:153], v[152:153], v[88:89]
    v_pk_fma_f32 v[154:155], v[74:75], v[74:75], v[154:155]
    v_pk_add_f32 v[152:153], v[152:153], v[90:91]
    v_pk_fma_f32 v[154:155], v[88:89], v[88:89], v[154:155]
    v_pk_fma_f32 v[154:155], v[90:91], v[90:91], v[154:155]
    v_add_f32 v152, v152, v153
    v_add_f32 v153, v154, v155
    v_permlane32_swap_b32 v140, v148
    v_permlane32_swap_b32 v144, v152
    v_permlane32_swap_b32 v141, v149
    v_permlane32_swap_b32 v145, v153
    v_pk_add_f32 v[140:141], v[140:141], v[148:149]
    v_pk_add_f32 v[144:145], v[144:145], v[152:153]
    s_nop 1
    v_permlane16_swap_b32 v140, v144
    v_permlane16_swap_b32 v141, v145
    v_pk_add_f32 v[140:141], v[140:141], v[144:145]
    s_mul_i32 s48, s22, 4608
    v_add_u32 v142, 138240, v9
    v_add_u32 v143, s48, v142
    ds_write_b64 v143, v[140:141]
    s_add_u32 s48, s48, 138240
    v_add_u32 v189, s48, v1
    s_add_u32 s48, s46, 0x730000
    s_cmp_eq_u32 s22, 0
    s_cselect_b32 s48, s48, 0x7f000000
    s_waitcnt lgkmcnt(0)
    s_barrier
    ds_read_b64 v[172:173], v142 offset:0
    ds_read_b64 v[174:175], v142 offset:4608
    ds_read_b64 v[176:177], v142 offset:9216
    ds_read_b64 v[178:179], v142 offset:13824
    s_waitcnt lgkmcnt(2)
    v_pk_add_f32 v[172:173], v[172:173], v[174:175]
    s_waitcnt lgkmcnt(0)
    v_pk_add_f32 v[176:177], v[176:177], v[178:179]
    v_pk_add_f32 v[190:191], v[172:173], v[176:177]
    buffer_store_dwordx2 v[190:191], v9, s[4:7], s48 offen offset:0 sc1
    ds_read_b128 v[140:143], v1 offset:0
    ds_read_b128 v[144:147], v1 offset:1024
    ds_read_b128 v[148:151], v1 offset:2048
    ds_read_b128 v[152:155], v1 offset:3072
    s_waitcnt lgkmcnt(3)
    v_mfma_f32_16x16x32_bf16 v[92:95], a[160:163], v[140:143], 0
    buffer_load_dwordx4 a[84:87], v6, s[4:7], s56 offen offset:1024
    ds_read_b128 v[156:159], v1 offset:4096
    v_mfma_f32_16x16x32_bf16 v[108:111], a[164:167], v[140:143], 0
    s_waitcnt lgkmcnt(3)
    v_mfma_f32_16x16x32_bf16 v[96:99], a[160:163], v[144:147], 0
    ds_read_b128 v[160:163], v1 offset:5120
    v_mfma_f32_16x16x32_bf16 v[112:115], a[164:167], v[144:147], 0
    s_waitcnt lgkmcnt(3)
    v_mfma_f32_16x16x32_bf16 v[100:103], a[160:163], v[148:151], 0
    ds_read_b128 v[164:167], v1 offset:6144
    v_mfma_f32_16x16x32_bf16 v[116:119], a[164:167], v[148:151], 0
    buffer_load_dwordx4 a[88:91], v6, s[4:7], s56 offen offset:2048
    s_waitcnt lgkmcnt(3)
    v_mfma_f32_16x16x32_bf16 v[104:107], a[160:163], v[152:155], 0
    ds_read_b128 v[168:171], v1 offset:7168
    v_mfma_f32_16x16x32_bf16 v[120:123], a[164:167], v[152:155], 0
    v_mfma_f32_16x16x32_bf16 v[132:135], a[160:163], v[36:39], 0
    v_mfma_f32_16x16x32_bf16 v[136:139], a[164:167], v[36:39], 0
    s_waitcnt lgkmcnt(3)
    v_mfma_f32_16x16x32_bf16 v[92:95], a[168:171], v[156:159], v[92:95]
    buffer_load_dwordx4 a[92:95], v6, s[4:7], s56 offen offset:3072
    ds_read_b64 v[140:141], v9 offset:8192
    ds_read_b64 v[142:143], v9 offset:8704
    v_mfma_f32_16x16x32_bf16 v[108:111], a[172:175], v[156:159], v[108:111]
    s_waitcnt lgkmcnt(4)
    v_mfma_f32_16x16x32_bf16 v[96:99], a[168:171], v[160:163], v[96:99]
    ds_read_b64 v[144:145], v9 offset:9216
    ds_read_b64 v[146:147], v9 offset:9728
    v_mfma_f32_16x16x32_bf16 v[112:115], a[172:175], v[160:163], v[112:115]
    s_waitcnt lgkmcnt(5)
    v_mfma_f32_16x16x32_bf16 v[100:103], a[168:171], v[164:167], v[100:103]
    s_xor_b32 s56, s30, 0x6000
    buffer_load_dwordx4 a[96:99], v6, s[4:7], s56 offen offset:0
    ds_read_b64 v[148:149], v9 offset:10240
    ds_read_b64 v[150:151], v9 offset:10752
    v_mfma_f32_16x16x32_bf16 v[116:119], a[172:175], v[164:167], v[116:119]
    s_waitcnt lgkmcnt(6)
    v_mfma_f32_16x16x32_bf16 v[104:107], a[168:171], v[168:171], v[104:107]
    ds_read_b64 v[152:153], v9 offset:11264
    ds_read_b64 v[154:155], v9 offset:11776
    v_mfma_f32_16x16x32_bf16 v[120:123], a[172:175], v[168:171], v[120:123]
    v_mfma_f32_16x16x32_bf16 v[132:135], a[168:171], v[36:39], v[132:135]
    v_mfma_f32_16x16x32_bf16 v[136:139], a[172:175], v[36:39], v[136:139]
    buffer_load_dwordx4 a[100:103], v6, s[4:7], s56 offen offset:1024
    s_waitcnt lgkmcnt(6)
    v_mfma_f32_16x16x32_bf16 v[92:95], a[176:179], v[140:143], v[92:95]
    ds_read_b128 v[156:159], v1 offset:12288
    v_mfma_f32_16x16x32_bf16 v[108:111], a[180:183], v[140:143], v[108:111]
    s_waitcnt lgkmcnt(5)
    v_mfma_f32_16x16x32_bf16 v[96:99], a[176:179], v[144:147], v[96:99]
    ds_read_b128 v[160:163], v1 offset:13312
    v_mfma_f32_16x16x32_bf16 v[112:115], a[180:183], v[144:147], v[112:115]
    s_waitcnt lgkmcnt(4)
    v_mfma_f32_16x16x32_bf16 v[100:103], a[176:179], v[148:151], v[100:103]
    buffer_load_dwordx4 a[104:107], v6, s[4:7], s56 offen offset:2048
    ds_read_b128 v[164:167], v1 offset:14336
    v_mfma_f32_16x16x32_bf16 v[116:119], a[180:183], v[148:151], v[116:119]
    s_waitcnt lgkmcnt(3)
    v_mfma_f32_16x16x32_bf16 v[104:107], a[176:179], v[152:155], v[104:107]
    ds_read_b128 v[168:171], v1 offset:15360
    v_mfma_f32_16x16x32_bf16 v[120:123], a[180:183], v[152:155], v[120:123]
    v_mfma_f32_16x16x32_bf16 v[132:135], a[176:179], v[36:39], v[132:135]
    v_mfma_f32_16x16x32_bf16 v[136:139], a[180:183], v[36:39], v[136:139]
    buffer_load_dwordx4 a[108:111], v6, s[4:7], s56 offen offset:3072
    s_waitcnt lgkmcnt(3)
    v_mfma_f32_16x16x32_bf16 v[92:95], a[184:187], v[156:159], v[92:95]
    ds_read_b128 v[140:143], v1 offset:16384
    v_mfma_f32_16x16x32_bf16 v[108:111], a[188:191], v[156:159], v[108:111]
    s_waitcnt lgkmcnt(3)
    v_mfma_f32_16x16x32_bf16 v[96:99], a[184:187], v[160:163], v[96:99]
    ds_read_b128 v[144:147], v1 offset:17408
    v_mfma_f32_16x16x32_bf16 v[112:115], a[188:191], v[160:163], v[112:115]
    s_waitcnt lgkmcnt(3)
    v_mfma_f32_16x16x32_bf16 v[100:103], a[184:187], v[164:167], v[100:103]
    s_xor_b32 s56, s30, 0x7000
    buffer_load_dwordx4 a[112:115], v6, s[4:7], s56 offen offset:0
    ds_read_b128 v[148:151], v1 offset:18432
    v_mfma_f32_16x16x32_bf16 v[116:119], a[188:191], v[164:167], v[116:119]
    s_waitcnt lgkmcnt(3)
    v_mfma_f32_16x16x32_bf16 v[104:107], a[184:187], v[168:171], v[104:107]
    ds_read_b128 v[152:155], v1 offset:19456
    v_mfma_f32_16x16x32_bf16 v[120:123], a[188:191], v[168:171], v[120:123]
    v_mfma_f32_16x16x32_bf16 v[132:135], a[184:187], v[36:39], v[132:135]
    v_mfma_f32_16x16x32_bf16 v[136:139], a[188:191], v[36:39], v[136:139]
    buffer_load_dwordx4 a[116:119], v6, s[4:7], s56 offen offset:1024
    s_waitcnt lgkmcnt(3)
    v_mfma_f32_16x16x32_bf16 v[92:95], a[192:195], v[140:143], v[92:95]
    ds_read_b128 v[156:159], v1 offset:20480
    v_mfma_f32_16x16x32_bf16 v[108:111], a[196:199], v[140:143], v[108:111]
    s_waitcnt lgkmcnt(3)
    v_mfma_f32_16x16x32_bf16 v[96:99], a[192:195], v[144:147], v[96:99]
    ds_read_b128 v[160:163], v1 offset:21504
    v_mfma_f32_16x16x32_bf16 v[112:115], a[196:199], v[144:147], v[112:115]
    s_waitcnt lgkmcnt(3)
    v_mfma_f32_16x16x32_bf16 v[100:103], a[192:195], v[148:151], v[100:103]
    buffer_load_dwordx4 a[120:123], v6, s[4:7], s56 offen offset:2048
    ds_read_b128 v[164:167], v1 offset:22528
    v_mfma_f32_16x16x32_bf16 v[116:119], a[196:199], v[148:151], v[116:119]
    s_waitcnt lgkmcnt(3)
    v_mfma_f32_16x16x32_bf16 v[104:107], a[192:195], v[152:155], v[104:107]
    ds_read_b128 v[168:171], v1 offset:23552
    v_mfma_f32_16x16x32_bf16 v[120:123], a[196:199], v[152:155], v[120:123]
    v_mfma_f32_16x16x32_bf16 v[132:135], a[192:195], v[36:39], v[132:135]
    v_mfma_f32_16x16x32_bf16 v[136:139], a[196:199], v[36:39], v[136:139]
    buffer_load_dwordx4 a[124:127], v6, s[4:7], s56 offen offset:3072
    s_waitcnt lgkmcnt(3)
    v_mfma_f32_16x16x32_bf16 v[92:95], a[200:203], v[156:159], v[92:95]
    ds_read_b128 v[140:143], v1 offset:24576
    v_mfma_f32_16x16x32_bf16 v[108:111], a[204:207], v[156:159], v[108:111]
    s_waitcnt lgkmcnt(3)
    v_mfma_f32_16x16x32_bf16 v[96:99], a[200:203], v[160:163], v[96:99]
    ds_read_b128 v[144:147], v1 offset:25600
    v_mfma_f32_16x16x32_bf16 v[112:115], a[204:207], v[160:163], v[112:115]
    s_waitcnt lgkmcnt(3)
    v_mfma_f32_16x16x32_bf16 v[100:103], a[200:203], v[164:167], v[100:103]
    s_xor_b32 s56, s30, 0x8000
    buffer_load_dwordx4 a[128:131], v6, s[4:7], s56 offen offset:0
    ds_read_b128 v[148:151], v1 offset:26624
    v_mfma_f32_16x16x32_bf16 v[116:119], a[204:207], v[164:167], v[116:119]
    s_waitcnt lgkmcnt(3)
    v_mfma_f32_16x16x32_bf16 v[104:107], a[200:203], v[168:171], v[104:107]
    ds_read_b128 v[152:155], v1 offset:27648
    v_mfma_f32_16x16x32_bf16 v[120:123], a[204:207], v[168:171], v[120:123]
    v_mfma_f32_16x16x32_bf16 v[132:135], a[200:203], v[36:39], v[132:135]
    v_mfma_f32_16x16x32_bf16 v[136:139], a[204:207], v[36:39], v[136:139]
    buffer_load_dwordx4 a[132:135], v6, s[4:7], s56 offen offset:1024
    s_waitcnt lgkmcnt(3)
    v_mfma_f32_16x16x32_bf16 v[92:95], a[208:211], v[140:143], v[92:95]
    ds_read_b64 v[156:157], v9 offset:28672
    ds_read_b64 v[158:159], v9 offset:29184
    v_mfma_f32_16x16x32_bf16 v[108:111], a[212:215], v[140:143], v[108:111]
    s_waitcnt lgkmcnt(4)
    v_mfma_f32_16x16x32_bf16 v[96:99], a[208:211], v[144:147], v[96:99]
    ds_read_b64 v[160:161], v9 offset:29696
    ds_read_b64 v[162:163], v9 offset:30208
    v_mfma_f32_16x16x32_bf16 v[112:115], a[212:215], v[144:147], v[112:115]
    s_waitcnt lgkmcnt(5)
    v_mfma_f32_16x16x32_bf16 v[100:103], a[208:211], v[148:151], v[100:103]
    buffer_load_dwordx4 a[136:139], v6, s[4:7], s56 offen offset:2048
    ds_read_b64 v[164:165], v9 offset:30720
    ds_read_b64 v[166:167], v9 offset:31232
    v_mfma_f32_16x16x32_bf16 v[116:119], a[212:215], v[148:151], v[116:119]
    s_waitcnt lgkmcnt(6)
    v_mfma_f32_16x16x32_bf16 v[104:107], a[208:211], v[152:155], v[104:107]
    ds_read_b64 v[168:169], v9 offset:31744
    ds_read_b64 v[170:171], v9 offset:32256
    v_mfma_f32_16x16x32_bf16 v[120:123], a[212:215], v[152:155], v[120:123]
    v_mfma_f32_16x16x32_bf16 v[132:135], a[208:211], v[36:39], v[132:135]
    buffer_load_dwordx4 a[140:143], v6, s[4:7], s56 offen offset:3072
    v_mfma_f32_16x16x32_bf16 v[136:139], a[212:215], v[36:39], v[136:139]
    s_waitcnt lgkmcnt(6)
    v_mfma_f32_16x16x32_bf16 v[92:95], a[216:219], v[156:159], v[92:95]
    ds_read_b128 v[140:143], v1 offset:32768
    v_mfma_f32_16x16x32_bf16 v[108:111], a[220:223], v[156:159], v[108:111]
    s_waitcnt lgkmcnt(5)
    v_mfma_f32_16x16x32_bf16 v[96:99], a[216:219], v[160:163], v[96:99]
    ds_read_b128 v[144:147], v1 offset:33792
    v_mfma_f32_16x16x32_bf16 v[112:115], a[220:223], v[160:163], v[112:115]
    s_xor_b32 s56, s30, 0x9000
    buffer_load_dwordx4 a[144:147], v6, s[4:7], s56 offen offset:0
    s_waitcnt lgkmcnt(4)
    v_mfma_f32_16x16x32_bf16 v[100:103], a[216:219], v[164:167], v[100:103]
    ds_read_b128 v[148:151], v1 offset:34816
    v_mfma_f32_16x16x32_bf16 v[116:119], a[220:223], v[164:167], v[116:119]
    s_waitcnt lgkmcnt(3)
    v_mfma_f32_16x16x32_bf16 v[104:107], a[216:219], v[168:171], v[104:107]
    ds_read_b128 v[152:155], v1 offset:35840
    v_mfma_f32_16x16x32_bf16 v[120:123], a[220:223], v[168:171], v[120:123]
    v_mfma_f32_16x16x32_bf16 v[132:135], a[216:219], v[36:39], v[132:135]
    buffer_load_dwordx4 a[148:151], v6, s[4:7], s56 offen offset:1024
    v_mfma_f32_16x16x32_bf16 v[136:139], a[220:223], v[36:39], v[136:139]
    s_waitcnt lgkmcnt(3)
    v_mfma_f32_16x16x32_bf16 v[92:95], a[224:227], v[140:143], v[92:95]
    ds_read_b128 v[156:159], v1 offset:36864
    v_mfma_f32_16x16x32_bf16 v[108:111], a[228:231], v[140:143], v[108:111]
    s_waitcnt lgkmcnt(3)
    v_mfma_f32_16x16x32_bf16 v[96:99], a[224:227], v[144:147], v[96:99]
    ds_read_b128 v[160:163], v1 offset:37888
    v_mfma_f32_16x16x32_bf16 v[112:115], a[228:231], v[144:147], v[112:115]
    s_waitcnt lgkmcnt(3)
    v_mfma_f32_16x16x32_bf16 v[100:103], a[224:227], v[148:151], v[100:103]
    ds_read_b128 v[164:167], v1 offset:38912
    v_mfma_f32_16x16x32_bf16 v[116:119], a[228:231], v[148:151], v[116:119]
    s_waitcnt lgkmcnt(3)
    v_mfma_f32_16x16x32_bf16 v[104:107], a[224:227], v[152:155], v[104:107]
    ds_read_b128 v[168:171], v1 offset:39936
    v_mfma_f32_16x16x32_bf16 v[120:123], a[228:231], v[152:155], v[120:123]
    v_mfma_f32_16x16x32_bf16 v[132:135], a[224:227], v[36:39], v[132:135]
    v_mfma_f32_16x16x32_bf16 v[136:139], a[228:231], v[36:39], v[136:139]
    s_waitcnt lgkmcnt(3)
    v_mfma_f32_16x16x32_bf16 v[92:95], a[232:235], v[156:159], v[92:95]
    ds_read_b128 v[140:143], v1 offset:40960
    v_mfma_f32_16x16x32_bf16 v[108:111], a[236:239], v[156:159], v[108:111]
    s_add_u32 s48, s44, 0x730000
    buffer_load_dwordx2 v[172:173], v9, s[4:7], s48 offen offset:0 sc1
    s_waitcnt lgkmcnt(3)
    v_mfma_f32_16x16x32_bf16 v[96:99], a[232:235], v[160:163], v[96:99]
    ds_read_b128 v[144:147], v1 offset:41984
    v_mfma_f32_16x16x32_bf16 v[112:115], a[236:239], v[160:163], v[112:115]
    buffer_load_dwordx2 v[174:175], v9, s[4:7], s48 offen offset:512 sc1
    buffer_load_dwordx2 v[176:177], v9, s[4:7], s48 offen offset:1024 sc1
    s_waitcnt lgkmcnt(3)
    v_mfma_f32_16x16x32_bf16 v[100:103], a[232:235], v[164:167], v[100:103]
    ds_read_b128 v[148:151], v1 offset:43008
    v_mfma_f32_16x16x32_bf16 v[116:119], a[236:239], v[164:167], v[116:119]
    buffer_load_dwordx2 v[178:179], v9, s[4:7], s48 offen offset:1536 sc1
    buffer_load_dwordx2 v[180:181], v9, s[4:7], s48 offen offset:2048 sc1
    s_waitcnt lgkmcnt(3)
    v_mfma_f32_16x16x32_bf16 v[104:107], a[232:235], v[168:171], v[104:107]
    ds_read_b128 v[152:155], v1 offset:44032
    v_mfma_f32_16x16x32_bf16 v[120:123], a[236:239], v[168:171], v[120:123]
    buffer_load_dwordx2 v[182:183], v9, s[4:7], s48 offen offset:2560 sc1
    buffer_load_dwordx2 v[184:185], v9, s[4:7], s48 offen offset:3072 sc1
    v_mfma_f32_16x16x32_bf16 v[132:135], a[232:235], v[36:39], v[132:135]
    buffer_load_dwordx2 v[186:187], v9, s[4:7], s48 offen offset:3584 sc1
    v_mfma_f32_16x16x32_bf16 v[136:139], a[236:239], v[36:39], v[136:139]
    s_waitcnt lgkmcnt(3)
    v_mfma_f32_16x16x32_bf16 v[92:95], a[240:243], v[140:143], v[92:95]
    v_mfma_f32_16x16x32_bf16 v[108:111], a[244:247], v[140:143], v[108:111]
    s_waitcnt lgkmcnt(2)
    v_mfma_f32_16x16x32_bf16 v[96:99], a[240:243], v[144:147], v[96:99]
    v_mfma_f32_16x16x32_bf16 v[112:115], a[244:247], v[144:147], v[112:115]
    s_waitcnt lgkmcnt(1)
    v_mfma_f32_16x16x32_bf16 v[100:103], a[240:243], v[148:151], v[100:103]
    v_mfma_f32_16x16x32_bf16 v[116:119], a[244:247], v[148:151], v[116:119]
    s_waitcnt lgkmcnt(0)
    v_mfma_f32_16x16x32_bf16 v[104:107], a[240:243], v[152:155], v[104:107]
    v_mfma_f32_16x16x32_bf16 v[120:123], a[244:247], v[152:155], v[120:123]
    v_mfma_f32_16x16x32_bf16 v[132:135], a[240:243], v[36:39], v[132:135]
    v_mfma_f32_16x16x32_bf16 v[136:139], a[244:247], v[36:39], v[136:139]
    s_mov_b32 s51, 0x20000
    s_nop 6
SPOLL_10:
    s_waitcnt vmcnt(0)
    v_min3_f32 v140, v173, v175, v177
    v_min3_f32 v141, v179, v181, v183
    v_min3_f32 v140, v140, v185, v187
    v_min_f32 v140, v140, v141
    v_cmp_gt_f32 vcc, 0, v140
    s_cbranch_vccz SPOLLD_11
    s_add_u32 s48, s44, 0x730000
    buffer_load_dwordx2 v[172:173], v9, s[4:7], s48 offen offset:0 sc1
    buffer_load_dwordx2 v[174:175], v9, s[4:7], s48 offen offset:512 sc1
    buffer_load_dwordx2 v[176:177], v9, s[4:7], s48 offen offset:1024 sc1
    buffer_load_dwordx2 v[178:179], v9, s[4:7], s48 offen offset:1536 sc1
    buffer_load_dwordx2 v[180:181], v9, s[4:7], s48 offen offset:2048 sc1
    buffer_load_dwordx2 v[182:183], v9, s[4:7], s48 offen offset:2560 sc1
    buffer_load_dwordx2 v[184:185], v9, s[4:7], s48 offen offset:3072 sc1
    buffer_load_dwordx2 v[186:187], v9, s[4:7], s48 offen offset:3584 sc1
    s_sub_u32 s51, s51, 1
    s_cbranch_scc0 SPOLL_10
    s_waitcnt vmcnt(0)
SPOLLD_11:
    buffer_load_dwordx4 a[152:155], v6, s[4:7], s56 offen offset:2048
    buffer_load_dwordx4 a[156:159], v6, s[4:7], s56 offen offset:3072
    s_xor_b32 s56, s30, 0xa000
    buffer_load_dwordx4 a[160:163], v6, s[4:7], s56 offen offset:0
    buffer_load_dwordx4 a[164:167], v6, s[4:7], s56 offen offset:1024
    v_pk_add_f32 v[172:173], v[172:173], v[180:181]
    v_pk_add_f32 v[174:175], v[174:175], v[182:183]
    v_pk_add_f32 v[176:177], v[176:177], v[184:185]
    v_pk_add_f32 v[178:179], v[178:179], v[186:187]
    v_pk_add_f32 v[172:173], v[172:173], v[176:177]
    v_pk_add_f32 v[174:175], v[174:175], v[178:179]
    v_pk_add_f32 v[172:173], v[172:173], v[174:175]
    v_mul_f32 v172, 0xba97b426, v172
    v_mul_f32 v173, 0x3a97b426, v173
    v_fma_f32 v173, -v172, v172, v173
    v_max_f32 v173, 0, v173
    v_add_f32 v173, 0x3727c5ac, v173
    v_rsq_f32 v173, v173
    s_nop 0
    v_mul_f32 v172, v172, v173
    ds_bpermute_b32 v156, v28, v172 offset:0
    ds_bpermute_b32 v157, v28, v173 offset:0
    ds_bpermute_b32 v158, v28, v172 offset:64
    ds_bpermute_b32 v159, v28, v173 offset:64
    ds_bpermute_b32 v160, v28, v172 offset:128
    ds_bpermute_b32 v161, v28, v173 offset:128
    ds_bpermute_b32 v162, v28, v172 offset:192
    ds_bpermute_b32 v163, v28, v173 offset:192
    s_add_u32 s48, s36, 0x1600000
    s_add_u32 s49, s37, 0x1600000
    s_waitcnt lgkmcnt(6)
    v_pk_fma_f32 v[60:61], v[60:61], v[156:157], v[156:157] op_sel:[0,1,0] op_sel_hi:[1,1,0]
    v_pk_fma_f32 v[62:63], v[62:63], v[156:157], v[156:157] op_sel:[0,1,0] op_sel_hi:[1,1,0]
    v_cvt_pk_bf16_f32 v60, v60, v61
    v_cvt_pk_bf16_f32 v61, v62, v63
    ds_write_b64 v33, v[60:61] offset:0
    v_pk_fma_f32 v[76:77], v[76:77], v[156:157], v[156:157] op_sel:[0,1,0] op_sel_hi:[1,1,0]
    v_pk_fma_f32 v[78:79], v[78:79], v[156:157], v[156:157] op_sel:[0,1,0] op_sel_hi:[1,1,0]
    v_cvt_pk_bf16_f32 v76, v76, v77
    v_cvt_pk_bf16_f32 v77, v78, v79
    ds_write_b64 v33, v[76:77] offset:32
    s_waitcnt lgkmcnt(6)
    v_pk_fma_f32 v[64:65], v[64:65], v[158:159], v[158:159] op_sel:[0,1,0] op_sel_hi:[1,1,0]
    v_pk_fma_f32 v[66:67], v[66:67], v[158:159], v[158:159] op_sel:[0,1,0] op_sel_hi:[1,1,0]
    v_cvt_pk_bf16_f32 v64, v64, v65
    v_cvt_pk_bf16_f32 v65, v66, v67
    ds_write_b64 v33, v[64:65] offset:72
    v_pk_fma_f32 v[80:81], v[80:81], v[158:159], v[158:159] op_sel:[0,1,0] op_sel_hi:[1,1,0]
    v_pk_fma_f32 v[82:83], v[82:83], v[158:159], v[158:159] op_sel:[0,1,0] op_sel_hi:[1,1,0]
    v_cvt_pk_bf16_f32 v80, v80, v81
    v_cvt_pk_bf16_f32 v81, v82, v83
    ds_write_b64 v33, v[80:81] offset:104
    ds_read_b64_tr_b16 v[172:173], v34 offset:0
    ds_read_b64_tr_b16 v[174:175], v34 offset:288
    ds_read_b64_tr_b16 v[176:177], v34 offset:32
    ds_read_b64_tr_b16 v[178:179], v34 offset:320
    s_waitcnt lgkmcnt(10)
    v_pk_fma_f32 v[68:69], v[68:69], v[160:161], v[160:161] op_sel:[0,1,0] op_sel_hi:[1,1,0]
    v_pk_fma_f32 v[70:71], v[70:71], v[160:161], v[160:161] op_sel:[0,1,0] op_sel_hi:[1,1,0]
    v_cvt_pk_bf16_f32 v68, v68, v69
    v_cvt_pk_bf16_f32 v69, v70, v71
    ds_write_b64 v33, v[68:69] offset:2304
    v_pk_fma_f32 v[84:85], v[84:85], v[160:161], v[160:161] op_sel:[0,1,0] op_sel_hi:[1,1,0]
    v_pk_fma_f32 v[86:87], v[86:87], v[160:161], v[160:161] op_sel:[0,1,0] op_sel_hi:[1,1,0]
    v_cvt_pk_bf16_f32 v84, v84, v85
    v_cvt_pk_bf16_f32 v85, v86, v87
    ds_write_b64 v33, v[84:85] offset:2336
    s_waitcnt lgkmcnt(10)
    v_pk_fma_f32 v[72:73], v[72:73], v[162:163], v[162:163] op_sel:[0,1,0] op_sel_hi:[1,1,0]
    v_pk_fma_f32 v[74:75], v[74:75], v[162:163], v[162:163] op_sel:[0,1,0] op_sel_hi:[1,1,0]
    v_cvt_pk_bf16_f32 v72, v72, v73
    v_cvt_pk_bf16_f32 v73, v74, v75
    ds_write_b64 v33, v[72:73] offset:2376
    v_pk_fma_f32 v[88:89], v[88:89], v[162:163], v[162:163] op_sel:[0,1,0] op_sel_hi:[1,1,0]
    v_pk_fma_f32 v[90:91], v[90:91], v[162:163], v[162:163] op_sel:[0,1,0] op_sel_hi:[1,1,0]
    v_cvt_pk_bf16_f32 v88, v88, v89
    v_cvt_pk_bf16_f32 v89, v90, v91
    ds_write_b64 v33, v[88:89] offset:2408
    ds_read_b64_tr_b16 v[180:181], v34 offset:2304
    ds_read_b64_tr_b16 v[182:183], v34 offset:2592
    ds_read_b64_tr_b16 v[184:185], v34 offset:2336
    ds_read_b64_tr_b16 v[186:187], v34 offset:2624
    s_waitcnt lgkmcnt(10)
    buffer_store_dwordx4 v[172:175], v1, s[4:7], s48 offen offset:0 sc1
    s_waitcnt lgkmcnt(8)
    buffer_store_dwordx4 v[176:179], v1, s[4:7], s49 offen offset:0 sc1
    s_waitcnt lgkmcnt(2)
    buffer_store_dwordx4 v[180:183], v1, s[4:7], s48 offen offset:1024 sc1
    s_waitcnt lgkmcnt(0)
    buffer_store_dwordx4 v[184:187], v1, s[4:7], s49 offen offset:1024 sc1
    ds_read_b128 v[156:159], v1 offset:45056
    ds_read_b128 v[160:163], v1 offset:46080
    ds_read_b128 v[164:167], v1 offset:47104
    ds_read_b128 v[168:171], v1 offset:48128
    s_waitcnt lgkmcnt(3)
    v_mfma_f32_16x16x32_bf16 v[92:95], a[248:251], v[156:159], v[92:95]
    ds_read_b64 v[140:141], v9 offset:49152
    ds_read_b64 v[142:143], v9 offset:49664
    v_mfma_f32_16x16x32_bf16 v[108:111], a[252:255], v[156:159], v[108:111]
    s_waitcnt lgkmcnt(4)
    v_mfma_f32_16x16x32_bf16 v[96:99], a[248:251], v[160:163], v[96:99]
    ds_read_b64 v[144:145], v9 offset:50176
    ds_read_b64 v[146:147], v9 offset:50688
    v_mfma_f32_16x16x32_bf16 v[112:115], a[252:255], v[160:163], v[112:115]
    s_waitcnt lgkmcnt(5)
    v_mfma_f32_16x16x32_bf16 v[100:103], a[248:251], v[164:167], v[100:103]
    ds_read_b64 v[148:149], v8 offset:0
    ds_read_b64 v[150:151], v8 offset:512
    v_mfma_f32_16x16x32_bf16 v[116:119], a[252:255], v[164:167], v[116:119]
    s_waitcnt lgkmcnt(6)
    v_mfma_f32_16x16x32_bf16 v[104:107], a[248:251], v[168:171], v[104:107]
    ds_read_b64 v[152:153], v8 offset:1024
    ds_read_b64 v[154:155], v8 offset:1536
    v_mfma_f32_16x16x32_bf16 v[120:123], a[252:255], v[168:171], v[120:123]
    v_mfma_f32_16x16x32_bf16 v[132:135], a[248:251], v[36:39], v[132:135]
    v_mfma_f32_16x16x32_bf16 v[136:139], a[252:255], v[36:39], v[136:139]
    buffer_load_dwordx4 a[168:171], v6, s[4:7], s56 offen offset:2048
    s_waitcnt lgkmcnt(6)
    v_mfma_f32_16x16x32_bf16 v[92:95], v[192:195], v[140:143], v[92:95]
    ds_read_b128 v[156:159], v2 offset:2048
    v_mfma_f32_16x16x32_bf16 v[108:111], v[196:199], v[140:143], v[108:111]
    s_waitcnt lgkmcnt(5)
    v_mfma_f32_16x16x32_bf16 v[96:99], v[192:195], v[144:147], v[96:99]
    ds_read_b128 v[160:163], v2 offset:3072
    v_mfma_f32_16x16x32_bf16 v[112:115], v[196:199], v[144:147], v[112:115]
    s_waitcnt lgkmcnt(4)
    v_mfma_f32_16x16x32_bf16 v[100:103], v[192:195], v[148:151], v[100:103]
    buffer_load_dwordx4 a[172:175], v6, s[4:7], s56 offen offset:3072
    ds_read_b128 v[164:167], v2 offset:4096
    v_mfma_f32_16x16x32_bf16 v[116:119], v[196:199], v[148:151], v[116:119]
    s_waitcnt lgkmcnt(3)
    v_mfma_f32_16x16x32_bf16 v[104:107], v[192:195], v[152:155], v[104:107]
    ds_read_b128 v[168:171], v2 offset:5120
    v_mfma_f32_16x16x32_bf16 v[120:123], v[196:199], v[152:155], v[120:123]
    v_mfma_f32_16x16x32_bf16 v[132:135], v[192:195], v[36:39], v[132:135]
    v_mfma_f32_16x16x32_bf16 v[136:139], v[196:199], v[36:39], v[136:139]
    s_xor_b32 s56, s30, 0xb000
    buffer_load_dwordx4 a[176:179], v6, s[4:7], s56 offen offset:0
    s_waitcnt lgkmcnt(3)
    v_mfma_f32_16x16x32_bf16 v[92:95], v[200:203], v[156:159], v[92:95]
    v_mfma_f32_16x16x32_bf16 v[108:111], v[204:207], v[156:159], v[108:111]
    s_waitcnt lgkmcnt(2)
    v_mfma_f32_16x16x32_bf16 v[96:99], v[200:203], v[160:163], v[96:99]
    v_mfma_f32_16x16x32_bf16 v[112:115], v[204:207], v[160:163], v[112:115]
    s_waitcnt lgkmcnt(1)
    v_mfma_f32_16x16x32_bf16 v[100:103], v[200:203], v[164:167], v[100:103]
    buffer_load_dwordx4 a[180:183], v6, s[4:7], s56 offen offset:1024
    v_mfma_f32_16x16x32_bf16 v[116:119], v[204:207], v[164:167], v[116:119]
    s_waitcnt lgkmcnt(0)
    v_mfma_f32_16x16x32_bf16 v[104:107], v[200:203], v[168:171], v[104:107]
    v_mfma_f32_16x16x32_bf16 v[120:123], v[204:207], v[168:171], v[120:123]
    v_mfma_f32_16x16x32_bf16 v[132:135], v[200:203], v[36:39], v[132:135]
    v_mfma_f32_16x16x32_bf16 v[136:139], v[204:207], v[36:39], v[136:139]
    buffer_load_dwordx4 a[184:187], v6, s[4:7], s56 offen offset:2048
    s_sub_u32 s58, s60, 10
    v_mov_b32 v26, s58
    s_mov_b64 exec, 1
    s_waitcnt vmcnt(5)
    buffer_store_dwordx2 v[26:27], off, s[4:7], s43 sc1
    s_mov_b64 exec, -1
    ds_read_b128 v[140:143], v2 offset:6144
    ds_read_b128 v[144:147], v2 offset:7168
    ds_read_b128 v[148:151], v2 offset:8192
    ds_read_b128 v[152:155], v2 offset:9216
    s_waitcnt lgkmcnt(3)
    v_mfma_f32_16x16x32_bf16 v[92:95], v[208:211], v[140:143], v[92:95]
    buffer_load_dwordx4 a[188:191], v6, s[4:7], s56 offen offset:3072
    ds_read_b128 v[156:159], v2 offset:10240
    v_mfma_f32_16x16x32_bf16 v[108:111], v[212:215], v[140:143], v[108:111]
    s_waitcnt lgkmcnt(3)
    v_mfma_f32_16x16x32_bf16 v[96:99], v[208:211], v[144:147], v[96:99]
    ds_read_b128 v[160:163], v2 offset:11264
    v_mfma_f32_16x16x32_bf16 v[112:115], v[212:215], v[144:147], v[112:115]
    s_waitcnt lgkmcnt(3)
    v_mfma_f32_16x16x32_bf16 v[100:103], v[208:211], v[148:151], v[100:103]
    ds_read_b128 v[164:167], v2 offset:12288
    v_mfma_f32_16x16x32_bf16 v[116:119], v[212:215], v[148:151], v[116:119]
    s_xor_b32 s56, s30, 0xc000
    buffer_load_dwordx4 a[192:195], v6, s[4:7], s56 offen offset:0
    s_waitcnt lgkmcnt(3)
    v_mfma_f32_16x16x32_bf16 v[104:107], v[208:211], v[152:155], v[104:107]
    ds_read_b128 v[168:171], v2 offset:13312
    v_mfma_f32_16x16x32_bf16 v[120:123], v[212:215], v[152:155], v[120:123]
    v_mfma_f32_16x16x32_bf16 v[132:135], v[208:211], v[36:39], v[132:135]
    v_mfma_f32_16x16x32_bf16 v[136:139], v[212:215], v[36:39], v[136:139]
    s_waitcnt lgkmcnt(3)
    v_mfma_f32_16x16x32_bf16 v[92:95], v[216:219], v[156:159], v[92:95]
    buffer_load_dwordx4 a[196:199], v6, s[4:7], s56 offen offset:1024
    ds_read_b128 v[140:143], v2 offset:14336
    v_mfma_f32_16x16x32_bf16 v[108:111], v[220:223], v[156:159], v[108:111]
    s_waitcnt lgkmcnt(3)
    v_mfma_f32_16x16x32_bf16 v[96:99], v[216:219], v[160:163], v[96:99]
    ds_read_b128 v[144:147], v2 offset:15360
    v_mfma_f32_16x16x32_bf16 v[112:115], v[220:223], v[160:163], v[112:115]
    s_waitcnt lgkmcnt(3)
    v_mfma_f32_16x16x32_bf16 v[100:103], v[216:219], v[164:167], v[100:103]
    ds_read_b128 v[148:151], v2 offset:16384
    v_mfma_f32_16x16x32_bf16 v[116:119], v[220:223], v[164:167], v[116:119]
    buffer_load_dwordx4 a[200:203], v6, s[4:7], s56 offen offset:2048
    s_waitcnt lgkmcnt(3)
    v_mfma_f32_16x16x32_bf16 v[104:107], v[216:219], v[168:171], v[104:107]
    ds_read_b128 v[152:155], v2 offset:17408
    v_mfma_f32_16x16x32_bf16 v[120:123], v[220:223], v[168:171], v[120:123]
    v_mfma_f32_16x16x32_bf16 v[132:135], v[216:219], v[36:39], v[132:135]
    v_mfma_f32_16x16x32_bf16 v[136:139], v[220:223], v[36:39], v[136:139]
    s_waitcnt lgkmcnt(3)
    v_mfma_f32_16x16x32_bf16 v[92:95], v[224:227], v[140:143], v[92:95]
    buffer_load_dwordx4 a[204:207], v6, s[4:7], s56 offen offset:3072
    ds_read_b64 v[156:157], v8 offset:18432
    ds_read_b64 v[158:159], v8 offset:18944
    v_mfma_f32_16x16x32_bf16 v[108:111], v[228:231], v[140:143], v[108:111]
    s_waitcnt lgkmcnt(4)
    v_mfma_f32_16x16x32_bf16 v[96:99], v[224:227], v[144:147], v[96:99]
    ds_read_b64 v[160:161], v8 offset:19456
    ds_read_b64 v[162:163], v8 offset:19968
    v_mfma_f32_16x16x32_bf16 v[112:115], v[228:231], v[144:147], v[112:115]
    s_waitcnt lgkmcnt(5)
    v_mfma_f32_16x16x32_bf16 v[100:103], v[224:227], v[148:151], v[100:103]
    s_xor_b32 s56, s30, 0xd000
    buffer_load_dwordx4 a[208:211], v6, s[4:7], s56 offen offset:0
    ds_read_b64 v[164:165], v8 offset:20480
    ds_read_b64 v[166:167], v8 offset:20992
    v_mfma_f32_16x16x32_bf16 v[116:119], v[228:231], v[148:151], v[116:119]
    s_waitcnt lgkmcnt(6)
    v_mfma_f32_16x16x32_bf16 v[104:107], v[224:227], v[152:155], v[104:107]
    ds_read_b64 v[168:169], v8 offset:21504
    ds_read_b64 v[170:171], v8 offset:22016
    v_mfma_f32_16x16x32_bf16 v[120:123], v[228:231], v[152:155], v[120:123]
    v_mfma_f32_16x16x32_bf16 v[132:135], v[224:227], v[36:39], v[132:135]
    v_mfma_f32_16x16x32_bf16 v[136:139], v[228:231], v[36:39], v[136:139]
    buffer_load_dwordx4 a[212:215], v6, s[4:7], s56 offen offset:1024
    s_waitcnt lgkmcnt(6)
    v_mfma_f32_16x16x32_bf16 v[92:95], v[232:235], v[156:159], v[92:95]
    ds_read_b128 v[140:143], v2 offset:22528
    v_mfma_f32_16x16x32_bf16 v[108:111], v[236:239], v[156:159], v[108:111]
    s_waitcnt lgkmcnt(5)
    v_mfma_f32_16x16x32_bf16 v[96:99], v[232:235], v[160:163], v[96:99]
    ds_read_b128 v[144:147], v2 offset:23552
    v_mfma_f32_16x16x32_bf16 v[112:115], v[236:239], v[160:163], v[112:115]
    s_waitcnt lgkmcnt(4)
    v_mfma_f32_16x16x32_bf16 v[100:103], v[232:235], v[164:167], v[100:103]
    buffer_load_dwordx4 a[216:219], v6, s[4:7], s56 offen offset:2048
    ds_read_b128 v[148:151], v2 offset:24576
    v_mfma_f32_16x16x32_bf16 v[116:119], v[236:239], v[164:167], v[116:119]
    s_waitcnt lgkmcnt(3)
    v_mfma_f32_16x16x32_bf16 v[104:107], v[232:235], v[168:171], v[104:107]
    ds_read_b128 v[152:155], v2 offset:25600
    v_mfma_f32_16x16x32_bf16 v[120:123], v[236:239], v[168:171], v[120:123]
    v_mfma_f32_16x16x32_bf16 v[132:135], v[232:235], v[36:39], v[132:135]
    v_mfma_f32_16x16x32_bf16 v[136:139], v[236:239], v[36:39], v[136:139]
    buffer_load_dwordx4 a[220:223], v6, s[4:7], s56 offen offset:3072
    s_waitcnt lgkmcnt(3)
    v_mfma_f32_16x16x32_bf16 v[92:95], v[240:243], v[140:143], v[92:95]
    ds_read_b128 v[156:159], v2 offset:26624
    v_mfma_f32_16x16x32_bf16 v[108:111], v[244:247], v[140:143], v[108:111]
    s_waitcnt lgkmcnt(3)
    v_mfma_f32_16x16x32_bf16 v[96:99], v[240:243], v[144:147], v[96:99]
    ds_read_b128 v[160:163], v2 offset:27648
    v_mfma_f32_16x16x32_bf16 v[112:115], v[244:247], v[144:147], v[112:115]
    s_waitcnt lgkmcnt(3)
    v_mfma_f32_16x16x32_bf16 v[100:103], v[240:243], v[148:151], v[100:103]
    s_xor_b32 s56, s30, 0xe000
    buffer_load_dwordx4 a[224:227], v6, s[4:7], s56 offen offset:0
    ds_read_b128 v[164:167], v2 offset:28672
    v_mfma_f32_16x16x32_bf16 v[116:119], v[244:247], v[148:151], v[116:119]
    s_waitcnt lgkmcnt(3)
    v_mfma_f32_16x16x32_bf16 v[104:107], v[240:243], v[152:155], v[104:107]
    ds_read_b128 v[168:171], v2 offset:29696
    v_mfma_f32_16x16x32_bf16 v[120:123], v[244:247], v[152:155], v[120:123]
    v_mfma_f32_16x16x32_bf16 v[132:135], v[240:243], v[36:39], v[132:135]
    v_mfma_f32_16x16x32_bf16 v[136:139], v[244:247], v[36:39], v[136:139]
    buffer_load_dwordx4 a[228:231], v6, s[4:7], s56 offen offset:1024
    s_waitcnt lgkmcnt(3)
    v_mfma_f32_16x16x32_bf16 v[92:95], v[248:251], v[156:159], v[92:95]
    v_mfma_f32_16x16x32_bf16 v[108:111], v[252:255], v[156:159], v[108:111]
    s_waitcnt lgkmcnt(2)
    v_mfma_f32_16x16x32_bf16 v[96:99], v[248:251], v[160:163], v[96:99]
    v_mfma_f32_16x16x32_bf16 v[112:115], v[252:255], v[160:163], v[112:115]
    s_waitcnt lgkmcnt(1)
    v_mfma_f32_16x16x32_bf16 v[100:103], v[248:251], v[164:167], v[100:103]
    buffer_load_dwordx4 a[232:235], v6, s[4:7], s56 offen offset:2048
    v_mfma_f32_16x16x32_bf16 v[116:119], v[252:255], v[164:167], v[116:119]
    s_waitcnt lgkmcnt(0)
    v_mfma_f32_16x16x32_bf16 v[104:107], v[248:251], v[168:171], v[104:107]
    v_mfma_f32_16x16x32_bf16 v[120:123], v[252:255], v[168:171], v[120:123]
    v_mfma_f32_16x16x32_bf16 v[132:135], v[248:251], v[36:39], v[132:135]
    v_mfma_f32_16x16x32_bf16 v[136:139], v[252:255], v[36:39], v[136:139]
    buffer_load_dwordx4 a[236:239], v6, s[4:7], s56 offen offset:3072
    s_barrier
    ds_write_b128 v188, v[124:127] offset:0
    ds_write_b128 v188, v[128:131] offset:64
    s_nop 2
    ds_write_b128 v188, v[132:135] offset:128
    s_xor_b32 s56, s30, 0xf000
    buffer_load_dwordx4 a[240:243], v6, s[4:7], s56 offen offset:0
    ds_write_b128 v188, v[136:139] offset:192
    v_lshlrev_b32 v24, 16, v24
    v_mov_b32 v124, v189
    v_pk_fma_f32 v[92:93], v[132:133], v[52:53], v[92:93] op_sel_hi:[1,0,1]
    v_pk_fma_f32 v[94:95], v[134:135], v[52:53], v[94:95] op_sel_hi:[1,0,1]
    v_pk_mul_f32 v[92:93], v[92:93], v[52:53] op_sel:[0,1]
    v_pk_mul_f32 v[94:95], v[94:95], v[52:53] op_sel:[0,1]
    buffer_load_dwordx4 a[244:247], v6, s[4:7], s56 offen offset:1024
    v_pk_mul_f32 v[140:141], v[92:93], v[92:93]
    v_pk_mul_f32 v[142:143], v[94:95], v[94:95]
    v_pk_fma_f32 v[140:141], v[140:141], s[52:53], s[52:53] op_sel:[0,0,1] op_sel_hi:[1,0,1]
    v_pk_fma_f32 v[142:143], v[142:143], s[52:53], s[52:53] op_sel:[0,0,1] op_sel_hi:[1,0,1]
    v_pk_mul_f32 v[140:141], v[140:141], v[92:93]
    v_pk_mul_f32 v[142:143], v[142:143], v[94:95]
    v_exp_f32 v140, v140
    v_exp_f32 v141, v141
    v_exp_f32 v142, v142
    v_exp_f32 v143, v143
    v_pk_add_f32 v[140:141], v[140:141], 1.0 op_sel_hi:[1,0]
    buffer_load_dwordx4 a[248:251], v6, s[4:7], s56 offen offset:2048
    v_pk_add_f32 v[142:143], v[142:143], 1.0 op_sel_hi:[1,0]
    v_rcp_f32 v140, v140
    v_rcp_f32 v141, v141
    v_rcp_f32 v142, v142
    v_rcp_f32 v143, v143
    v_pk_mul_f32 v[92:93], v[92:93], v[140:141]
    v_pk_mul_f32 v[94:95], v[94:95], v[142:143]
    v_cvt_pk_bf16_f32 v44, v92, v93
    v_cvt_pk_bf16_f32 v45, v94, v95
    v_pk_fma_f32 v[108:109], v[136:137], v[52:53], v[108:109] op_sel_hi:[1,0,1]
    buffer_load_dwordx4 a[252:255], v6, s[4:7], s56 offen offset:3072
    v_pk_fma_f32 v[110:111], v[138:139], v[52:53], v[110:111] op_sel_hi:[1,0,1]
    v_pk_mul_f32 v[108:109], v[108:109], v[52:53] op_sel:[0,1]
    v_pk_mul_f32 v[110:111], v[110:111], v[52:53] op_sel:[0,1]
    v_pk_mul_f32 v[144:145], v[108:109], v[108:109]
    v_pk_mul_f32 v[146:147], v[110:111], v[110:111]
    v_pk_fma_f32 v[144:145], v[144:145], s[52:53], s[52:53] op_sel:[0,0,1] op_sel_hi:[1,0,1]
    v_pk_fma_f32 v[146:147], v[146:147], s[52:53], s[52:53] op_sel:[0,0,1] op_sel_hi:[1,0,1]
    v_pk_mul_f32 v[144:145], v[144:145], v[108:109]
    v_pk_mul_f32 v[146:147], v[146:147], v[110:111]
    v_exp_f32 v144, v144
    v_exp_f32 v145, v145
    v_exp_f32 v146, v146
    s_mul_i32 s57, s22, 12288
    s_add_u32 s56, s29, 0x5d5000
    s_add_u32 s56, s56, s57
    s_add_u32 m0, s57, 0x8000
    s_nop 0
    buffer_load_dwordx4 v1, s[4:7], s56 offen offset:0 lds
    v_exp_f32 v147, v147
    v_pk_add_f32 v[144:145], v[144:145], 1.0 op_sel_hi:[1,0]
    v_pk_add_f32 v[146:147], v[146:147], 1.0 op_sel_hi:[1,0]
    v_rcp_f32 v144, v144
    v_rcp_f32 v145, v145
    v_rcp_f32 v146, v146
    v_rcp_f32 v147, v147
    v_pk_mul_f32 v[108:109], v[108:109], v[144:145]
    s_add_u32 m0, s57, 0x8000
    s_nop 0
    buffer_load_dwordx4 v1, s[4:7], s56 offen offset:1024 lds
    v_pk_mul_f32 v[110:111], v[110:111], v[146:147]
    v_cvt_pk_bf16_f32 v46, v108, v109
    v_cvt_pk_bf16_f32 v47, v110, v111
    ds_write_b128 v124, v[44:47] offset:0
    v_pk_fma_f32 v[96:97], v[132:133], v[54:55], v[96:97] op_sel_hi:[1,0,1]
    v_pk_fma_f32 v[98:99], v[134:135], v[54:55], v[98:99] op_sel_hi:[1,0,1]
    v_pk_mul_f32 v[96:97], v[96:97], v[54:55] op_sel:[0,1]
    v_pk_mul_f32 v[98:99], v[98:99], v[54:55] op_sel:[0,1]
    s_add_u32 m0, s57, 0x8000
    s_nop 0
    buffer_load_dwordx4 v1, s[4:7], s56 offen offset:2048 lds
    v_pk_mul_f32 v[140:141], v[96:97], v[96:97]
    v_pk_mul_f32 v[142:143], v[98:99], v[98:99]
    v_pk_fma_f32 v[140:141], v[140:141], s[52:53], s[52:53] op_sel:[0,0,1] op_sel_hi:[1,0,1]
    v_pk_fma_f32 v[142:143], v[142:143], s[52:53], s[52:53] op_sel:[0,0,1] op_sel_hi:[1,0,1]
    v_pk_mul_f32 v[140:141], v[140:141], v[96:97]
    v_pk_mul_f32 v[142:143], v[142:143], v[98:99]
    v_exp_f32 v140, v140
    v_exp_f32 v141, v141
    v_exp_f32 v142, v142
    v_exp_f32 v143, v143
    s_add_u32 m0, s57, 0x8000
    s_nop 0
    buffer_load_dwordx4 v1, s[4:7], s56 offen offset:3072 lds
    v_pk_add_f32 v[140:141], v[140:141], 1.0 op_sel_hi:[1,0]
    v_pk_add_f32 v[142:143], v[142:143], 1.0 op_sel_hi:[1,0]
    v_rcp_f32 v140, v140
    v_rcp_f32 v141, v141
    v_rcp_f32 v142, v142
    v_rcp_f32 v143, v143
    v_pk_mul_f32 v[96:97], v[96:97], v[140:141]
    v_pk_mul_f32 v[98:99], v[98:99], v[142:143]
    v_cvt_pk_bf16_f32 v48, v96, v97
    s_add_u32 s56, s29, 0x5d6000
    s_add_u32 s56, s56, s57
    s_add_u32 m0, s57, 0x9000
    s_nop 0
    buffer_load_dwordx4 v1, s[4:7], s56 offen offset:0 lds
    v_cvt_pk_bf16_f32 v49, v98, v99
    v_pk_fma_f32 v[112:113], v[136:137], v[54:55], v[112:113] op_sel_hi:[1,0,1]
    v_pk_fma_f32 v[114:115], v[138:139], v[54:55], v[114:115] op_sel_hi:[1,0,1]
    v_pk_mul_f32 v[112:113], v[112:113], v[54:55] op_sel:[0,1]
    v_pk_mul_f32 v[114:115], v[114:115], v[54:55] op_sel:[0,1]
    v_pk_mul_f32 v[144:145], v[112:113], v[112:113]
    v_pk_mul_f32 v[146:147], v[114:115], v[114:115]
    v_pk_fma_f32 v[144:145], v[144:145], s[52:53], s[52:53] op_sel:[0,0,1] op_sel_hi:[1,0,1]
    v_pk_fma_f32 v[146:147], v[146:147], s[52:53], s[52:53] op_sel:[0,0,1] op_sel_hi:[1,0,1]
    v_pk_mul_f32 v[144:145], v[144:145], v[112:113]
    v_pk_mul_f32 v[146:147], v[146:147], v[114:115]
    v_exp_f32 v144, v144
    s_add_u32 m0, s57, 0x9000
    s_nop 0
    buffer_load_dwordx4 v1, s[4:7], s56 offen offset:1024 lds
    v_exp_f32 v145, v145
    v_exp_f32 v146, v146
    v_exp_f32 v147, v147
    v_pk_add_f32 v[144:145], v[144:145], 1.0 op_sel_hi:[1,0]
    v_pk_add_f32 v[146:147], v[146:147], 1.0 op_sel_hi:[1,0]
    v_rcp_f32 v144, v144
    v_rcp_f32 v145, v145
    v_rcp_f32 v146, v146
    s_add_u32 m0, s57, 0x9000
    s_nop 0
    buffer_load_dwordx4 v1, s[4:7], s56 offen offset:2048 lds
    v_rcp_f32 v147, v147
    v_pk_mul_f32 v[112:113], v[112:113], v[144:145]
    v_pk_mul_f32 v[114:115], v[114:115], v[146:147]
    v_cvt_pk_bf16_f32 v50, v112, v113
    v_cvt_pk_bf16_f32 v51, v114, v115
    ds_write_b128 v124, v[48:51] offset:1024
    v_pk_fma_f32 v[100:101], v[132:133], v[56:57], v[100:101] op_sel_hi:[1,0,1]
    s_add_u32 m0, s57, 0x9000
    s_nop 0
    buffer_load_dwordx4 v1, s[4:7], s56 offen offset:3072 lds
    v_pk_fma_f32 v[102:103], v[134:135], v[56:57], v[102:103] op_sel_hi:[1,0,1]
    v_pk_mul_f32 v[100:101], v[100:101], v[56:57] op_sel:[0,1]
    v_pk_mul_f32 v[102:103], v[102:103], v[56:57] op_sel:[0,1]
    v_pk_mul_f32 v[140:141], v[100:101], v[100:101]
    v_pk_mul_f32 v[142:143], v[102:103], v[102:103]
    v_pk_fma_f32 v[140:141], v[140:141], s[52:53], s[52:53] op_sel:[0,0,1] op_sel_hi:[1,0,1]
    v_pk_fma_f32 v[142:143], v[142:143], s[52:53], s[52:53] op_sel:[0,0,1] op_sel_hi:[1,0,1]
    v_pk_mul_f32 v[140:141], v[140:141], v[100:101]
    v_pk_mul_f32 v[142:143], v[142:143], v[102:103]
    v_exp_f32 v140, v140
    v_exp_f32 v141, v141
    s_add_u32 s56, s29, 0x5d7000
    s_add_u32 s56, s56, s57
    s_add_u32 m0, s57, 0xa000
    s_nop 0
    buffer_load_dwordx4 v1, s[4:7], s56 offen offset:0 lds
    v_exp_f32 v142, v142
    v_exp_f32 v143, v143
    v_pk_add_f32 v[140:141], v[140:141], 1.0 op_sel_hi:[1,0]
    v_pk_add_f32 v[142:143], v[142:143], 1.0 op_sel_hi:[1,0]
    v_rcp_f32 v140, v140
    v_rcp_f32 v141, v141
    v_rcp_f32 v142, v142
    v_rcp_f32 v143, v143
    s_add_u32 m0, s57, 0xa000
    s_nop 0
    buffer_load_dwordx4 v1, s[4:7], s56 offen offset:1024 lds
    v_pk_mul_f32 v[100:101], v[100:101], v[140:141]
    v_pk_mul_f32 v[102:103], v[102:103], v[142:143]
    v_cvt_pk_bf16_f32 v52, v100, v101
    v_cvt_pk_bf16_f32 v53, v102, v103
    v_lshrrev_b32 v42, 2, v7
    v_and_b32 v43, 3, v0
    v_lshlrev_b32 v42, 12, v42
    v_lshl_add_u32 v42, v43, 10, v42
    s_lshl_b32 s48, s22, 15
    s_lshl_b32 s49, s21, 7
    s_add_u32 s48, s48, s49
    s_add_u32 s48, s48, 0x702000
    v_add_u32 v42, s48, v42
    buffer_load_dwordx2 v[40:41], v42, s[4:7], 0 offen sc1
    s_mov_b32 s51, 0x20000
    s_add_u32 m0, s57, 0xa000
    s_nop 0
    buffer_load_dwordx4 v1, s[4:7], s56 offen offset:2048 lds
    s_add_u32 m0, s57, 0xa000
    s_nop 0
    buffer_load_dwordx4 v1, s[4:7], s56 offen offset:3072 lds
    s_waitcnt vmcnt(2)
    v_cmp_gt_u64 vcc, s[58:59], v[40:41]
    v_cmp_lt_u64 s[48:49], s[60:61], v[40:41]
    s_nop 0
    s_or_b64 vcc, vcc, s[48:49]
    s_cbranch_scc0 POLLD_13
    s_nop 1
POLL_12:
    buffer_load_dwordx2 v[40:41], v42, s[4:7], 0 offen sc1
    s_sub_u32 s51, s51, 1
    s_cbranch_scc1 POLLD_13X
    s_waitcnt vmcnt(0)
    v_cmp_gt_u64 vcc, s[58:59], v[40:41]
    v_cmp_lt_u64 s[48:49], s[60:61], v[40:41]
    s_nop 0
    s_or_b64 vcc, vcc, s[48:49]
    s_cbranch_scc1 POLL_12
POLLD_13X:
    s_waitcnt vmcnt(0)
POLLD_13:
    s_xor_b32 s48, s38, 0x0
    s_add_u32 s48, s48, 0x1600000
    buffer_load_dwordx4 v[148:151], v1, s[4:7], s48 offen offset:0 sc1
    buffer_load_dwordx4 v[152:155], v1, s[4:7], s48 offen offset:1024 sc1
    buffer_load_dwordx4 v[156:159], v1, s[4:7], s48 offen offset:2048 sc1
    buffer_load_dwordx4 v[160:163], v1, s[4:7], s48 offen offset:3072 sc1
    s_xor_b32 s48, s38, 0x1000
    s_add_u32 s48, s48, 0x1600000
    buffer_load_dwordx4 v[164:167], v1, s[4:7], s48 offen offset:0 sc1
    buffer_load_dwordx4 v[168:171], v1, s[4:7], s48 offen offset:1024 sc1
    v_pk_fma_f32 v[116:117], v[136:137], v[56:57], v[116:117] op_sel_hi:[1,0,1]
    v_pk_fma_f32 v[118:119], v[138:139], v[56:57], v[118:119] op_sel_hi:[1,0,1]
    v_pk_mul_f32 v[116:117], v[116:117], v[56:57] op_sel:[0,1]
    v_pk_mul_f32 v[118:119], v[118:119], v[56:57] op_sel:[0,1]
    v_pk_mul_f32 v[144:145], v[116:117], v[116:117]
    buffer_load_dwordx4 v[172:175], v1, s[4:7], s48 offen offset:2048 sc1
    v_pk_mul_f32 v[146:147], v[118:119], v[118:119]
    v_pk_fma_f32 v[144:145], v[144:145], s[52:53], s[52:53] op_sel:[0,0,1] op_sel_hi:[1,0,1]
    v_pk_fma_f32 v[146:147], v[146:147], s[52:53], s[52:53] op_sel:[0,0,1] op_sel_hi:[1,0,1]
    v_pk_mul_f32 v[144:145], v[144:145], v[116:117]
    v_pk_mul_f32 v[146:147], v[146:147], v[118:119]
    buffer_load_dwordx4 v[176:179], v1, s[4:7], s48 offen offset:3072 sc1
    v_exp_f32 v144, v144
    v_exp_f32 v145, v145
    v_exp_f32 v146, v146
    v_exp_f32 v147, v147
    v_pk_add_f32 v[144:145], v[144:145], 1.0 op_sel_hi:[1,0]
    s_xor_b32 s48, s38, 0x2000
    s_add_u32 s48, s48, 0x1600000
    buffer_load_dwordx4 v[180:183], v1, s[4:7], s48 offen offset:0 sc1
    v_pk_add_f32 v[146:147], v[146:147], 1.0 op_sel_hi:[1,0]
    v_rcp_f32 v144, v144
    v_rcp_f32 v145, v145
    v_rcp_f32 v146, v146
    v_rcp_f32 v147, v147
    buffer_load_dwordx4 v[184:187], v1, s[4:7], s48 offen offset:1024 sc1
    v_pk_mul_f32 v[116:117], v[116:117], v[144:145]
    v_pk_mul_f32 v[118:119], v[118:119], v[146:147]
    v_cvt_pk_bf16_f32 v54, v116, v117
    v_cvt_pk_bf16_f32 v55, v118, v119
    ds_write_b128 v124, v[52:55] offset:2048
    buffer_load_dwordx4 v[188:191], v1, s[4:7], s48 offen offset:2048 sc1
    v_pk_fma_f32 v[104:105], v[132:133], v[58:59], v[104:105] op_sel_hi:[1,0,1]
    v_pk_fma_f32 v[106:107], v[134:135], v[58:59], v[106:107] op_sel_hi:[1,0,1]
    v_pk_mul_f32 v[104:105], v[104:105], v[58:59] op_sel:[0,1]
    v_pk_mul_f32 v[106:107], v[106:107], v[58:59] op_sel:[0,1]
    v_pk_mul_f32 v[140:141], v[104:105], v[104:105]
    buffer_load_dwordx4 v[192:195], v1, s[4:7], s48 offen offset:3072 sc1
    v_pk_mul_f32 v[142:143], v[106:107], v[106:107]
    v_pk_fma_f32 v[140:141], v[140:141], s[52:53], s[52:53] op_sel:[0,0,1] op_sel_hi:[1,0,1]
    v_pk_fma_f32 v[142:143], v[142:143], s[52:53], s[52:53] op_sel:[0,0,1] op_sel_hi:[1,0,1]
    v_pk_mul_f32 v[140:141], v[140:141], v[104:105]
    v_pk_mul_f32 v[142:143], v[142:143], v[106:107]
    s_xor_b32 s48, s38, 0x3000
    s_add_u32 s48, s48, 0x1600000
    buffer_load_dwordx4 v[196:199], v1, s[4:7], s48 offen offset:0 sc1
    v_exp_f32 v140, v140
    v_exp_f32 v141, v141
    v_exp_f32 v142, v142
    v_exp_f32 v143, v143
    v_pk_add_f32 v[140:141], v[140:141], 1.0 op_sel_hi:[1,0]
    buffer_load_dwordx4 v[200:203], v1, s[4:7], s48 offen offset:1024 sc1
    v_pk_add_f32 v[142:143], v[142:143], 1.0 op_sel_hi:[1,0]
    v_rcp_f32 v140, v140
    v_rcp_f32 v141, v141
    v_rcp_f32 v142, v142
    v_rcp_f32 v143, v143
    buffer_load_dwordx4 v[204:207], v1, s[4:7], s48 offen offset:2048 sc1
    v_pk_mul_f32 v[104:105], v[104:105], v[140:141]
    v_pk_mul_f32 v[106:107], v[106:107], v[142:143]
    v_cvt_pk_bf16_f32 v56, v104, v105
    v_cvt_pk_bf16_f32 v57, v106, v107
    v_pk_fma_f32 v[120:121], v[136:137], v[58:59], v[120:121] op_sel_hi:[1,0,1]
    buffer_load_dwordx4 v[208:211], v1, s[4:7], s48 offen offset:3072 sc1
    v_pk_fma_f32 v[122:123], v[138:139], v[58:59], v[122:123] op_sel_hi:[1,0,1]
    v_pk_mul_f32 v[120:121], v[120:121], v[58:59] op_sel:[0,1]
    v_pk_mul_f32 v[122:123], v[122:123], v[58:59] op_sel:[0,1]
    v_pk_mul_f32 v[144:145], v[120:121], v[120:121]
    v_pk_mul_f32 v[146:147], v[122:123], v[122:123]
    s_xor_b32 s48, s38, 0x0
    s_add_u32 s48, s48, 0x1610000
    buffer_load_dwordx4 v[212:215], v1, s[4:7], s48 offen offset:0 sc1
    v_pk_fma_f32 v[144:145], v[144:145], s[52:53], s[52:53] op_sel:[0,0,1] op_sel_hi:[1,0,1]
    v_pk_fma_f32 v[146:147], v[146:147], s[52:53], s[52:53] op_sel:[0,0,1] op_sel_hi:[1,0,1]
    v_pk_mul_f32 v[144:145], v[144:145], v[120:121]
    v_pk_mul_f32 v[146:147], v[146:147], v[122:123]
    v_exp_f32 v144, v144
    buffer_load_dwordx4 v[216:219], v1, s[4:7], s48 offen offset:1024 sc1
    v_exp_f32 v145, v145
    v_exp_f32 v146, v146
    v_exp_f32 v147, v147
    v_pk_add_f32 v[144:145], v[144:145], 1.0 op_sel_hi:[1,0]
    v_pk_add_f32 v[146:147], v[146:147], 1.0 op_sel_hi:[1,0]
    buffer_load_dwordx4 v[220:223], v1, s[4:7], s48 offen offset:2048 sc1
    v_rcp_f32 v144, v144
    v_rcp_f32 v145, v145
    v_rcp_f32 v146, v146
    v_rcp_f32 v147, v147
    v_pk_mul_f32 v[120:121], v[120:121], v[144:145]
    buffer_load_dwordx4 v[224:227], v1, s[4:7], s48 offen offset:3072 sc1
    v_pk_mul_f32 v[122:123], v[122:123], v[146:147]
    v_cvt_pk_bf16_f32 v58, v120, v121
    v_cvt_pk_bf16_f32 v59, v122, v123
    ds_write_b128 v124, v[56:59] offset:3072
    s_lshl_b32 s54, s22, 12
    v_add_u32 v97, s54, v1
    s_lshl_b32 s54, s22, 10
    v_add_u32 v42, s54, v1
    v_add_u32 v43, 138240, v42
    s_add_u32 s52, s39, 0x1d00000
    s_add_u32 s53, s40, 0x1d00000
    s_add_u32 s55, s52, 2048
    s_cmp_eq_u32 s21, 7
    s_cselect_b32 s55, 0x7f000000, s55
    s_lshl_b32 s14, s22, 12
    s_add_u32 s15, s29, s14
    s_waitcnt vmcnt(19)
    v_mfma_f32_16x16x32_bf16 v[44:47], v[148:151], a[0:3], 0
    v_mfma_f32_16x16x32_bf16 v[48:51], v[148:151], a[4:7], 0
    v_mfma_f32_16x16x32_bf16 v[52:55], v[148:151], a[8:11], 0
    v_mfma_f32_16x16x32_bf16 v[56:59], v[148:151], a[12:15], 0
    s_xor_b32 s48, s38, 0x1000
    s_add_u32 s48, s48, 0x1610000
    buffer_load_dwordx4 v[228:231], v1, s[4:7], s48 offen offset:0 sc1
    s_waitcnt vmcnt(19)
    v_mfma_f32_16x16x32_bf16 v[44:47], v[152:155], a[16:19], v[44:47]
    v_mfma_f32_16x16x32_bf16 v[48:51], v[152:155], a[20:23], v[48:51]
    v_mfma_f32_16x16x32_bf16 v[52:55], v[152:155], a[24:27], v[52:55]
    v_mfma_f32_16x16x32_bf16 v[56:59], v[152:155], a[28:31], v[56:59]
    buffer_load_dwordx4 v[232:235], v1, s[4:7], s48 offen offset:1024 sc1
    s_waitcnt vmcnt(19)
    v_mfma_f32_16x16x32_bf16 v[44:47], v[156:159], a[32:35], v[44:47]
    v_mfma_f32_16x16x32_bf16 v[48:51], v[156:159], a[36:39], v[48:51]
    v_mfma_f32_16x16x32_bf16 v[52:55], v[156:159], a[40:43], v[52:55]
    v_mfma_f32_16x16x32_bf16 v[56:59], v[156:159], a[44:47], v[56:59]
    buffer_load_dwordx4 v[236:239], v1, s[4:7], s48 offen offset:2048 sc1
    s_waitcnt vmcnt(19)
    v_mfma_f32_16x16x32_bf16 v[44:47], v[160:163], a[48:51], v[44:47]
    v_mfma_f32_16x16x32_bf16 v[48:51], v[160:163], a[52:55], v[48:51]
    v_mfma_f32_16x16x32_bf16 v[52:55], v[160:163], a[56:59], v[52:55]
    v_mfma_f32_16x16x32_bf16 v[56:59], v[160:163], a[60:63], v[56:59]
    buffer_load_dwordx4 v[240:243], v1, s[4:7], s48 offen offset:3072 sc1
    s_waitcnt vmcnt(19)
    v_mfma_f32_16x16x32_bf16 v[44:47], v[164:167], a[64:67], v[44:47]
    v_mfma_f32_16x16x32_bf16 v[48:51], v[164:167], a[68:71], v[48:51]
    v_mfma_f32_16x16x32_bf16 v[52:55], v[164:167], a[72:75], v[52:55]
    v_mfma_f32_16x16x32_bf16 v[56:59], v[164:167], a[76:79], v[56:59]
    s_xor_b32 s48, s38, 0x2000
    s_add_u32 s48, s48, 0x1610000
    buffer_load_dwordx4 v[244:247], v1, s[4:7], s48 offen offset:0 sc1
    s_waitcnt vmcnt(19)
    v_mfma_f32_16x16x32_bf16 v[44:47], v[168:171], a[80:83], v[44:47]
    v_mfma_f32_16x16x32_bf16 v[48:51], v[168:171], a[84:87], v[48:51]
    v_mfma_f32_16x16x32_bf16 v[52:55], v[168:171], a[88:91], v[52:55]
    v_mfma_f32_16x16x32_bf16 v[56:59], v[168:171], a[92:95], v[56:59]
    buffer_load_dwordx4 v[248:251], v1, s[4:7], s48 offen offset:1024 sc1
    s_waitcnt vmcnt(19)
    v_mfma_f32_16x16x32_bf16 v[44:47], v[172:175], a[96:99], v[44:47]
    v_mfma_f32_16x16x32_bf16 v[48:51], v[172:175], a[100:103], v[48:51]
    v_mfma_f32_16x16x32_bf16 v[52:55], v[172:175], a[104:107], v[52:55]
    v_mfma_f32_16x16x32_bf16 v[56:59], v[172:175], a[108:111], v[56:59]
    buffer_load_dwordx4 v[252:255], v1, s[4:7], s48 offen offset:2048 sc1
    s_waitcnt vmcnt(19)
    v_mfma_f32_16x16x32_bf16 v[44:47], v[176:179], a[112:115], v[44:47]
    v_mfma_f32_16x16x32_bf16 v[48:51], v[176:179], a[116:119], v[48:51]
    v_mfma_f32_16x16x32_bf16 v[52:55], v[176:179], a[120:123], v[52:55]
    v_mfma_f32_16x16x32_bf16 v[56:59], v[176:179], a[124:127], v[56:59]
    buffer_load_dwordx4 v[112:115], v1, s[4:7], s48 offen offset:3072 sc1
    s_waitcnt vmcnt(19)
    v_mfma_f32_16x16x32_bf16 v[44:47], v[180:183], a[128:131], v[44:47]
    v_mfma_f32_16x16x32_bf16 v[48:51], v[180:183], a[132:135], v[48:51]
    v_mfma_f32_16x16x32_bf16 v[52:55], v[180:183], a[136:139], v[52:55]
    v_mfma_f32_16x16x32_bf16 v[56:59], v[180:183], a[140:143], v[56:59]
    s_xor_b32 s48, s38, 0x3000
    s_add_u32 s48, s48, 0x1610000
    buffer_load_dwordx4 v[116:119], v1, s[4:7], s48 offen offset:0 sc1
    s_waitcnt vmcnt(19)
    v_mfma_f32_16x16x32_bf16 v[44:47], v[184:187], a[144:147], v[44:47]
    v_mfma_f32_16x16x32_bf16 v[48:51], v[184:187], a[148:151], v[48:51]
    v_mfma_f32_16x16x32_bf16 v[52:55], v[184:187], a[152:155], v[52:55]
    v_mfma_f32_16x16x32_bf16 v[56:59], v[184:187], a[156:159], v[56:59]
    buffer_load_dwordx4 v[120:123], v1, s[4:7], s48 offen offset:1024 sc1
    s_waitcnt vmcnt(19)
    v_mfma_f32_16x16x32_bf16 v[44:47], v[188:191], a[160:163], v[44:47]
    v_mfma_f32_16x16x32_bf16 v[48:51], v[188:191], a[164:167], v[48:51]
    v_mfma_f32_16x16x32_bf16 v[52:55], v[188:191], a[168:171], v[52:55]
    v_mfma_f32_16x16x32_bf16 v[56:59], v[188:191], a[172:175], v[56:59]
    buffer_load_dwordx4 v[124:127], v1, s[4:7], s48 offen offset:2048 sc1
    s_waitcnt vmcnt(19)
    v_mfma_f32_16x16x32_bf16 v[44:47], v[192:195], a[176:179], v[44:47]
    v_mfma_f32_16x16x32_bf16 v[48:51], v[192:195], a[180:183], v[48:51]
    v_mfma_f32_16x16x32_bf16 v[52:55], v[192:195], a[184:187], v[52:55]
    v_mfma_f32_16x16x32_bf16 v[56:59], v[192:195], a[188:191], v[56:59]
    buffer_load_dwordx4 v[128:131], v1, s[4:7], s48 offen offset:3072 sc1
    s_waitcnt vmcnt(19)
    v_mfma_f32_16x16x32_bf16 v[44:47], v[196:199], a[192:195], v[44:47]
    v_mfma_f32_16x16x32_bf16 v[48:51], v[196:199], a[196:199], v[48:51]
    v_mfma_f32_16x16x32_bf16 v[52:55], v[196:199], a[200:203], v[52:55]
    v_mfma_f32_16x16x32_bf16 v[56:59], v[196:199], a[204:207], v[56:59]
    s_xor_b32 s48, s38, 0x0
    s_add_u32 s48, s48, 0x1620000
    buffer_load_dwordx4 v[132:135], v1, s[4:7], s48 offen offset:0 sc1
    s_waitcnt vmcnt(19)
    v_mfma_f32_16x16x32_bf16 v[44:47], v[200:203], a[208:211], v[44:47]
    v_mfma_f32_16x16x32_bf16 v[48:51], v[200:203], a[212:215], v[48:51]
    v_mfma_f32_16x16x32_bf16 v[52:55], v[200:203], a[216:219], v[52:55]
    v_mfma_f32_16x16x32_bf16 v[56:59], v[200:203], a[220:223], v[56:59]
    buffer_load_dwordx4 v[136:139], v1, s[4:7], s48 offen offset:1024 sc1
    s_waitcnt vmcnt(19)
    v_mfma_f32_16x16x32_bf16 v[44:47], v[204:207], a[224:227], v[44:47]
    v_mfma_f32_16x16x32_bf16 v[48:51], v[204:207], a[228:231], v[48:51]
    v_mfma_f32_16x16x32_bf16 v[52:55], v[204:207], a[232:235], v[52:55]
    v_mfma_f32_16x16x32_bf16 v[56:59], v[204:207], a[236:239], v[56:59]
    buffer_load_dwordx4 v[140:143], v1, s[4:7], s48 offen offset:2048 sc1
    s_waitcnt vmcnt(19)
    v_mfma_f32_16x16x32_bf16 v[44:47], v[208:211], a[240:243], v[44:47]
    v_mfma_f32_16x16x32_bf16 v[48:51], v[208:211], a[244:247], v[48:51]
    v_mfma_f32_16x16x32_bf16 v[52:55], v[208:211], a[248:251], v[52:55]
    v_mfma_f32_16x16x32_bf16 v[56:59], v[208:211], a[252:255], v[56:59]
    buffer_load_dwordx4 v[144:147], v1, s[4:7], s48 offen offset:3072 sc1
    s_waitcnt vmcnt(19)
    v_mfma_f32_16x16x32_bf16 v[60:63], v[212:215], a[0:3], 0
    v_mfma_f32_16x16x32_bf16 v[64:67], v[212:215], a[4:7], 0
    v_mfma_f32_16x16x32_bf16 v[68:71], v[212:215], a[8:11], 0
    v_mfma_f32_16x16x32_bf16 v[72:75], v[212:215], a[12:15], 0
    s_xor_b32 s48, s38, 0x1000
    s_add_u32 s48, s48, 0x1620000
    buffer_load_dwordx4 v[148:151], v1, s[4:7], s48 offen offset:0 sc1
    s_waitcnt vmcnt(19)
    v_mfma_f32_16x16x32_bf16 v[60:63], v[216:219], a[16:19], v[60:63]
    v_mfma_f32_16x16x32_bf16 v[64:67], v[216:219], a[20:23], v[64:67]
    ds_write_b128 v97, v[44:47] offset:0
    v_mfma_f32_16x16x32_bf16 v[68:71], v[216:219], a[24:27], v[68:71]
    v_mfma_f32_16x16x32_bf16 v[72:75], v[216:219], a[28:31], v[72:75]
    buffer_load_dwordx4 v[152:155], v1, s[4:7], s48 offen offset:1024 sc1
    s_waitcnt vmcnt(19)
    v_mfma_f32_16x16x32_bf16 v[60:63], v[220:223], a[32:35], v[60:63]
    v_mfma_f32_16x16x32_bf16 v[64:67], v[220:223], a[36:39], v[64:67]
    ds_write_b128 v97, v[48:51] offset:1024
    v_mfma_f32_16x16x32_bf16 v[68:71], v[220:223], a[40:43], v[68:71]
    v_mfma_f32_16x16x32_bf16 v[72:75], v[220:223], a[44:47], v[72:75]
    buffer_load_dwordx4 v[156:159], v1, s[4:7], s48 offen offset:2048 sc1
    s_waitcnt vmcnt(19)
    v_mfma_f32_16x16x32_bf16 v[60:63], v[224:227], a[48:51], v[60:63]
    v_mfma_f32_16x16x32_bf16 v[64:67], v[224:227], a[52:55], v[64:67]
    ds_write_b128 v97, v[52:55] offset:2048
    v_mfma_f32_16x16x32_bf16 v[68:71], v[224:227], a[56:59], v[68:71]
    v_mfma_f32_16x16x32_bf16 v[72:75], v[224:227], a[60:63], v[72:75]
    buffer_load_dwordx4 v[160:163], v1, s[4:7], s48 offen offset:3072 sc1
    s_waitcnt vmcnt(19)
    v_mfma_f32_16x16x32_bf16 v[60:63], v[228:231], a[64:67], v[60:63]
    v_mfma_f32_16x16x32_bf16 v[64:67], v[228:231], a[68:71], v[64:67]
    ds_write_b128 v97, v[56:59] offset:3072
    v_mfma_f32_16x16x32_bf16 v[68:71], v[228:231], a[72:75], v[68:71]
    v_mfma_f32_16x16x32_bf16 v[72:75], v[228:231], a[76:79], v[72:75]
    s_xor_b32 s48, s38, 0x2000
    s_add_u32 s48, s48, 0x1620000
    buffer_load_dwordx4 v[164:167], v1, s[4:7], s48 offen offset:0 sc1
    s_waitcnt vmcnt(19)
    v_mfma_f32_16x16x32_bf16 v[60:63], v[232:235], a[80:83], v[60:63]
    v_mfma_f32_16x16x32_bf16 v[64:67], v[232:235], a[84:87], v[64:67]
    v_mfma_f32_16x16x32_bf16 v[68:71], v[232:235], a[88:91], v[68:71]
    v_mfma_f32_16x16x32_bf16 v[72:75], v[232:235], a[92:95], v[72:75]
    buffer_load_dwordx4 v[168:171], v1, s[4:7], s48 offen offset:1024 sc1
    s_waitcnt lgkmcnt(0)
    s_barrier
    s_waitcnt vmcnt(19)
    v_mfma_f32_16x16x32_bf16 v[60:63], v[236:239], a[96:99], v[60:63]
    ds_read_b128 v[92:95], v43 offset:0
    ds_read_b128 v[76:79], v42 offset:0
    v_mfma_f32_16x16x32_bf16 v[64:67], v[236:239], a[100:103], v[64:67]
    ds_read_b128 v[80:83], v42 offset:4096
    v_mfma_f32_16x16x32_bf16 v[68:71], v[236:239], a[104:107], v[68:71]
    ds_read_b128 v[84:87], v42 offset:8192
    ds_read_b128 v[88:91], v42 offset:12288
    v_mfma_f32_16x16x32_bf16 v[72:75], v[236:239], a[108:111], v[72:75]
    buffer_load_dwordx4 v[172:175], v1, s[4:7], s48 offen offset:2048 sc1
    s_waitcnt vmcnt(19)
    v_mfma_f32_16x16x32_bf16 v[60:63], v[240:243], a[112:115], v[60:63]
    v_mfma_f32_16x16x32_bf16 v[64:67], v[240:243], a[116:119], v[64:67]
    v_mfma_f32_16x16x32_bf16 v[68:71], v[240:243], a[120:123], v[68:71]
    v_mfma_f32_16x16x32_bf16 v[72:75], v[240:243], a[124:127], v[72:75]
    buffer_load_dwordx4 v[176:179], v1, s[4:7], s48 offen offset:3072 sc1
    s_waitcnt vmcnt(19)
    v_mfma_f32_16x16x32_bf16 v[60:63], v[244:247], a[128:131], v[60:63]
    v_mfma_f32_16x16x32_bf16 v[64:67], v[244:247], a[132:135], v[64:67]
    v_mfma_f32_16x16x32_bf16 v[68:71], v[244:247], a[136:139], v[68:71]
    v_mfma_f32_16x16x32_bf16 v[72:75], v[244:247], a[140:143], v[72:75]
    s_xor_b32 s48, s38, 0x3000
    s_add_u32 s48, s48, 0x1620000
    buffer_load_dwordx4 v[180:183], v1, s[4:7], s48 offen offset:0 sc1
    s_waitcnt vmcnt(19)
    v_mfma_f32_16x16x32_bf16 v[60:63], v[248:251], a[144:147], v[60:63]
    s_waitcnt lgkmcnt(4)
    v_lshlrev_b32 v100, 16, v92
    v_and_b32 v101, 0xffff0000, v92
    v_mfma_f32_16x16x32_bf16 v[64:67], v[248:251], a[148:151], v[64:67]
    v_lshlrev_b32 v102, 16, v93
    v_mfma_f32_16x16x32_bf16 v[68:71], v[248:251], a[152:155], v[68:71]
    v_and_b32 v103, 0xffff0000, v93
    s_waitcnt lgkmcnt(3)
    v_add_f32 v76, v76, v24
    v_mfma_f32_16x16x32_bf16 v[72:75], v[248:251], a[156:159], v[72:75]
    buffer_load_dwordx4 v[184:187], v1, s[4:7], s48 offen offset:1024 sc1
    s_waitcnt vmcnt(19)
    v_mfma_f32_16x16x32_bf16 v[60:63], v[252:255], a[160:163], v[60:63]
    v_add_f32 v77, v77, v24
    v_add_f32 v78, v78, v24
    v_mfma_f32_16x16x32_bf16 v[64:67], v[252:255], a[164:167], v[64:67]
    v_add_f32 v79, v79, v24
    v_mfma_f32_16x16x32_bf16 v[68:71], v[252:255], a[168:171], v[68:71]
    s_waitcnt lgkmcnt(2)
    v_add_f32 v76, v76, v80
    v_add_f32 v77, v77, v81
    v_mfma_f32_16x16x32_bf16 v[72:75], v[252:255], a[172:175], v[72:75]
    buffer_load_dwordx4 v[188:191], v1, s[4:7], s48 offen offset:2048 sc1
    s_waitcnt vmcnt(19)
    v_mfma_f32_16x16x32_bf16 v[60:63], v[112:115], a[176:179], v[60:63]
    v_add_f32 v78, v78, v82
    v_add_f32 v79, v79, v83
    v_mfma_f32_16x16x32_bf16 v[64:67], v[112:115], a[180:183], v[64:67]
    s_waitcnt lgkmcnt(0)
    v_add_f32 v84, v84, v88
    v_mfma_f32_16x16x32_bf16 v[68:71], v[112:115], a[184:187], v[68:71]
    v_add_f32 v85, v85, v89
    v_add_f32 v86, v86, v90
    v_mfma_f32_16x16x32_bf16 v[72:75], v[112:115], a[188:191], v[72:75]
    buffer_load_dwordx4 v[192:195], v1, s[4:7], s48 offen offset:3072 sc1
    s_waitcnt vmcnt(19)
    v_mfma_f32_16x16x32_bf16 v[60:63], v[116:119], a[192:195], v[60:63]
    v_add_f32 v87, v87, v91
    v_add_f32 v76, v76, v84
    v_mfma_f32_16x16x32_bf16 v[64:67], v[116:119], a[196:199], v[64:67]
    v_add_f32 v77, v77, v85
    v_mfma_f32_16x16x32_bf16 v[68:71], v[116:119], a[200:203], v[68:71]
    v_add_f32 v78, v78, v86
    v_add_f32 v79, v79, v87
    v_mfma_f32_16x16x32_bf16 v[72:75], v[116:119], a[204:207], v[72:75]
    s_xor_b32 s48, s38, 0x0
    s_add_u32 s48, s48, 0x1630000
    buffer_load_dwordx4 v[196:199], v1, s[4:7], s48 offen offset:0 sc1
    s_waitcnt vmcnt(19)
    v_mfma_f32_16x16x32_bf16 v[60:63], v[120:123], a[208:211], v[60:63]
    v_mul_f32 v76, v76, v100
    v_mul_f32 v77, v77, v101
    v_mfma_f32_16x16x32_bf16 v[64:67], v[120:123], a[212:215], v[64:67]
    v_mul_f32 v78, v78, v102
    v_mfma_f32_16x16x32_bf16 v[68:71], v[120:123], a[216:219], v[68:71]
    v_mul_f32 v79, v79, v103
    v_cvt_pk_bf16_f32 v104, v76, v77
    v_mfma_f32_16x16x32_bf16 v[72:75], v[120:123], a[220:223], v[72:75]
    buffer_load_dwordx4 v[200:203], v1, s[4:7], s48 offen offset:1024 sc1
    s_waitcnt vmcnt(19)
    v_mfma_f32_16x16x32_bf16 v[60:63], v[124:127], a[224:227], v[60:63]
    v_cvt_pk_bf16_f32 v105, v78, v79
    v_mfma_f32_16x16x32_bf16 v[64:67], v[124:127], a[228:231], v[64:67]
    v_mfma_f32_16x16x32_bf16 v[68:71], v[124:127], a[232:235], v[68:71]
    v_mfma_f32_16x16x32_bf16 v[72:75], v[124:127], a[236:239], v[72:75]
    buffer_load_dwordx4 v[204:207], v1, s[4:7], s48 offen offset:2048 sc1
    s_waitcnt vmcnt(19)
    v_mfma_f32_16x16x32_bf16 v[60:63], v[128:131], a[240:243], v[60:63]
    v_mfma_f32_16x16x32_bf16 v[64:67], v[128:131], a[244:247], v[64:67]
    v_mfma_f32_16x16x32_bf16 v[68:71], v[128:131], a[248:251], v[68:71]
    v_mfma_f32_16x16x32_bf16 v[72:75], v[128:131], a[252:255], v[72:75]
    buffer_load_dwordx4 v[208:211], v1, s[4:7], s48 offen offset:3072 sc1
    s_waitcnt vmcnt(19)
    v_mfma_f32_16x16x32_bf16 v[44:47], v[132:135], a[0:3], 0
    v_mfma_f32_16x16x32_bf16 v[48:51], v[132:135], a[4:7], 0
    v_mfma_f32_16x16x32_bf16 v[52:55], v[132:135], a[8:11], 0
    v_mfma_f32_16x16x32_bf16 v[56:59], v[132:135], a[12:15], 0
    s_xor_b32 s48, s38, 0x1000
    s_add_u32 s48, s48, 0x1630000
    buffer_load_dwordx4 v[212:215], v1, s[4:7], s48 offen offset:0 sc1
    s_waitcnt vmcnt(19)
    v_mfma_f32_16x16x32_bf16 v[44:47], v[136:139], a[16:19], v[44:47]
    v_mfma_f32_16x16x32_bf16 v[48:51], v[136:139], a[20:23], v[48:51]
    ds_write_b128 v97, v[60:63] offset:16384
    v_mfma_f32_16x16x32_bf16 v[52:55], v[136:139], a[24:27], v[52:55]
    v_mfma_f32_16x16x32_bf16 v[56:59], v[136:139], a[28:31], v[56:59]
    buffer_load_dwordx4 v[216:219], v1, s[4:7], s48 offen offset:1024 sc1
    s_waitcnt vmcnt(19)
    v_mfma_f32_16x16x32_bf16 v[44:47], v[140:143], a[32:35], v[44:47]
    v_mfma_f32_16x16x32_bf16 v[48:51], v[140:143], a[36:39], v[48:51]
    ds_write_b128 v97, v[64:67] offset:17408
    v_mfma_f32_16x16x32_bf16 v[52:55], v[140:143], a[40:43], v[52:55]
    v_mfma_f32_16x16x32_bf16 v[56:59], v[140:143], a[44:47], v[56:59]
    buffer_load_dwordx4 v[220:223], v1, s[4:7], s48 offen offset:2048 sc1
    s_waitcnt vmcnt(19)
    v_mfma_f32_16x16x32_bf16 v[44:47], v[144:147], a[48:51], v[44:47]
    v_mfma_f32_16x16x32_bf16 v[48:51], v[144:147], a[52:55], v[48:51]
    ds_write_b128 v97, v[68:71] offset:18432
    v_mfma_f32_16x16x32_bf16 v[52:55], v[144:147], a[56:59], v[52:55]
    v_mfma_f32_16x16x32_bf16 v[56:59], v[144:147], a[60:63], v[56:59]
    buffer_load_dwordx4 v[224:227], v1, s[4:7], s48 offen offset:3072 sc1
    s_waitcnt vmcnt(19)
    v_mfma_f32_16x16x32_bf16 v[44:47], v[148:151], a[64:67], v[44:47]
    v_mfma_f32_16x16x32_bf16 v[48:51], v[148:151], a[68:71], v[48:51]
    ds_write_b128 v97, v[72:75] offset:19456
    v_mfma_f32_16x16x32_bf16 v[52:55], v[148:151], a[72:75], v[52:55]
    v_mfma_f32_16x16x32_bf16 v[56:59], v[148:151], a[76:79], v[56:59]
    s_xor_b32 s48, s38, 0x2000
    s_add_u32 s48, s48, 0x1630000
    buffer_load_dwordx4 v[228:231], v1, s[4:7], s48 offen offset:0 sc1
    s_waitcnt vmcnt(19)
    v_mfma_f32_16x16x32_bf16 v[44:47], v[152:155], a[80:83], v[44:47]
    v_mfma_f32_16x16x32_bf16 v[48:51], v[152:155], a[84:87], v[48:51]
    v_mfma_f32_16x16x32_bf16 v[52:55], v[152:155], a[88:91], v[52:55]
    v_mfma_f32_16x16x32_bf16 v[56:59], v[152:155], a[92:95], v[56:59]
    buffer_load_dwordx4 v[232:235], v1, s[4:7], s48 offen offset:1024 sc1
    s_waitcnt lgkmcnt(0)
    s_barrier
    s_waitcnt vmcnt(19)
    v_mfma_f32_16x16x32_bf16 v[44:47], v[156:159], a[96:99], v[44:47]
    ds_read_b128 v[76:79], v42 offset:16384
    ds_read_b128 v[80:83], v42 offset:20480
    v_mfma_f32_16x16x32_bf16 v[48:51], v[156:159], a[100:103], v[48:51]
    ds_read_b128 v[84:87], v42 offset:24576
    v_mfma_f32_16x16x32_bf16 v[52:55], v[156:159], a[104:107], v[52:55]
    ds_read_b128 v[88:91], v42 offset:28672
    v_mfma_f32_16x16x32_bf16 v[56:59], v[156:159], a[108:111], v[56:59]
    buffer_load_dwordx4 v[236:239], v1, s[4:7], s48 offen offset:2048 sc1
    s_waitcnt vmcnt(19)
    v_mfma_f32_16x16x32_bf16 v[44:47], v[160:163], a[112:115], v[44:47]
    v_mfma_f32_16x16x32_bf16 v[48:51], v[160:163], a[116:119], v[48:51]
    v_mfma_f32_16x16x32_bf16 v[52:55], v[160:163], a[120:123], v[52:55]
    v_mfma_f32_16x16x32_bf16 v[56:59], v[160:163], a[124:127], v[56:59]
    buffer_load_dwordx4 v[240:243], v1, s[4:7], s48 offen offset:3072 sc1
    s_waitcnt vmcnt(19)
    v_mfma_f32_16x16x32_bf16 v[44:47], v[164:167], a[128:131], v[44:47]
    v_mfma_f32_16x16x32_bf16 v[48:51], v[164:167], a[132:135], v[48:51]
    v_mfma_f32_16x16x32_bf16 v[52:55], v[164:167], a[136:139], v[52:55]
    v_mfma_f32_16x16x32_bf16 v[56:59], v[164:167], a[140:143], v[56:59]
    s_xor_b32 s48, s38, 0x3000
    s_add_u32 s48, s48, 0x1630000
    buffer_load_dwordx4 v[244:247], v1, s[4:7], s48 offen offset:0 sc1
    s_waitcnt vmcnt(19)
    v_mfma_f32_16x16x32_bf16 v[44:47], v[168:171], a[144:147], v[44:47]
    v_lshlrev_b32 v100, 16, v94
    v_and_b32 v101, 0xffff0000, v94
    v_mfma_f32_16x16x32_bf16 v[48:51], v[168:171], a[148:151], v[48:51]
    v_lshlrev_b32 v102, 16, v95
    v_mfma_f32_16x16x32_bf16 v[52:55], v[168:171], a[152:155], v[52:55]
    v_and_b32 v103, 0xffff0000, v95
    s_waitcnt lgkmcnt(3)
    v_add_f32 v76, v76, v24
    v_mfma_f32_16x16x32_bf16 v[56:59], v[168:171], a[156:159], v[56:59]
    buffer_load_dwordx4 v[248:251], v1, s[4:7], s48 offen offset:1024 sc1
    s_waitcnt vmcnt(19)
    v_mfma_f32_16x16x32_bf16 v[44:47], v[172:175], a[160:163], v[44:47]
    v_add_f32 v77, v77, v24
    v_add_f32 v78, v78, v24
    v_mfma_f32_16x16x32_bf16 v[48:51], v[172:175], a[164:167], v[48:51]
    v_add_f32 v79, v79, v24
    v_mfma_f32_16x16x32_bf16 v[52:55], v[172:175], a[168:171], v[52:55]
    s_waitcnt lgkmcnt(2)
    v_add_f32 v76, v76, v80
    v_add_f32 v77, v77, v81
    v_mfma_f32_16x16x32_bf16 v[56:59], v[172:175], a[172:175], v[56:59]
    buffer_load_dwordx4 v[252:255], v1, s[4:7], s48 offen offset:2048 sc1
    s_waitcnt vmcnt(19)
    v_mfma_f32_16x16x32_bf16 v[44:47], v[176:179], a[176:179], v[44:47]
    v_add_f32 v78, v78, v82
    v_add_f32 v79, v79, v83
    v_mfma_f32_16x16x32_bf16 v[48:51], v[176:179], a[180:183], v[48:51]
    s_waitcnt lgkmcnt(0)
    v_add_f32 v84, v84, v88
    v_mfma_f32_16x16x32_bf16 v[52:55], v[176:179], a[184:187], v[52:55]
    v_add_f32 v85, v85, v89
    v_add_f32 v86, v86, v90
    v_mfma_f32_16x16x32_bf16 v[56:59], v[176:179], a[188:191], v[56:59]
    buffer_load_dwordx4 v[112:115], v1, s[4:7], s48 offen offset:3072 sc1
    s_waitcnt vmcnt(19)
    v_mfma_f32_16x16x32_bf16 v[44:47], v[180:183], a[192:195], v[44:47]
    v_add_f32 v87, v87, v91
    v_add_f32 v76, v76, v84
    v_mfma_f32_16x16x32_bf16 v[48:51], v[180:183], a[196:199], v[48:51]
    v_add_f32 v77, v77, v85
    v_mfma_f32_16x16x32_bf16 v[52:55], v[180:183], a[200:203], v[52:55]
    v_add_f32 v78, v78, v86
    v_add_f32 v79, v79, v87
    v_mfma_f32_16x16x32_bf16 v[56:59], v[180:183], a[204:207], v[56:59]
    s_xor_b32 s48, s38, 0x0
    s_add_u32 s48, s48, 0x1640000
    buffer_load_dwordx4 v[116:119], v1, s[4:7], s48 offen offset:0 sc1
    s_waitcnt vmcnt(19)
    v_mfma_f32_16x16x32_bf16 v[44:47], v[184:187], a[208:211], v[44:47]
    v_mul_f32 v76, v76, v100
    v_mul_f32 v77, v77, v101
    v_mfma_f32_16x16x32_bf16 v[48:51], v[184:187], a[212:215], v[48:51]
    v_mul_f32 v78, v78, v102
    v_mfma_f32_16x16x32_bf16 v[52:55], v[184:187], a[216:219], v[52:55]
    v_mul_f32 v79, v79, v103
    v_cvt_pk_bf16_f32 v106, v76, v77
    v_mfma_f32_16x16x32_bf16 v[56:59], v[184:187], a[220:223], v[56:59]
    buffer_load_dwordx4 v[120:123], v1, s[4:7], s48 offen offset:1024 sc1
    s_waitcnt vmcnt(19)
    v_mfma_f32_16x16x32_bf16 v[44:47], v[188:191], a[224:227], v[44:47]
    v_cvt_pk_bf16_f32 v107, v78, v79
    buffer_store_dwordx4 v[104:107], v1, s[4:7], s52 offen offset:0 sc1
    v_mfma_f32_16x16x32_bf16 v[48:51], v[188:191], a[228:231], v[48:51]
    v_mfma_f32_16x16x32_bf16 v[52:55], v[188:191], a[232:235], v[52:55]
    v_mfma_f32_16x16x32_bf16 v[56:59], v[188:191], a[236:239], v[56:59]
    buffer_load_dwordx4 v[124:127], v1, s[4:7], s48 offen offset:2048 sc1
    s_waitcnt vmcnt(20)
    v_mfma_f32_16x16x32_bf16 v[44:47], v[192:195], a[240:243], v[44:47]
    v_mfma_f32_16x16x32_bf16 v[48:51], v[192:195], a[244:247], v[48:51]
    v_mfma_f32_16x16x32_bf16 v[52:55], v[192:195], a[248:251], v[52:55]
    v_mfma_f32_16x16x32_bf16 v[56:59], v[192:195], a[252:255], v[56:59]
    buffer_load_dwordx4 v[128:131], v1, s[4:7], s48 offen offset:3072 sc1
    s_waitcnt vmcnt(20)
    v_mfma_f32_16x16x32_bf16 v[60:63], v[196:199], a[0:3], 0
    v_mfma_f32_16x16x32_bf16 v[64:67], v[196:199], a[4:7], 0
    v_mfma_f32_16x16x32_bf16 v[68:71], v[196:199], a[8:11], 0
    v_mfma_f32_16x16x32_bf16 v[72:75], v[196:199], a[12:15], 0
    s_xor_b32 s48, s38, 0x1000
    s_add_u32 s48, s48, 0x1640000
    buffer_load_dwordx4 v[132:135], v1, s[4:7], s48 offen offset:0 sc1
    s_waitcnt vmcnt(20)
    v_mfma_f32_16x16x32_bf16 v[60:63], v[200:203], a[16:19], v[60:63]
    v_mfma_f32_16x16x32_bf16 v[64:67], v[200:203], a[20:23], v[64:67]
    ds_write_b128 v97, v[44:47] offset:0
    v_mfma_f32_16x16x32_bf16 v[68:71], v[200:203], a[24:27], v[68:71]
    v_mfma_f32_16x16x32_bf16 v[72:75], v[200:203], a[28:31], v[72:75]
    buffer_load_dwordx4 v[136:139], v1, s[4:7], s48 offen offset:1024 sc1
    s_waitcnt vmcnt(20)
    v_mfma_f32_16x16x32_bf16 v[60:63], v[204:207], a[32:35], v[60:63]
    v_mfma_f32_16x16x32_bf16 v[64:67], v[204:207], a[36:39], v[64:67]
    ds_write_b128 v97, v[48:51] offset:1024
    v_mfma_f32_16x16x32_bf16 v[68:71], v[204:207], a[40:43], v[68:71]
    v_mfma_f32_16x16x32_bf16 v[72:75], v[204:207], a[44:47], v[72:75]
    buffer_load_dwordx4 v[140:143], v1, s[4:7], s48 offen offset:2048 sc1
    s_waitcnt vmcnt(20)
    v_mfma_f32_16x16x32_bf16 v[60:63], v[208:211], a[48:51], v[60:63]
    v_mfma_f32_16x16x32_bf16 v[64:67], v[208:211], a[52:55], v[64:67]
    ds_write_b128 v97, v[52:55] offset:2048
    v_mfma_f32_16x16x32_bf16 v[68:71], v[208:211], a[56:59], v[68:71]
    v_mfma_f32_16x16x32_bf16 v[72:75], v[208:211], a[60:63], v[72:75]
    buffer_load_dwordx4 v[144:147], v1, s[4:7], s48 offen offset:3072 sc1
    s_waitcnt vmcnt(20)
    v_mfma_f32_16x16x32_bf16 v[60:63], v[212:215], a[64:67], v[60:63]
    v_mfma_f32_16x16x32_bf16 v[64:67], v[212:215], a[68:71], v[64:67]
    ds_write_b128 v97, v[56:59] offset:3072
    v_mfma_f32_16x16x32_bf16 v[68:71], v[212:215], a[72:75], v[68:71]
    v_mfma_f32_16x16x32_bf16 v[72:75], v[212:215], a[76:79], v[72:75]
    s_xor_b32 s48, s38, 0x2000
    s_add_u32 s48, s48, 0x1640000
    buffer_load_dwordx4 v[148:151], v1, s[4:7], s48 offen offset:0 sc1
    s_waitcnt vmcnt(20)
    v_mfma_f32_16x16x32_bf16 v[60:63], v[216:219], a[80:83], v[60:63]
    v_mfma_f32_16x16x32_bf16 v[64:67], v[216:219], a[84:87], v[64:67]
    v_mfma_f32_16x16x32_bf16 v[68:71], v[216:219], a[88:91], v[68:71]
    v_mfma_f32_16x16x32_bf16 v[72:75], v[216:219], a[92:95], v[72:75]
    buffer_load_dwordx4 v[152:155], v1, s[4:7], s48 offen offset:1024 sc1
    s_waitcnt lgkmcnt(0)
    s_barrier
    s_waitcnt vmcnt(20)
    v_mfma_f32_16x16x32_bf16 v[60:63], v[220:223], a[96:99], v[60:63]
    ds_read_b128 v[92:95], v43 offset:4608
    ds_read_b128 v[76:79], v42 offset:0
    v_mfma_f32_16x16x32_bf16 v[64:67], v[220:223], a[100:103], v[64:67]
    ds_read_b128 v[80:83], v42 offset:4096
    v_mfma_f32_16x16x32_bf16 v[68:71], v[220:223], a[104:107], v[68:71]
    ds_read_b128 v[84:87], v42 offset:8192
    ds_read_b128 v[88:91], v42 offset:12288
    v_mfma_f32_16x16x32_bf16 v[72:75], v[220:223], a[108:111], v[72:75]
    buffer_load_dwordx4 v[156:159], v1, s[4:7], s48 offen offset:2048 sc1
    s_waitcnt vmcnt(20)
    v_mfma_f32_16x16x32_bf16 v[60:63], v[224:227], a[112:115], v[60:63]
    v_mfma_f32_16x16x32_bf16 v[64:67], v[224:227], a[116:119], v[64:67]
    v_mfma_f32_16x16x32_bf16 v[68:71], v[224:227], a[120:123], v[68:71]
    v_mfma_f32_16x16x32_bf16 v[72:75], v[224:227], a[124:127], v[72:75]
    buffer_load_dwordx4 v[160:163], v1, s[4:7], s48 offen offset:3072 sc1
    s_waitcnt vmcnt(20)
    v_mfma_f32_16x16x32_bf16 v[60:63], v[228:231], a[128:131], v[60:63]
    v_mfma_f32_16x16x32_bf16 v[64:67], v[228:231], a[132:135], v[64:67]
    v_mfma_f32_16x16x32_bf16 v[68:71], v[228:231], a[136:139], v[68:71]
    v_mfma_f32_16x16x32_bf16 v[72:75], v[228:231], a[140:143], v[72:75]
    s_xor_b32 s48, s38, 0x3000
    s_add_u32 s48, s48, 0x1640000
    buffer_load_dwordx4 v[164:167], v1, s[4:7], s48 offen offset:0 sc1
    s_waitcnt vmcnt(20)
    v_mfma_f32_16x16x32_bf16 v[60:63], v[232:235], a[144:147], v[60:63]
    s_waitcnt lgkmcnt(4)
    v_lshlrev_b32 v100, 16, v92
    v_and_b32 v101, 0xffff0000, v92
    v_mfma_f32_16x16x32_bf16 v[64:67], v[232:235], a[148:151], v[64:67]
    v_lshlrev_b32 v102, 16, v93
    v_mfma_f32_16x16x32_bf16 v[68:71], v[232:235], a[152:155], v[68:71]
    v_and_b32 v103, 0xffff0000, v93
    s_waitcnt lgkmcnt(3)
    v_add_f32 v76, v76, v24
    v_mfma_f32_16x16x32_bf16 v[72:75], v[232:235], a[156:159], v[72:75]
    buffer_load_dwordx4 v[168:171], v1, s[4:7], s48 offen offset:1024 sc1
    s_waitcnt vmcnt(20)
    v_mfma_f32_16x16x32_bf16 v[60:63], v[236:239], a[160:163], v[60:63]
    v_add_f32 v77, v77, v24
    v_add_f32 v78, v78, v24
    v_mfma_f32_16x16x32_bf16 v[64:67], v[236:239], a[164:167], v[64:67]
    v_add_f32 v79, v79, v24
    v_mfma_f32_16x16x32_bf16 v[68:71], v[236:239], a[168:171], v[68:71]
    s_waitcnt lgkmcnt(2)
    v_add_f32 v76, v76, v80
    v_add_f32 v77, v77, v81
    v_mfma_f32_16x16x32_bf16 v[72:75], v[236:239], a[172:175], v[72:75]
    buffer_load_dwordx4 v[172:175], v1, s[4:7], s48 offen offset:2048 sc1
    s_waitcnt vmcnt(20)
    v_mfma_f32_16x16x32_bf16 v[60:63], v[240:243], a[176:179], v[60:63]
    v_add_f32 v78, v78, v82
    v_add_f32 v79, v79, v83
    v_mfma_f32_16x16x32_bf16 v[64:67], v[240:243], a[180:183], v[64:67]
    s_waitcnt lgkmcnt(0)
    v_add_f32 v84, v84, v88
    v_mfma_f32_16x16x32_bf16 v[68:71], v[240:243], a[184:187], v[68:71]
    v_add_f32 v85, v85, v89
    v_add_f32 v86, v86, v90
    v_mfma_f32_16x16x32_bf16 v[72:75], v[240:243], a[188:191], v[72:75]
    buffer_load_dwordx4 v[176:179], v1, s[4:7], s48 offen offset:3072 sc1
    s_waitcnt vmcnt(20)
    v_mfma_f32_16x16x32_bf16 v[60:63], v[244:247], a[192:195], v[60:63]
    v_add_f32 v87, v87, v91
    v_add_f32 v76, v76, v84
    v_mfma_f32_16x16x32_bf16 v[64:67], v[244:247], a[196:199], v[64:67]
    v_add_f32 v77, v77, v85
    v_mfma_f32_16x16x32_bf16 v[68:71], v[244:247], a[200:203], v[68:71]
    v_add_f32 v78, v78, v86
    v_add_f32 v79, v79, v87
    v_mfma_f32_16x16x32_bf16 v[72:75], v[244:247], a[204:207], v[72:75]
    s_xor_b32 s48, s38, 0x0
    s_add_u32 s48, s48, 0x1650000
    buffer_load_dwordx4 v[180:183], v1, s[4:7], s48 offen offset:0 sc1
    s_waitcnt vmcnt(20)
    v_mfma_f32_16x16x32_bf16 v[60:63], v[248:251], a[208:211], v[60:63]
    v_mul_f32 v76, v76, v100
    v_mul_f32 v77, v77, v101
    v_mfma_f32_16x16x32_bf16 v[64:67], v[248:251], a[212:215], v[64:67]
    v_mul_f32 v78, v78, v102
    v_mfma_f32_16x16x32_bf16 v[68:71], v[248:251], a[216:219], v[68:71]
    v_mul_f32 v79, v79, v103
    v_cvt_pk_bf16_f32 v108, v76, v77
    v_mfma_f32_16x16x32_bf16 v[72:75], v[248:251], a[220:223], v[72:75]
    buffer_load_dwordx4 v[184:187], v1, s[4:7], s48 offen offset:1024 sc1
    s_waitcnt vmcnt(20)
    v_mfma_f32_16x16x32_bf16 v[60:63], v[252:255], a[224:227], v[60:63]
    v_cvt_pk_bf16_f32 v109, v78, v79
    v_mfma_f32_16x16x32_bf16 v[64:67], v[252:255], a[228:231], v[64:67]
    v_mfma_f32_16x16x32_bf16 v[68:71], v[252:255], a[232:235], v[68:71]
    v_mfma_f32_16x16x32_bf16 v[72:75], v[252:255], a[236:239], v[72:75]
    buffer_load_dwordx4 v[188:191], v1, s[4:7], s48 offen offset:2048 sc1
    s_waitcnt vmcnt(20)
    v_mfma_f32_16x16x32_bf16 v[60:63], v[112:115], a[240:243], v[60:63]
    v_mfma_f32_16x16x32_bf16 v[64:67], v[112:115], a[244:247], v[64:67]
    v_mfma_f32_16x16x32_bf16 v[68:71], v[112:115], a[248:251], v[68:71]
    v_mfma_f32_16x16x32_bf16 v[72:75], v[112:115], a[252:255], v[72:75]
    buffer_load_dwordx4 v[192:195], v1, s[4:7], s48 offen offset:3072 sc1
    s_waitcnt vmcnt(20)
    v_mfma_f32_16x16x32_bf16 v[44:47], v[116:119], a[0:3], 0
    v_mfma_f32_16x16x32_bf16 v[48:51], v[116:119], a[4:7], 0
    v_mfma_f32_16x16x32_bf16 v[52:55], v[116:119], a[8:11], 0
    v_mfma_f32_16x16x32_bf16 v[56:59], v[116:119], a[12:15], 0
    s_xor_b32 s48, s38, 0x1000
    s_add_u32 s48, s48, 0x1650000
    buffer_load_dwordx4 v[196:199], v1, s[4:7], s48 offen offset:0 sc1
    s_waitcnt vmcnt(20)
    v_mfma_f32_16x16x32_bf16 v[44:47], v[120:123], a[16:19], v[44:47]
    v_mfma_f32_16x16x32_bf16 v[48:51], v[120:123], a[20:23], v[48:51]
    ds_write_b128 v97, v[60:63] offset:16384
    v_mfma_f32_16x16x32_bf16 v[52:55], v[120:123], a[24:27], v[52:55]
    v_mfma_f32_16x16x32_bf16 v[56:59], v[120:123], a[28:31], v[56:59]
    buffer_load_dwordx4 v[200:203], v1, s[4:7], s48 offen offset:1024 sc1
    s_waitcnt vmcnt(19)
    v_mfma_f32_16x16x32_bf16 v[44:47], v[124:127], a[32:35], v[44:47]
    v_mfma_f32_16x16x32_bf16 v[48:51], v[124:127], a[36:39], v[48:51]
    ds_write_b128 v97, v[64:67] offset:17408
    v_mfma_f32_16x16x32_bf16 v[52:55], v[124:127], a[40:43], v[52:55]
    v_mfma_f32_16x16x32_bf16 v[56:59], v[124:127], a[44:47], v[56:59]
    buffer_load_dwordx4 v[204:207], v1, s[4:7], s48 offen offset:2048 sc1
    s_waitcnt vmcnt(19)
    v_mfma_f32_16x16x32_bf16 v[44:47], v[128:131], a[48:51], v[44:47]
    v_mfma_f32_16x16x32_bf16 v[48:51], v[128:131], a[52:55], v[48:51]
    ds_write_b128 v97, v[68:71] offset:18432
    v_mfma_f32_16x16x32_bf16 v[52:55], v[128:131], a[56:59], v[52:55]
    v_mfma_f32_16x16x32_bf16 v[56:59], v[128:131], a[60:63], v[56:59]
    buffer_load_dwordx4 v[208:211], v1, s[4:7], s48 offen offset:3072 sc1
    s_waitcnt vmcnt(19)
    v_mfma_f32_16x16x32_bf16 v[44:47], v[132:135], a[64:67], v[44:47]
    v_mfma_f32_16x16x32_bf16 v[48:51], v[132:135], a[68:71], v[48:51]
    ds_write_b128 v97, v[72:75] offset:19456
    v_mfma_f32_16x16x32_bf16 v[52:55], v[132:135], a[72:75], v[52:55]
    v_mfma_f32_16x16x32_bf16 v[56:59], v[132:135], a[76:79], v[56:59]
    s_xor_b32 s48, s38, 0x2000
    s_add_u32 s48, s48, 0x1650000
    buffer_load_dwordx4 v[212:215], v1, s[4:7], s48 offen offset:0 sc1
    s_waitcnt vmcnt(19)
    v_mfma_f32_16x16x32_bf16 v[44:47], v[136:139], a[80:83], v[44:47]
    v_mfma_f32_16x16x32_bf16 v[48:51], v[136:139], a[84:87], v[48:51]
    v_mfma_f32_16x16x32_bf16 v[52:55], v[136:139], a[88:91], v[52:55]
    v_mfma_f32_16x16x32_bf16 v[56:59], v[136:139], a[92:95], v[56:59]
    buffer_load_dwordx4 v[112:115], v1, s[4:7], s48 offen offset:1024 sc1
    s_waitcnt lgkmcnt(0)
    s_barrier
    s_waitcnt vmcnt(19)
    v_mfma_f32_16x16x32_bf16 v[44:47], v[140:143], a[96:99], v[44:47]
    ds_read_b128 v[76:79], v42 offset:16384
    ds_read_b128 v[80:83], v42 offset:20480
    v_mfma_f32_16x16x32_bf16 v[48:51], v[140:143], a[100:103], v[48:51]
    ds_read_b128 v[84:87], v42 offset:24576
    v_mfma_f32_16x16x32_bf16 v[52:55], v[140:143], a[104:107], v[52:55]
    ds_read_b128 v[88:91], v42 offset:28672
    v_mfma_f32_16x16x32_bf16 v[56:59], v[140:143], a[108:111], v[56:59]
    buffer_load_dwordx4 v[116:119], v1, s[4:7], s48 offen offset:2048 sc1
    s_waitcnt vmcnt(19)
    v_mfma_f32_16x16x32_bf16 v[44:47], v[144:147], a[112:115], v[44:47]
    v_mfma_f32_16x16x32_bf16 v[48:51], v[144:147], a[116:119], v[48:51]
    v_mfma_f32_16x16x32_bf16 v[52:55], v[144:147], a[120:123], v[52:55]
    v_mfma_f32_16x16x32_bf16 v[56:59], v[144:147], a[124:127], v[56:59]
    buffer_load_dwordx4 v[120:123], v1, s[4:7], s48 offen offset:3072 sc1
    s_waitcnt vmcnt(19)
    v_mfma_f32_16x16x32_bf16 v[44:47], v[148:151], a[128:131], v[44:47]
    v_mfma_f32_16x16x32_bf16 v[48:51], v[148:151], a[132:135], v[48:51]
    v_mfma_f32_16x16x32_bf16 v[52:55], v[148:151], a[136:139], v[52:55]
    v_mfma_f32_16x16x32_bf16 v[56:59], v[148:151], a[140:143], v[56:59]
    s_xor_b32 s48, s38, 0x3000
    s_add_u32 s48, s48, 0x1650000
    buffer_load_dwordx4 v[124:127], v1, s[4:7], s48 offen offset:0 sc1
    s_waitcnt vmcnt(19)
    v_mfma_f32_16x16x32_bf16 v[44:47], v[152:155], a[144:147], v[44:47]
    v_lshlrev_b32 v100, 16, v94
    v_and_b32 v101, 0xffff0000, v94
    v_mfma_f32_16x16x32_bf16 v[48:51], v[152:155], a[148:151], v[48:51]
    v_lshlrev_b32 v102, 16, v95
    v_mfma_f32_16x16x32_bf16 v[52:55], v[152:155], a[152:155], v[52:55]
    v_and_b32 v103, 0xffff0000, v95
    s_waitcnt lgkmcnt(3)
    v_add_f32 v76, v76, v24
    v_mfma_f32_16x16x32_bf16 v[56:59], v[152:155], a[156:159], v[56:59]
    buffer_load_dwordx4 v[128:131], v1, s[4:7], s48 offen offset:1024 sc1
    s_waitcnt vmcnt(19)
    v_mfma_f32_16x16x32_bf16 v[44:47], v[156:159], a[160:163], v[44:47]
    v_add_f32 v77, v77, v24
    v_add_f32 v78, v78, v24
    v_mfma_f32_16x16x32_bf16 v[48:51], v[156:159], a[164:167], v[48:51]
    v_add_f32 v79, v79, v24
    v_mfma_f32_16x16x32_bf16 v[52:55], v[156:159], a[168:171], v[52:55]
    s_waitcnt lgkmcnt(2)
    v_add_f32 v76, v76, v80
    v_add_f32 v77, v77, v81
    v_mfma_f32_16x16x32_bf16 v[56:59], v[156:159], a[172:175], v[56:59]
    buffer_load_dwordx4 v[132:135], v1, s[4:7], s48 offen offset:2048 sc1
    s_waitcnt vmcnt(19)
    v_mfma_f32_16x16x32_bf16 v[44:47], v[160:163], a[176:179], v[44:47]
    v_add_f32 v78, v78, v82
    v_add_f32 v79, v79, v83
    v_mfma_f32_16x16x32_bf16 v[48:51], v[160:163], a[180:183], v[48:51]
    s_waitcnt lgkmcnt(0)
    v_add_f32 v84, v84, v88
    v_mfma_f32_16x16x32_bf16 v[52:55], v[160:163], a[184:187], v[52:55]
    v_add_f32 v85, v85, v89
    v_add_f32 v86, v86, v90
    v_mfma_f32_16x16x32_bf16 v[56:59], v[160:163], a[188:191], v[56:59]
    buffer_load_dwordx4 v[136:139], v1, s[4:7], s48 offen offset:3072 sc1
    s_waitcnt vmcnt(19)
    v_mfma_f32_16x16x32_bf16 v[44:47], v[164:167], a[192:195], v[44:47]
    v_add_f32 v87, v87, v91
    v_add_f32 v76, v76, v84
    v_mfma_f32_16x16x32_bf16 v[48:51], v[164:167], a[196:199], v[48:51]
    v_add_f32 v77, v77, v85
    v_mfma_f32_16x16x32_bf16 v[52:55], v[164:167], a[200:203], v[52:55]
    v_add_f32 v78, v78, v86
    v_add_f32 v79, v79, v87
    v_mfma_f32_16x16x32_bf16 v[56:59], v[164:167], a[204:207], v[56:59]
    s_xor_b32 s48, s38, 0x0
    s_add_u32 s48, s48, 0x1660000
    buffer_load_dwordx4 v[140:143], v1, s[4:7], s48 offen offset:0 sc1
    s_waitcnt vmcnt(19)
    v_mfma_f32_16x16x32_bf16 v[44:47], v[168:171], a[208:211], v[44:47]
    v_mul_f32 v76, v76, v100
    v_mul_f32 v77, v77, v101
    v_mfma_f32_16x16x32_bf16 v[48:51], v[168:171], a[212:215], v[48:51]
    v_mul_f32 v78, v78, v102
    v_mfma_f32_16x16x32_bf16 v[52:55], v[168:171], a[216:219], v[52:55]
    v_mul_f32 v79, v79, v103
    v_cvt_pk_bf16_f32 v110, v76, v77
    v_mfma_f32_16x16x32_bf16 v[56:59], v[168:171], a[220:223], v[56:59]
    buffer_load_dwordx4 v[144:147], v1, s[4:7], s48 offen offset:1024 sc1
    s_waitcnt vmcnt(19)
    v_mfma_f32_16x16x32_bf16 v[44:47], v[172:175], a[224:227], v[44:47]
    v_cvt_pk_bf16_f32 v111, v78, v79
    buffer_store_dwordx4 v[108:111], v1, s[4:7], s52 offen offset:1024 sc1
    v_mfma_f32_16x16x32_bf16 v[48:51], v[172:175], a[228:231], v[48:51]
    v_mfma_f32_16x16x32_bf16 v[52:55], v[172:175], a[232:235], v[52:55]
    v_mfma_f32_16x16x32_bf16 v[56:59], v[172:175], a[236:239], v[56:59]
    buffer_load_dwordx4 v[148:151], v1, s[4:7], s48 offen offset:2048 sc1
    s_waitcnt vmcnt(20)
    v_mfma_f32_16x16x32_bf16 v[44:47], v[176:179], a[240:243], v[44:47]
    v_mfma_f32_16x16x32_bf16 v[48:51], v[176:179], a[244:247], v[48:51]
    v_mfma_f32_16x16x32_bf16 v[52:55], v[176:179], a[248:251], v[52:55]
    v_mfma_f32_16x16x32_bf16 v[56:59], v[176:179], a[252:255], v[56:59]
    buffer_load_dwordx4 v[152:155], v1, s[4:7], s48 offen offset:3072 sc1
    s_waitcnt vmcnt(20)
    v_mfma_f32_16x16x32_bf16 v[60:63], v[180:183], a[0:3], 0
    v_mfma_f32_16x16x32_bf16 v[64:67], v[180:183], a[4:7], 0
    v_mfma_f32_16x16x32_bf16 v[68:71], v[180:183], a[8:11], 0
    v_mfma_f32_16x16x32_bf16 v[72:75], v[180:183], a[12:15], 0
    s_xor_b32 s48, s38, 0x1000
    s_add_u32 s48, s48, 0x1660000
    buffer_load_dwordx4 v[156:159], v1, s[4:7], s48 offen offset:0 sc1
    s_waitcnt vmcnt(20)
    v_mfma_f32_16x16x32_bf16 v[60:63], v[184:187], a[16:19], v[60:63]
    v_mfma_f32_16x16x32_bf16 v[64:67], v[184:187], a[20:23], v[64:67]
    ds_write_b128 v97, v[44:47] offset:0
    v_mfma_f32_16x16x32_bf16 v[68:71], v[184:187], a[24:27], v[68:71]
    v_mfma_f32_16x16x32_bf16 v[72:75], v[184:187], a[28:31], v[72:75]
    buffer_load_dwordx4 v[160:163], v1, s[4:7], s48 offen offset:1024 sc1
    s_waitcnt vmcnt(20)
    v_mfma_f32_16x16x32_bf16 v[60:63], v[188:191], a[32:35], v[60:63]
    v_mfma_f32_16x16x32_bf16 v[64:67], v[188:191], a[36:39], v[64:67]
    ds_write_b128 v97, v[48:51] offset:1024
    v_mfma_f32_16x16x32_bf16 v[68:71], v[188:191], a[40:43], v[68:71]
    v_mfma_f32_16x16x32_bf16 v[72:75], v[188:191], a[44:47], v[72:75]
    buffer_load_dwordx4 v[164:167], v1, s[4:7], s48 offen offset:2048 sc1
    s_waitcnt vmcnt(20)
    v_mfma_f32_16x16x32_bf16 v[60:63], v[192:195], a[48:51], v[60:63]
    v_mfma_f32_16x16x32_bf16 v[64:67], v[192:195], a[52:55], v[64:67]
    ds_write_b128 v97, v[52:55] offset:2048
    v_mfma_f32_16x16x32_bf16 v[68:71], v[192:195], a[56:59], v[68:71]
    v_mfma_f32_16x16x32_bf16 v[72:75], v[192:195], a[60:63], v[72:75]
    buffer_load_dwordx4 v[168:171], v1, s[4:7], s48 offen offset:3072 sc1
    s_waitcnt vmcnt(20)
    v_mfma_f32_16x16x32_bf16 v[60:63], v[196:199], a[64:67], v[60:63]
    v_mfma_f32_16x16x32_bf16 v[64:67], v[196:199], a[68:71], v[64:67]
    ds_write_b128 v97, v[56:59] offset:3072
    v_mfma_f32_16x16x32_bf16 v[68:71], v[196:199], a[72:75], v[68:71]
    v_mfma_f32_16x16x32_bf16 v[72:75], v[196:199], a[76:79], v[72:75]
    s_xor_b32 s48, s38, 0x2000
    s_add_u32 s48, s48, 0x1660000
    buffer_load_dwordx4 v[172:175], v1, s[4:7], s48 offen offset:0 sc1
    s_waitcnt vmcnt(20)
    v_mfma_f32_16x16x32_bf16 v[60:63], v[200:203], a[80:83], v[60:63]
    v_mfma_f32_16x16x32_bf16 v[64:67], v[200:203], a[84:87], v[64:67]
    v_mfma_f32_16x16x32_bf16 v[68:71], v[200:203], a[88:91], v[68:71]
    v_mfma_f32_16x16x32_bf16 v[72:75], v[200:203], a[92:95], v[72:75]
    buffer_load_dwordx4 v[176:179], v1, s[4:7], s48 offen offset:1024 sc1
    s_waitcnt lgkmcnt(0)
    s_barrier
    s_waitcnt vmcnt(20)
    v_mfma_f32_16x16x32_bf16 v[60:63], v[204:207], a[96:99], v[60:63]
    ds_read_b128 v[92:95], v43 offset:9216
    ds_read_b128 v[76:79], v42 offset:0
    v_mfma_f32_16x16x32_bf16 v[64:67], v[204:207], a[100:103], v[64:67]
    ds_read_b128 v[80:83], v42 offset:4096
    v_mfma_f32_16x16x32_bf16 v[68:71], v[204:207], a[104:107], v[68:71]
    ds_read_b128 v[84:87], v42 offset:8192
    ds_read_b128 v[88:91], v42 offset:12288
    v_mfma_f32_16x16x32_bf16 v[72:75], v[204:207], a[108:111], v[72:75]
    buffer_load_dwordx4 v[180:183], v1, s[4:7], s48 offen offset:2048 sc1
    s_waitcnt vmcnt(20)
    v_mfma_f32_16x16x32_bf16 v[60:63], v[208:211], a[112:115], v[60:63]
    v_mfma_f32_16x16x32_bf16 v[64:67], v[208:211], a[116:119], v[64:67]
    v_mfma_f32_16x16x32_bf16 v[68:71], v[208:211], a[120:123], v[68:71]
    v_mfma_f32_16x16x32_bf16 v[72:75], v[208:211], a[124:127], v[72:75]
    buffer_load_dwordx4 v[184:187], v1, s[4:7], s48 offen offset:3072 sc1
    s_waitcnt vmcnt(20)
    v_mfma_f32_16x16x32_bf16 v[60:63], v[212:215], a[128:131], v[60:63]
    v_mfma_f32_16x16x32_bf16 v[64:67], v[212:215], a[132:135], v[64:67]
    v_mfma_f32_16x16x32_bf16 v[68:71], v[212:215], a[136:139], v[68:71]
    v_mfma_f32_16x16x32_bf16 v[72:75], v[212:215], a[140:143], v[72:75]
    s_xor_b32 s48, s38, 0x3000
    s_add_u32 s48, s48, 0x1660000
    buffer_load_dwordx4 v[188:191], v1, s[4:7], s48 offen offset:0 sc1
    s_waitcnt vmcnt(20)
    v_mfma_f32_16x16x32_bf16 v[60:63], v[112:115], a[144:147], v[60:63]
    s_waitcnt lgkmcnt(4)
    v_lshlrev_b32 v100, 16, v92
    v_and_b32 v101, 0xffff0000, v92
    v_mfma_f32_16x16x32_bf16 v[64:67], v[112:115], a[148:151], v[64:67]
    v_lshlrev_b32 v102, 16, v93
    v_mfma_f32_16x16x32_bf16 v[68:71], v[112:115], a[152:155], v[68:71]
    v_and_b32 v103, 0xffff0000, v93
    s_waitcnt lgkmcnt(3)
    v_add_f32 v76, v76, v24
    v_mfma_f32_16x16x32_bf16 v[72:75], v[112:115], a[156:159], v[72:75]
    buffer_load_dwordx4 v[192:195], v1, s[4:7], s48 offen offset:1024 sc1
    s_waitcnt vmcnt(20)
    v_mfma_f32_16x16x32_bf16 v[60:63], v[116:119], a[160:163], v[60:63]
    v_add_f32 v77, v77, v24
    v_add_f32 v78, v78, v24
    v_mfma_f32_16x16x32_bf16 v[64:67], v[116:119], a[164:167], v[64:67]
    v_add_f32 v79, v79, v24
    v_mfma_f32_16x16x32_bf16 v[68:71], v[116:119], a[168:171], v[68:71]
    s_waitcnt lgkmcnt(2)
    v_add_f32 v76, v76, v80
    v_add_f32 v77, v77, v81
    v_mfma_f32_16x16x32_bf16 v[72:75], v[116:119], a[172:175], v[72:75]
    buffer_load_dwordx4 v[196:199], v1, s[4:7], s48 offen offset:2048 sc1
    s_waitcnt vmcnt(20)
    v_mfma_f32_16x16x32_bf16 v[60:63], v[120:123], a[176:179], v[60:63]
    v_add_f32 v78, v78, v82
    v_add_f32 v79, v79, v83
    v_mfma_f32_16x16x32_bf16 v[64:67], v[120:123], a[180:183], v[64:67]
    s_waitcnt lgkmcnt(0)
    v_add_f32 v84, v84, v88
    v_mfma_f32_16x16x32_bf16 v[68:71], v[120:123], a[184:187], v[68:71]
    v_add_f32 v85, v85, v89
    v_add_f32 v86, v86, v90
    v_mfma_f32_16x16x32_bf16 v[72:75], v[120:123], a[188:191], v[72:75]
    buffer_load_dwordx4 v[200:203], v1, s[4:7], s48 offen offset:3072 sc1
    s_barrier
    s_waitcnt vmcnt(20)
    v_mfma_f32_16x16x32_bf16 v[60:63], v[124:127], a[192:195], v[60:63]
    v_add_f32 v87, v87, v91
    v_add_f32 v76, v76, v84
    v_mfma_f32_16x16x32_bf16 v[64:67], v[124:127], a[196:199], v[64:67]
    v_add_f32 v77, v77, v85
    v_mfma_f32_16x16x32_bf16 v[68:71], v[124:127], a[200:203], v[68:71]
    v_add_f32 v78, v78, v86
    v_add_f32 v79, v79, v87
    v_mfma_f32_16x16x32_bf16 v[72:75], v[124:127], a[204:207], v[72:75]
    s_add_u32 s49, s15, 0x5eec00
    s_add_u32 m0, s14, 16384
    s_nop 0
    buffer_load_dwordx4 v1, s[4:7], s49 offen offset:0 lds
    s_waitcnt vmcnt(20)
    v_mfma_f32_16x16x32_bf16 v[60:63], v[128:131], a[208:211], v[60:63]
    v_mul_f32 v76, v76, v100
    v_mul_f32 v77, v77, v101
    v_mfma_f32_16x16x32_bf16 v[64:67], v[128:131], a[212:215], v[64:67]
    v_mul_f32 v78, v78, v102
    v_mfma_f32_16x16x32_bf16 v[68:71], v[128:131], a[216:219], v[68:71]
    v_mul_f32 v79, v79, v103
    v_cvt_pk_bf16_f32 v104, v76, v77
    v_mfma_f32_16x16x32_bf16 v[72:75], v[128:131], a[220:223], v[72:75]
    s_add_u32 s49, s15, 0x5eec00
    s_add_u32 m0, s14, 16384
    s_nop 0
    buffer_load_dwordx4 v1, s[4:7], s49 offen offset:1024 lds
    s_waitcnt vmcnt(20)
    v_mfma_f32_16x16x32_bf16 v[60:63], v[132:135], a[224:227], v[60:63]
    v_cvt_pk_bf16_f32 v105, v78, v79
    v_mfma_f32_16x16x32_bf16 v[64:67], v[132:135], a[228:231], v[64:67]
    v_mfma_f32_16x16x32_bf16 v[68:71], v[132:135], a[232:235], v[68:71]
    v_mfma_f32_16x16x32_bf16 v[72:75], v[132:135], a[236:239], v[72:75]
    s_add_u32 s49, s15, 0x5eec00
    s_add_u32 m0, s14, 16384
    s_nop 0
    buffer_load_dwordx4 v1, s[4:7], s49 offen offset:2048 lds
    s_waitcnt vmcnt(20)
    v_mfma_f32_16x16x32_bf16 v[60:63], v[136:139], a[240:243], v[60:63]
    v_mfma_f32_16x16x32_bf16 v[64:67], v[136:139], a[244:247], v[64:67]
    v_mfma_f32_16x16x32_bf16 v[68:71], v[136:139], a[248:251], v[68:71]
    v_mfma_f32_16x16x32_bf16 v[72:75], v[136:139], a[252:255], v[72:75]
    s_add_u32 s49, s15, 0x5eec00
    s_add_u32 m0, s14, 16384
    s_nop 0
    buffer_load_dwordx4 v1, s[4:7], s49 offen offset:3072 lds
    s_waitcnt vmcnt(20)
    v_mfma_f32_16x16x32_bf16 v[44:47], v[140:143], a[0:3], 0
    v_mfma_f32_16x16x32_bf16 v[48:51], v[140:143], a[4:7], 0
    v_mfma_f32_16x16x32_bf16 v[52:55], v[140:143], a[8:11], 0
    v_mfma_f32_16x16x32_bf16 v[56:59], v[140:143], a[12:15], 0
    s_waitcnt vmcnt(19)
    v_mfma_f32_16x16x32_bf16 v[44:47], v[144:147], a[16:19], v[44:47]
    v_mfma_f32_16x16x32_bf16 v[48:51], v[144:147], a[20:23], v[48:51]
    ds_write_b128 v97, v[60:63] offset:0
    v_mfma_f32_16x16x32_bf16 v[52:55], v[144:147], a[24:27], v[52:55]
    v_mfma_f32_16x16x32_bf16 v[56:59], v[144:147], a[28:31], v[56:59]
    s_waitcnt vmcnt(17)
    v_mfma_f32_16x16x32_bf16 v[44:47], v[148:151], a[32:35], v[44:47]
    s_xor_b32 s56, s26, 0x3019000
    buffer_load_dwordx4 v[204:207], v1, s[4:7], s56 offen offset:3072
    v_mfma_f32_16x16x32_bf16 v[48:51], v[148:151], a[36:39], v[48:51]
    ds_write_b128 v97, v[64:67] offset:1024
    v_mfma_f32_16x16x32_bf16 v[52:55], v[148:151], a[40:43], v[52:55]
    v_mfma_f32_16x16x32_bf16 v[56:59], v[148:151], a[44:47], v[56:59]
    s_waitcnt vmcnt(17)
    v_mfma_f32_16x16x32_bf16 v[44:47], v[152:155], a[48:51], v[44:47]
    s_xor_b32 s56, s26, 0x301a000
    buffer_load_dwordx4 v[208:211], v1, s[4:7], s56 offen offset:0
    v_mfma_f32_16x16x32_bf16 v[48:51], v[152:155], a[52:55], v[48:51]
    ds_write_b128 v97, v[68:71] offset:2048
    v_mfma_f32_16x16x32_bf16 v[52:55], v[152:155], a[56:59], v[52:55]
    v_mfma_f32_16x16x32_bf16 v[56:59], v[152:155], a[60:63], v[56:59]
    s_sub_u32 s58, s60, 9
    v_mov_b32 v26, s58
    v_lshl_add_u32 v96, v7, 3, s34
    s_mov_b64 exec, 1
    buffer_store_dwordx2 v[26:27], off, s[4:7], s35
    s_mov_b64 exec, -1
    s_waitcnt vmcnt(18)
    v_mfma_f32_16x16x32_bf16 v[44:47], v[156:159], a[64:67], v[44:47]
    v_mfma_f32_16x16x32_bf16 v[48:51], v[156:159], a[68:71], v[48:51]
    buffer_load_dwordx4 v[212:215], v1, s[4:7], s56 offen offset:1024
    ds_write_b128 v97, v[72:75] offset:3072
    v_mfma_f32_16x16x32_bf16 v[52:55], v[156:159], a[72:75], v[52:55]
    v_mfma_f32_16x16x32_bf16 v[56:59], v[156:159], a[76:79], v[56:59]
    s_waitcnt vmcnt(18)
    v_mfma_f32_16x16x32_bf16 v[44:47], v[160:163], a[80:83], v[44:47]
    buffer_load_dwordx4 v[216:219], v1, s[4:7], s56 offen offset:2048
    v_mfma_f32_16x16x32_bf16 v[48:51], v[160:163], a[84:87], v[48:51]
    v_mfma_f32_16x16x32_bf16 v[52:55], v[160:163], a[88:91], v[52:55]
    v_mfma_f32_16x16x32_bf16 v[56:59], v[160:163], a[92:95], v[56:59]
    s_waitcnt lgkmcnt(0)
    s_barrier
    s_waitcnt vmcnt(18)
    v_mfma_f32_16x16x32_bf16 v[44:47], v[164:167], a[96:99], v[44:47]
    ds_read_b128 v[76:79], v42 offset:0
    ds_read_b128 v[80:83], v42 offset:4096
    v_mfma_f32_16x16x32_bf16 v[48:51], v[164:167], a[100:103], v[48:51]
    buffer_load_dwordx4 v[220:223], v1, s[4:7], s56 offen offset:3072
    ds_read_b128 v[84:87], v42 offset:8192
    v_mfma_f32_16x16x32_bf16 v[52:55], v[164:167], a[104:107], v[52:55]
    ds_read_b128 v[88:91], v42 offset:12288
    v_mfma_f32_16x16x32_bf16 v[56:59], v[164:167], a[108:111], v[56:59]
    s_waitcnt vmcnt(18)
    v_mfma_f32_16x16x32_bf16 v[44:47], v[168:171], a[112:115], v[44:47]
    v_mfma_f32_16x16x32_bf16 v[48:51], v[168:171], a[116:119], v[48:51]
    v_mfma_f32_16x16x32_bf16 v[52:55], v[168:171], a[120:123], v[52:55]
    s_xor_b32 s56, s26, 0x301b000
    buffer_load_dwordx4 v[224:227], v1, s[4:7], s56 offen offset:0
    v_mfma_f32_16x16x32_bf16 v[56:59], v[168:171], a[124:127], v[56:59]
    s_waitcnt vmcnt(18)
    v_mfma_f32_16x16x32_bf16 v[44:47], v[172:175], a[128:131], v[44:47]
    v_mfma_f32_16x16x32_bf16 v[48:51], v[172:175], a[132:135], v[48:51]
    v_mfma_f32_16x16x32_bf16 v[52:55], v[172:175], a[136:139], v[52:55]
    v_mfma_f32_16x16x32_bf16 v[56:59], v[172:175], a[140:143], v[56:59]
    buffer_load_dwordx4 v[228:231], v1, s[4:7], s56 offen offset:1024
    s_waitcnt vmcnt(18)
    v_mfma_f32_16x16x32_bf16 v[44:47], v[176:179], a[144:147], v[44:47]
    v_lshlrev_b32 v100, 16, v94
    v_and_b32 v101, 0xffff0000, v94
    v_mfma_f32_16x16x32_bf16 v[48:51], v[176:179], a[148:151], v[48:51]
    v_lshlrev_b32 v102, 16, v95
    v_mfma_f32_16x16x32_bf16 v[52:55], v[176:179], a[152:155], v[52:55]
    v_and_b32 v103, 0xffff0000, v95
    s_waitcnt lgkmcnt(3)
    v_add_f32 v76, v76, v24
    v_mfma_f32_16x16x32_bf16 v[56:59], v[176:179], a[156:159], v[56:59]
    s_waitcnt vmcnt(17)
    v_mfma_f32_16x16x32_bf16 v[44:47], v[180:183], a[160:163], v[44:47]
    buffer_load_dwordx4 v[232:235], v1, s[4:7], s56 offen offset:2048
    v_add_f32 v77, v77, v24
    v_add_f32 v78, v78, v24
    v_mfma_f32_16x16x32_bf16 v[48:51], v[180:183], a[164:167], v[48:51]
    v_add_f32 v79, v79, v24
    v_mfma_f32_16x16x32_bf16 v[52:55], v[180:183], a[168:171], v[52:55]
    s_waitcnt lgkmcnt(2)
    v_add_f32 v76, v76, v80
    v_add_f32 v77, v77, v81
    v_mfma_f32_16x16x32_bf16 v[56:59], v[180:183], a[172:175], v[56:59]
    s_waitcnt vmcnt(17)
    v_mfma_f32_16x16x32_bf16 v[44:47], v[184:187], a[176:179], v[44:47]
    buffer_load_dwordx4 v[236:239], v1, s[4:7], s56 offen offset:3072
    v_add_f32 v78, v78, v82
    v_add_f32 v79, v79, v83
    v_mfma_f32_16x16x32_bf16 v[48:51], v[184:187], a[180:183], v[48:51]
    s_waitcnt lgkmcnt(0)
    v_add_f32 v84, v84, v88
    v_mfma_f32_16x16x32_bf16 v[52:55], v[184:187], a[184:187], v[52:55]
    v_add_f32 v85, v85, v89
    v_add_f32 v86, v86, v90
    v_mfma_f32_16x16x32_bf16 v[56:59], v[184:187], a[188:191], v[56:59]
    s_barrier
    s_waitcnt vmcnt(17)
    v_mfma_f32_16x16x32_bf16 v[44:47], v[188:191], a[192:195], v[44:47]
    v_add_f32 v87, v87, v91
    v_add_f32 v76, v76, v84
    s_xor_b32 s56, s26, 0x301c000
    buffer_load_dwordx4 v[240:243], v1, s[4:7], s56 offen offset:0
    v_mfma_f32_16x16x32_bf16 v[48:51], v[188:191], a[196:199], v[48:51]
    v_add_f32 v77, v77, v85
    v_mfma_f32_16x16x32_bf16 v[52:55], v[188:191], a[200:203], v[52:55]
    v_add_f32 v78, v78, v86
    v_add_f32 v79, v79, v87
    v_mfma_f32_16x16x32_bf16 v[56:59], v[188:191], a[204:207], v[56:59]
    buffer_load_dwordx2 v[40:41], v96, s[4:7], 0 offen sc1
    s_waitcnt vmcnt(18)
    v_mfma_f32_16x16x32_bf16 v[44:47], v[192:195], a[208:211], v[44:47]
    v_mul_f32 v76, v76, v100
    v_mul_f32 v77, v77, v101
    v_mfma_f32_16x16x32_bf16 v[48:51], v[192:195], a[212:215], v[48:51]
    v_mul_f32 v78, v78, v102
    v_mfma_f32_16x16x32_bf16 v[52:55], v[192:195], a[216:219], v[52:55]
    v_mul_f32 v79, v79, v103
    v_cvt_pk_bf16_f32 v106, v76, v77
    v_mfma_f32_16x16x32_bf16 v[56:59], v[192:195], a[220:223], v[56:59]
    buffer_load_dwordx4 v[244:247], v1, s[4:7], s56 offen offset:1024
    s_waitcnt vmcnt(18)
    v_mfma_f32_16x16x32_bf16 v[44:47], v[196:199], a[224:227], v[44:47]
    v_cvt_pk_bf16_f32 v107, v78, v79
    buffer_store_dwordx4 v[104:107], v1, s[4:7], s55 offen offset:0 sc1
    v_mfma_f32_16x16x32_bf16 v[48:51], v[196:199], a[228:231], v[48:51]
    v_mfma_f32_16x16x32_bf16 v[52:55], v[196:199], a[232:235], v[52:55]
    v_mfma_f32_16x16x32_bf16 v[56:59], v[196:199], a[236:239], v[56:59]
    s_waitcnt vmcnt(18)
    v_mfma_f32_16x16x32_bf16 v[44:47], v[200:203], a[240:243], v[44:47]
    v_mfma_f32_16x16x32_bf16 v[48:51], v[200:203], a[244:247], v[48:51]
    v_mfma_f32_16x16x32_bf16 v[52:55], v[200:203], a[248:251], v[52:55]
    v_mfma_f32_16x16x32_bf16 v[56:59], v[200:203], a[252:255], v[56:59]
    s_nop 4
    ds_write_b128 v97, v[44:47] offset:0
    ds_write_b128 v97, v[48:51] offset:1024
    ds_write_b128 v97, v[52:55] offset:2048
    ds_write_b128 v97, v[56:59] offset:3072
    s_waitcnt lgkmcnt(0)
    s_barrier
    ds_read_b128 v[92:95], v43 offset:13824
    ds_read_b128 v[76:79], v42 offset:0
    ds_read_b128 v[80:83], v42 offset:4096
    ds_read_b128 v[84:87], v42 offset:8192
    ds_read_b128 v[88:91], v42 offset:12288
    v_lshlrev_b32 v43, 7, v7
    v_add_u32 v43, s42, v43
    v_mov_b32 v42, v96
    s_waitcnt lgkmcnt(4)
    v_lshlrev_b32 v100, 16, v92
    v_and_b32 v101, 0xffff0000, v92
    v_lshlrev_b32 v102, 16, v93
    v_and_b32 v103, 0xffff0000, v93
    s_waitcnt lgkmcnt(3)
    v_pk_add_f32 v[76:77], v[76:77], v[24:25] op_sel_hi:[1,0]
    v_pk_add_f32 v[78:79], v[78:79], v[24:25] op_sel_hi:[1,0]
    s_waitcnt lgkmcnt(2)
    v_pk_add_f32 v[76:77], v[76:77], v[80:81]
    v_pk_add_f32 v[78:79], v[78:79], v[82:83]
    s_waitcnt lgkmcnt(0)
    v_pk_add_f32 v[84:85], v[84:85], v[88:89]
    v_pk_add_f32 v[86:87], v[86:87], v[90:91]
    v_pk_add_f32 v[76:77], v[76:77], v[84:85]
    v_pk_add_f32 v[78:79], v[78:79], v[86:87]
    v_pk_mul_f32 v[76:77], v[76:77], v[100:101]
    v_pk_mul_f32 v[78:79], v[78:79], v[102:103]
    v_cvt_pk_bf16_f32 v108, v76, v77
    v_cvt_pk_bf16_f32 v109, v78, v79
    buffer_store_dwordx2 v[108:109], v9, s[4:7], s53 offen offset:0 sc1
    s_mov_b32 s51, 0x20000
    s_waitcnt vmcnt(3)
    v_cmp_gt_u64 vcc, s[58:59], v[40:41]
    v_cmp_lt_u64 s[48:49], s[60:61], v[40:41]
    s_nop 0
    s_or_b64 vcc, vcc, s[48:49]
    s_cbranch_scc0 POLLD_15
    s_mov_b64 exec, 1
    buffer_store_dwordx2 v[26:27], off, s[4:7], s43 sc1
    s_mov_b64 exec, -1
POLL_14:
    buffer_load_dwordx2 v[40:41], v42, s[4:7], 0 offen sc1
    s_sub_u32 s51, s51, 1
    s_cbranch_scc1 POLLD_15X
    s_cmp_eq_u32 s51, 0x1ffd8
    s_cselect_b64 vcc, -1, 0
    v_cndmask_b32 v42, v42, v43, vcc
    s_waitcnt vmcnt(0)
    v_cmp_gt_u64 vcc, s[58:59], v[40:41]
    v_cmp_lt_u64 s[48:49], s[60:61], v[40:41]
    s_nop 0
    s_or_b64 vcc, vcc, s[48:49]
    s_cbranch_scc1 POLL_14
POLLD_15X:
    s_waitcnt vmcnt(0)
POLLD_15:
    s_add_u32 s48, s41, 0x1d00000
    buffer_load_dwordx4 v[112:115], v1, s[4:7], s48 offen offset:0 sc1
    buffer_load_dwordx4 v[116:119], v1, s[4:7], s48 offen offset:1024 sc1
    buffer_load_dwordx4 v[120:123], v1, s[4:7], s48 offen offset:3072 sc1
    s_add_u32 s48, s41, 0x1d01000
    buffer_load_dwordx4 v[124:127], v1, s[4:7], s48 offen offset:0 sc1
    buffer_load_dwordx4 v[128:131], v1, s[4:7], s48 offen offset:2048 sc1
    buffer_load_dwordx4 v[132:135], v1, s[4:7], s48 offen offset:3072 sc1
    s_add_u32 s48, s41, 0x1d02400
    buffer_load_dwordx4 v[136:139], v1, s[4:7], s48 offen offset:0 sc1
    buffer_load_dwordx4 v[140:143], v1, s[4:7], s48 offen offset:1024 sc1
    buffer_load_dwordx4 v[248:251], v1, s[4:7], s56 offen offset:2048
    buffer_load_dwordx4 v[252:255], v1, s[4:7], s56 offen offset:3072
    s_sub_u32 s58, s60, 8
    v_mov_b32 v26, s58
    s_mov_b64 exec, 1
    s_waitcnt vmcnt(10)
    buffer_store_dwordx2 v[26:27], off, s[4:7], s35
    s_mov_b64 exec, -1
    s_add_u32 s48, s41, 0x1d03000
    buffer_load_dwordx4 v[144:147], v1, s[4:7], s48 offen offset:0 sc1
    buffer_load_dwordx4 v[148:151], v1, s[4:7], s48 offen offset:1024 sc1
    buffer_load_dwordx4 v[152:155], v1, s[4:7], s48 offen offset:3072 sc1
    s_add_u32 s48, s41, 0x1d04000
    buffer_load_dwordx4 v[156:159], v1, s[4:7], s48 offen offset:0 sc1
    buffer_load_dwordx4 v[160:163], v1, s[4:7], s48 offen offset:2048 sc1
    buffer_load_dwordx4 v[164:167], v1, s[4:7], s48 offen offset:3072 sc1
    s_add_u32 s48, s41, 0x1d05400
    buffer_load_dwordx4 v[168:171], v1, s[4:7], s48 offen offset:0 sc1
    buffer_load_dwordx4 v[64:67], v1, s[4:7], s48 offen offset:1024 sc1
    s_barrier
    s_lshl_b32 s54, s22, 12
    s_add_u32 s52, s29, s54
    v_lshlrev_b32 v44, 16, v16
    v_and_b32 v45, 0xffff0000, v16
    v_lshlrev_b32 v46, 16, v17
    v_and_b32 v47, 0xffff0000, v17
    v_lshlrev_b32 v48, 16, v18
    v_and_b32 v49, 0xffff0000, v18
    v_lshlrev_b32 v50, 16, v19
    v_and_b32 v51, 0xffff0000, v19
    v_lshlrev_b32 v52, 16, v20
    v_and_b32 v53, 0xffff0000, v20
    v_lshlrev_b32 v54, 16, v21
    v_and_b32 v55, 0xffff0000, v21
    v_lshlrev_b32 v56, 16, v22
    v_and_b32 v57, 0xffff0000, v22
    v_lshlrev_b32 v58, 16, v23
    v_and_b32 v59, 0xffff0000, v23
    v_lshlrev_b32 v60, 16, v14
    v_and_b32 v61, 0xffff0000, v14
    v_lshlrev_b32 v62, 16, v15
    v_and_b32 v63, 0xffff0000, v15
    ds_read_b128 v[172:175], v1 offset:32768
    ds_read_b128 v[176:179], v1 offset:33792
    ds_read_b128 v[180:183], v1 offset:34816
    ds_read_b128 v[184:187], v1 offset:35840
    ds_read_b128 v[188:191], v1 offset:36864
    ds_read_b128 v[192:195], v1 offset:37888
    ds_read_b128 v[196:199], v1 offset:38912
    ds_read_b128 v[200:203], v1 offset:39936
    buffer_load_dwordx2 v[40:41], v42, s[4:7], 0 offen sc1
    s_mov_b32 s51, 0x20000
    s_mov_b64 exec, 1
    buffer_store_dwordx2 v[26:27], off, s[4:7], s43 sc1
    s_mov_b64 exec, -1
    s_lshr_b32 s50, s2, 3
    s_lshl_b32 s50, s50, 2
    s_add_u32 s50, s50, s22
    s_lshl_b32 s50, s50, 10
    v_add_u32 v68, s50, v1
    v_min_u32 v68, MK_codeend-CPF_18-32, v68
    s_getpc_b64 s[48:49]
CPF_18:
    global_load_dword v68, v68, s[48:49]
    s_waitcnt vmcnt(21) lgkmcnt(7)
    v_mfma_f32_16x16x32_bf16 v[44:47], v[172:175], v[112:115], v[44:47]
    ds_read_b128 v[172:175], v1 offset:40960
    s_waitcnt lgkmcnt(7)
    v_mfma_f32_16x16x32_bf16 v[48:51], v[176:179], v[112:115], v[48:51]
    ds_read_b128 v[176:179], v1 offset:41984
    s_waitcnt lgkmcnt(7)
    v_mfma_f32_16x16x32_bf16 v[52:55], v[180:183], v[112:115], v[52:55]
    ds_read_b128 v[180:183], v1 offset:48128
    s_waitcnt lgkmcnt(7)
    v_mfma_f32_16x16x32_bf16 v[56:59], v[184:187], v[112:115], v[56:59]
    ds_read_b128 v[184:187], v1 offset:49152
    s_waitcnt lgkmcnt(7)
    v_mfma_f32_16x16x32_bf16 v[60:63], v[188:191], v[112:115], v[60:63]
    ds_read_b128 v[188:191], v1 offset:50176
    s_waitcnt vmcnt(20) lgkmcnt(7)
    v_mfma_f32_16x16x32_bf16 v[44:47], v[192:195], v[116:119], v[44:47]
    ds_read_b128 v[192:195], v2 offset:0
    s_waitcnt lgkmcnt(7)
    v_mfma_f32_16x16x32_bf16 v[48:51], v[196:199], v[116:119], v[48:51]
    ds_read_b128 v[196:199], v2 offset:1024
    s_waitcnt lgkmcnt(7)
    v_mfma_f32_16x16x32_bf16 v[52:55], v[200:203], v[116:119], v[52:55]
    ds_read_b128 v[200:203], v2 offset:2048
    s_waitcnt lgkmcnt(7)
    v_mfma_f32_16x16x32_bf16 v[56:59], v[172:175], v[116:119], v[56:59]
    ds_read_b128 v[172:175], v2 offset:3072
    s_waitcnt lgkmcnt(7)
    v_mfma_f32_16x16x32_bf16 v[60:63], v[176:179], v[116:119], v[60:63]
    ds_read_b128 v[176:179], v2 offset:4096
    s_waitcnt vmcnt(19) lgkmcnt(7)
    v_mfma_f32_16x16x32_bf16 v[44:47], v[180:183], v[120:123], v[44:47]
    ds_read_b128 v[180:183], v2 offset:5120
    s_waitcnt lgkmcnt(7)
    v_mfma_f32_16x16x32_bf16 v[48:51], v[184:187], v[120:123], v[48:51]
    ds_read_b128 v[184:187], v2 offset:6144
    s_waitcnt lgkmcnt(7)
    v_mfma_f32_16x16x32_bf16 v[52:55], v[188:191], v[120:123], v[52:55]
    ds_read_b128 v[188:191], v2 offset:12288
    s_waitcnt lgkmcnt(7)
    v_mfma_f32_16x16x32_bf16 v[56:59], v[192:195], v[120:123], v[56:59]
    ds_read_b128 v[192:195], v2 offset:13312
    s_waitcnt lgkmcnt(7)
    v_mfma_f32_16x16x32_bf16 v[60:63], v[196:199], v[120:123], v[60:63]
    ds_read_b128 v[196:199], v2 offset:14336
    s_waitcnt vmcnt(18) lgkmcnt(7)
    v_mfma_f32_16x16x32_bf16 v[44:47], v[200:203], v[124:127], v[44:47]
    ds_read_b128 v[200:203], v2 offset:15360
    s_waitcnt lgkmcnt(7)
    v_mfma_f32_16x16x32_bf16 v[48:51], v[172:175], v[124:127], v[48:51]
    ds_read_b128 v[172:175], v2 offset:16384
    s_waitcnt lgkmcnt(7)
    v_mfma_f32_16x16x32_bf16 v[52:55], v[176:179], v[124:127], v[52:55]
    ds_read_b128 v[176:179], v2 offset:17408
    s_waitcnt lgkmcnt(7)
    v_mfma_f32_16x16x32_bf16 v[56:59], v[180:183], v[124:127], v[56:59]
    ds_read_b128 v[180:183], v2 offset:18432
    s_waitcnt lgkmcnt(7)
    v_mfma_f32_16x16x32_bf16 v[60:63], v[184:187], v[124:127], v[60:63]
    ds_read_b128 v[184:187], v2 offset:19456
    s_waitcnt vmcnt(17) lgkmcnt(7)
    v_mfma_f32_16x16x32_bf16 v[44:47], v[188:191], v[128:131], v[44:47]
    ds_read_b128 v[188:191], v2 offset:20480
    s_waitcnt lgkmcnt(7)
    v_mfma_f32_16x16x32_bf16 v[48:51], v[192:195], v[128:131], v[48:51]
    ds_read_b128 v[192:195], v2 offset:21504
    s_waitcnt lgkmcnt(7)
    v_mfma_f32_16x16x32_bf16 v[52:55], v[196:199], v[128:131], v[52:55]
    ds_read_b128 v[196:199], v2 offset:27648
    s_waitcnt lgkmcnt(7)
    v_mfma_f32_16x16x32_bf16 v[56:59], v[200:203], v[128:131], v[56:59]
    ds_read_b128 v[200:203], v2 offset:28672
    s_waitcnt lgkmcnt(7)
    v_mfma_f32_16x16x32_bf16 v[60:63], v[172:175], v[128:131], v[60:63]
    ds_read_b128 v[172:175], v2 offset:29696
    s_waitcnt vmcnt(16) lgkmcnt(7)
    v_mfma_f32_16x16x32_bf16 v[44:47], v[176:179], v[132:135], v[44:47]
    ds_read_b128 v[176:179], v2 offset:30720
    s_waitcnt lgkmcnt(7)
    v_mfma_f32_16x16x32_bf16 v[48:51], v[180:183], v[132:135], v[48:51]
    ds_read_b128 v[180:183], v2 offset:31744
    s_waitcnt lgkmcnt(7)
    v_mfma_f32_16x16x32_bf16 v[52:55], v[184:187], v[132:135], v[52:55]
    ds_read_b128 v[184:187], v2 offset:32768
    s_waitcnt lgkmcnt(7)
    v_mfma_f32_16x16x32_bf16 v[56:59], v[188:191], v[132:135], v[56:59]
    ds_read_b128 v[188:191], v2 offset:33792
    s_waitcnt lgkmcnt(7)
    v_mfma_f32_16x16x32_bf16 v[60:63], v[192:195], v[132:135], v[60:63]
    ds_read_b128 v[192:195], v2 offset:34816
    s_xor_b32 s56, s26, 0x3000000
    buffer_load_dwordx4 a[0:3], v1, s[4:7], s56 offen offset:0
    buffer_load_dwordx4 a[4:7], v1, s[4:7], s56 offen offset:1024
    buffer_load_dwordx4 a[8:11], v1, s[4:7], s56 offen offset:2048
    buffer_load_dwordx4 a[12:15], v1, s[4:7], s56 offen offset:3072
    s_xor_b32 s56, s26, 0x3001000
    buffer_load_dwordx4 a[16:19], v1, s[4:7], s56 offen offset:0
    buffer_load_dwordx4 a[20:23], v1, s[4:7], s56 offen offset:1024
    s_waitcnt vmcnt(8)
    v_cmp_gt_u64 vcc, s[58:59], v[40:41]
    v_cmp_lt_u64 s[48:49], s[60:61], v[40:41]
    s_nop 0
    s_or_b64 vcc, vcc, s[48:49]
    s_cbranch_scc0 POLLD_17
    s_nop 1
POLL_16:
    buffer_load_dwordx2 v[40:41], v42, s[4:7], 0 offen sc1
    s_sub_u32 s51, s51, 1
    s_cbranch_scc1 POLLD_17X
    s_cmp_eq_u32 s51, 0x1ffd8
    s_cselect_b64 vcc, -1, 0
    v_cndmask_b32 v42, v42, v43, vcc
    s_waitcnt vmcnt(0)
    v_cmp_gt_u64 vcc, s[58:59], v[40:41]
    v_cmp_lt_u64 s[48:49], s[60:61], v[40:41]
    s_nop 0
    s_or_b64 vcc, vcc, s[48:49]
    s_cbranch_scc1 POLL_16
POLLD_17X:
    s_waitcnt vmcnt(0)
POLLD_17:
    s_add_u32 s48, s41, 0x1d00800
    buffer_load_dwordx4 v[68:71], v1, s[4:7], s48 offen offset:0 sc1
    s_waitcnt lgkmcnt(7)
    v_mfma_f32_16x16x32_bf16 v[44:47], v[196:199], v[136:139], v[44:47]
    ds_read_b128 v[196:199], v2 offset:35840
    s_waitcnt lgkmcnt(7)
    v_mfma_f32_16x16x32_bf16 v[48:51], v[200:203], v[136:139], v[48:51]
    ds_read_b128 v[200:203], v2 offset:36864
    buffer_load_dwordx4 v[72:75], v1, s[4:7], s48 offen offset:3072 sc1
    s_waitcnt lgkmcnt(7)
    v_mfma_f32_16x16x32_bf16 v[52:55], v[172:175], v[136:139], v[52:55]
    ds_read_b128 v[172:175], v2 offset:43008
    s_waitcnt lgkmcnt(7)
    v_mfma_f32_16x16x32_bf16 v[56:59], v[176:179], v[136:139], v[56:59]
    ds_read_b128 v[176:179], v2 offset:44032
    s_add_u32 s48, s41, 0x1d02000
    buffer_load_dwordx4 v[76:79], v1, s[4:7], s48 offen offset:0 sc1
    s_waitcnt lgkmcnt(7)
    v_mfma_f32_16x16x32_bf16 v[60:63], v[180:183], v[136:139], v[60:63]
    ds_read_b128 v[180:183], v2 offset:45056
    s_waitcnt lgkmcnt(7)
    v_mfma_f32_16x16x32_bf16 v[44:47], v[184:187], v[140:143], v[44:47]
    ds_read_b128 v[184:187], v2 offset:46080
    buffer_load_dwordx4 v[80:83], v1, s[4:7], s48 offen offset:3072 sc1
    s_waitcnt lgkmcnt(7)
    v_mfma_f32_16x16x32_bf16 v[48:51], v[188:191], v[140:143], v[48:51]
    ds_read_b128 v[188:191], v2 offset:47104
    s_waitcnt lgkmcnt(7)
    v_mfma_f32_16x16x32_bf16 v[52:55], v[192:195], v[140:143], v[52:55]
    ds_read_b128 v[192:195], v2 offset:48128
    s_add_u32 s48, s41, 0x1d03800
    buffer_load_dwordx4 v[84:87], v1, s[4:7], s48 offen offset:0 sc1
    s_waitcnt lgkmcnt(7)
    v_mfma_f32_16x16x32_bf16 v[56:59], v[196:199], v[140:143], v[56:59]
    ds_read_b128 v[196:199], v2 offset:49152
    s_waitcnt lgkmcnt(7)
    v_mfma_f32_16x16x32_bf16 v[60:63], v[200:203], v[140:143], v[60:63]
    ds_read_b128 v[200:203], v2 offset:50176
    buffer_load_dwordx4 v[88:91], v1, s[4:7], s48 offen offset:3072 sc1
    s_waitcnt lgkmcnt(7)
    v_mfma_f32_16x16x32_bf16 v[44:47], v[172:175], v[144:147], v[44:47]
    ds_read_b128 v[172:175], v3 offset:0
    s_waitcnt lgkmcnt(7)
    v_mfma_f32_16x16x32_bf16 v[48:51], v[176:179], v[144:147], v[48:51]
    ds_read_b128 v[176:179], v3 offset:1024
    s_add_u32 s48, s41, 0x1d05000
    buffer_load_dwordx4 v[92:95], v1, s[4:7], s48 offen offset:0 sc1
    s_waitcnt lgkmcnt(7)
    v_mfma_f32_16x16x32_bf16 v[52:55], v[180:183], v[144:147], v[52:55]
    ds_read_b128 v[180:183], v3 offset:7168
    s_waitcnt lgkmcnt(7)
    v_mfma_f32_16x16x32_bf16 v[56:59], v[184:187], v[144:147], v[56:59]
    ds_read_b128 v[184:187], v3 offset:8192
    s_add_u32 s48, s41, 0x1d05c00
    buffer_load_dwordx2 v[96:97], v9, s[4:7], s48 offen offset:0 sc1
    s_waitcnt lgkmcnt(7)
    v_mfma_f32_16x16x32_bf16 v[60:63], v[188:191], v[144:147], v[60:63]
    ds_read_b128 v[188:191], v3 offset:9216
    s_waitcnt lgkmcnt(7)
    v_mfma_f32_16x16x32_bf16 v[44:47], v[192:195], v[148:151], v[44:47]
    ds_read_b128 v[192:195], v3 offset:10240
    buffer_load_dwordx2 v[98:99], v9, s[4:7], s48 offen offset:512 sc1
    s_waitcnt lgkmcnt(7)
    v_mfma_f32_16x16x32_bf16 v[48:51], v[196:199], v[148:151], v[48:51]
    ds_read_b128 v[196:199], v3 offset:11264
    s_waitcnt lgkmcnt(7)
    v_mfma_f32_16x16x32_bf16 v[52:55], v[200:203], v[148:151], v[52:55]
    ds_read_b128 v[200:203], v3 offset:12288
    buffer_load_dwordx2 v[100:101], v9, s[4:7], s48 offen offset:1024 sc1
    s_waitcnt lgkmcnt(7)
    v_mfma_f32_16x16x32_bf16 v[56:59], v[172:175], v[148:151], v[56:59]
    ds_read_b128 v[172:175], v3 offset:13312
    s_waitcnt lgkmcnt(7)
    v_mfma_f32_16x16x32_bf16 v[60:63], v[176:179], v[148:151], v[60:63]
    ds_read_b128 v[176:179], v3 offset:14336
    buffer_load_dwordx2 v[102:103], v9, s[4:7], s48 offen offset:1536 sc1
    s_waitcnt lgkmcnt(7)
    v_mfma_f32_16x16x32_bf16 v[44:47], v[180:183], v[152:155], v[44:47]
    ds_read_b128 v[180:183], v3 offset:15360
    s_waitcnt lgkmcnt(7)
    v_mfma_f32_16x16x32_bf16 v[48:51], v[184:187], v[152:155], v[48:51]
    ds_read_b128 v[184:187], v3 offset:16384
    buffer_load_dwordx2 v[104:105], v9, s[4:7], s48 offen offset:2048 sc1
    s_waitcnt lgkmcnt(7)
    v_mfma_f32_16x16x32_bf16 v[52:55], v[188:191], v[152:155], v[52:55]
    ds_read_b128 v[188:191], v3 offset:22528
    s_waitcnt lgkmcnt(7)
    v_mfma_f32_16x16x32_bf16 v[56:59], v[192:195], v[152:155], v[56:59]
    ds_read_b128 v[192:195], v3 offset:23552
    buffer_load_dwordx2 v[106:107], v9, s[4:7], s48 offen offset:2560 sc1
    s_waitcnt lgkmcnt(7)
    v_mfma_f32_16x16x32_bf16 v[60:63], v[196:199], v[152:155], v[60:63]
    ds_read_b128 v[196:199], v3 offset:24576
    s_waitcnt lgkmcnt(7)
    v_mfma_f32_16x16x32_bf16 v[44:47], v[200:203], v[156:159], v[44:47]
    ds_read_b128 v[200:203], v3 offset:25600
    buffer_load_dwordx2 v[108:109], v9, s[4:7], s48 offen offset:3072 sc1
    s_waitcnt lgkmcnt(7)
    v_mfma_f32_16x16x32_bf16 v[48:51], v[172:175], v[156:159], v[48:51]
    ds_read_b128 v[172:175], v3 offset:26624
    s_waitcnt lgkmcnt(7)
    v_mfma_f32_16x16x32_bf16 v[52:55], v[176:179], v[156:159], v[52:55]
    ds_read_b128 v[176:179], v3 offset:27648
    buffer_load_dwordx2 v[110:111], v9, s[4:7], s48 offen offset:3584 sc1
    s_waitcnt lgkmcnt(7)
    v_mfma_f32_16x16x32_bf16 v[56:59], v[180:183], v[156:159], v[56:59]
    ds_read_b128 v[180:183], v3 offset:28672
    s_waitcnt lgkmcnt(7)
    v_mfma_f32_16x16x32_bf16 v[60:63], v[184:187], v[156:159], v[60:63]
    ds_read_b128 v[184:187], v3 offset:29696
    s_add_u32 s49, s52, 0x5f2c00
    s_add_u32 m0, s54, 0x0
    s_nop 0
    buffer_load_dwordx4 v1, s[4:7], s49 offen offset:0 lds
    s_waitcnt lgkmcnt(7)
    v_mfma_f32_16x16x32_bf16 v[44:47], v[188:191], v[160:163], v[44:47]
    ds_read_b128 v[188:191], v3 offset:30720
    s_waitcnt lgkmcnt(7)
    v_mfma_f32_16x16x32_bf16 v[48:51], v[192:195], v[160:163], v[48:51]
    ds_read_b128 v[192:195], v3 offset:31744
    buffer_load_dwordx4 v1, s[4:7], s49 offen offset:1024 lds
    s_waitcnt lgkmcnt(7)
    v_mfma_f32_16x16x32_bf16 v[52:55], v[196:199], v[160:163], v[52:55]
    ds_read_b128 v[196:199], v1 offset:18432
    s_waitcnt lgkmcnt(7)
    v_mfma_f32_16x16x32_bf16 v[56:59], v[200:203], v[160:163], v[56:59]
    ds_read_b128 v[200:203], v1 offset:19456
    buffer_load_dwordx4 v1, s[4:7], s49 offen offset:2048 lds
    s_waitcnt lgkmcnt(7)
    v_mfma_f32_16x16x32_bf16 v[60:63], v[172:175], v[160:163], v[60:63]
    ds_read_b128 v[172:175], v1 offset:20480
    s_waitcnt lgkmcnt(7)
    v_mfma_f32_16x16x32_bf16 v[44:47], v[176:179], v[164:167], v[44:47]
    ds_read_b128 v[176:179], v1 offset:21504
    buffer_load_dwordx4 v1, s[4:7], s49 offen offset:3072 lds
    s_waitcnt lgkmcnt(7)
    v_mfma_f32_16x16x32_bf16 v[48:51], v[180:183], v[164:167], v[48:51]
    ds_read_b128 v[180:183], v1 offset:22528
    s_waitcnt lgkmcnt(7)
    v_mfma_f32_16x16x32_bf16 v[52:55], v[184:187], v[164:167], v[52:55]
    ds_read_b128 v[184:187], v1 offset:23552
    s_waitcnt lgkmcnt(7)
    v_mfma_f32_16x16x32_bf16 v[56:59], v[188:191], v[164:167], v[56:59]
    ds_read_b128 v[188:191], v1 offset:24576
    s_waitcnt lgkmcnt(7)
    v_mfma_f32_16x16x32_bf16 v[60:63], v[192:195], v[164:167], v[60:63]
    ds_read_b128 v[192:195], v1 offset:25600
    s_waitcnt lgkmcnt(7)
    v_mfma_f32_16x16x32_bf16 v[44:47], v[196:199], v[168:171], v[44:47]
    ds_read_b128 v[196:199], v1 offset:26624
    s_waitcnt lgkmcnt(7)
    v_mfma_f32_16x16x32_bf16 v[48:51], v[200:203], v[168:171], v[48:51]
    ds_read_b128 v[200:203], v1 offset:27648
    s_waitcnt lgkmcnt(7)
    v_mfma_f32_16x16x32_bf16 v[52:55], v[172:175], v[168:171], v[52:55]
    ds_read_b128 v[172:175], v1 offset:43008
    s_waitcnt lgkmcnt(7)
    v_mfma_f32_16x16x32_bf16 v[56:59], v[176:179], v[168:171], v[56:59]
    ds_read_b128 v[176:179], v1 offset:44032
    s_waitcnt lgkmcnt(7)
    v_mfma_f32_16x16x32_bf16 v[60:63], v[180:183], v[168:171], v[60:63]
    ds_read_b128 v[180:183], v1 offset:45056
    s_waitcnt lgkmcnt(7)
    v_mfma_f32_16x16x32_bf16 v[44:47], v[184:187], v[64:67], v[44:47]
    ds_read_b128 v[184:187], v1 offset:46080
    s_waitcnt lgkmcnt(7)
    v_mfma_f32_16x16x32_bf16 v[48:51], v[188:191], v[64:67], v[48:51]
    buffer_load_dwordx4 a[24:27], v1, s[4:7], s56 offen offset:2048
    ds_read_b128 v[188:191], v1 offset:47104
    s_waitcnt lgkmcnt(7)
    v_mfma_f32_16x16x32_bf16 v[52:55], v[192:195], v[64:67], v[52:55]
    ds_read_b128 v[192:195], v2 offset:7168
    s_waitcnt lgkmcnt(7)
    v_mfma_f32_16x16x32_bf16 v[56:59], v[196:199], v[64:67], v[56:59]
    ds_read_b128 v[196:199], v2 offset:8192
    s_waitcnt lgkmcnt(7)
    v_mfma_f32_16x16x32_bf16 v[60:63], v[200:203], v[64:67], v[60:63]
    ds_read_b128 v[200:203], v2 offset:9216
    s_waitcnt vmcnt(19) lgkmcnt(7)
    v_mfma_f32_16x16x32_bf16 v[44:47], v[172:175], v[68:71], v[44:47]
    ds_read_b128 v[172:175], v2 offset:10240
    s_waitcnt lgkmcnt(7)
    v_mfma_f32_16x16x32_bf16 v[48:51], v[176:179], v[68:71], v[48:51]
    buffer_load_dwordx4 a[28:31], v1, s[4:7], s56 offen offset:3072
    ds_read_b128 v[176:179], v2 offset:11264
    s_waitcnt lgkmcnt(7)
    v_mfma_f32_16x16x32_bf16 v[52:55], v[180:183], v[68:71], v[52:55]
    ds_read_b128 v[180:183], v2 offset:22528
    s_waitcnt lgkmcnt(7)
    v_mfma_f32_16x16x32_bf16 v[56:59], v[184:187], v[68:71], v[56:59]
    ds_read_b128 v[184:187], v2 offset:23552
    s_waitcnt lgkmcnt(7)
    v_mfma_f32_16x16x32_bf16 v[60:63], v[188:191], v[68:71], v[60:63]
    ds_read_b128 v[188:191], v2 offset:24576
    s_waitcnt vmcnt(19) lgkmcnt(7)
    v_mfma_f32_16x16x32_bf16 v[44:47], v[192:195], v[72:75], v[44:47]
    ds_read_b128 v[192:195], v2 offset:25600
    s_waitcnt lgkmcnt(7)
    v_mfma_f32_16x16x32_bf16 v[48:51], v[196:199], v[72:75], v[48:51]
    s_xor_b32 s56, s26, 0x3002000
    buffer_load_dwordx4 a[32:35], v1, s[4:7], s56 offen offset:0
    ds_read_b128 v[196:199], v2 offset:26624
    s_waitcnt lgkmcnt(7)
    v_mfma_f32_16x16x32_bf16 v[52:55], v[200:203], v[72:75], v[52:55]
    ds_read_b128 v[200:203], v2 offset:37888
    s_waitcnt lgkmcnt(7)
    v_mfma_f32_16x16x32_bf16 v[56:59], v[172:175], v[72:75], v[56:59]
    ds_read_b128 v[172:175], v2 offset:38912
    s_waitcnt lgkmcnt(7)
    v_mfma_f32_16x16x32_bf16 v[60:63], v[176:179], v[72:75], v[60:63]
    ds_read_b128 v[176:179], v2 offset:39936
    s_waitcnt vmcnt(19) lgkmcnt(7)
    v_mfma_f32_16x16x32_bf16 v[44:47], v[180:183], v[76:79], v[44:47]
    ds_read_b128 v[180:183], v2 offset:40960
    s_waitcnt lgkmcnt(7)
    v_mfma_f32_16x16x32_bf16 v[48:51], v[184:187], v[76:79], v[48:51]
    buffer_load_dwordx4 a[36:39], v1, s[4:7], s56 offen offset:1024
    ds_read_b128 v[184:187], v2 offset:41984
    s_waitcnt lgkmcnt(7)
    v_mfma_f32_16x16x32_bf16 v[52:55], v[188:191], v[76:79], v[52:55]
    ds_read_b128 v[188:191], v3 offset:2048
    s_waitcnt lgkmcnt(7)
    v_mfma_f32_16x16x32_bf16 v[56:59], v[192:195], v[76:79], v[56:59]
    ds_read_b128 v[192:195], v3 offset:3072
    s_waitcnt lgkmcnt(7)
    v_mfma_f32_16x16x32_bf16 v[60:63], v[196:199], v[76:79], v[60:63]
    ds_read_b128 v[196:199], v3 offset:4096
    s_waitcnt vmcnt(19) lgkmcnt(7)
    v_mfma_f32_16x16x32_bf16 v[44:47], v[200:203], v[80:83], v[44:47]
    ds_read_b128 v[200:203], v3 offset:5120
    s_waitcnt lgkmcnt(7)
    v_mfma_f32_16x16x32_bf16 v[48:51], v[172:175], v[80:83], v[48:51]
    buffer_load_dwordx4 a[40:43], v1, s[4:7], s56 offen offset:2048
    ds_read_b128 v[172:175], v3 offset:6144
    s_waitcnt lgkmcnt(7)
    v_mfma_f32_16x16x32_bf16 v[52:55], v[176:179], v[80:83], v[52:55]
    ds_read_b128 v[176:179], v3 offset:17408
    s_waitcnt lgkmcnt(7)
    v_mfma_f32_16x16x32_bf16 v[56:59], v[180:183], v[80:83], v[56:59]
    ds_read_b128 v[180:183], v3 offset:18432
    s_waitcnt lgkmcnt(7)
    v_mfma_f32_16x16x32_bf16 v[60:63], v[184:187], v[80:83], v[60:63]
    ds_read_b128 v[184:187], v3 offset:19456
    s_waitcnt vmcnt(19) lgkmcnt(7)
    v_mfma_f32_16x16x32_bf16 v[44:47], v[188:191], v[84:87], v[44:47]
    ds_read_b128 v[188:191], v3 offset:20480
    s_waitcnt lgkmcnt(7)
    v_mfma_f32_16x16x32_bf16 v[48:51], v[192:195], v[84:87], v[48:51]
    buffer_load_dwordx4 a[44:47], v1, s[4:7], s56 offen offset:3072
    ds_read_b128 v[192:195], v3 offset:21504
    s_waitcnt lgkmcnt(7)
    v_mfma_f32_16x16x32_bf16 v[52:55], v[196:199], v[84:87], v[52:55]
    ds_read_b128 v[196:199], v3 offset:32768
    s_waitcnt lgkmcnt(7)
    v_mfma_f32_16x16x32_bf16 v[56:59], v[200:203], v[84:87], v[56:59]
    ds_read_b128 v[200:203], v3 offset:33792
    s_waitcnt lgkmcnt(7)
    v_mfma_f32_16x16x32_bf16 v[60:63], v[172:175], v[84:87], v[60:63]
    ds_read_b128 v[172:175], v3 offset:34816
    s_waitcnt vmcnt(19) lgkmcnt(7)
    v_mfma_f32_16x16x32_bf16 v[44:47], v[176:179], v[88:91], v[44:47]
    ds_read_b128 v[176:179], v1 offset:16384
    s_waitcnt lgkmcnt(7)
    v_mfma_f32_16x16x32_bf16 v[48:51], v[180:183], v[88:91], v[48:51]
    s_xor_b32 s56, s26, 0x3003000
    buffer_load_dwordx4 a[48:51], v1, s[4:7], s56 offen offset:0
    ds_read_b128 v[180:183], v1 offset:17408
    s_waitcnt lgkmcnt(7)
    v_mfma_f32_16x16x32_bf16 v[52:55], v[184:187], v[88:91], v[52:55]
    ds_read_b128 v[184:187], v1 offset:28672
    s_waitcnt lgkmcnt(7)
    v_mfma_f32_16x16x32_bf16 v[56:59], v[188:191], v[88:91], v[56:59]
    ds_read_b128 v[188:191], v1 offset:29696
    s_waitcnt lgkmcnt(7)
    v_mfma_f32_16x16x32_bf16 v[60:63], v[192:195], v[88:91], v[60:63]
    ds_read_b128 v[192:195], v1 offset:30720
    s_waitcnt vmcnt(19) lgkmcnt(7)
    v_mfma_f32_16x16x32_bf16 v[44:47], v[196:199], v[92:95], v[44:47]
    ds_read_b128 v[196:199], v1 offset:31744
    s_waitcnt vmcnt(7)
    s_barrier
    s_waitcnt lgkmcnt(7)
    v_mfma_f32_16x16x32_bf16 v[48:51], v[200:203], v[92:95], v[48:51]
    buffer_load_dwordx4 a[52:55], v1, s[4:7], s56 offen offset:1024
    ds_read_b128 v[200:203], v1 offset:0
    s_waitcnt lgkmcnt(7)
    v_mfma_f32_16x16x32_bf16 v[52:55], v[172:175], v[92:95], v[52:55]
    ds_read_b128 v[172:175], v1 offset:1024
    s_waitcnt lgkmcnt(7)
    v_mfma_f32_16x16x32_bf16 v[56:59], v[176:179], v[92:95], v[56:59]
    ds_read_b128 v[176:179], v1 offset:2048
    s_waitcnt lgkmcnt(7)
    v_mfma_f32_16x16x32_bf16 v[60:63], v[180:183], v[92:95], v[60:63]
    ds_read_b128 v[180:183], v1 offset:3072
    s_waitcnt lgkmcnt(7)
    v_mfma_f32_16x16x32_bf16 v[44:47], v[184:187], v[96:99], v[44:47]
    ds_read_b128 v[184:187], v1 offset:4096
    s_waitcnt lgkmcnt(7)
    v_mfma_f32_16x16x32_bf16 v[48:51], v[188:191], v[96:99], v[48:51]
    ds_read_b128 v[188:191], v1 offset:5120
    s_waitcnt lgkmcnt(7)
    v_mfma_f32_16x16x32_bf16 v[52:55], v[192:195], v[96:99], v[52:55]
    ds_read_b128 v[192:195], v1 offset:6144
    s_waitcnt lgkmcnt(7)
    v_mfma_f32_16x16x32_bf16 v[56:59], v[196:199], v[96:99], v[56:59]
    ds_read_b128 v[196:199], v1 offset:7168
    s_waitcnt lgkmcnt(7)
    v_mfma_f32_16x16x32_bf16 v[60:63], v[200:203], v[96:99], v[60:63]
    ds_read_b128 v[200:203], v1 offset:8192
    s_waitcnt lgkmcnt(7)
    v_mfma_f32_16x16x32_bf16 v[44:47], v[172:175], v[100:103], v[44:47]
    ds_read_b128 v[172:175], v1 offset:9216
    s_waitcnt lgkmcnt(7)
    v_mfma_f32_16x16x32_bf16 v[48:51], v[176:179], v[100:103], v[48:51]
    ds_read_b128 v[176:179], v1 offset:10240
    s_waitcnt lgkmcnt(7)
    v_mfma_f32_16x16x32_bf16 v[52:55], v[180:183], v[100:103], v[52:55]
    ds_read_b128 v[180:183], v1 offset:11264
    s_waitcnt lgkmcnt(7)
    v_mfma_f32_16x16x32_bf16 v[56:59], v[184:187], v[100:103], v[56:59]
    ds_read_b128 v[184:187], v1 offset:12288
    s_waitcnt lgkmcnt(7)
    v_mfma_f32_16x16x32_bf16 v[60:63], v[188:191], v[100:103], v[60:63]
    ds_read_b128 v[188:191], v1 offset:13312
    s_waitcnt lgkmcnt(7)
    v_mfma_f32_16x16x32_bf16 v[44:47], v[192:195], v[104:107], v[44:47]
    ds_read_b128 v[192:195], v1 offset:14336
    s_waitcnt lgkmcnt(7)
    v_mfma_f32_16x16x32_bf16 v[48:51], v[196:199], v[104:107], v[48:51]
    ds_read_b128 v[196:199], v1 offset:15360
    s_waitcnt lgkmcnt(7)
    v_mfma_f32_16x16x32_bf16 v[52:55], v[200:203], v[104:107], v[52:55]
    s_waitcnt lgkmcnt(6)
    v_mfma_f32_16x16x32_bf16 v[56:59], v[172:175], v[104:107], v[56:59]
    s_waitcnt lgkmcnt(5)
    v_mfma_f32_16x16x32_bf16 v[60:63], v[176:179], v[104:107], v[60:63]
    s_waitcnt lgkmcnt(4)
    v_mfma_f32_16x16x32_bf16 v[44:47], v[180:183], v[108:111], v[44:47]
    s_waitcnt lgkmcnt(3)
    v_mfma_f32_16x16x32_bf16 v[48:51], v[184:187], v[108:111], v[48:51]
    s_waitcnt lgkmcnt(2)
    v_mfma_f32_16x16x32_bf16 v[52:55], v[188:191], v[108:111], v[52:55]
    s_waitcnt lgkmcnt(1)
    v_mfma_f32_16x16x32_bf16 v[56:59], v[192:195], v[108:111], v[56:59]
    s_waitcnt lgkmcnt(0)
    v_mfma_f32_16x16x32_bf16 v[60:63], v[196:199], v[108:111], v[60:63]
    v_cvt_pk_bf16_f32 v16, v44, v45
    v_cvt_pk_bf16_f32 v17, v46, v47
    v_cvt_pk_bf16_f32 v18, v48, v49
    v_cvt_pk_bf16_f32 v19, v50, v51
    v_cvt_pk_bf16_f32 v20, v52, v53
    v_cvt_pk_bf16_f32 v21, v54, v55
    v_cvt_pk_bf16_f32 v22, v56, v57
    v_cvt_pk_bf16_f32 v23, v58, v59
    v_cvt_pk_bf16_f32 v14, v60, v61
    v_cvt_pk_bf16_f32 v15, v62, v63
    s_add_u32 s48, s32, 0xc00000
    buffer_store_dwordx4 v[16:19], v1, s[4:7], s48 offen offset:0 sc1
    s_add_u32 s49, s32, 0xc01000
    buffer_store_dwordx4 v[20:23], v1, s[4:7], s49 offen offset:0 sc1
    s_add_u32 s50, s33, 0xc00000
    buffer_store_dwordx2 v[14:15], v9, s[4:7], s50 offen offset:0 sc1
    v_dot2_f32_bf16 v44, v14, v36, 0
    v_dot2_f32_bf16 v46, v14, v14, 0
    v_dot2_f32_bf16 v45, v15, v36, 0
    v_dot2_f32_bf16 v47, v15, v15, 0
    v_dot2_f32_bf16 v44, v16, v36, v44
    v_dot2_f32_bf16 v46, v16, v16, v46
    v_dot2_f32_bf16 v45, v17, v36, v45
    v_dot2_f32_bf16 v47, v17, v17, v47
    v_dot2_f32_bf16 v44, v18, v36, v44
    v_dot2_f32_bf16 v46, v18, v18, v46
    v_dot2_f32_bf16 v45, v19, v36, v45
    v_dot2_f32_bf16 v47, v19, v19, v47
    v_dot2_f32_bf16 v44, v20, v36, v44
    v_dot2_f32_bf16 v46, v20, v20, v46
    v_dot2_f32_bf16 v45, v21, v36, v45
    v_dot2_f32_bf16 v47, v21, v21, v47
    v_dot2_f32_bf16 v44, v22, v36, v44
    v_dot2_f32_bf16 v46, v22, v22, v46
    v_dot2_f32_bf16 v45, v23, v36, v45
    v_dot2_f32_bf16 v47, v23, v23, v47
    s_nop 1
    v_add_f32 v44, v44, v45
    v_add_f32 v45, v46, v47
    s_nop 1
    v_permlane32_swap_b32 v44, v45
    v_add_f32 v44, v44, v45
    v_mov_b32 v45, v44
    s_nop 1
    v_permlane16_swap_b32 v44, v45
    v_add_f32 v44, v44, v45
    s_add_u32 s48, s46, 0x7b0000
    buffer_store_dword v44, v13, s[4:7], s48 offen offset:0 sc1
    buffer_load_dwordx4 a[56:59], v1, s[4:7], s56 offen offset:2048
    buffer_load_dwordx4 a[60:63], v1, s[4:7], s56 offen offset:3072
    s_xor_b32 s56, s26, 0x3004000
    buffer_load_dwordx4 a[64:67], v1, s[4:7], s56 offen offset:0
    buffer_load_dwordx4 a[68:71], v1, s[4:7], s56 offen offset:1024
    s_sub_u32 s58, s60, 7
    v_mov_b32 v26, s58
    s_mov_b64 exec, 1
    s_waitcnt vmcnt(4)
    buffer_store_dwordx2 v[26:27], off, s[4:7], s43 sc1
    buffer_store_dwordx2 v[26:27], off, s[4:7], s35
    s_mov_b64 exec, -1
    s_barrier
    v_lshrrev_b32 v41, 3, v4
    v_and_b32 v42, 7, v4
    v_lshlrev_b32 v6, 10, v41
    v_lshl_add_u32 v6, v5, 8, v6
    v_lshl_add_u32 v6, v42, 4, v6
    v_add_u32 v6, 2176, v6
    v_lshrrev_b32 v191, 3, v0
    v_lshlrev_b32 v190, 7, v191
    v_and_b32 v191, 3, v0
    v_lshl_add_u32 v190, v191, 4, v190
    v_bfe_u32 v191, v0, 2, 1
    v_lshl_add_u32 v190, v191, 10, v190
    v_add_u32 v190, 2112, v190
    s_sub_u32 s53, s25, s24
    s_mul_i32 s54, s22, 5120
    v_lshlrev_b32 v43, 7, v7
    v_add_u32 v43, s42, v43
    v_lshl_add_u32 v42, v7, 3, s34
    s_sub_u32 s48, s20, s23
    s_lshl_b32 s49, s48, 8
    s_lshl_b32 s48, s48, 12
    s_mov_b32 exec_lo, 0
    v_or_b32 v41, 16, v7
    v_sub_u32 v41, v41, v7
    v_lshl_add_u32 v43, v41, 7, v43
    v_lshl_add_u32 v42, v41, 3, v42
    v_subrev_u32 v43, s48, v43
    v_subrev_u32 v42, s49, v42
    s_and_b32 s48, s23, 3
    s_cmp_eq_u32 s48, 3
    s_cselect_b64 vcc, -1, 0
    v_cndmask_b32 v42, v42, v43, vcc
    s_mov_b64 exec, -1
    buffer_load_dwordx2 v[40:41], v42, s[4:7], 0 offen sc1
    s_mov_b32 s51, 0x20000
    buffer_load_dwordx4 a[72:75], v1, s[4:7], s56 offen offset:2048
    buffer_load_dwordx4 a[76:79], v1, s[4:7], s56 offen offset:3072
    s_xor_b32 s56, s26, 0x3008000
    buffer_load_dwordx4 a[80:83], v1, s[4:7], s56 offen offset:0
    buffer_load_dwordx4 a[84:87], v1, s[4:7], s56 offen offset:1024
    buffer_load_dwordx4 a[88:91], v1, s[4:7], s56 offen offset:2048
    buffer_load_dwordx4 a[92:95], v1, s[4:7], s56 offen offset:3072
    s_xor_b32 s56, s26, 0x3009000
    buffer_load_dwordx4 a[96:99], v1, s[4:7], s56 offen offset:0
    buffer_load_dwordx4 a[100:103], v1, s[4:7], s56 offen offset:1024
    buffer_load_dwordx4 a[104:107], v1, s[4:7], s56 offen offset:2048
    buffer_load_dwordx4 a[108:111], v1, s[4:7], s56 offen offset:3072
    s_waitcnt vmcnt(10)
    v_cmp_gt_u64 vcc, s[58:59], v[40:41]
    v_cmp_lt_u64 s[48:49], s[60:61], v[40:41]
    s_nop 0
    s_or_b64 vcc, vcc, s[48:49]
    s_cbranch_scc0 POLLD_20
    s_nop 1
POLL_19:
    buffer_load_dwordx2 v[40:41], v42, s[4:7], 0 offen sc1
    s_sub_u32 s51, s51, 1
    s_cbranch_scc1 POLLD_20X
    s_cmp_eq_u32 s51, 0x1ffd8
    s_cselect_b64 vcc, -1, 0
    v_cndmask_b32 v42, v42, v43, vcc
    s_waitcnt vmcnt(0)
    v_cmp_gt_u64 vcc, s[58:59], v[40:41]
    v_cmp_lt_u64 s[48:49], s[60:61], v[40:41]
    s_nop 0
    s_or_b64 vcc, vcc, s[48:49]
    s_cbranch_scc1 POLL_19
POLLD_20X:
    s_waitcnt vmcnt(0)
POLLD_20:
    s_add_u32 s49, s62, 0xc00000
    s_add_u32 m0, s54, 0x0
    s_nop 0
    buffer_load_dwordx4 v1, s[4:7], s49 offen offset:0 sc1 lds
    buffer_load_dwordx4 v1, s[4:7], s49 offen offset:1024 sc1 lds
    buffer_load_dwordx4 v1, s[4:7], s49 offen offset:2048 sc1 lds
    buffer_load_dwordx4 v1, s[4:7], s49 offen offset:3072 sc1 lds
    s_add_u32 s49, s49, s53
    s_add_u32 m0, s54, 0x1000
    s_cmp_eq_u32 s22, 2
    s_cselect_b64 vcc, -1, 0
    v_cndmask_b32 v191, v6, v190, vcc
    buffer_load_dwordx4 v191, s[4:7], s49 offen sc1 lds
    s_add_u32 s49, s63, 0xc00000
    s_add_u32 m0, s54, 0x5000
    s_nop 0
    buffer_load_dwordx4 v1, s[4:7], s49 offen offset:0 sc1 lds
    buffer_load_dwordx4 v1, s[4:7], s49 offen offset:1024 sc1 lds
    buffer_load_dwordx4 v1, s[4:7], s49 offen offset:2048 sc1 lds
    buffer_load_dwordx4 v1, s[4:7], s49 offen offset:3072 sc1 lds
    s_add_u32 s49, s49, s53
    s_add_u32 m0, s54, 0x6000
    s_cmp_eq_u32 s22, 3
    s_cselect_b64 vcc, -1, 0
    v_cndmask_b32 v191, v6, v190, vcc
    buffer_load_dwordx4 v191, s[4:7], s49 offen sc1 lds
    s_add_u32 s49, s64, 0xc00000
    s_add_u32 m0, s54, 0xa000
    s_nop 0
    buffer_load_dwordx4 v1, s[4:7], s49 offen offset:0 sc1 lds
    buffer_load_dwordx4 v1, s[4:7], s49 offen offset:1024 sc1 lds
    buffer_load_dwordx4 v1, s[4:7], s49 offen offset:2048 sc1 lds
    buffer_load_dwordx4 v1, s[4:7], s49 offen offset:3072 sc1 lds
    s_add_u32 s49, s49, s53
    s_add_u32 m0, s54, 0xb000
    s_nop 0
    buffer_load_dwordx4 v6, s[4:7], s49 offen sc1 lds
    s_add_u32 s49, s65, 0xc00000
    s_add_u32 m0, s54, 0xf000
    s_nop 0
    buffer_load_dwordx4 v1, s[4:7], s49 offen offset:0 sc1 lds
    buffer_load_dwordx4 v1, s[4:7], s49 offen offset:1024 sc1 lds
    buffer_load_dwordx4 v1, s[4:7], s49 offen offset:2048 sc1 lds
    buffer_load_dwordx4 v1, s[4:7], s49 offen offset:3072 sc1 lds
    s_add_u32 s49, s49, s53
    s_add_u32 m0, s54, 0x10000
    s_cmp_eq_u32 s22, 0
    s_cselect_b64 vcc, -1, 0
    v_cndmask_b32 v191, v6, v190, vcc
    buffer_load_dwordx4 v191, s[4:7], s49 offen sc1 lds
    s_add_u32 s49, s66, 0xc00000
    s_add_u32 m0, s54, 0x14000
    s_nop 0
    buffer_load_dwordx4 v1, s[4:7], s49 offen offset:0 sc1 lds
    buffer_load_dwordx4 v1, s[4:7], s49 offen offset:1024 sc1 lds
    buffer_load_dwordx4 v1, s[4:7], s49 offen offset:2048 sc1 lds
    buffer_load_dwordx4 v1, s[4:7], s49 offen offset:3072 sc1 lds
    s_add_u32 s49, s49, s53
    s_add_u32 m0, s54, 0x15000
    s_cmp_eq_u32 s22, 1
    s_cselect_b64 vcc, -1, 0
    v_cndmask_b32 v191, v6, v190, vcc
    buffer_load_dwordx4 v191, s[4:7], s49 offen sc1 lds
    s_lshl_b32 s48, s22, 8
    v_lshlrev_b32 v190, 4, v5
    v_add_u32 v190, s48, v190
    v_add_u32 v190, 160768, v190
    v_lshrrev_b32 v191, 3, v4
    v_lshl_add_u32 v191, v191, 3, v4
    v_lshlrev_b32 v191, 3, v191
    v_add_u32 v191, 320, v191
    s_waitcnt vmcnt(20)
    s_barrier
    ds_read_b128 v[140:143], v1 offset:0
    ds_read_b128 v[144:147], v1 offset:1024
    ds_read_b128 v[148:151], v1 offset:2048
    ds_read_b128 v[152:155], v1 offset:3072
    ds_read_b128 v[156:159], v1 offset:4096
    s_waitcnt lgkmcnt(4)
    v_mfma_f32_16x16x32_bf16 v[60:63], a[0:3], v[140:143], 0
    ds_read_b128 v[160:163], v1 offset:5120
    v_mfma_f32_16x16x32_bf16 v[80:83], a[4:7], v[140:143], 0
    s_add_u32 s48, s44, 0x7b0000
    v_mfma_f32_16x16x32_bf16 v[100:103], a[8:11], v[140:143], 0
    buffer_load_dwordx2 v[44:45], v9, s[4:7], s48 offen offset:0 sc1
    v_mfma_f32_16x16x32_bf16 v[120:123], a[12:15], v[140:143], 0
    buffer_load_dwordx2 v[46:47], v9, s[4:7], s48 offen offset:512 sc1
    s_waitcnt lgkmcnt(4)
    v_mfma_f32_16x16x32_bf16 v[64:67], a[0:3], v[144:147], 0
    ds_read_b128 v[164:167], v1 offset:6144
    v_mfma_f32_16x16x32_bf16 v[84:87], a[4:7], v[144:147], 0
    buffer_load_dwordx2 v[48:49], v9, s[4:7], s48 offen offset:1024 sc1
    v_mfma_f32_16x16x32_bf16 v[104:107], a[8:11], v[144:147], 0
    buffer_load_dwordx2 v[50:51], v9, s[4:7], s48 offen offset:1536 sc1
    v_mfma_f32_16x16x32_bf16 v[124:127], a[12:15], v[144:147], 0
    buffer_load_dwordx2 v[52:53], v9, s[4:7], s48 offen offset:2048 sc1
    s_waitcnt lgkmcnt(4)
    v_mfma_f32_16x16x32_bf16 v[68:71], a[0:3], v[148:151], 0
    ds_read_b128 v[168:171], v1 offset:7168
    v_mfma_f32_16x16x32_bf16 v[88:91], a[4:7], v[148:151], 0
    buffer_load_dwordx2 v[54:55], v9, s[4:7], s48 offen offset:2560 sc1
    v_mfma_f32_16x16x32_bf16 v[108:111], a[8:11], v[148:151], 0
    buffer_load_dwordx2 v[56:57], v9, s[4:7], s48 offen offset:3072 sc1
    v_mfma_f32_16x16x32_bf16 v[128:131], a[12:15], v[148:151], 0
    buffer_load_dwordx2 v[58:59], v9, s[4:7], s48 offen offset:3584 sc1
    s_waitcnt lgkmcnt(4)
    v_mfma_f32_16x16x32_bf16 v[72:75], a[0:3], v[152:155], 0
    ds_read_b128 v[172:175], v1 offset:8192
    v_mfma_f32_16x16x32_bf16 v[92:95], a[4:7], v[152:155], 0
    v_mfma_f32_16x16x32_bf16 v[112:115], a[8:11], v[152:155], 0
    v_mfma_f32_16x16x32_bf16 v[132:135], a[12:15], v[152:155], 0
    s_waitcnt lgkmcnt(4)
    v_mfma_f32_16x16x32_bf16 v[96:99], a[4:7], v[156:159], 0
    ds_read_b128 v[176:179], v1 offset:9216
    v_mfma_f32_16x16x32_bf16 v[116:119], a[8:11], v[156:159], 0
    v_mfma_f32_16x16x32_bf16 v[136:139], a[12:15], v[156:159], 0
    s_waitcnt lgkmcnt(4)
    v_mfma_f32_16x16x32_bf16 v[60:63], a[16:19], v[160:163], v[60:63]
    ds_read_b64 v[140:141], v9 offset:10240
    ds_read_b64 v[142:143], v9 offset:10752
    s_xor_b32 s56, s26, 0x300a000
    buffer_load_dwordx4 a[112:115], v1, s[4:7], s56 offen offset:0
    v_mfma_f32_16x16x32_bf16 v[80:83], a[20:23], v[160:163], v[80:83]
    v_mfma_f32_16x16x32_bf16 v[100:103], a[24:27], v[160:163], v[100:103]
    v_mfma_f32_16x16x32_bf16 v[120:123], a[28:31], v[160:163], v[120:123]
    s_waitcnt lgkmcnt(5)
    v_mfma_f32_16x16x32_bf16 v[64:67], a[16:19], v[164:167], v[64:67]
    buffer_load_dwordx4 a[116:119], v1, s[4:7], s56 offen offset:1024
    ds_read_b64 v[144:145], v9 offset:11264
    ds_read_b64 v[146:147], v9 offset:11776
    v_mfma_f32_16x16x32_bf16 v[84:87], a[20:23], v[164:167], v[84:87]
    v_mfma_f32_16x16x32_bf16 v[104:107], a[24:27], v[164:167], v[104:107]
    v_mfma_f32_16x16x32_bf16 v[124:127], a[28:31], v[164:167], v[124:127]
    s_waitcnt lgkmcnt(6)
    v_mfma_f32_16x16x32_bf16 v[68:71], a[16:19], v[168:171], v[68:71]
    ds_read_b64 v[148:149], v9 offset:12288
    ds_read_b64 v[150:151], v9 offset:12800
    buffer_load_dwordx4 a[120:123], v1, s[4:7], s56 offen offset:2048
    v_mfma_f32_16x16x32_bf16 v[88:91], a[20:23], v[168:171], v[88:91]
    v_mfma_f32_16x16x32_bf16 v[108:111], a[24:27], v[168:171], v[108:111]
    v_mfma_f32_16x16x32_bf16 v[128:131], a[28:31], v[168:171], v[128:131]
    s_waitcnt lgkmcnt(7)
    v_mfma_f32_16x16x32_bf16 v[72:75], a[16:19], v[172:175], v[72:75]
    ds_read_b64 v[152:153], v9 offset:13312
    ds_read_b64 v[154:155], v9 offset:13824
    buffer_load_dwordx4 a[124:127], v1, s[4:7], s56 offen offset:3072
    v_mfma_f32_16x16x32_bf16 v[92:95], a[20:23], v[172:175], v[92:95]
    v_mfma_f32_16x16x32_bf16 v[112:115], a[24:27], v[172:175], v[112:115]
    v_mfma_f32_16x16x32_bf16 v[132:135], a[28:31], v[172:175], v[132:135]
    s_waitcnt lgkmcnt(8)
    v_mfma_f32_16x16x32_bf16 v[96:99], a[20:23], v[176:179], v[96:99]
    ds_read_b64 v[156:157], v9 offset:14336
    ds_read_b64 v[158:159], v9 offset:14848
    s_xor_b32 s56, s26, 0x300b000
    buffer_load_dwordx4 a[128:131], v1, s[4:7], s56 offen offset:0
    v_mfma_f32_16x16x32_bf16 v[116:119], a[24:27], v[176:179], v[116:119]
    v_mfma_f32_16x16x32_bf16 v[136:139], a[28:31], v[176:179], v[136:139]
    s_waitcnt lgkmcnt(8)
    v_mfma_f32_16x16x32_bf16 v[60:63], a[32:35], v[140:143], v[60:63]
    ds_read_b128 v[160:163], v1 offset:15360
    v_mfma_f32_16x16x32_bf16 v[80:83], a[36:39], v[140:143], v[80:83]
    v_mfma_f32_16x16x32_bf16 v[100:103], a[40:43], v[140:143], v[100:103]
    buffer_load_dwordx4 a[132:135], v1, s[4:7], s56 offen offset:1024
    v_mfma_f32_16x16x32_bf16 v[120:123], a[44:47], v[140:143], v[120:123]
    s_waitcnt lgkmcnt(7)
    v_mfma_f32_16x16x32_bf16 v[64:67], a[32:35], v[144:147], v[64:67]
    ds_read_b128 v[164:167], v1 offset:16384
    v_mfma_f32_16x16x32_bf16 v[84:87], a[36:39], v[144:147], v[84:87]
    v_mfma_f32_16x16x32_bf16 v[104:107], a[40:43], v[144:147], v[104:107]
    v_mfma_f32_16x16x32_bf16 v[124:127], a[44:47], v[144:147], v[124:127]
    buffer_load_dwordx4 a[136:139], v1, s[4:7], s56 offen offset:2048
    s_waitcnt lgkmcnt(6)
    v_mfma_f32_16x16x32_bf16 v[68:71], a[32:35], v[148:151], v[68:71]
    ds_read_b128 v[168:171], v1 offset:17408
    v_mfma_f32_16x16x32_bf16 v[88:91], a[36:39], v[148:151], v[88:91]
    v_mfma_f32_16x16x32_bf16 v[108:111], a[40:43], v[148:151], v[108:111]
    v_mfma_f32_16x16x32_bf16 v[128:131], a[44:47], v[148:151], v[128:131]
    s_waitcnt lgkmcnt(5)
    v_mfma_f32_16x16x32_bf16 v[72:75], a[32:35], v[152:155], v[72:75]
    buffer_load_dwordx4 a[140:143], v1, s[4:7], s56 offen offset:3072
    ds_read_b128 v[172:175], v1 offset:18432
    v_mfma_f32_16x16x32_bf16 v[92:95], a[36:39], v[152:155], v[92:95]
    v_mfma_f32_16x16x32_bf16 v[112:115], a[40:43], v[152:155], v[112:115]
    v_mfma_f32_16x16x32_bf16 v[132:135], a[44:47], v[152:155], v[132:135]
    s_waitcnt lgkmcnt(4)
    v_mfma_f32_16x16x32_bf16 v[96:99], a[36:39], v[156:159], v[96:99]
    ds_read_b128 v[176:179], v1 offset:19456
    v_mfma_f32_16x16x32_bf16 v[116:119], a[40:43], v[156:159], v[116:119]
    s_xor_b32 s56, s26, 0x300c000
    buffer_load_dwordx4 a[144:147], v1, s[4:7], s56 offen offset:0
    v_mfma_f32_16x16x32_bf16 v[136:139], a[44:47], v[156:159], v[136:139]
    s_waitcnt vmcnt(32)
    s_barrier
    s_waitcnt lgkmcnt(4)
    v_mfma_f32_16x16x32_bf16 v[60:63], a[48:51], v[160:163], v[60:63]
    ds_read_b128 v[140:143], v1 offset:20480
    v_mfma_f32_16x16x32_bf16 v[80:83], a[52:55], v[160:163], v[80:83]
    v_mfma_f32_16x16x32_bf16 v[100:103], a[56:59], v[160:163], v[100:103]
    v_mfma_f32_16x16x32_bf16 v[120:123], a[60:63], v[160:163], v[120:123]
    buffer_load_dwordx4 a[148:151], v1, s[4:7], s56 offen offset:1024
    s_waitcnt lgkmcnt(4)
    v_mfma_f32_16x16x32_bf16 v[64:67], a[48:51], v[164:167], v[64:67]
    ds_read_b128 v[144:147], v1 offset:21504
    v_mfma_f32_16x16x32_bf16 v[84:87], a[52:55], v[164:167], v[84:87]
    v_mfma_f32_16x16x32_bf16 v[104:107], a[56:59], v[164:167], v[104:107]
    v_mfma_f32_16x16x32_bf16 v[124:127], a[60:63], v[164:167], v[124:127]
    s_waitcnt lgkmcnt(4)
    v_mfma_f32_16x16x32_bf16 v[68:71], a[48:51], v[168:171], v[68:71]
    buffer_load_dwordx4 a[152:155], v1, s[4:7], s56 offen offset:2048
    ds_read_b128 v[148:151], v1 offset:22528
    v_mfma_f32_16x16x32_bf16 v[88:91], a[52:55], v[168:171], v[88:91]
    v_mfma_f32_16x16x32_bf16 v[108:111], a[56:59], v[168:171], v[108:111]
    v_mfma_f32_16x16x32_bf16 v[128:131], a[60:63], v[168:171], v[128:131]
    s_waitcnt lgkmcnt(4)
    v_mfma_f32_16x16x32_bf16 v[72:75], a[48:51], v[172:175], v[72:75]
    ds_read_b128 v[152:155], v1 offset:23552
    v_mfma_f32_16x16x32_bf16 v[92:95], a[52:55], v[172:175], v[92:95]
    buffer_load_dwordx4 a[156:159], v1, s[4:7], s56 offen offset:3072
    v_mfma_f32_16x16x32_bf16 v[112:115], a[56:59], v[172:175], v[112:115]
    v_mfma_f32_16x16x32_bf16 v[132:135], a[60:63], v[172:175], v[132:135]
    s_waitcnt lgkmcnt(4)
    v_mfma_f32_16x16x32_bf16 v[96:99], a[52:55], v[176:179], v[96:99]
    ds_read_b128 v[156:159], v1 offset:24576
    v_mfma_f32_16x16x32_bf16 v[116:119], a[56:59], v[176:179], v[116:119]
    v_mfma_f32_16x16x32_bf16 v[136:139], a[60:63], v[176:179], v[136:139]
    s_xor_b32 s56, s26, 0x3010000
    buffer_load_dwordx4 a[160:163], v1, s[4:7], s56 offen offset:0
    s_waitcnt lgkmcnt(4)
    v_mfma_f32_16x16x32_bf16 v[60:63], a[64:67], v[140:143], v[60:63]
    ds_read_b128 v[160:163], v1 offset:25600
    v_mfma_f32_16x16x32_bf16 v[80:83], a[68:71], v[140:143], v[80:83]
    v_mfma_f32_16x16x32_bf16 v[100:103], a[72:75], v[140:143], v[100:103]
    v_mfma_f32_16x16x32_bf16 v[120:123], a[76:79], v[140:143], v[120:123]
    s_waitcnt lgkmcnt(4)
    v_mfma_f32_16x16x32_bf16 v[64:67], a[64:67], v[144:147], v[64:67]
    buffer_load_dwordx4 a[164:167], v1, s[4:7], s56 offen offset:1024
    ds_read_b128 v[164:167], v1 offset:26624
    v_mfma_f32_16x16x32_bf16 v[84:87], a[68:71], v[144:147], v[84:87]
    v_mfma_f32_16x16x32_bf16 v[104:107], a[72:75], v[144:147], v[104:107]
    v_mfma_f32_16x16x32_bf16 v[124:127], a[76:79], v[144:147], v[124:127]
    s_waitcnt lgkmcnt(4)
    v_mfma_f32_16x16x32_bf16 v[68:71], a[64:67], v[148:151], v[68:71]
    ds_read_b128 v[168:171], v1 offset:27648
    v_mfma_f32_16x16x32_bf16 v[88:91], a[68:71], v[148:151], v[88:91]
    buffer_load_dwordx4 a[168:171], v1, s[4:7], s56 offen offset:2048
    v_mfma_f32_16x16x32_bf16 v[108:111], a[72:75], v[148:151], v[108:111]
    v_mfma_f32_16x16x32_bf16 v[128:131], a[76:79], v[148:151], v[128:131]
    s_waitcnt lgkmcnt(4)
    v_mfma_f32_16x16x32_bf16 v[72:75], a[64:67], v[152:155], v[72:75]
    ds_read_b128 v[172:175], v1 offset:28672
    v_mfma_f32_16x16x32_bf16 v[92:95], a[68:71], v[152:155], v[92:95]
    v_mfma_f32_16x16x32_bf16 v[112:115], a[72:75], v[152:155], v[112:115]
    buffer_load_dwordx4 a[172:175], v1, s[4:7], s56 offen offset:3072
    v_mfma_f32_16x16x32_bf16 v[132:135], a[76:79], v[152:155], v[132:135]
    s_waitcnt lgkmcnt(4)
    v_mfma_f32_16x16x32_bf16 v[96:99], a[68:71], v[156:159], v[96:99]
    ds_read_b128 v[176:179], v1 offset:29696
    v_mfma_f32_16x16x32_bf16 v[116:119], a[72:75], v[156:159], v[116:119]
    v_mfma_f32_16x16x32_bf16 v[136:139], a[76:79], v[156:159], v[136:139]
    s_waitcnt lgkmcnt(4)
    v_mfma_f32_16x16x32_bf16 v[60:63], a[80:83], v[160:163], v[60:63]
    s_xor_b32 s56, s26, 0x3011000
    buffer_load_dwordx4 a[176:179], v1, s[4:7], s56 offen offset:0
    ds_read_b128 v[140:143], v1 offset:30720
    v_mfma_f32_16x16x32_bf16 v[80:83], a[84:87], v[160:163], v[80:83]
    v_mfma_f32_16x16x32_bf16 v[100:103], a[88:91], v[160:163], v[100:103]
    v_mfma_f32_16x16x32_bf16 v[120:123], a[92:95], v[160:163], v[120:123]
    s_waitcnt lgkmcnt(4)
    v_mfma_f32_16x16x32_bf16 v[64:67], a[80:83], v[164:167], v[64:67]
    ds_read_b128 v[144:147], v1 offset:31744
    v_mfma_f32_16x16x32_bf16 v[84:87], a[84:87], v[164:167], v[84:87]
    buffer_load_dwordx4 a[180:183], v1, s[4:7], s56 offen offset:1024
    v_mfma_f32_16x16x32_bf16 v[104:107], a[88:91], v[164:167], v[104:107]
    v_mfma_f32_16x16x32_bf16 v[124:127], a[92:95], v[164:167], v[124:127]
    s_waitcnt lgkmcnt(4)
    v_mfma_f32_16x16x32_bf16 v[68:71], a[80:83], v[168:171], v[68:71]
    ds_read_b128 v[148:151], v1 offset:32768
    v_mfma_f32_16x16x32_bf16 v[88:91], a[84:87], v[168:171], v[88:91]
    v_mfma_f32_16x16x32_bf16 v[108:111], a[88:91], v[168:171], v[108:111]
    buffer_load_dwordx4 a[184:187], v1, s[4:7], s56 offen offset:2048
    v_mfma_f32_16x16x32_bf16 v[128:131], a[92:95], v[168:171], v[128:131]
    s_waitcnt lgkmcnt(4)
    v_mfma_f32_16x16x32_bf16 v[72:75], a[80:83], v[172:175], v[72:75]
    ds_read_b128 v[152:155], v1 offset:33792
    v_mfma_f32_16x16x32_bf16 v[92:95], a[84:87], v[172:175], v[92:95]
    v_mfma_f32_16x16x32_bf16 v[112:115], a[88:91], v[172:175], v[112:115]
    v_mfma_f32_16x16x32_bf16 v[132:135], a[92:95], v[172:175], v[132:135]
    buffer_load_dwordx4 a[188:191], v1, s[4:7], s56 offen offset:3072
    s_waitcnt lgkmcnt(4)
    v_mfma_f32_16x16x32_bf16 v[96:99], a[84:87], v[176:179], v[96:99]
    ds_read_b128 v[156:159], v1 offset:34816
    v_mfma_f32_16x16x32_bf16 v[116:119], a[88:91], v[176:179], v[116:119]
    v_mfma_f32_16x16x32_bf16 v[136:139], a[92:95], v[176:179], v[136:139]
    s_waitcnt lgkmcnt(4)
    v_mfma_f32_16x16x32_bf16 v[60:63], a[96:99], v[140:143], v[60:63]
    ds_read_b64 v[160:161], v9 offset:35840
    ds_read_b64 v[162:163], v9 offset:36352
    s_xor_b32 s56, s26, 0x3012000
    buffer_load_dwordx4 a[192:195], v1, s[4:7], s56 offen offset:0
    v_mfma_f32_16x16x32_bf16 v[80:83], a[100:103], v[140:143], v[80:83]
    s_waitcnt vmcnt(24)
    v_add_f32 v44, v44, v52
    v_mfma_f32_16x16x32_bf16 v[100:103], a[104:107], v[140:143], v[100:103]
    v_add_f32 v45, v45, v53
    v_mfma_f32_16x16x32_bf16 v[120:123], a[108:111], v[140:143], v[120:123]
    s_waitcnt vmcnt(23)
    v_add_f32 v46, v46, v54
    s_waitcnt lgkmcnt(5)
    v_mfma_f32_16x16x32_bf16 v[64:67], a[96:99], v[144:147], v[64:67]
    ds_read_b64 v[164:165], v9 offset:36864
    ds_read_b64 v[166:167], v9 offset:37376
    buffer_load_dwordx4 a[196:199], v1, s[4:7], s56 offen offset:1024
    v_mfma_f32_16x16x32_bf16 v[84:87], a[100:103], v[144:147], v[84:87]
    v_add_f32 v47, v47, v55
    v_mfma_f32_16x16x32_bf16 v[104:107], a[104:107], v[144:147], v[104:107]
    s_waitcnt vmcnt(23)
    v_add_f32 v48, v48, v56
    v_mfma_f32_16x16x32_bf16 v[124:127], a[108:111], v[144:147], v[124:127]
    v_add_f32 v49, v49, v57
    s_waitcnt lgkmcnt(6)
    v_mfma_f32_16x16x32_bf16 v[68:71], a[96:99], v[148:151], v[68:71]
    ds_read_b64 v[168:169], v9 offset:37888
    ds_read_b64 v[170:171], v9 offset:38400
    buffer_load_dwordx4 a[200:203], v1, s[4:7], s56 offen offset:2048
    v_mfma_f32_16x16x32_bf16 v[88:91], a[100:103], v[148:151], v[88:91]
    s_waitcnt vmcnt(23)
    v_add_f32 v50, v50, v58
    v_mfma_f32_16x16x32_bf16 v[108:111], a[104:107], v[148:151], v[108:111]
    v_add_f32 v51, v51, v59
    v_mfma_f32_16x16x32_bf16 v[128:131], a[108:111], v[148:151], v[128:131]
    v_add_f32 v44, v44, v48
    s_waitcnt lgkmcnt(7)
    v_mfma_f32_16x16x32_bf16 v[72:75], a[96:99], v[152:155], v[72:75]
    ds_read_b64 v[172:173], v9 offset:38912
    ds_read_b64 v[174:175], v9 offset:39424
    buffer_load_dwordx4 a[204:207], v1, s[4:7], s56 offen offset:3072
    v_mfma_f32_16x16x32_bf16 v[92:95], a[100:103], v[152:155], v[92:95]
    v_add_f32 v45, v45, v49
    v_mfma_f32_16x16x32_bf16 v[112:115], a[104:107], v[152:155], v[112:115]
    v_add_f32 v46, v46, v50
    v_mfma_f32_16x16x32_bf16 v[132:135], a[108:111], v[152:155], v[132:135]
    v_add_f32 v47, v47, v51
    s_waitcnt lgkmcnt(8)
    v_mfma_f32_16x16x32_bf16 v[96:99], a[100:103], v[156:159], v[96:99]
    ds_read_b64 v[176:177], v9 offset:39936
    ds_read_b64 v[178:179], v9 offset:40448
    s_xor_b32 s56, s26, 0x3013000
    buffer_load_dwordx4 a[208:211], v1, s[4:7], s56 offen offset:0
    v_mfma_f32_16x16x32_bf16 v[116:119], a[104:107], v[156:159], v[116:119]
    v_add_f32 v44, v44, v46
    v_mfma_f32_16x16x32_bf16 v[136:139], a[108:111], v[156:159], v[136:139]
    v_add_f32 v45, v45, v47
    s_barrier
    s_waitcnt vmcnt(24) lgkmcnt(8)
    v_mfma_f32_16x16x32_bf16 v[60:63], a[112:115], v[160:163], v[60:63]
    ds_read_b128 v[140:143], v1 offset:40960
    s_waitcnt vmcnt(23)
    v_mfma_f32_16x16x32_bf16 v[80:83], a[116:119], v[160:163], v[80:83]
    buffer_load_dwordx4 a[212:215], v1, s[4:7], s56 offen offset:1024
    v_mul_f32 v44, 0xbacccccd, v44
    s_waitcnt vmcnt(23)
    v_mfma_f32_16x16x32_bf16 v[100:103], a[120:123], v[160:163], v[100:103]
    v_mul_f32 v45, 0x3acccccd, v45
    s_waitcnt vmcnt(22)
    v_mfma_f32_16x16x32_bf16 v[120:123], a[124:127], v[160:163], v[120:123]
    v_fma_f32 v45, -v44, v44, v45
    s_waitcnt lgkmcnt(7)
    v_mfma_f32_16x16x32_bf16 v[64:67], a[112:115], v[164:167], v[64:67]
    ds_read_b128 v[144:147], v1 offset:41984
    v_mfma_f32_16x16x32_bf16 v[84:87], a[116:119], v[164:167], v[84:87]
    v_max_f32 v45, 0, v45
    v_mfma_f32_16x16x32_bf16 v[104:107], a[120:123], v[164:167], v[104:107]
    buffer_load_dwordx4 a[216:219], v1, s[4:7], s56 offen offset:2048
    v_add_f32 v45, 0x3727c5ac, v45
    v_mfma_f32_16x16x32_bf16 v[124:127], a[124:127], v[164:167], v[124:127]
    v_rsq_f32 v45, v45
    s_waitcnt lgkmcnt(6)
    v_mfma_f32_16x16x32_bf16 v[68:71], a[112:115], v[168:171], v[68:71]
    ds_read_b128 v[148:151], v1 offset:43008
    v_mfma_f32_16x16x32_bf16 v[88:91], a[116:119], v[168:171], v[88:91]
    ds_bpermute_b32 v180, v28, v44 offset:0
    v_mfma_f32_16x16x32_bf16 v[108:111], a[120:123], v[168:171], v[108:111]
    ds_bpermute_b32 v181, v28, v45 offset:0
    v_mfma_f32_16x16x32_bf16 v[128:131], a[124:127], v[168:171], v[128:131]
    buffer_load_dwordx4 a[220:223], v1, s[4:7], s56 offen offset:3072
    ds_bpermute_b32 v182, v28, v44 offset:64
    s_waitcnt lgkmcnt(8)
    v_mfma_f32_16x16x32_bf16 v[72:75], a[112:115], v[172:175], v[72:75]
    ds_read_b128 v[152:155], v1 offset:44032
    v_mfma_f32_16x16x32_bf16 v[92:95], a[116:119], v[172:175], v[92:95]
    ds_bpermute_b32 v183, v28, v45 offset:64
    v_mfma_f32_16x16x32_bf16 v[112:115], a[120:123], v[172:175], v[112:115]
    ds_bpermute_b32 v184, v28, v44 offset:128
    v_mfma_f32_16x16x32_bf16 v[132:135], a[124:127], v[172:175], v[132:135]
    ds_bpermute_b32 v185, v28, v45 offset:128
    s_waitcnt lgkmcnt(10)
    v_mfma_f32_16x16x32_bf16 v[96:99], a[116:119], v[176:179], v[96:99]
    s_xor_b32 s56, s26, 0x3014000
    buffer_load_dwordx4 a[224:227], v1, s[4:7], s56 offen offset:0
    ds_read_b128 v[156:159], v1 offset:45056
    v_mfma_f32_16x16x32_bf16 v[116:119], a[120:123], v[176:179], v[116:119]
    ds_bpermute_b32 v186, v28, v44 offset:192
    v_mfma_f32_16x16x32_bf16 v[136:139], a[124:127], v[176:179], v[136:139]
    ds_bpermute_b32 v187, v28, v45 offset:192
    s_waitcnt vmcnt(24) lgkmcnt(12)
    v_mfma_f32_16x16x32_bf16 v[60:63], a[128:131], v[140:143], v[60:63]
    ds_read_b128 v[160:163], v1 offset:46080
    s_waitcnt vmcnt(23)
    v_mfma_f32_16x16x32_bf16 v[80:83], a[132:135], v[140:143], v[80:83]
    s_waitcnt vmcnt(22)
    v_mfma_f32_16x16x32_bf16 v[100:103], a[136:139], v[140:143], v[100:103]
    buffer_load_dwordx4 a[228:231], v1, s[4:7], s56 offen offset:1024
    s_waitcnt vmcnt(22)
    v_mfma_f32_16x16x32_bf16 v[120:123], a[140:143], v[140:143], v[120:123]
    s_waitcnt lgkmcnt(12)
    v_mfma_f32_16x16x32_bf16 v[64:67], a[128:131], v[144:147], v[64:67]
    ds_read_b128 v[164:167], v1 offset:47104
    v_mfma_f32_16x16x32_bf16 v[84:87], a[132:135], v[144:147], v[84:87]
    v_mfma_f32_16x16x32_bf16 v[104:107], a[136:139], v[144:147], v[104:107]
    v_mfma_f32_16x16x32_bf16 v[124:127], a[140:143], v[144:147], v[124:127]
    buffer_load_dwordx4 a[232:235], v1, s[4:7], s56 offen offset:2048
    s_waitcnt lgkmcnt(12)
    v_mfma_f32_16x16x32_bf16 v[68:71], a[128:131], v[148:151], v[68:71]
    ds_read_b128 v[168:171], v1 offset:48128
    v_mfma_f32_16x16x32_bf16 v[88:91], a[132:135], v[148:151], v[88:91]
    v_mfma_f32_16x16x32_bf16 v[108:111], a[136:139], v[148:151], v[108:111]
    v_mfma_f32_16x16x32_bf16 v[128:131], a[140:143], v[148:151], v[128:131]
    s_waitcnt lgkmcnt(9)
    v_mfma_f32_16x16x32_bf16 v[72:75], a[128:131], v[152:155], v[72:75]
    buffer_load_dwordx4 a[236:239], v1, s[4:7], s56 offen offset:3072
    ds_read_b128 v[172:175], v1 offset:49152
    v_mfma_f32_16x16x32_bf16 v[92:95], a[132:135], v[152:155], v[92:95]
    v_mfma_f32_16x16x32_bf16 v[112:115], a[136:139], v[152:155], v[112:115]
    v_mfma_f32_16x16x32_bf16 v[132:135], a[140:143], v[152:155], v[132:135]
    s_waitcnt lgkmcnt(6)
    v_mfma_f32_16x16x32_bf16 v[96:99], a[132:135], v[156:159], v[96:99]
    ds_read_b128 v[176:179], v1 offset:50176
    v_mfma_f32_16x16x32_bf16 v[116:119], a[136:139], v[156:159], v[116:119]
    s_xor_b32 s56, s26, 0x3018000
    buffer_load_dwordx4 a[240:243], v1, s[4:7], s56 offen offset:0
    v_mfma_f32_16x16x32_bf16 v[136:139], a[140:143], v[156:159], v[136:139]
    s_waitcnt vmcnt(24) lgkmcnt(4)
    v_mfma_f32_16x16x32_bf16 v[60:63], a[144:147], v[160:163], v[60:63]
    ds_read_b128 v[140:143], v2 offset:0
    s_waitcnt vmcnt(23)
    v_mfma_f32_16x16x32_bf16 v[80:83], a[148:151], v[160:163], v[80:83]
    s_add_u32 s48, s45, 0x7b0000
    s_waitcnt vmcnt(22)
    v_mfma_f32_16x16x32_bf16 v[100:103], a[152:155], v[160:163], v[100:103]
    buffer_load_dwordx2 v[44:45], v191, s[4:7], s48 offen offset:0 sc1
    s_waitcnt vmcnt(22)
    v_mfma_f32_16x16x32_bf16 v[120:123], a[156:159], v[160:163], v[120:123]
    buffer_load_dwordx2 v[46:47], v191, s[4:7], s48 offen offset:512 sc1
    s_waitcnt lgkmcnt(4)
    v_mfma_f32_16x16x32_bf16 v[64:67], a[144:147], v[164:167], v[64:67]
    ds_read_b128 v[144:147], v2 offset:1024
    v_mfma_f32_16x16x32_bf16 v[84:87], a[148:151], v[164:167], v[84:87]
    buffer_load_dwordx2 v[48:49], v191, s[4:7], s48 offen offset:1024 sc1
    v_mfma_f32_16x16x32_bf16 v[104:107], a[152:155], v[164:167], v[104:107]
    buffer_load_dwordx2 v[50:51], v191, s[4:7], s48 offen offset:1536 sc1
    v_mfma_f32_16x16x32_bf16 v[124:127], a[156:159], v[164:167], v[124:127]
    buffer_load_dwordx2 v[52:53], v191, s[4:7], s48 offen offset:2048 sc1
    s_waitcnt lgkmcnt(4)
    v_mfma_f32_16x16x32_bf16 v[68:71], a[144:147], v[168:171], v[68:71]
    ds_read_b128 v[148:151], v2 offset:2048
    v_mfma_f32_16x16x32_bf16 v[88:91], a[148:151], v[168:171], v[88:91]
    buffer_load_dwordx2 v[54:55], v191, s[4:7], s48 offen offset:2560 sc1
    v_mfma_f32_16x16x32_bf16 v[108:111], a[152:155], v[168:171], v[108:111]
    buffer_load_dwordx2 v[56:57], v191, s[4:7], s48 offen offset:3072 sc1
    v_mfma_f32_16x16x32_bf16 v[128:131], a[156:159], v[168:171], v[128:131]
    buffer_load_dwordx2 v[58:59], v191, s[4:7], s48 offen offset:3584 sc1
    s_waitcnt lgkmcnt(4)
    v_mfma_f32_16x16x32_bf16 v[72:75], a[144:147], v[172:175], v[72:75]
    ds_read_b128 v[152:155], v2 offset:3072
    v_mfma_f32_16x16x32_bf16 v[92:95], a[148:151], v[172:175], v[92:95]
    v_mfma_f32_16x16x32_bf16 v[112:115], a[152:155], v[172:175], v[112:115]
    v_mfma_f32_16x16x32_bf16 v[132:135], a[156:159], v[172:175], v[132:135]
    s_waitcnt lgkmcnt(4)
    v_mfma_f32_16x16x32_bf16 v[96:99], a[148:151], v[176:179], v[96:99]
    ds_read_b128 v[156:159], v2 offset:4096
    v_mfma_f32_16x16x32_bf16 v[116:119], a[152:155], v[176:179], v[116:119]
    v_mfma_f32_16x16x32_bf16 v[136:139], a[156:159], v[176:179], v[136:139]
    s_waitcnt vmcnt(28) lgkmcnt(4)
    v_mfma_f32_16x16x32_bf16 v[60:63], a[160:163], v[140:143], v[60:63]
    ds_read_b128 v[160:163], v2 offset:5120
    s_waitcnt vmcnt(27)
    v_mfma_f32_16x16x32_bf16 v[80:83], a[164:167], v[140:143], v[80:83]
    buffer_load_dwordx4 a[244:247], v1, s[4:7], s56 offen offset:1024
    s_waitcnt vmcnt(27)
    v_mfma_f32_16x16x32_bf16 v[100:103], a[168:171], v[140:143], v[100:103]
    s_waitcnt vmcnt(26)
    v_mfma_f32_16x16x32_bf16 v[120:123], a[172:175], v[140:143], v[120:123]
    s_waitcnt lgkmcnt(4)
    v_mfma_f32_16x16x32_bf16 v[64:67], a[160:163], v[144:147], v[64:67]
    ds_read_b128 v[164:167], v2 offset:6144
    v_mfma_f32_16x16x32_bf16 v[84:87], a[164:167], v[144:147], v[84:87]
    v_mfma_f32_16x16x32_bf16 v[104:107], a[168:171], v[144:147], v[104:107]
    buffer_load_dwordx4 a[248:251], v1, s[4:7], s56 offen offset:2048
    v_mfma_f32_16x16x32_bf16 v[124:127], a[172:175], v[144:147], v[124:127]
    s_waitcnt lgkmcnt(4)
    v_mfma_f32_16x16x32_bf16 v[68:71], a[160:163], v[148:151], v[68:71]
    ds_read_b128 v[168:171], v2 offset:7168
    v_mfma_f32_16x16x32_bf16 v[88:91], a[164:167], v[148:151], v[88:91]
    v_mfma_f32_16x16x32_bf16 v[108:111], a[168:171], v[148:151], v[108:111]
    v_mfma_f32_16x16x32_bf16 v[128:131], a[172:175], v[148:151], v[128:131]
    buffer_load_dwordx4 a[252:255], v1, s[4:7], s56 offen offset:3072
    s_waitcnt lgkmcnt(4)
    v_mfma_f32_16x16x32_bf16 v[72:75], a[160:163], v[152:155], v[72:75]
    ds_read_b128 v[172:175], v2 offset:8192
    v_mfma_f32_16x16x32_bf16 v[92:95], a[164:167], v[152:155], v[92:95]
    v_mfma_f32_16x16x32_bf16 v[112:115], a[168:171], v[152:155], v[112:115]
    v_mfma_f32_16x16x32_bf16 v[132:135], a[172:175], v[152:155], v[132:135]
    s_waitcnt lgkmcnt(4)
    v_mfma_f32_16x16x32_bf16 v[96:99], a[164:167], v[156:159], v[96:99]
    s_xor_b32 s56, s26, 0x3019000
    buffer_load_dwordx4 v[192:195], v1, s[4:7], s56 offen offset:0
    ds_read_b128 v[176:179], v2 offset:9216
    v_mfma_f32_16x16x32_bf16 v[116:119], a[168:171], v[156:159], v[116:119]
    v_mfma_f32_16x16x32_bf16 v[136:139], a[172:175], v[156:159], v[136:139]
    s_barrier
    s_waitcnt vmcnt(28) lgkmcnt(4)
    v_mfma_f32_16x16x32_bf16 v[60:63], a[176:179], v[160:163], v[60:63]
    ds_read_b64 v[140:141], v8 offset:10240
    ds_read_b64 v[142:143], v8 offset:10752
    s_waitcnt vmcnt(27)
    v_mfma_f32_16x16x32_bf16 v[80:83], a[180:183], v[160:163], v[80:83]
    s_waitcnt vmcnt(26)
    v_mfma_f32_16x16x32_bf16 v[100:103], a[184:187], v[160:163], v[100:103]
    buffer_load_dwordx4 v[196:199], v1, s[4:7], s56 offen offset:1024
    s_waitcnt vmcnt(26)
    v_mfma_f32_16x16x32_bf16 v[120:123], a[188:191], v[160:163], v[120:123]
    s_waitcnt lgkmcnt(5)
    v_mfma_f32_16x16x32_bf16 v[64:67], a[176:179], v[164:167], v[64:67]
    ds_read_b64 v[144:145], v8 offset:11264
    ds_read_b64 v[146:147], v8 offset:11776
    v_mfma_f32_16x16x32_bf16 v[84:87], a[180:183], v[164:167], v[84:87]
    v_mfma_f32_16x16x32_bf16 v[104:107], a[184:187], v[164:167], v[104:107]
    v_mfma_f32_16x16x32_bf16 v[124:127], a[188:191], v[164:167], v[124:127]
    buffer_load_dwordx4 v[200:203], v1, s[4:7], s56 offen offset:2048
    s_waitcnt lgkmcnt(6)
    v_mfma_f32_16x16x32_bf16 v[68:71], a[176:179], v[168:171], v[68:71]
    ds_read_b64 v[148:149], v8 offset:12288
    ds_read_b64 v[150:151], v8 offset:12800
    v_mfma_f32_16x16x32_bf16 v[88:91], a[180:183], v[168:171], v[88:91]
    v_mfma_f32_16x16x32_bf16 v[108:111], a[184:187], v[168:171], v[108:111]
    v_mfma_f32_16x16x32_bf16 v[128:131], a[188:191], v[168:171], v[128:131]
    s_waitcnt lgkmcnt(7)
    v_mfma_f32_16x16x32_bf16 v[72:75], a[176:179], v[172:175], v[72:75]
    s_mul_i32 s57, s22, 8192
    s_add_u32 s56, s28, 0x503000
    s_add_u32 s56, s56, s57
    s_add_u32 m0, s57, 0x19000
    s_nop 0
    buffer_load_dwordx4 v1, s[4:7], s56 offen offset:0 lds
    ds_read_b64 v[152:153], v8 offset:13312
    ds_read_b64 v[154:155], v8 offset:13824
    v_mfma_f32_16x16x32_bf16 v[92:95], a[180:183], v[172:175], v[92:95]
    v_mfma_f32_16x16x32_bf16 v[112:115], a[184:187], v[172:175], v[112:115]
    v_mfma_f32_16x16x32_bf16 v[132:135], a[188:191], v[172:175], v[132:135]
    s_waitcnt lgkmcnt(8)
    v_mfma_f32_16x16x32_bf16 v[96:99], a[180:183], v[176:179], v[96:99]
    s_add_u32 m0, s57, 0x19000
    s_nop 0
    buffer_load_dwordx4 v1, s[4:7], s56 offen offset:1024 lds
    ds_read_b64 v[156:157], v8 offset:14336
    ds_read_b64 v[158:159], v8 offset:14848
    v_mfma_f32_16x16x32_bf16 v[116:119], a[184:187], v[176:179], v[116:119]
    v_mfma_f32_16x16x32_bf16 v[136:139], a[188:191], v[176:179], v[136:139]
    s_waitcnt vmcnt(28) lgkmcnt(8)
    v_mfma_f32_16x16x32_bf16 v[60:63], a[192:195], v[140:143], v[60:63]
    ds_read_b128 v[160:163], v2 offset:15360
    s_waitcnt vmcnt(27)
    v_mfma_f32_16x16x32_bf16 v[80:83], a[196:199], v[140:143], v[80:83]
    s_add_u32 m0, s57, 0x19000
    s_nop 0
    buffer_load_dwordx4 v1, s[4:7], s56 offen offset:2048 lds
    s_waitcnt vmcnt(27)
    v_mfma_f32_16x16x32_bf16 v[100:103], a[200:203], v[140:143], v[100:103]
    s_waitcnt vmcnt(26)
    v_mfma_f32_16x16x32_bf16 v[120:123], a[204:207], v[140:143], v[120:123]
    s_waitcnt lgkmcnt(7)
    v_mfma_f32_16x16x32_bf16 v[64:67], a[192:195], v[144:147], v[64:67]
    ds_read_b128 v[164:167], v2 offset:16384
    v_mfma_f32_16x16x32_bf16 v[84:87], a[196:199], v[144:147], v[84:87]
    v_mfma_f32_16x16x32_bf16 v[104:107], a[200:203], v[144:147], v[104:107]
    s_add_u32 m0, s57, 0x19000
    s_nop 0
    buffer_load_dwordx4 v1, s[4:7], s56 offen offset:3072 lds
    v_mfma_f32_16x16x32_bf16 v[124:127], a[204:207], v[144:147], v[124:127]
    s_waitcnt lgkmcnt(6)
    v_mfma_f32_16x16x32_bf16 v[68:71], a[192:195], v[148:151], v[68:71]
    ds_read_b128 v[168:171], v2 offset:17408
    v_mfma_f32_16x16x32_bf16 v[88:91], a[196:199], v[148:151], v[88:91]
    v_mfma_f32_16x16x32_bf16 v[108:111], a[200:203], v[148:151], v[108:111]
    v_mfma_f32_16x16x32_bf16 v[128:131], a[204:207], v[148:151], v[128:131]
    s_add_u32 s56, s28, 0x504000
    s_add_u32 s56, s56, s57
    s_add_u32 m0, s57, 0x1a000
    s_nop 0
    buffer_load_dwordx4 v1, s[4:7], s56 offen offset:0 lds
    s_waitcnt lgkmcnt(5)
    v_mfma_f32_16x16x32_bf16 v[72:75], a[192:195], v[152:155], v[72:75]
    ds_read_b128 v[172:175], v2 offset:18432
    v_mfma_f32_16x16x32_bf16 v[92:95], a[196:199], v[152:155], v[92:95]
    v_mfma_f32_16x16x32_bf16 v[112:115], a[200:203], v[152:155], v[112:115]
    v_mfma_f32_16x16x32_bf16 v[132:135], a[204:207], v[152:155], v[132:135]
    s_add_u32 m0, s57, 0x1a000
    s_nop 0
    buffer_load_dwordx4 v1, s[4:7], s56 offen offset:1024 lds
    s_waitcnt lgkmcnt(4)
    v_mfma_f32_16x16x32_bf16 v[96:99], a[196:199], v[156:159], v[96:99]
    ds_read_b128 v[176:179], v2 offset:19456
    v_mfma_f32_16x16x32_bf16 v[116:119], a[200:203], v[156:159], v[116:119]
    v_mfma_f32_16x16x32_bf16 v[136:139], a[204:207], v[156:159], v[136:139]
    s_waitcnt vmcnt(28) lgkmcnt(4)
    v_mfma_f32_16x16x32_bf16 v[60:63], a[208:211], v[160:163], v[60:63]
    ds_read_b128 v[140:143], v2 offset:20480
    s_waitcnt vmcnt(27)
    v_mfma_f32_16x16x32_bf16 v[80:83], a[212:215], v[160:163], v[80:83]
    s_add_u32 m0, s57, 0x1a000
    s_nop 0
    buffer_load_dwordx4 v1, s[4:7], s56 offen offset:2048 lds
    s_waitcnt vmcnt(27)
    v_mfma_f32_16x16x32_bf16 v[100:103], a[216:219], v[160:163], v[100:103]
    s_waitcnt vmcnt(26)
    v_mfma_f32_16x16x32_bf16 v[120:123], a[220:223], v[160:163], v[120:123]
    s_waitcnt lgkmcnt(4)
    v_mfma_f32_16x16x32_bf16 v[64:67], a[208:211], v[164:167], v[64:67]
    ds_read_b128 v[144:147], v2 offset:21504
    v_mfma_f32_16x16x32_bf16 v[84:87], a[212:215], v[164:167], v[84:87]
    v_mfma_f32_16x16x32_bf16 v[104:107], a[216:219], v[164:167], v[104:107]
    s_add_u32 m0, s57, 0x1a000
    s_nop 0
    buffer_load_dwordx4 v1, s[4:7], s56 offen offset:3072 lds
    v_mfma_f32_16x16x32_bf16 v[124:127], a[220:223], v[164:167], v[124:127]
    s_waitcnt lgkmcnt(4)
    v_mfma_f32_16x16x32_bf16 v[68:71], a[208:211], v[168:171], v[68:71]
    ds_read_b128 v[148:151], v2 offset:22528
    v_mfma_f32_16x16x32_bf16 v[88:91], a[212:215], v[168:171], v[88:91]
    v_mfma_f32_16x16x32_bf16 v[108:111], a[216:219], v[168:171], v[108:111]
    v_mfma_f32_16x16x32_bf16 v[128:131], a[220:223], v[168:171], v[128:131]
    s_mul_i32 s57, s22, 8192
    s_add_u32 s56, s28, 0x50b000
    s_add_u32 s56, s56, s57
    s_add_u32 m0, s57, 0x0
    s_nop 0
    buffer_load_dwordx4 v1, s[4:7], s56 offen offset:0 lds
    s_waitcnt lgkmcnt(4)
    v_mfma_f32_16x16x32_bf16 v[72:75], a[208:211], v[172:175], v[72:75]
    ds_read_b128 v[152:155], v2 offset:23552
    v_mfma_f32_16x16x32_bf16 v[92:95], a[212:215], v[172:175], v[92:95]
    v_mfma_f32_16x16x32_bf16 v[112:115], a[216:219], v[172:175], v[112:115]
    v_mfma_f32_16x16x32_bf16 v[132:135], a[220:223], v[172:175], v[132:135]
    s_add_u32 m0, s57, 0x0
    s_nop 0
    buffer_load_dwordx4 v1, s[4:7], s56 offen offset:1024 lds
    s_waitcnt lgkmcnt(4)
    v_mfma_f32_16x16x32_bf16 v[96:99], a[212:215], v[176:179], v[96:99]
    ds_read_b128 v[156:159], v2 offset:24576
    v_mfma_f32_16x16x32_bf16 v[116:119], a[216:219], v[176:179], v[116:119]
    v_mfma_f32_16x16x32_bf16 v[136:139], a[220:223], v[176:179], v[136:139]
    s_waitcnt vmcnt(28) lgkmcnt(4)
    v_mfma_f32_16x16x32_bf16 v[60:63], a[224:227], v[140:143], v[60:63]
    ds_read_b128 v[160:163], v2 offset:25600
    s_waitcnt vmcnt(27)
    v_mfma_f32_16x16x32_bf16 v[80:83], a[228:231], v[140:143], v[80:83]
    s_add_u32 m0, s57, 0x0
    s_nop 0
    buffer_load_dwordx4 v1, s[4:7], s56 offen offset:2048 lds
    s_waitcnt vmcnt(27)
    v_mfma_f32_16x16x32_bf16 v[100:103], a[232:235], v[140:143], v[100:103]
    s_waitcnt vmcnt(26)
    v_mfma_f32_16x16x32_bf16 v[120:123], a[236:239], v[140:143], v[120:123]
    s_waitcnt lgkmcnt(4)
    v_mfma_f32_16x16x32_bf16 v[64:67], a[224:227], v[144:147], v[64:67]
    ds_read_b128 v[164:167], v2 offset:26624
    v_mfma_f32_16x16x32_bf16 v[84:87], a[228:231], v[144:147], v[84:87]
    v_mfma_f32_16x16x32_bf16 v[104:107], a[232:235], v[144:147], v[104:107]
    s_add_u32 m0, s57, 0x0
    s_nop 0
    buffer_load_dwordx4 v1, s[4:7], s56 offen offset:3072 lds
    v_mfma_f32_16x16x32_bf16 v[124:127], a[236:239], v[144:147], v[124:127]
    s_waitcnt lgkmcnt(4)
    v_mfma_f32_16x16x32_bf16 v[68:71], a[224:227], v[148:151], v[68:71]
    ds_read_b128 v[168:171], v2 offset:27648
    v_mfma_f32_16x16x32_bf16 v[88:91], a[228:231], v[148:151], v[88:91]
    v_mfma_f32_16x16x32_bf16 v[108:111], a[232:235], v[148:151], v[108:111]
    v_mfma_f32_16x16x32_bf16 v[128:131], a[236:239], v[148:151], v[128:131]
    s_add_u32 s56, s28, 0x50c000
    s_add_u32 s56, s56, s57
    s_add_u32 m0, s57, 0x1000
    s_nop 0
    buffer_load_dwordx4 v1, s[4:7], s56 offen offset:0 lds
    s_waitcnt lgkmcnt(4)
    v_mfma_f32_16x16x32_bf16 v[72:75], a[224:227], v[152:155], v[72:75]
    ds_read_b128 v[172:175], v2 offset:28672
    v_mfma_f32_16x16x32_bf16 v[92:95], a[228:231], v[152:155], v[92:95]
    v_mfma_f32_16x16x32_bf16 v[112:115], a[232:235], v[152:155], v[112:115]
    v_mfma_f32_16x16x32_bf16 v[132:135], a[236:239], v[152:155], v[132:135]
    s_add_u32 m0, s57, 0x1000
    s_nop 0
    buffer_load_dwordx4 v1, s[4:7], s56 offen offset:1024 lds
    s_waitcnt lgkmcnt(4)
    v_mfma_f32_16x16x32_bf16 v[96:99], a[228:231], v[156:159], v[96:99]
    ds_read_b128 v[176:179], v2 offset:29696
    v_mfma_f32_16x16x32_bf16 v[116:119], a[232:235], v[156:159], v[116:119]
    v_mfma_f32_16x16x32_bf16 v[136:139], a[236:239], v[156:159], v[136:139]
    s_barrier
    s_waitcnt vmcnt(28) lgkmcnt(4)
    v_mfma_f32_16x16x32_bf16 v[60:63], a[240:243], v[160:163], v[60:63]
    ds_read_b128 v[140:143], v2 offset:30720
    s_waitcnt vmcnt(19)
    v_mfma_f32_16x16x32_bf16 v[80:83], a[244:247], v[160:163], v[80:83]
    s_add_u32 m0, s57, 0x1000
    s_nop 0
    buffer_load_dwordx4 v1, s[4:7], s56 offen offset:2048 lds
    v_add_f32 v44, v44, v52
    s_waitcnt vmcnt(19)
    v_mfma_f32_16x16x32_bf16 v[100:103], a[248:251], v[160:163], v[100:103]
    v_add_f32 v45, v45, v53
    s_waitcnt vmcnt(18)
    v_mfma_f32_16x16x32_bf16 v[120:123], a[252:255], v[160:163], v[120:123]
    v_add_f32 v46, v46, v54
    s_waitcnt lgkmcnt(4)
    v_mfma_f32_16x16x32_bf16 v[64:67], a[240:243], v[164:167], v[64:67]
    ds_read_b128 v[144:147], v2 offset:31744
    v_mfma_f32_16x16x32_bf16 v[84:87], a[244:247], v[164:167], v[84:87]
    v_add_f32 v47, v47, v55
    v_mfma_f32_16x16x32_bf16 v[104:107], a[248:251], v[164:167], v[104:107]
    s_add_u32 m0, s57, 0x1000
    s_nop 0
    buffer_load_dwordx4 v1, s[4:7], s56 offen offset:3072 lds
    v_add_f32 v48, v48, v56
    v_mfma_f32_16x16x32_bf16 v[124:127], a[252:255], v[164:167], v[124:127]
    v_add_f32 v49, v49, v57
    s_waitcnt lgkmcnt(4)
    v_mfma_f32_16x16x32_bf16 v[68:71], a[240:243], v[168:171], v[68:71]
    ds_read_b128 v[148:151], v2 offset:32768
    v_mfma_f32_16x16x32_bf16 v[88:91], a[244:247], v[168:171], v[88:91]
    v_add_f32 v50, v50, v58
    v_mfma_f32_16x16x32_bf16 v[108:111], a[248:251], v[168:171], v[108:111]
    v_add_f32 v51, v51, v59
    v_mfma_f32_16x16x32_bf16 v[128:131], a[252:255], v[168:171], v[128:131]
    s_mul_i32 s57, s22, 9216
    s_add_u32 s56, s28, 0x513000
    s_add_u32 s56, s56, s57
    s_add_u32 m0, s57, 0x8000
    s_nop 0
    buffer_load_dwordx4 v1, s[4:7], s56 offen offset:0 lds
    v_add_f32 v44, v44, v48
    s_waitcnt lgkmcnt(4)
    v_mfma_f32_16x16x32_bf16 v[72:75], a[240:243], v[172:175], v[72:75]
    ds_read_b128 v[152:155], v2 offset:33792
    v_mfma_f32_16x16x32_bf16 v[92:95], a[244:247], v[172:175], v[92:95]
    v_add_f32 v45, v45, v49
    v_mfma_f32_16x16x32_bf16 v[112:115], a[248:251], v[172:175], v[112:115]
    v_add_f32 v46, v46, v50
    v_mfma_f32_16x16x32_bf16 v[132:135], a[252:255], v[172:175], v[132:135]
    s_add_u32 m0, s57, 0x8000
    s_nop 0
    buffer_load_dwordx4 v1, s[4:7], s56 offen offset:1024 lds
    v_add_f32 v47, v47, v51
    s_waitcnt lgkmcnt(4)
    v_mfma_f32_16x16x32_bf16 v[96:99], a[244:247], v[176:179], v[96:99]
    ds_read_b128 v[156:159], v2 offset:34816
    v_mfma_f32_16x16x32_bf16 v[116:119], a[248:251], v[176:179], v[116:119]
    v_add_f32 v44, v44, v46
    v_mfma_f32_16x16x32_bf16 v[136:139], a[252:255], v[176:179], v[136:139]
    v_add_f32 v45, v45, v47
    s_waitcnt vmcnt(20) lgkmcnt(4)
    v_mfma_f32_16x16x32_bf16 v[60:63], v[192:195], v[140:143], v[60:63]
    ds_read_b64 v[160:161], v8 offset:35840
    ds_read_b64 v[162:163], v8 offset:36352
    s_add_u32 m0, s57, 0x8000
    s_nop 0
    buffer_load_dwordx4 v1, s[4:7], s56 offen offset:2048 lds
    s_waitcnt vmcnt(20)
    v_mfma_f32_16x16x32_bf16 v[80:83], v[196:199], v[140:143], v[80:83]
    v_mul_f32 v44, 0xbacccccd, v44
    s_waitcnt vmcnt(19)
    v_mfma_f32_16x16x32_bf16 v[100:103], v[200:203], v[140:143], v[100:103]
    v_mul_f32 v45, 0x3acccccd, v45
    v_mfma_f32_16x16x32_bf16 v[120:123], v[204:207], v[140:143], v[120:123]
    v_fma_f32 v45, -v44, v44, v45
    s_waitcnt lgkmcnt(5)
    v_mfma_f32_16x16x32_bf16 v[64:67], v[192:195], v[144:147], v[64:67]
    s_add_u32 m0, s57, 0x8000
    s_nop 0
    buffer_load_dwordx4 v1, s[4:7], s56 offen offset:3072 lds
    ds_read_b64 v[164:165], v8 offset:36864
    ds_read_b64 v[166:167], v8 offset:37376
    v_mfma_f32_16x16x32_bf16 v[84:87], v[196:199], v[144:147], v[84:87]
    v_max_f32 v45, 0, v45
    v_mfma_f32_16x16x32_bf16 v[104:107], v[200:203], v[144:147], v[104:107]
    v_add_f32 v45, 0x3727c5ac, v45
    v_mfma_f32_16x16x32_bf16 v[124:127], v[204:207], v[144:147], v[124:127]
    v_rsq_f32 v45, v45
    s_waitcnt lgkmcnt(6)
    v_mfma_f32_16x16x32_bf16 v[68:71], v[192:195], v[148:151], v[68:71]
    ds_read_b64 v[168:169], v8 offset:37888
    ds_read_b64 v[170:171], v8 offset:38400
    s_add_u32 s56, s28, 0x514000
    s_add_u32 s56, s56, s57
    s_add_u32 m0, s57, 0x9000
    s_nop 0
    buffer_load_dwordx4 v1, s[4:7], s56 offen offset:0 lds
    v_mfma_f32_16x16x32_bf16 v[88:91], v[196:199], v[148:151], v[88:91]
    v_mov_b32 v188, v44
    v_mfma_f32_16x16x32_bf16 v[108:111], v[200:203], v[148:151], v[108:111]
    v_mov_b32 v189, v45
    v_mfma_f32_16x16x32_bf16 v[128:131], v[204:207], v[148:151], v[128:131]
    s_waitcnt lgkmcnt(7)
    v_mfma_f32_16x16x32_bf16 v[72:75], v[192:195], v[152:155], v[72:75]
    s_add_u32 m0, s57, 0x9000
    s_nop 0
    buffer_load_dwordx4 v1, s[4:7], s56 offen offset:1024 lds
    ds_read_b64 v[172:173], v8 offset:38912
    ds_read_b64 v[174:175], v8 offset:39424
    v_mfma_f32_16x16x32_bf16 v[92:95], v[196:199], v[152:155], v[92:95]
    v_mfma_f32_16x16x32_bf16 v[112:115], v[200:203], v[152:155], v[112:115]
    v_mfma_f32_16x16x32_bf16 v[132:135], v[204:207], v[152:155], v[132:135]
    s_waitcnt lgkmcnt(8)
    v_mfma_f32_16x16x32_bf16 v[96:99], v[196:199], v[156:159], v[96:99]
    ds_read_b64 v[176:177], v8 offset:39936
    ds_read_b64 v[178:179], v8 offset:40448
    s_add_u32 m0, s57, 0x9000
    s_nop 0
    buffer_load_dwordx4 v1, s[4:7], s56 offen offset:2048 lds
    v_mfma_f32_16x16x32_bf16 v[116:119], v[200:203], v[156:159], v[116:119]
    v_mfma_f32_16x16x32_bf16 v[136:139], v[204:207], v[156:159], v[136:139]
    s_waitcnt lgkmcnt(8)
    v_mfma_f32_16x16x32_bf16 v[60:63], v[208:211], v[160:163], v[60:63]
    ds_read_b128 v[140:143], v2 offset:40960
    v_mfma_f32_16x16x32_bf16 v[80:83], v[212:215], v[160:163], v[80:83]
    s_add_u32 m0, s57, 0x9000
    s_nop 0
    buffer_load_dwordx4 v1, s[4:7], s56 offen offset:3072 lds
    v_mfma_f32_16x16x32_bf16 v[100:103], v[216:219], v[160:163], v[100:103]
    v_mfma_f32_16x16x32_bf16 v[120:123], v[220:223], v[160:163], v[120:123]
    s_waitcnt lgkmcnt(7)
    v_mfma_f32_16x16x32_bf16 v[64:67], v[208:211], v[164:167], v[64:67]
    ds_read_b128 v[144:147], v2 offset:41984
    v_mfma_f32_16x16x32_bf16 v[84:87], v[212:215], v[164:167], v[84:87]
    v_mfma_f32_16x16x32_bf16 v[104:107], v[216:219], v[164:167], v[104:107]
    s_add_u32 s56, s28, 0x515000
    s_add_u32 s56, s56, s57
    s_add_u32 m0, s57, 0xa000
    s_nop 0
    buffer_load_dwordx4 v1, s[4:7], s56 offen offset:0 lds
    v_mfma_f32_16x16x32_bf16 v[124:127], v[220:223], v[164:167], v[124:127]
    s_waitcnt lgkmcnt(6)
    v_mfma_f32_16x16x32_bf16 v[68:71], v[208:211], v[168:171], v[68:71]
    ds_read_b128 v[148:151], v2 offset:43008
    v_mfma_f32_16x16x32_bf16 v[88:91], v[212:215], v[168:171], v[88:91]
    v_mfma_f32_16x16x32_bf16 v[108:111], v[216:219], v[168:171], v[108:111]
    s_xor_b32 s56, s27, 0x3400000
    buffer_load_dwordx4 a[0:3], v1, s[4:7], s56 offen offset:0
    v_mfma_f32_16x16x32_bf16 v[128:131], v[220:223], v[168:171], v[128:131]
    s_waitcnt lgkmcnt(5)
    v_mfma_f32_16x16x32_bf16 v[72:75], v[208:211], v[172:175], v[72:75]
    ds_read_b128 v[152:155], v2 offset:44032
    v_mfma_f32_16x16x32_bf16 v[92:95], v[212:215], v[172:175], v[92:95]
    v_mfma_f32_16x16x32_bf16 v[112:115], v[216:219], v[172:175], v[112:115]
    v_mfma_f32_16x16x32_bf16 v[132:135], v[220:223], v[172:175], v[132:135]
    buffer_load_dwordx4 a[4:7], v10, s[4:7], s56 offen offset:1024
    s_waitcnt lgkmcnt(4)
    v_mfma_f32_16x16x32_bf16 v[96:99], v[212:215], v[176:179], v[96:99]
    ds_read_b128 v[156:159], v2 offset:45056
    v_mfma_f32_16x16x32_bf16 v[116:119], v[216:219], v[176:179], v[116:119]
    v_mfma_f32_16x16x32_bf16 v[136:139], v[220:223], v[176:179], v[136:139]
    s_waitcnt lgkmcnt(4)
    v_mfma_f32_16x16x32_bf16 v[60:63], v[224:227], v[140:143], v[60:63]
    ds_read_b128 v[160:163], v2 offset:46080
    v_mfma_f32_16x16x32_bf16 v[80:83], v[228:231], v[140:143], v[80:83]
    buffer_load_dwordx4 a[8:11], v1, s[4:7], s56 offen offset:2048
    ds_read_b128 v[44:47], v190 offset:0
    v_mfma_f32_16x16x32_bf16 v[100:103], v[232:235], v[140:143], v[100:103]
    ds_read_b128 v[48:51], v190 offset:64
    v_mfma_f32_16x16x32_bf16 v[120:123], v[236:239], v[140:143], v[120:123]
    ds_read_b128 v[52:55], v190 offset:128
    s_waitcnt lgkmcnt(7)
    v_mfma_f32_16x16x32_bf16 v[64:67], v[224:227], v[144:147], v[64:67]
    ds_read_b128 v[164:167], v2 offset:47104
    v_mfma_f32_16x16x32_bf16 v[84:87], v[228:231], v[144:147], v[84:87]
    ds_read_b128 v[56:59], v190 offset:192
    v_mfma_f32_16x16x32_bf16 v[104:107], v[232:235], v[144:147], v[104:107]
    buffer_load_dwordx4 a[12:15], v10, s[4:7], s56 offen offset:3072
    v_mfma_f32_16x16x32_bf16 v[124:127], v[236:239], v[144:147], v[124:127]
    s_waitcnt lgkmcnt(8)
    v_mfma_f32_16x16x32_bf16 v[68:71], v[224:227], v[148:151], v[68:71]
    ds_read_b128 v[168:171], v2 offset:48128
    v_mfma_f32_16x16x32_bf16 v[88:91], v[228:231], v[148:151], v[88:91]
    v_mfma_f32_16x16x32_bf16 v[108:111], v[232:235], v[148:151], v[108:111]
    v_mfma_f32_16x16x32_bf16 v[128:131], v[236:239], v[148:151], v[128:131]
    s_xor_b32 s56, s27, 0x3401000
    buffer_load_dwordx4 a[16:19], v1, s[4:7], s56 offen offset:0
    s_waitcnt lgkmcnt(8)
    v_mfma_f32_16x16x32_bf16 v[72:75], v[224:227], v[152:155], v[72:75]
    ds_read_b128 v[172:175], v2 offset:49152
    v_mfma_f32_16x16x32_bf16 v[92:95], v[228:231], v[152:155], v[92:95]
    v_mfma_f32_16x16x32_bf16 v[112:115], v[232:235], v[152:155], v[112:115]
    v_mfma_f32_16x16x32_bf16 v[132:135], v[236:239], v[152:155], v[132:135]
    s_waitcnt lgkmcnt(8)
    v_mfma_f32_16x16x32_bf16 v[96:99], v[228:231], v[156:159], v[96:99]
    buffer_load_dwordx4 a[20:23], v10, s[4:7], s56 offen offset:1024
    ds_read_b128 v[176:179], v2 offset:50176
    v_mfma_f32_16x16x32_bf16 v[116:119], v[232:235], v[156:159], v[116:119]
    v_mfma_f32_16x16x32_bf16 v[136:139], v[236:239], v[156:159], v[136:139]
    s_waitcnt lgkmcnt(8)
    v_mfma_f32_16x16x32_bf16 v[60:63], v[240:243], v[160:163], v[60:63]
    v_mfma_f32_16x16x32_bf16 v[80:83], v[244:247], v[160:163], v[80:83]
    v_mfma_f32_16x16x32_bf16 v[100:103], v[248:251], v[160:163], v[100:103]
    buffer_load_dwordx4 a[24:27], v1, s[4:7], s56 offen offset:2048
    v_mfma_f32_16x16x32_bf16 v[120:123], v[252:255], v[160:163], v[120:123]
    s_waitcnt lgkmcnt(4)
    v_mfma_f32_16x16x32_bf16 v[64:67], v[240:243], v[164:167], v[64:67]
    v_mfma_f32_16x16x32_bf16 v[84:87], v[244:247], v[164:167], v[84:87]
    v_mfma_f32_16x16x32_bf16 v[104:107], v[248:251], v[164:167], v[104:107]
    v_mfma_f32_16x16x32_bf16 v[124:127], v[252:255], v[164:167], v[124:127]
    buffer_load_dwordx4 a[28:31], v10, s[4:7], s56 offen offset:3072
    s_waitcnt lgkmcnt(2)
    v_mfma_f32_16x16x32_bf16 v[68:71], v[240:243], v[168:171], v[68:71]
    v_mfma_f32_16x16x32_bf16 v[88:91], v[244:247], v[168:171], v[88:91]
    v_mfma_f32_16x16x32_bf16 v[108:111], v[248:251], v[168:171], v[108:111]
    v_mfma_f32_16x16x32_bf16 v[128:131], v[252:255], v[168:171], v[128:131]
    s_waitcnt lgkmcnt(1)
    v_mfma_f32_16x16x32_bf16 v[72:75], v[240:243], v[172:175], v[72:75]
    s_xor_b32 s56, s27, 0x3402000
    buffer_load_dwordx4 a[32:35], v1, s[4:7], s56 offen offset:0
    v_mfma_f32_16x16x32_bf16 v[92:95], v[244:247], v[172:175], v[92:95]
    v_mfma_f32_16x16x32_bf16 v[112:115], v[248:251], v[172:175], v[112:115]
    v_mfma_f32_16x16x32_bf16 v[132:135], v[252:255], v[172:175], v[132:135]
    s_waitcnt lgkmcnt(0)
    v_mfma_f32_16x16x32_bf16 v[96:99], v[244:247], v[176:179], v[96:99]
    v_mfma_f32_16x16x32_bf16 v[116:119], v[248:251], v[176:179], v[116:119]
    buffer_load_dwordx4 a[36:39], v10, s[4:7], s56 offen offset:1024
    v_mfma_f32_16x16x32_bf16 v[136:139], v[252:255], v[176:179], v[136:139]
    s_nop 5
    v_pk_fma_f32 v[116:117], v[52:53], v[188:189], v[116:117] op_sel_hi:[1,0,1]
    v_pk_fma_f32 v[118:119], v[54:55], v[188:189], v[118:119] op_sel_hi:[1,0,1]
    v_pk_mul_f32 v[116:117], v[116:117], v[188:189] op_sel:[0,1]
    v_pk_mul_f32 v[118:119], v[118:119], v[188:189] op_sel:[0,1]
    v_cvt_pk_bf16_f32 v176, v116, v117
    v_cvt_pk_bf16_f32 v177, v118, v119
    ds_write_b64 v29, v[176:177] offset:3072
    v_pk_fma_f32 v[136:137], v[56:57], v[188:189], v[136:137] op_sel_hi:[1,0,1]
    v_pk_fma_f32 v[138:139], v[58:59], v[188:189], v[138:139] op_sel_hi:[1,0,1]
    s_xor_b32 s56, s27, 0x3404000
    buffer_load_dwordx4 a[40:43], v1, s[4:7], s56 offen offset:0
    v_pk_mul_f32 v[136:137], v[136:137], v[188:189] op_sel:[0,1]
    v_pk_mul_f32 v[138:139], v[138:139], v[188:189] op_sel:[0,1]
    v_cvt_pk_bf16_f32 v174, v136, v137
    v_cvt_pk_bf16_f32 v175, v138, v139
    ds_write_b64 v30, v[174:175] offset:3072
    v_pk_fma_f32 v[96:97], v[48:49], v[188:189], v[96:97] op_sel_hi:[1,0,1]
    v_pk_fma_f32 v[98:99], v[50:51], v[188:189], v[98:99] op_sel_hi:[1,0,1]
    v_pk_mul_f32 v[96:97], v[96:97], v[188:189] op_sel:[0,1]
    v_pk_mul_f32 v[98:99], v[98:99], v[188:189] op_sel:[0,1]
    v_cvt_pk_bf16_f32 v172, v96, v97
    v_cvt_pk_bf16_f32 v173, v98, v99
    v_pk_fma_f32 v[100:101], v[52:53], v[180:181], v[100:101] op_sel_hi:[1,0,1]
    v_pk_fma_f32 v[102:103], v[54:55], v[180:181], v[102:103] op_sel_hi:[1,0,1]
    buffer_load_dwordx4 a[44:47], v10, s[4:7], s56 offen offset:1024
    v_pk_mul_f32 v[100:101], v[100:101], v[180:181] op_sel:[0,1]
    v_pk_mul_f32 v[102:103], v[102:103], v[180:181] op_sel:[0,1]
    v_cvt_pk_bf16_f32 v176, v100, v101
    v_cvt_pk_bf16_f32 v177, v102, v103
    ds_write_b64 v29, v[176:177] offset:0
    v_and_b32 v142, v35, v176
    v_and_b32 v143, v35, v177
    v_pk_fma_f32 v[120:121], v[56:57], v[180:181], v[120:121] op_sel_hi:[1,0,1]
    v_pk_fma_f32 v[122:123], v[58:59], v[180:181], v[122:123] op_sel_hi:[1,0,1]
    v_pk_mul_f32 v[120:121], v[120:121], v[180:181] op_sel:[0,1]
    v_pk_mul_f32 v[122:123], v[122:123], v[180:181] op_sel:[0,1]
    v_cvt_pk_bf16_f32 v158, v120, v121
    v_cvt_pk_bf16_f32 v159, v122, v123
    ds_write_b64 v30, v[158:159] offset:0
    s_xor_b32 s56, s27, 0x3404000
    buffer_load_dwordx4 a[48:51], v1, s[4:7], s56 offen offset:2048
    v_pk_fma_f32 v[80:81], v[48:49], v[180:181], v[80:81] op_sel_hi:[1,0,1]
    v_pk_fma_f32 v[82:83], v[50:51], v[180:181], v[82:83] op_sel_hi:[1,0,1]
    v_pk_mul_f32 v[80:81], v[80:81], v[180:181] op_sel:[0,1]
    v_pk_mul_f32 v[82:83], v[82:83], v[180:181] op_sel:[0,1]
    v_cvt_pk_bf16_f32 v156, v80, v81
    v_cvt_pk_bf16_f32 v157, v82, v83
    v_pk_fma_f32 v[60:61], v[44:45], v[180:181], v[60:61] op_sel_hi:[1,0,1]
    v_pk_fma_f32 v[62:63], v[46:47], v[180:181], v[62:63] op_sel_hi:[1,0,1]
    v_pk_mul_f32 v[60:61], v[60:61], v[180:181] op_sel:[0,1]
    v_pk_mul_f32 v[62:63], v[62:63], v[180:181] op_sel:[0,1]
    v_cvt_pk_bf16_f32 v140, v60, v61
    v_cvt_pk_bf16_f32 v141, v62, v63
    v_pk_fma_f32 v[104:105], v[52:53], v[182:183], v[104:105] op_sel_hi:[1,0,1]
    buffer_load_dwordx4 a[52:55], v10, s[4:7], s56 offen offset:3072
    v_pk_fma_f32 v[106:107], v[54:55], v[182:183], v[106:107] op_sel_hi:[1,0,1]
    v_pk_mul_f32 v[104:105], v[104:105], v[182:183] op_sel:[0,1]
    v_pk_mul_f32 v[106:107], v[106:107], v[182:183] op_sel:[0,1]
    v_cvt_pk_bf16_f32 v178, v104, v105
    v_cvt_pk_bf16_f32 v179, v106, v107
    ds_write_b64 v29, v[178:179] offset:768
    v_and_b32 v146, v35, v178
    v_and_b32 v147, v35, v179
    v_pk_fma_f32 v[124:125], v[56:57], v[182:183], v[124:125] op_sel_hi:[1,0,1]
    v_pk_fma_f32 v[126:127], v[58:59], v[182:183], v[126:127] op_sel_hi:[1,0,1]
    v_pk_mul_f32 v[124:125], v[124:125], v[182:183] op_sel:[0,1]
    v_pk_mul_f32 v[126:127], v[126:127], v[182:183] op_sel:[0,1]
    v_cvt_pk_bf16_f32 v162, v124, v125
    v_cvt_pk_bf16_f32 v163, v126, v127
    s_xor_b32 s56, s27, 0x3405000
    buffer_load_dwordx4 a[56:59], v1, s[4:7], s56 offen offset:0
    ds_write_b64 v30, v[162:163] offset:768
    v_pk_fma_f32 v[84:85], v[48:49], v[182:183], v[84:85] op_sel_hi:[1,0,1]
    v_pk_fma_f32 v[86:87], v[50:51], v[182:183], v[86:87] op_sel_hi:[1,0,1]
    v_pk_mul_f32 v[84:85], v[84:85], v[182:183] op_sel:[0,1]
    v_pk_mul_f32 v[86:87], v[86:87], v[182:183] op_sel:[0,1]
    v_cvt_pk_bf16_f32 v160, v84, v85
    v_cvt_pk_bf16_f32 v161, v86, v87
    v_pk_fma_f32 v[64:65], v[44:45], v[182:183], v[64:65] op_sel_hi:[1,0,1]
    v_pk_fma_f32 v[66:67], v[46:47], v[182:183], v[66:67] op_sel_hi:[1,0,1]
    v_pk_mul_f32 v[64:65], v[64:65], v[182:183] op_sel:[0,1]
    v_pk_mul_f32 v[66:67], v[66:67], v[182:183] op_sel:[0,1]
    v_cvt_pk_bf16_f32 v144, v64, v65
    v_cvt_pk_bf16_f32 v145, v66, v67
    buffer_load_dwordx4 a[60:63], v10, s[4:7], s56 offen offset:1024
    v_pk_fma_f32 v[108:109], v[52:53], v[184:185], v[108:109] op_sel_hi:[1,0,1]
    v_pk_fma_f32 v[110:111], v[54:55], v[184:185], v[110:111] op_sel_hi:[1,0,1]
    v_pk_mul_f32 v[108:109], v[108:109], v[184:185] op_sel:[0,1]
    v_pk_mul_f32 v[110:111], v[110:111], v[184:185] op_sel:[0,1]
    v_cvt_pk_bf16_f32 v176, v108, v109
    v_cvt_pk_bf16_f32 v177, v110, v111
    ds_write_b64 v29, v[176:177] offset:1536
    v_and_b32 v150, v35, v176
    v_and_b32 v151, v35, v177
    v_pk_fma_f32 v[128:129], v[56:57], v[184:185], v[128:129] op_sel_hi:[1,0,1]
    v_pk_fma_f32 v[130:131], v[58:59], v[184:185], v[130:131] op_sel_hi:[1,0,1]
    v_pk_mul_f32 v[128:129], v[128:129], v[184:185] op_sel:[0,1]
    v_pk_mul_f32 v[130:131], v[130:131], v[184:185] op_sel:[0,1]
    s_xor_b32 s56, s27, 0x3405000
    buffer_load_dwordx4 a[64:67], v1, s[4:7], s56 offen offset:2048
    v_cvt_pk_bf16_f32 v166, v128, v129
    v_cvt_pk_bf16_f32 v167, v130, v131
    ds_write_b64 v30, v[166:167] offset:1536
    v_pk_fma_f32 v[88:89], v[48:49], v[184:185], v[88:89] op_sel_hi:[1,0,1]
    v_pk_fma_f32 v[90:91], v[50:51], v[184:185], v[90:91] op_sel_hi:[1,0,1]
    v_pk_mul_f32 v[88:89], v[88:89], v[184:185] op_sel:[0,1]
    v_pk_mul_f32 v[90:91], v[90:91], v[184:185] op_sel:[0,1]
    v_cvt_pk_bf16_f32 v164, v88, v89
    v_cvt_pk_bf16_f32 v165, v90, v91
    v_pk_fma_f32 v[68:69], v[44:45], v[184:185], v[68:69] op_sel_hi:[1,0,1]
    v_pk_fma_f32 v[70:71], v[46:47], v[184:185], v[70:71] op_sel_hi:[1,0,1]
    v_pk_mul_f32 v[68:69], v[68:69], v[184:185] op_sel:[0,1]
    v_pk_mul_f32 v[70:71], v[70:71], v[184:185] op_sel:[0,1]
    buffer_load_dwordx4 a[68:71], v10, s[4:7], s56 offen offset:3072
    v_cvt_pk_bf16_f32 v148, v68, v69
    v_cvt_pk_bf16_f32 v149, v70, v71
    v_pk_fma_f32 v[112:113], v[52:53], v[186:187], v[112:113] op_sel_hi:[1,0,1]
    v_pk_fma_f32 v[114:115], v[54:55], v[186:187], v[114:115] op_sel_hi:[1,0,1]
    v_pk_mul_f32 v[112:113], v[112:113], v[186:187] op_sel:[0,1]
    v_pk_mul_f32 v[114:115], v[114:115], v[186:187] op_sel:[0,1]
    v_cvt_pk_bf16_f32 v178, v112, v113
    v_cvt_pk_bf16_f32 v179, v114, v115
    ds_write_b64 v29, v[178:179] offset:2304
    v_and_b32 v154, v35, v178
    v_and_b32 v155, v35, v179
    v_pk_fma_f32 v[132:133], v[56:57], v[186:187], v[132:133] op_sel_hi:[1,0,1]
    v_pk_fma_f32 v[134:135], v[58:59], v[186:187], v[134:135] op_sel_hi:[1,0,1]
    v_pk_mul_f32 v[132:133], v[132:133], v[186:187] op_sel:[0,1]
    s_xor_b32 s56, s27, 0x3406000
    buffer_load_dwordx4 a[72:75], v1, s[4:7], s56 offen offset:0
    v_pk_mul_f32 v[134:135], v[134:135], v[186:187] op_sel:[0,1]
    v_cvt_pk_bf16_f32 v170, v132, v133
    v_cvt_pk_bf16_f32 v171, v134, v135
    ds_write_b64 v30, v[170:171] offset:2304
    v_pk_fma_f32 v[92:93], v[48:49], v[186:187], v[92:93] op_sel_hi:[1,0,1]
    v_pk_fma_f32 v[94:95], v[50:51], v[186:187], v[94:95] op_sel_hi:[1,0,1]
    v_pk_mul_f32 v[92:93], v[92:93], v[186:187] op_sel:[0,1]
    v_pk_mul_f32 v[94:95], v[94:95], v[186:187] op_sel:[0,1]
    v_cvt_pk_bf16_f32 v168, v92, v93
    v_cvt_pk_bf16_f32 v169, v94, v95
    v_pk_fma_f32 v[72:73], v[44:45], v[186:187], v[72:73] op_sel_hi:[1,0,1]
    v_pk_fma_f32 v[74:75], v[46:47], v[186:187], v[74:75] op_sel_hi:[1,0,1]
    v_pk_mul_f32 v[72:73], v[72:73], v[186:187] op_sel:[0,1]
    buffer_load_dwordx4 a[76:79], v10, s[4:7], s56 offen offset:1024
    v_pk_mul_f32 v[74:75], v[74:75], v[186:187] op_sel:[0,1]
    v_cvt_pk_bf16_f32 v152, v72, v73
    v_cvt_pk_bf16_f32 v153, v74, v75
    ds_read_b128 v[60:63], v3 offset:54272
    ds_read_b128 v[64:67], v3 offset:55296
    ds_read_b128 v[68:71], v3 offset:56320
    ds_read_b128 v[72:75], v3 offset:57344
    ds_read_b64_tr_b16 v[108:109], v31 offset:3072
    ds_read_b64_tr_b16 v[110:111], v31 offset:0
    ds_read_b64_tr_b16 v[112:113], v32 offset:3072
    ds_read_b64_tr_b16 v[114:115], v32 offset:0
    ds_read_b64_tr_b16 v[116:117], v31 offset:3072
    ds_read_b64_tr_b16 v[118:119], v31 offset:768
    ds_read_b64_tr_b16 v[120:121], v32 offset:3072
    ds_read_b64_tr_b16 v[122:123], v32 offset:768
    s_xor_b32 s56, s27, 0x3408000
    buffer_load_dwordx4 a[80:83], v1, s[4:7], s56 offen offset:0
    ds_read_b64_tr_b16 v[124:125], v31 offset:0
    ds_read_b64_tr_b16 v[126:127], v31 offset:1536
    ds_read_b64_tr_b16 v[128:129], v32 offset:0
    ds_read_b64_tr_b16 v[130:131], v32 offset:1536
    ds_read_b64_tr_b16 v[132:133], v31 offset:768
    ds_read_b64_tr_b16 v[134:135], v31 offset:2304
    ds_read_b64_tr_b16 v[136:137], v32 offset:768
    ds_read_b64_tr_b16 v[138:139], v32 offset:2304
    s_waitcnt lgkmcnt(14)
    v_mfma_f32_16x16x32_bf16 v[76:79], v[172:175], v[140:143], v[68:71]
    v_mfma_f32_16x16x32_bf16 v[80:83], v[156:159], v[140:143], v[60:63]
    buffer_load_dwordx4 a[84:87], v10, s[4:7], s56 offen offset:1024
    v_mfma_f32_16x16x32_bf16 v[84:87], v[172:175], v[144:147], v[72:75]
    v_mfma_f32_16x16x32_bf16 v[88:91], v[160:163], v[144:147], v[60:63]
    v_mfma_f32_16x16x32_bf16 v[92:95], v[156:159], v[148:151], v[64:67]
    v_mfma_f32_16x16x32_bf16 v[96:99], v[164:167], v[148:151], v[60:63]
    v_mfma_f32_16x16x32_bf16 v[100:103], v[160:163], v[152:155], v[64:67]
    buffer_load_dwordx4 a[88:91], v1, s[4:7], s56 offen offset:2048
    v_mfma_f32_16x16x32_bf16 v[104:107], v[168:171], v[152:155], v[60:63]
    s_mov_b32 s52, 0x3ea52b5c
    v_max3_f32 v44, v76, v77, v78
    v_max3_f32 v48, v79, v80, v81
    v_max3_f32 v44, v44, v82, v83
    v_max_f32 v44, v44, v48
    v_max3_f32 v45, v84, v85, v86
    v_max3_f32 v49, v87, v88, v89
    v_max3_f32 v45, v45, v90, v91
    v_max_f32 v45, v45, v49
    v_max3_f32 v46, v92, v93, v94
    v_max3_f32 v50, v95, v96, v97
    v_max3_f32 v46, v46, v98, v99
    v_max_f32 v46, v46, v50
    v_max3_f32 v47, v100, v101, v102
    v_max3_f32 v51, v103, v104, v105
    buffer_load_dwordx4 a[92:95], v10, s[4:7], s56 offen offset:3072
    v_max3_f32 v47, v47, v106, v107
    v_max_f32 v47, v47, v51
    v_mov_b32 v48, v44
    v_mov_b32 v49, v45
    v_mov_b32 v50, v46
    v_mov_b32 v51, v47
    v_permlane32_swap_b32 v44, v48
    v_permlane32_swap_b32 v45, v49
    v_permlane32_swap_b32 v46, v50
    v_permlane32_swap_b32 v47, v51
    v_max_f32 v44, v44, v48
    v_max_f32 v45, v45, v49
    v_max_f32 v46, v46, v50
    v_max_f32 v47, v47, v51
    s_xor_b32 s56, s27, 0x3409000
    buffer_load_dwordx4 a[96:99], v1, s[4:7], s56 offen offset:0
    v_mov_b32 v48, v44
    v_mov_b32 v49, v45
    v_mov_b32 v50, v46
    v_mov_b32 v51, v47
    v_permlane16_swap_b32 v44, v48
    v_permlane16_swap_b32 v45, v49
    v_permlane16_swap_b32 v46, v50
    v_permlane16_swap_b32 v47, v51
    v_max_f32 v44, v44, v48
    v_max_f32 v45, v45, v49
    v_max_f32 v46, v46, v50
    v_max_f32 v47, v47, v51
    v_mul_f32 v44, s52, v44
    v_mul_f32 v45, s52, v45
    buffer_load_dwordx4 a[100:103], v10, s[4:7], s56 offen offset:1024
    v_mul_f32 v46, s52, v46
    v_mul_f32 v47, s52, v47
    v_fma_f32 v76, v76, s52, -v44
    v_fma_f32 v77, v77, s52, -v44
    v_fma_f32 v78, v78, s52, -v44
    v_fma_f32 v79, v79, s52, -v44
    v_fma_f32 v80, v80, s52, -v44
    v_fma_f32 v81, v81, s52, -v44
    v_fma_f32 v82, v82, s52, -v44
    v_fma_f32 v83, v83, s52, -v44
    v_exp_f32 v76, v76
    v_exp_f32 v77, v77
    buffer_load_dwordx4 a[104:107], v1, s[4:7], s56 offen offset:2048
    v_exp_f32 v78, v78
    v_exp_f32 v79, v79
    v_exp_f32 v80, v80
    v_exp_f32 v81, v81
    v_exp_f32 v82, v82
    v_exp_f32 v83, v83
    v_cvt_pk_bf16_f32 v140, v76, v77
    v_cvt_pk_bf16_f32 v141, v78, v79
    v_cvt_pk_bf16_f32 v142, v80, v81
    buffer_load_dwordx4 a[108:111], v10, s[4:7], s56 offen offset:3072
    v_cvt_pk_bf16_f32 v143, v82, v83
    s_nop 1
    v_mfma_f32_16x16x32_bf16 v[164:167], v[36:39], v[140:143], 0
    v_mfma_f32_16x16x32_bf16 v[156:159], v[108:111], v[140:143], 0
    s_waitcnt lgkmcnt(12)
    v_mfma_f32_16x16x32_bf16 v[160:163], v[112:115], v[140:143], 0
    v_fma_f32 v84, v84, s52, -v45
    v_fma_f32 v85, v85, s52, -v45
    v_fma_f32 v86, v86, s52, -v45
    v_fma_f32 v87, v87, s52, -v45
    v_fma_f32 v88, v88, s52, -v45
    s_xor_b32 s56, s27, 0x340a000
    buffer_load_dwordx4 a[112:115], v1, s[4:7], s56 offen offset:0
    v_fma_f32 v89, v89, s52, -v45
    v_fma_f32 v90, v90, s52, -v45
    v_fma_f32 v91, v91, s52, -v45
    v_exp_f32 v84, v84
    v_exp_f32 v85, v85
    v_exp_f32 v86, v86
    v_exp_f32 v87, v87
    v_exp_f32 v88, v88
    v_exp_f32 v89, v89
    buffer_load_dwordx4 a[116:119], v10, s[4:7], s56 offen offset:1024
    v_exp_f32 v90, v90
    v_exp_f32 v91, v91
    v_cvt_pk_bf16_f32 v144, v84, v85
    v_cvt_pk_bf16_f32 v145, v86, v87
    v_cvt_pk_bf16_f32 v146, v88, v89
    v_cvt_pk_bf16_f32 v147, v90, v91
    s_nop 1
    v_mfma_f32_16x16x32_bf16 v[176:179], v[36:39], v[144:147], 0
    s_waitcnt lgkmcnt(10)
    v_mfma_f32_16x16x32_bf16 v[168:171], v[116:119], v[144:147], 0
    s_xor_b32 s56, s27, 0x340c000
    buffer_load_dwordx4 a[120:123], v1, s[4:7], s56 offen offset:0
    s_waitcnt lgkmcnt(8)
    v_mfma_f32_16x16x32_bf16 v[172:175], v[120:123], v[144:147], 0
    v_rcp_f32 v164, v164
    s_nop 0
    v_pk_mul_f32 v[156:157], v[156:157], v[164:165] op_sel_hi:[1,0]
    v_pk_mul_f32 v[158:159], v[158:159], v[164:165] op_sel_hi:[1,0]
    v_pk_mul_f32 v[160:161], v[160:161], v[164:165] op_sel_hi:[1,0]
    v_pk_mul_f32 v[162:163], v[162:163], v[164:165] op_sel_hi:[1,0]
    v_cvt_pk_bf16_f32 v156, v156, v157
    v_cvt_pk_bf16_f32 v157, v158, v159
    v_cvt_pk_bf16_f32 v158, v160, v161
    v_cvt_pk_bf16_f32 v159, v162, v163
    s_add_u32 s48, s24, 0x1380000
    buffer_store_dwordx4 v[156:159], v11, s[4:7], s48 offen offset:0 sc1
    buffer_store_dwordx2 v[156:157], v12, s[4:7], s48 offen offset:0 sc1
    v_fma_f32 v92, v92, s52, -v46
    v_fma_f32 v93, v93, s52, -v46
    v_fma_f32 v94, v94, s52, -v46
    v_fma_f32 v95, v95, s52, -v46
    v_fma_f32 v96, v96, s52, -v46
    v_fma_f32 v97, v97, s52, -v46
    v_fma_f32 v98, v98, s52, -v46
    v_fma_f32 v99, v99, s52, -v46
    v_exp_f32 v92, v92
    v_exp_f32 v93, v93
    v_exp_f32 v94, v94
    v_exp_f32 v95, v95
    v_exp_f32 v96, v96
    v_exp_f32 v97, v97
    v_exp_f32 v98, v98
    v_exp_f32 v99, v99
    v_cvt_pk_bf16_f32 v148, v92, v93
    v_cvt_pk_bf16_f32 v149, v94, v95
    v_cvt_pk_bf16_f32 v150, v96, v97
    v_cvt_pk_bf16_f32 v151, v98, v99
    s_nop 1
    v_mfma_f32_16x16x32_bf16 v[188:191], v[36:39], v[148:151], 0
    s_waitcnt lgkmcnt(6)
    v_mfma_f32_16x16x32_bf16 v[180:183], v[124:127], v[148:151], 0
    s_waitcnt lgkmcnt(4)
    v_mfma_f32_16x16x32_bf16 v[184:187], v[128:131], v[148:151], 0
    v_rcp_f32 v176, v176
    s_nop 0
    v_pk_mul_f32 v[168:169], v[168:169], v[176:177] op_sel_hi:[1,0]
    v_pk_mul_f32 v[170:171], v[170:171], v[176:177] op_sel_hi:[1,0]
    v_pk_mul_f32 v[172:173], v[172:173], v[176:177] op_sel_hi:[1,0]
    v_pk_mul_f32 v[174:175], v[174:175], v[176:177] op_sel_hi:[1,0]
    v_cvt_pk_bf16_f32 v168, v168, v169
    v_cvt_pk_bf16_f32 v169, v170, v171
    v_cvt_pk_bf16_f32 v170, v172, v173
    v_cvt_pk_bf16_f32 v171, v174, v175
    s_add_u32 s48, s24, 0x1385000
    buffer_store_dwordx4 v[168:171], v11, s[4:7], s48 offen offset:0 sc1
    buffer_store_dwordx2 v[168:169], v12, s[4:7], s48 offen offset:0 sc1
    v_fma_f32 v100, v100, s52, -v47
    v_fma_f32 v101, v101, s52, -v47
    v_fma_f32 v102, v102, s52, -v47
    v_fma_f32 v103, v103, s52, -v47
    v_fma_f32 v104, v104, s52, -v47
    v_fma_f32 v105, v105, s52, -v47
    v_fma_f32 v106, v106, s52, -v47
    v_fma_f32 v107, v107, s52, -v47
    v_exp_f32 v100, v100
    v_exp_f32 v101, v101
    v_exp_f32 v102, v102
    v_exp_f32 v103, v103
    v_exp_f32 v104, v104
    v_exp_f32 v105, v105
    v_exp_f32 v106, v106
    v_exp_f32 v107, v107
    v_cvt_pk_bf16_f32 v152, v100, v101
    v_cvt_pk_bf16_f32 v153, v102, v103
    v_cvt_pk_bf16_f32 v154, v104, v105
    v_cvt_pk_bf16_f32 v155, v106, v107
    s_nop 1
    v_mfma_f32_16x16x32_bf16 v[68:71], v[36:39], v[152:155], 0
    s_waitcnt lgkmcnt(2)
    v_mfma_f32_16x16x32_bf16 v[60:63], v[132:135], v[152:155], 0
    s_waitcnt lgkmcnt(0)
    v_mfma_f32_16x16x32_bf16 v[64:67], v[136:139], v[152:155], 0
    v_rcp_f32 v188, v188
    s_nop 0
    v_pk_mul_f32 v[180:181], v[180:181], v[188:189] op_sel_hi:[1,0]
    v_pk_mul_f32 v[182:183], v[182:183], v[188:189] op_sel_hi:[1,0]
    v_pk_mul_f32 v[184:185], v[184:185], v[188:189] op_sel_hi:[1,0]
    v_pk_mul_f32 v[186:187], v[186:187], v[188:189] op_sel_hi:[1,0]
    v_cvt_pk_bf16_f32 v180, v180, v181
    v_cvt_pk_bf16_f32 v181, v182, v183
    v_cvt_pk_bf16_f32 v182, v184, v185
    v_cvt_pk_bf16_f32 v183, v186, v187
    s_add_u32 s48, s24, 0x138a000
    buffer_store_dwordx4 v[180:183], v11, s[4:7], s48 offen offset:0 sc1
    buffer_store_dwordx2 v[180:181], v12, s[4:7], s48 offen offset:0 sc1
    v_rcp_f32 v68, v68
    s_nop 0
    v_pk_mul_f32 v[60:61], v[60:61], v[68:69] op_sel_hi:[1,0]
    v_pk_mul_f32 v[62:63], v[62:63], v[68:69] op_sel_hi:[1,0]
    v_pk_mul_f32 v[64:65], v[64:65], v[68:69] op_sel_hi:[1,0]
    v_pk_mul_f32 v[66:67], v[66:67], v[68:69] op_sel_hi:[1,0]
    v_cvt_pk_bf16_f32 v60, v60, v61
    v_cvt_pk_bf16_f32 v61, v62, v63
    v_cvt_pk_bf16_f32 v62, v64, v65
    v_cvt_pk_bf16_f32 v63, v66, v67
    s_add_u32 s48, s24, 0x138f000
    buffer_store_dwordx4 v[60:63], v11, s[4:7], s48 offen offset:0 sc1
    buffer_store_dwordx2 v[60:61], v12, s[4:7], s48 offen offset:0 sc1
    buffer_load_dwordx4 a[124:127], v10, s[4:7], s56 offen offset:1024
    buffer_load_dwordx4 a[128:131], v1, s[4:7], s56 offen offset:2048
    buffer_load_dwordx4 a[132:135], v10, s[4:7], s56 offen offset:3072
    s_xor_b32 s56, s27, 0x340d000
    buffer_load_dwordx4 a[136:139], v1, s[4:7], s56 offen offset:0
    buffer_load_dwordx4 a[140:143], v10, s[4:7], s56 offen offset:1024
    buffer_load_dwordx4 a[144:147], v1, s[4:7], s56 offen offset:2048
    buffer_load_dwordx4 a[148:151], v10, s[4:7], s56 offen offset:3072
    s_xor_b32 s56, s27, 0x340e000
    buffer_load_dwordx4 a[152:155], v1, s[4:7], s56 offen offset:0
    s_sub_u32 s58, s60, 6
    v_mov_b32 v26, s58
    s_mov_b64 exec, 1
    s_waitcnt vmcnt(8)
    buffer_store_dwordx2 v[26:27], off, s[4:7], s35
    s_mov_b64 exec, -1
    s_barrier
    buffer_load_dwordx4 a[156:159], v10, s[4:7], s56 offen offset:1024
    s_xor_b32 s56, s27, 0x3410000
    buffer_load_dwordx4 a[160:163], v1, s[4:7], s56 offen offset:0
    v_lshlrev_b32 v140, 16, v16
    v_and_b32 v141, 0xffff0000, v16
    v_lshlrev_b32 v142, 16, v17
    v_and_b32 v143, 0xffff0000, v17
    v_lshlrev_b32 v144, 16, v18
    v_and_b32 v145, 0xffff0000, v18
    v_lshlrev_b32 v146, 16, v19
    v_and_b32 v147, 0xffff0000, v19
    v_lshlrev_b32 v148, 16, v20
    v_and_b32 v149, 0xffff0000, v20
    v_lshlrev_b32 v150, 16, v21
    v_and_b32 v151, 0xffff0000, v21
    v_lshlrev_b32 v152, 16, v22
    v_and_b32 v153, 0xffff0000, v22
    v_lshlrev_b32 v154, 16, v23
    v_and_b32 v155, 0xffff0000, v23
    v_lshlrev_b32 v156, 16, v14
    v_and_b32 v157, 0xffff0000, v14
    v_lshlrev_b32 v158, 16, v15
    v_and_b32 v159, 0xffff0000, v15
    ds_read_b128 v[160:163], v3 offset:0
    ds_read_b128 v[164:167], v3 offset:1024
    ds_read_b128 v[168:171], v3 offset:2048
    ds_read_b128 v[172:175], v3 offset:3072
    ds_read_b128 v[176:179], v3 offset:4096
    ds_read_b128 v[180:183], v3 offset:5120
    ds_read_b128 v[184:187], v3 offset:6144
    ds_read_b128 v[188:191], v3 offset:7168
    s_load_dwordx2 s[16:17], s[0:1], 64
    v_lshlrev_b32 v43, 7, v7
    v_add_u32 v43, s42, v43
    v_lshl_add_u32 v42, v7, 3, s34
    buffer_load_dwordx2 v[40:41], v42, s[4:7], 0 offen sc1
    s_mov_b32 s51, 0x20000
    s_mov_b64 exec, 1
    buffer_store_dwordx2 v[26:27], off, s[4:7], s43 sc1
    s_mov_b64 exec, -1
    s_lshr_b32 s50, s2, 3
    s_lshl_b32 s50, s50, 2
    s_add_u32 s50, s50, s22
    s_lshl_b32 s50, s50, 10
    v_add_u32 v60, s50, v1
    v_min_u32 v60, MK_codeend-CPF_23-32, v60
    s_getpc_b64 s[48:49]
CPF_23:
    global_load_dword v60, v60, s[48:49]
    buffer_load_dwordx4 a[164:167], v10, s[4:7], s56 offen offset:1024
    buffer_load_dwordx4 a[168:171], v1, s[4:7], s56 offen offset:2048
    buffer_load_dwordx4 a[172:175], v10, s[4:7], s56 offen offset:3072
    s_xor_b32 s56, s27, 0x3411000
    buffer_load_dwordx4 a[176:179], v1, s[4:7], s56 offen offset:0
    buffer_load_dwordx4 a[180:183], v10, s[4:7], s56 offen offset:1024
    buffer_load_dwordx4 a[184:187], v1, s[4:7], s56 offen offset:2048
    buffer_load_dwordx4 a[188:191], v10, s[4:7], s56 offen offset:3072
    s_xor_b32 s56, s27, 0x3412000
    buffer_load_dwordx4 a[192:195], v1, s[4:7], s56 offen offset:0
    s_waitcnt vmcnt(10)
    v_cmp_gt_u64 vcc, s[58:59], v[40:41]
    v_cmp_lt_u64 s[48:49], s[60:61], v[40:41]
    s_nop 0
    s_or_b64 vcc, vcc, s[48:49]
    s_cbranch_scc0 POLLD_22
    s_nop 1
POLL_21:
    buffer_load_dwordx2 v[40:41], v42, s[4:7], 0 offen sc1
    s_sub_u32 s51, s51, 1
    s_cbranch_scc1 POLLD_22X
    s_cmp_eq_u32 s51, 0x1ffd8
    s_cselect_b64 vcc, -1, 0
    v_cndmask_b32 v42, v42, v43, vcc
    s_waitcnt vmcnt(0)
    v_cmp_gt_u64 vcc, s[58:59], v[40:41]
    v_cmp_lt_u64 s[48:49], s[60:61], v[40:41]
    s_nop 0
    s_or_b64 vcc, vcc, s[48:49]
    s_cbranch_scc1 POLL_21
POLLD_22X:
    s_waitcnt vmcnt(0)
POLLD_22:
    s_add_u32 s48, s31, 0x1380000
    buffer_load_dwordx4 v[60:63], v1, s[4:7], s48 offen offset:0 sc1
    buffer_load_dwordx4 v[64:67], v1, s[4:7], s48 offen offset:1024 sc1
    buffer_load_dwordx4 v[68:71], v1, s[4:7], s48 offen offset:2048 sc1
    buffer_load_dwordx4 v[72:75], v1, s[4:7], s48 offen offset:3072 sc1
    s_add_u32 s48, s31, 0x1381000
    buffer_load_dwordx4 v[76:79], v1, s[4:7], s48 offen offset:0 sc1
    buffer_load_dwordx4 v[80:83], v1, s[4:7], s48 offen offset:1024 sc1
    buffer_load_dwordx4 v[84:87], v1, s[4:7], s48 offen offset:2048 sc1
    buffer_load_dwordx4 v[88:91], v1, s[4:7], s48 offen offset:3072 sc1
    s_add_u32 s48, s31, 0x1382000
    buffer_load_dwordx4 v[92:95], v1, s[4:7], s48 offen offset:0 sc1
    buffer_load_dwordx4 v[96:99], v1, s[4:7], s48 offen offset:1024 sc1
    buffer_load_dwordx4 v[100:103], v1, s[4:7], s48 offen offset:2048 sc1
    buffer_load_dwordx4 v[104:107], v1, s[4:7], s48 offen offset:3072 sc1
    s_add_u32 s48, s31, 0x1383000
    buffer_load_dwordx4 v[108:111], v1, s[4:7], s48 offen offset:0 sc1
    buffer_load_dwordx4 v[112:115], v1, s[4:7], s48 offen offset:1024 sc1
    buffer_load_dwordx4 v[116:119], v1, s[4:7], s48 offen offset:2048 sc1
    buffer_load_dwordx4 v[120:123], v1, s[4:7], s48 offen offset:3072 sc1
    s_add_u32 s48, s31, 0x1384000
    buffer_load_dwordx2 v[124:125], v25, s[4:7], s48 offen offset:0 sc1
    buffer_load_dwordx2 v[126:127], v25, s[4:7], s48 offen offset:128 sc1
    buffer_load_dwordx2 v[128:129], v25, s[4:7], s48 offen offset:1024 sc1
    buffer_load_dwordx2 v[130:131], v25, s[4:7], s48 offen offset:1152 sc1
    buffer_load_dwordx2 v[132:133], v25, s[4:7], s48 offen offset:2048 sc1
    buffer_load_dwordx2 v[134:135], v25, s[4:7], s48 offen offset:2176 sc1
    buffer_load_dwordx2 v[136:137], v25, s[4:7], s48 offen offset:3072 sc1
    buffer_load_dwordx2 v[138:139], v25, s[4:7], s48 offen offset:3200 sc1
    s_waitcnt vmcnt(23) lgkmcnt(0)
    v_mfma_f32_16x16x32_bf16 v[140:143], v[160:163], v[60:63], v[140:143]
    ds_read_b128 v[160:163], v3 offset:8192
    v_mfma_f32_16x16x32_bf16 v[144:147], v[164:167], v[60:63], v[144:147]
    ds_read_b128 v[164:167], v3 offset:9216
    v_mfma_f32_16x16x32_bf16 v[148:151], v[168:171], v[60:63], v[148:151]
    ds_read_b128 v[168:171], v3 offset:10240
    v_mfma_f32_16x16x32_bf16 v[152:155], v[172:175], v[60:63], v[152:155]
    ds_read_b128 v[172:175], v3 offset:11264
    v_mfma_f32_16x16x32_bf16 v[156:159], v[176:179], v[60:63], v[156:159]
    ds_read_b128 v[176:179], v3 offset:12288
    s_waitcnt vmcnt(22)
    v_mfma_f32_16x16x32_bf16 v[140:143], v[180:183], v[64:67], v[140:143]
    ds_read_b128 v[180:183], v3 offset:13312
    v_mfma_f32_16x16x32_bf16 v[144:147], v[184:187], v[64:67], v[144:147]
    ds_read_b128 v[184:187], v3 offset:14336
    v_mfma_f32_16x16x32_bf16 v[148:151], v[188:191], v[64:67], v[148:151]
    ds_read_b128 v[188:191], v3 offset:15360
    s_waitcnt lgkmcnt(7)
    v_mfma_f32_16x16x32_bf16 v[152:155], v[160:163], v[64:67], v[152:155]
    buffer_load_dwordx4 a[196:199], v10, s[4:7], s56 offen offset:1024
    ds_read_b128 v[160:163], v3 offset:16384
    s_waitcnt lgkmcnt(7)
    v_mfma_f32_16x16x32_bf16 v[156:159], v[164:167], v[64:67], v[156:159]
    ds_read_b128 v[164:167], v3 offset:17408
    s_waitcnt vmcnt(22) lgkmcnt(7)
    v_mfma_f32_16x16x32_bf16 v[140:143], v[168:171], v[68:71], v[140:143]
    ds_read_b128 v[168:171], v3 offset:18432
    s_waitcnt lgkmcnt(7)
    v_mfma_f32_16x16x32_bf16 v[144:147], v[172:175], v[68:71], v[144:147]
    ds_read_b128 v[172:175], v3 offset:19456
    s_waitcnt lgkmcnt(7)
    v_mfma_f32_16x16x32_bf16 v[148:151], v[176:179], v[68:71], v[148:151]
    ds_read_b128 v[176:179], v3 offset:20480
    s_waitcnt lgkmcnt(7)
    v_mfma_f32_16x16x32_bf16 v[152:155], v[180:183], v[68:71], v[152:155]
    s_xor_b32 s56, s27, 0x3414000
    buffer_load_dwordx4 a[200:203], v1, s[4:7], s56 offen offset:0
    ds_read_b128 v[180:183], v3 offset:21504
    s_waitcnt lgkmcnt(7)
    v_mfma_f32_16x16x32_bf16 v[156:159], v[184:187], v[68:71], v[156:159]
    ds_read_b128 v[184:187], v3 offset:22528
    s_waitcnt vmcnt(22) lgkmcnt(7)
    v_mfma_f32_16x16x32_bf16 v[140:143], v[188:191], v[72:75], v[140:143]
    ds_read_b128 v[188:191], v3 offset:23552
    s_waitcnt lgkmcnt(7)
    v_mfma_f32_16x16x32_bf16 v[144:147], v[160:163], v[72:75], v[144:147]
    ds_read_b128 v[160:163], v3 offset:24576
    s_waitcnt lgkmcnt(7)
    v_mfma_f32_16x16x32_bf16 v[148:151], v[164:167], v[72:75], v[148:151]
    ds_read_b128 v[164:167], v3 offset:25600
    s_waitcnt lgkmcnt(7)
    v_mfma_f32_16x16x32_bf16 v[152:155], v[168:171], v[72:75], v[152:155]
    buffer_load_dwordx4 a[204:207], v10, s[4:7], s56 offen offset:1024
    ds_read_b128 v[168:171], v3 offset:26624
    s_waitcnt lgkmcnt(7)
    v_mfma_f32_16x16x32_bf16 v[156:159], v[172:175], v[72:75], v[156:159]
    ds_read_b128 v[172:175], v3 offset:27648
    s_waitcnt vmcnt(22) lgkmcnt(7)
    v_mfma_f32_16x16x32_bf16 v[140:143], v[176:179], v[76:79], v[140:143]
    ds_read_b128 v[176:179], v3 offset:28672
    s_waitcnt lgkmcnt(7)
    v_mfma_f32_16x16x32_bf16 v[144:147], v[180:183], v[76:79], v[144:147]
    ds_read_b128 v[180:183], v3 offset:29696
    s_waitcnt lgkmcnt(7)
    v_mfma_f32_16x16x32_bf16 v[148:151], v[184:187], v[76:79], v[148:151]
    ds_read_b128 v[184:187], v3 offset:30720
    s_waitcnt lgkmcnt(7)
    v_mfma_f32_16x16x32_bf16 v[152:155], v[188:191], v[76:79], v[152:155]
    buffer_load_dwordx4 a[208:211], v1, s[4:7], s56 offen offset:2048
    ds_read_b128 v[188:191], v3 offset:31744
    s_waitcnt lgkmcnt(7)
    v_mfma_f32_16x16x32_bf16 v[156:159], v[160:163], v[76:79], v[156:159]
    ds_read_b128 v[160:163], v1 offset:0
    s_waitcnt vmcnt(22) lgkmcnt(7)
    v_mfma_f32_16x16x32_bf16 v[140:143], v[164:167], v[80:83], v[140:143]
    ds_read_b128 v[164:167], v1 offset:1024
    s_waitcnt lgkmcnt(7)
    v_mfma_f32_16x16x32_bf16 v[144:147], v[168:171], v[80:83], v[144:147]
    ds_read_b128 v[168:171], v1 offset:2048
    s_waitcnt lgkmcnt(7)
    v_mfma_f32_16x16x32_bf16 v[148:151], v[172:175], v[80:83], v[148:151]
    ds_read_b128 v[172:175], v1 offset:3072
    s_waitcnt lgkmcnt(7)
    v_mfma_f32_16x16x32_bf16 v[152:155], v[176:179], v[80:83], v[152:155]
    buffer_load_dwordx4 a[212:215], v10, s[4:7], s56 offen offset:3072
    ds_read_b128 v[176:179], v1 offset:4096
    s_waitcnt lgkmcnt(7)
    v_mfma_f32_16x16x32_bf16 v[156:159], v[180:183], v[80:83], v[156:159]
    ds_read_b128 v[180:183], v1 offset:5120
    s_waitcnt vmcnt(22) lgkmcnt(7)
    v_mfma_f32_16x16x32_bf16 v[140:143], v[184:187], v[84:87], v[140:143]
    ds_read_b128 v[184:187], v1 offset:6144
    s_waitcnt lgkmcnt(7)
    v_mfma_f32_16x16x32_bf16 v[144:147], v[188:191], v[84:87], v[144:147]
    ds_read_b128 v[188:191], v1 offset:7168
    s_waitcnt lgkmcnt(7)
    v_mfma_f32_16x16x32_bf16 v[148:151], v[160:163], v[84:87], v[148:151]
    ds_read_b128 v[160:163], v1 offset:8192
    s_waitcnt lgkmcnt(7)
    v_mfma_f32_16x16x32_bf16 v[152:155], v[164:167], v[84:87], v[152:155]
    s_xor_b32 s56, s27, 0x3415000
    buffer_load_dwordx4 a[216:219], v1, s[4:7], s56 offen offset:0
    ds_read_b128 v[164:167], v1 offset:9216
    s_waitcnt lgkmcnt(7)
    v_mfma_f32_16x16x32_bf16 v[156:159], v[168:171], v[84:87], v[156:159]
    ds_read_b128 v[168:171], v1 offset:10240
    s_waitcnt vmcnt(22) lgkmcnt(7)
    v_mfma_f32_16x16x32_bf16 v[140:143], v[172:175], v[88:91], v[140:143]
    ds_read_b128 v[172:175], v1 offset:11264
    s_waitcnt lgkmcnt(7)
    v_mfma_f32_16x16x32_bf16 v[144:147], v[176:179], v[88:91], v[144:147]
    ds_read_b128 v[176:179], v1 offset:12288
    s_waitcnt lgkmcnt(7)
    v_mfma_f32_16x16x32_bf16 v[148:151], v[180:183], v[88:91], v[148:151]
    ds_read_b128 v[180:183], v1 offset:13312
    s_waitcnt lgkmcnt(7)
    v_mfma_f32_16x16x32_bf16 v[152:155], v[184:187], v[88:91], v[152:155]
    buffer_load_dwordx4 a[220:223], v10, s[4:7], s56 offen offset:1024
    ds_read_b128 v[184:187], v1 offset:14336
    s_waitcnt lgkmcnt(7)
    v_mfma_f32_16x16x32_bf16 v[156:159], v[188:191], v[88:91], v[156:159]
    ds_read_b128 v[188:191], v1 offset:15360
    s_waitcnt vmcnt(22) lgkmcnt(7)
    v_mfma_f32_16x16x32_bf16 v[140:143], v[160:163], v[92:95], v[140:143]
    ds_read_b128 v[160:163], v1 offset:16384
    s_waitcnt lgkmcnt(7)
    v_mfma_f32_16x16x32_bf16 v[144:147], v[164:167], v[92:95], v[144:147]
    ds_read_b128 v[164:167], v1 offset:17408
    s_waitcnt lgkmcnt(7)
    v_mfma_f32_16x16x32_bf16 v[148:151], v[168:171], v[92:95], v[148:151]
    ds_read_b128 v[168:171], v1 offset:18432
    s_waitcnt lgkmcnt(7)
    v_mfma_f32_16x16x32_bf16 v[152:155], v[172:175], v[92:95], v[152:155]
    buffer_load_dwordx4 a[224:227], v1, s[4:7], s56 offen offset:2048
    ds_read_b128 v[172:175], v1 offset:19456
    s_waitcnt lgkmcnt(7)
    v_mfma_f32_16x16x32_bf16 v[156:159], v[176:179], v[92:95], v[156:159]
    ds_read_b128 v[176:179], v1 offset:20480
    s_waitcnt vmcnt(22) lgkmcnt(7)
    v_mfma_f32_16x16x32_bf16 v[140:143], v[180:183], v[96:99], v[140:143]
    ds_read_b128 v[180:183], v1 offset:21504
    s_waitcnt lgkmcnt(7)
    v_mfma_f32_16x16x32_bf16 v[144:147], v[184:187], v[96:99], v[144:147]
    ds_read_b128 v[184:187], v1 offset:22528
    s_waitcnt lgkmcnt(7)
    v_mfma_f32_16x16x32_bf16 v[148:151], v[188:191], v[96:99], v[148:151]
    ds_read_b128 v[188:191], v1 offset:23552
    s_waitcnt lgkmcnt(7)
    v_mfma_f32_16x16x32_bf16 v[152:155], v[160:163], v[96:99], v[152:155]
    buffer_load_dwordx4 a[228:231], v10, s[4:7], s56 offen offset:3072
    ds_read_b128 v[160:163], v1 offset:24576
    s_waitcnt lgkmcnt(7)
    v_mfma_f32_16x16x32_bf16 v[156:159], v[164:167], v[96:99], v[156:159]
    ds_read_b128 v[164:167], v1 offset:25600
    s_waitcnt vmcnt(22) lgkmcnt(7)
    v_mfma_f32_16x16x32_bf16 v[140:143], v[168:171], v[100:103], v[140:143]
    ds_read_b128 v[168:171], v1 offset:26624
    s_waitcnt lgkmcnt(7)
    v_mfma_f32_16x16x32_bf16 v[144:147], v[172:175], v[100:103], v[144:147]
    ds_read_b128 v[172:175], v1 offset:27648
    s_waitcnt lgkmcnt(7)
    v_mfma_f32_16x16x32_bf16 v[148:151], v[176:179], v[100:103], v[148:151]
    ds_read_b128 v[176:179], v1 offset:28672
    s_waitcnt lgkmcnt(7)
    v_mfma_f32_16x16x32_bf16 v[152:155], v[180:183], v[100:103], v[152:155]
    s_xor_b32 s56, s27, 0x3416000
    buffer_load_dwordx4 a[232:235], v1, s[4:7], s56 offen offset:0
    ds_read_b128 v[180:183], v1 offset:29696
    s_waitcnt lgkmcnt(7)
    v_mfma_f32_16x16x32_bf16 v[156:159], v[184:187], v[100:103], v[156:159]
    ds_read_b128 v[184:187], v1 offset:30720
    s_waitcnt vmcnt(22) lgkmcnt(7)
    v_mfma_f32_16x16x32_bf16 v[140:143], v[188:191], v[104:107], v[140:143]
    ds_read_b128 v[188:191], v1 offset:31744
    s_waitcnt lgkmcnt(7)
    v_mfma_f32_16x16x32_bf16 v[144:147], v[160:163], v[104:107], v[144:147]
    ds_read_b128 v[160:163], v1 offset:32768
    s_waitcnt lgkmcnt(7)
    v_mfma_f32_16x16x32_bf16 v[148:151], v[164:167], v[104:107], v[148:151]
    ds_read_b128 v[164:167], v1 offset:33792
    s_waitcnt lgkmcnt(7)
    v_mfma_f32_16x16x32_bf16 v[152:155], v[168:171], v[104:107], v[152:155]
    buffer_load_dwordx4 a[236:239], v10, s[4:7], s56 offen offset:1024
    ds_read_b128 v[168:171], v1 offset:34816
    s_waitcnt lgkmcnt(7)
    v_mfma_f32_16x16x32_bf16 v[156:159], v[172:175], v[104:107], v[156:159]
    ds_read_b128 v[172:175], v1 offset:35840
    s_waitcnt vmcnt(22) lgkmcnt(7)
    v_mfma_f32_16x16x32_bf16 v[140:143], v[176:179], v[108:111], v[140:143]
    ds_read_b128 v[176:179], v1 offset:36864
    s_waitcnt lgkmcnt(7)
    v_mfma_f32_16x16x32_bf16 v[144:147], v[180:183], v[108:111], v[144:147]
    ds_read_b128 v[180:183], v1 offset:37888
    s_waitcnt lgkmcnt(7)
    v_mfma_f32_16x16x32_bf16 v[148:151], v[184:187], v[108:111], v[148:151]
    ds_read_b128 v[184:187], v1 offset:38912
    s_waitcnt lgkmcnt(7)
    v_mfma_f32_16x16x32_bf16 v[152:155], v[188:191], v[108:111], v[152:155]
    s_xor_b32 s56, s27, 0x3418000
    buffer_load_dwordx4 a[240:243], v1, s[4:7], s56 offen offset:0
    ds_read_b128 v[188:191], v1 offset:39936
    s_waitcnt lgkmcnt(7)
    v_mfma_f32_16x16x32_bf16 v[156:159], v[160:163], v[108:111], v[156:159]
    ds_read_b128 v[160:163], v1 offset:40960
    s_waitcnt vmcnt(22) lgkmcnt(7)
    v_mfma_f32_16x16x32_bf16 v[140:143], v[164:167], v[112:115], v[140:143]
    ds_read_b128 v[164:167], v1 offset:41984
    s_waitcnt lgkmcnt(7)
    v_mfma_f32_16x16x32_bf16 v[144:147], v[168:171], v[112:115], v[144:147]
    ds_read_b128 v[168:171], v1 offset:43008
    s_waitcnt lgkmcnt(7)
    v_mfma_f32_16x16x32_bf16 v[148:151], v[172:175], v[112:115], v[148:151]
    ds_read_b128 v[172:175], v1 offset:44032
    s_waitcnt lgkmcnt(7)
    v_mfma_f32_16x16x32_bf16 v[152:155], v[176:179], v[112:115], v[152:155]
    buffer_load_dwordx4 a[244:247], v10, s[4:7], s56 offen offset:1024
    ds_read_b128 v[176:179], v1 offset:45056
    s_waitcnt lgkmcnt(7)
    v_mfma_f32_16x16x32_bf16 v[156:159], v[180:183], v[112:115], v[156:159]
    ds_read_b128 v[180:183], v1 offset:46080
    s_waitcnt vmcnt(22) lgkmcnt(7)
    v_mfma_f32_16x16x32_bf16 v[140:143], v[184:187], v[116:119], v[140:143]
    ds_read_b128 v[184:187], v1 offset:47104
    s_waitcnt lgkmcnt(7)
    v_mfma_f32_16x16x32_bf16 v[144:147], v[188:191], v[116:119], v[144:147]
    ds_read_b128 v[188:191], v1 offset:48128
    s_waitcnt lgkmcnt(7)
    v_mfma_f32_16x16x32_bf16 v[148:151], v[160:163], v[116:119], v[148:151]
    ds_read_b128 v[160:163], v1 offset:49152
    s_waitcnt lgkmcnt(7)
    v_mfma_f32_16x16x32_bf16 v[152:155], v[164:167], v[116:119], v[152:155]
    ds_read_b128 v[164:167], v1 offset:50176
    s_waitcnt lgkmcnt(7)
    v_mfma_f32_16x16x32_bf16 v[156:159], v[168:171], v[116:119], v[156:159]
    ds_read_b128 v[168:171], v2 offset:0
    s_waitcnt vmcnt(21) lgkmcnt(7)
    v_mfma_f32_16x16x32_bf16 v[140:143], v[172:175], v[120:123], v[140:143]
    ds_read_b128 v[172:175], v2 offset:1024
    s_waitcnt lgkmcnt(7)
    v_mfma_f32_16x16x32_bf16 v[144:147], v[176:179], v[120:123], v[144:147]
    ds_read_b128 v[176:179], v2 offset:2048
    s_waitcnt lgkmcnt(7)
    v_mfma_f32_16x16x32_bf16 v[148:151], v[180:183], v[120:123], v[148:151]
    ds_read_b128 v[180:183], v2 offset:3072
    s_waitcnt lgkmcnt(7)
    v_mfma_f32_16x16x32_bf16 v[152:155], v[184:187], v[120:123], v[152:155]
    ds_read_b128 v[184:187], v2 offset:4096
    s_waitcnt lgkmcnt(7)
    v_mfma_f32_16x16x32_bf16 v[156:159], v[188:191], v[120:123], v[156:159]
    ds_read_b128 v[188:191], v2 offset:5120
    s_waitcnt vmcnt(19) lgkmcnt(7)
    v_mfma_f32_16x16x32_bf16 v[140:143], v[160:163], v[124:127], v[140:143]
    ds_read_b128 v[160:163], v2 offset:6144
    s_waitcnt lgkmcnt(7)
    v_mfma_f32_16x16x32_bf16 v[144:147], v[164:167], v[124:127], v[144:147]
    ds_read_b128 v[164:167], v2 offset:7168
    s_waitcnt lgkmcnt(7)
    v_mfma_f32_16x16x32_bf16 v[148:151], v[168:171], v[124:127], v[148:151]
    ds_read_b128 v[168:171], v2 offset:8192
    s_waitcnt lgkmcnt(7)
    v_mfma_f32_16x16x32_bf16 v[152:155], v[172:175], v[124:127], v[152:155]
    ds_read_b128 v[172:175], v2 offset:9216
    s_waitcnt lgkmcnt(7)
    v_mfma_f32_16x16x32_bf16 v[156:159], v[176:179], v[124:127], v[156:159]
    ds_read_b128 v[176:179], v2 offset:10240
    s_waitcnt vmcnt(17) lgkmcnt(7)
    v_mfma_f32_16x16x32_bf16 v[140:143], v[180:183], v[128:131], v[140:143]
    ds_read_b128 v[180:183], v2 offset:11264
    s_waitcnt lgkmcnt(7)
    v_mfma_f32_16x16x32_bf16 v[144:147], v[184:187], v[128:131], v[144:147]
    ds_read_b128 v[184:187], v2 offset:12288
    s_waitcnt lgkmcnt(7)
    v_mfma_f32_16x16x32_bf16 v[148:151], v[188:191], v[128:131], v[148:151]
    ds_read_b128 v[188:191], v2 offset:13312
    s_waitcnt lgkmcnt(7)
    v_mfma_f32_16x16x32_bf16 v[152:155], v[160:163], v[128:131], v[152:155]
    ds_read_b128 v[160:163], v2 offset:14336
    s_waitcnt lgkmcnt(7)
    v_mfma_f32_16x16x32_bf16 v[156:159], v[164:167], v[128:131], v[156:159]
    ds_read_b128 v[164:167], v2 offset:15360
    s_waitcnt vmcnt(15) lgkmcnt(7)
    v_mfma_f32_16x16x32_bf16 v[140:143], v[168:171], v[132:135], v[140:143]
    ds_read_b128 v[168:171], v2 offset:16384
    s_waitcnt lgkmcnt(7)
    v_mfma_f32_16x16x32_bf16 v[144:147], v[172:175], v[132:135], v[144:147]
    ds_read_b128 v[172:175], v2 offset:17408
    s_waitcnt lgkmcnt(7)
    v_mfma_f32_16x16x32_bf16 v[148:151], v[176:179], v[132:135], v[148:151]
    s_waitcnt lgkmcnt(6)
    v_mfma_f32_16x16x32_bf16 v[152:155], v[180:183], v[132:135], v[152:155]
    s_waitcnt lgkmcnt(5)
    v_mfma_f32_16x16x32_bf16 v[156:159], v[184:187], v[132:135], v[156:159]
    s_waitcnt vmcnt(13) lgkmcnt(4)
    v_mfma_f32_16x16x32_bf16 v[140:143], v[188:191], v[136:139], v[140:143]
    s_waitcnt lgkmcnt(3)
    v_mfma_f32_16x16x32_bf16 v[144:147], v[160:163], v[136:139], v[144:147]
    s_waitcnt lgkmcnt(2)
    v_mfma_f32_16x16x32_bf16 v[148:151], v[164:167], v[136:139], v[148:151]
    s_waitcnt lgkmcnt(1)
    v_mfma_f32_16x16x32_bf16 v[152:155], v[168:171], v[136:139], v[152:155]
    s_waitcnt lgkmcnt(0)
    v_mfma_f32_16x16x32_bf16 v[156:159], v[172:175], v[136:139], v[156:159]
    v_cvt_pk_bf16_f32 v16, v140, v141
    v_cvt_pk_bf16_f32 v17, v142, v143
    v_cvt_pk_bf16_f32 v18, v144, v145
    v_cvt_pk_bf16_f32 v19, v146, v147
    v_cvt_pk_bf16_f32 v20, v148, v149
    v_cvt_pk_bf16_f32 v21, v150, v151
    v_cvt_pk_bf16_f32 v22, v152, v153
    v_cvt_pk_bf16_f32 v23, v154, v155
    v_cvt_pk_bf16_f32 v14, v156, v157
    v_cvt_pk_bf16_f32 v15, v158, v159
    s_add_u32 s48, s32, 0xe80000
    buffer_store_dwordx4 v[16:19], v1, s[4:7], s48 offen offset:0 sc1
    s_add_u32 s49, s32, 0xe81000
    buffer_store_dwordx4 v[20:23], v1, s[4:7], s49 offen offset:0 sc1
    s_add_u32 s50, s33, 0xe80000
    buffer_store_dwordx2 v[14:15], v9, s[4:7], s50 offen offset:0 sc1
    v_dot2_f32_bf16 v140, v14, v36, 0
    v_dot2_f32_bf16 v142, v14, v14, 0
    v_dot2_f32_bf16 v141, v15, v36, 0
    v_dot2_f32_bf16 v143, v15, v15, 0
    v_dot2_f32_bf16 v140, v16, v36, v140
    v_dot2_f32_bf16 v142, v16, v16, v142
    v_dot2_f32_bf16 v141, v17, v36, v141
    v_dot2_f32_bf16 v143, v17, v17, v143
    v_dot2_f32_bf16 v140, v18, v36, v140
    v_dot2_f32_bf16 v142, v18, v18, v142
    v_dot2_f32_bf16 v141, v19, v36, v141
    v_dot2_f32_bf16 v143, v19, v19, v143
    v_dot2_f32_bf16 v140, v20, v36, v140
    v_dot2_f32_bf16 v142, v20, v20, v142
    v_dot2_f32_bf16 v141, v21, v36, v141
    v_dot2_f32_bf16 v143, v21, v21, v143
    v_dot2_f32_bf16 v140, v22, v36, v140
    v_dot2_f32_bf16 v142, v22, v22, v142
    v_dot2_f32_bf16 v141, v23, v36, v141
    v_dot2_f32_bf16 v143, v23, v23, v143
    s_nop 1
    v_add_f32 v140, v140, v141
    v_add_f32 v141, v142, v143
    s_nop 1
    v_permlane32_swap_b32 v140, v141
    v_add_f32 v140, v140, v141
    v_mov_b32 v141, v140
    s_nop 1
    v_permlane16_swap_b32 v140, v141
    v_add_f32 v140, v140, v141
    s_add_u32 s48, s46, 0x7d0000
    buffer_store_dword v140, v13, s[4:7], s48 offen offset:0 sc1
    buffer_load_dwordx4 a[248:251], v1, s[4:7], s56 offen offset:2048
    buffer_load_dwordx4 a[252:255], v10, s[4:7], s56 offen offset:3072
    s_xor_b32 s56, s27, 0x3419000
    buffer_load_dwordx4 v[192:195], v1, s[4:7], s56 offen offset:0
    buffer_load_dwordx4 v[196:199], v10, s[4:7], s56 offen offset:1024
    buffer_load_dwordx4 v[200:203], v1, s[4:7], s56 offen offset:2048
    buffer_load_dwordx4 v[204:207], v10, s[4:7], s56 offen offset:3072
    s_xor_b32 s56, s27, 0x341a000
    buffer_load_dwordx4 v[208:211], v1, s[4:7], s56 offen offset:0
    buffer_load_dwordx4 v[212:215], v10, s[4:7], s56 offen offset:1024
    s_sub_u32 s58, s60, 5
    v_mov_b32 v26, s58
    s_mov_b64 exec, 1
    s_waitcnt vmcnt(8)
    buffer_store_dwordx2 v[26:27], off, s[4:7], s35
    s_mov_b64 exec, -1
    s_barrier
    s_xor_b32 s56, s27, 0x341c000
    buffer_load_dwordx4 v[216:219], v1, s[4:7], s56 offen offset:0
    buffer_load_dwordx4 v[220:223], v10, s[4:7], s56 offen offset:1024
    v_lshrrev_b32 v188, 3, v4
    v_and_b32 v6, 7, v4
    v_lshlrev_b32 v6, 4, v6
    v_lshl_add_u32 v6, v188, 9, v6
    v_lshl_add_u32 v6, v5, 7, v6
    s_lshl_b32 s48, s22, 8
    v_lshlrev_b32 v188, 4, v5
    v_add_u32 v188, s48, v188
    v_add_u32 v188, 161792, v188
    ds_read_b128 v[124:127], v188 offset:0
    ds_read_b128 v[128:131], v188 offset:64
    ds_read_b128 v[132:135], v188 offset:128
    ds_read_b128 v[136:139], v188 offset:192
    s_lshl_b32 s54, s22, 12
    s_mov_b32 s52, 0xbdd2d3e8
    s_mov_b32 s53, 0xc0135761
    v_lshlrev_b32 v43, 7, v7
    v_add_u32 v43, s42, v43
    v_lshl_add_u32 v42, v7, 3, s34
    buffer_load_dwordx2 v[40:41], v42, s[4:7], 0 offen sc1
    s_mov_b32 s51, 0x20000
    s_mov_b64 exec, 1
    buffer_store_dwordx2 v[26:27], off, s[4:7], s43 sc1
    s_mov_b64 exec, -1
    buffer_load_dwordx4 v[224:227], v1, s[4:7], s56 offen offset:2048
    buffer_load_dwordx4 v[228:231], v10, s[4:7], s56 offen offset:3072
    s_xor_b32 s56, s27, 0x341d000
    buffer_load_dwordx4 v[232:235], v1, s[4:7], s56 offen offset:0
    buffer_load_dwordx4 v[236:239], v10, s[4:7], s56 offen offset:1024
    buffer_load_dwordx4 v[240:243], v1, s[4:7], s56 offen offset:2048
    buffer_load_dwordx4 v[244:247], v10, s[4:7], s56 offen offset:3072
    s_xor_b32 s56, s27, 0x341e000
    buffer_load_dwordx4 v[248:251], v1, s[4:7], s56 offen offset:0
    buffer_load_dwordx4 v[252:255], v10, s[4:7], s56 offen offset:1024
    s_waitcnt vmcnt(9)
    v_cmp_gt_u64 vcc, s[58:59], v[40:41]
    v_cmp_lt_u64 s[48:49], s[60:61], v[40:41]
    s_nop 0
    s_or_b64 vcc, vcc, s[48:49]
    s_cbranch_scc0 POLLD_25
    s_nop 1
POLL_24:
    buffer_load_dwordx2 v[40:41], v42, s[4:7], 0 offen sc1
    s_sub_u32 s51, s51, 1
    s_cbranch_scc1 POLLD_25X
    s_cmp_eq_u32 s51, 0x1ffd8
    s_cselect_b64 vcc, -1, 0
    v_cndmask_b32 v42, v42, v43, vcc
    s_waitcnt vmcnt(0)
    v_cmp_gt_u64 vcc, s[58:59], v[40:41]
    v_cmp_lt_u64 s[48:49], s[60:61], v[40:41]
    s_nop 0
    s_or_b64 vcc, vcc, s[48:49]
    s_cbranch_scc1 POLL_24
POLLD_25X:
    s_waitcnt vmcnt(0)
POLLD_25:
    s_add_u32 s49, s62, 0xe80000
    s_add_u32 m0, s54, 0x0
    s_nop 0
    buffer_load_dwordx4 v1, s[4:7], s49 offen offset:0 sc1 lds
    buffer_load_dwordx4 v1, s[4:7], s49 offen offset:1024 sc1 lds
    buffer_load_dwordx4 v1, s[4:7], s49 offen offset:2048 sc1 lds
    buffer_load_dwordx4 v1, s[4:7], s49 offen offset:3072 sc1 lds
    s_add_u32 s49, s63, 0xe80000
    s_add_u32 m0, s54, 0x4000
    s_nop 0
    buffer_load_dwordx4 v1, s[4:7], s49 offen offset:0 sc1 lds
    buffer_load_dwordx4 v1, s[4:7], s49 offen offset:1024 sc1 lds
    buffer_load_dwordx4 v1, s[4:7], s49 offen offset:2048 sc1 lds
    buffer_load_dwordx4 v1, s[4:7], s49 offen offset:3072 sc1 lds
    s_add_u32 s49, s64, 0xe80000
    s_add_u32 m0, s54, 0x8000
    s_nop 0
    buffer_load_dwordx4 v1, s[4:7], s49 offen offset:0 sc1 lds
    buffer_load_dwordx4 v1, s[4:7], s49 offen offset:1024 sc1 lds
    buffer_load_dwordx4 v1, s[4:7], s49 offen offset:2048 sc1 lds
    buffer_load_dwordx4 v1, s[4:7], s49 offen offset:3072 sc1 lds
    s_add_u32 s49, s65, 0xe80000
    s_add_u32 m0, s54, 0xc000
    s_nop 0
    buffer_load_dwordx4 v1, s[4:7], s49 offen offset:0 sc1 lds
    buffer_load_dwordx4 v1, s[4:7], s49 offen offset:1024 sc1 lds
    buffer_load_dwordx4 v1, s[4:7], s49 offen offset:2048 sc1 lds
    buffer_load_dwordx4 v1, s[4:7], s49 offen offset:3072 sc1 lds
    s_add_u32 s49, s66, 0xe80000
    s_add_u32 m0, s54, 0x10000
    s_nop 0
    buffer_load_dwordx4 v1, s[4:7], s49 offen offset:0 sc1 lds
    buffer_load_dwordx4 v1, s[4:7], s49 offen offset:1024 sc1 lds
    buffer_load_dwordx4 v1, s[4:7], s49 offen offset:2048 sc1 lds
    buffer_load_dwordx4 v1, s[4:7], s49 offen offset:3072 sc1 lds
    s_waitcnt vmcnt(16)
    s_waitcnt lgkmcnt(0)
    s_barrier
    ds_read_b128 v[140:143], v1 offset:0
    ds_read_b128 v[144:147], v1 offset:1024
    ds_read_b128 v[148:151], v1 offset:2048
    ds_read_b128 v[152:155], v1 offset:3072
    s_waitcnt lgkmcnt(3)
    v_mfma_f32_16x16x32_bf16 v[60:63], a[0:3], v[140:143], 0
    ds_read_b128 v[156:159], v1 offset:4096
    v_mfma_f32_16x16x32_bf16 v[76:79], a[4:7], v[140:143], 0
    s_waitcnt lgkmcnt(3)
    v_mfma_f32_16x16x32_bf16 v[64:67], a[0:3], v[144:147], 0
    ds_read_b128 v[160:163], v1 offset:5120
    v_mfma_f32_16x16x32_bf16 v[80:83], a[4:7], v[144:147], 0
    s_waitcnt lgkmcnt(3)
    v_mfma_f32_16x16x32_bf16 v[68:71], a[0:3], v[148:151], 0
    ds_read_b128 v[164:167], v1 offset:6144
    v_mfma_f32_16x16x32_bf16 v[84:87], a[4:7], v[148:151], 0
    s_waitcnt lgkmcnt(3)
    v_mfma_f32_16x16x32_bf16 v[72:75], a[0:3], v[152:155], 0
    ds_read_b128 v[168:171], v1 offset:7168
    v_mfma_f32_16x16x32_bf16 v[88:91], a[4:7], v[152:155], 0
    s_waitcnt lgkmcnt(3)
    v_mfma_f32_16x16x32_bf16 v[60:63], a[8:11], v[156:159], v[60:63]
    ds_read_b64 v[140:141], v9 offset:8192
    ds_read_b64 v[142:143], v9 offset:8704
    v_mfma_f32_16x16x32_bf16 v[76:79], a[12:15], v[156:159], v[76:79]
    s_add_u32 s48, s44, 0x7d0000
    buffer_load_dwordx2 v[92:93], v9, s[4:7], s48 offen offset:0 sc1
    s_waitcnt lgkmcnt(4)
    v_mfma_f32_16x16x32_bf16 v[64:67], a[8:11], v[160:163], v[64:67]
    ds_read_b64 v[144:145], v9 offset:9216
    ds_read_b64 v[146:147], v9 offset:9728
    v_mfma_f32_16x16x32_bf16 v[80:83], a[12:15], v[160:163], v[80:83]
    buffer_load_dwordx2 v[94:95], v9, s[4:7], s48 offen offset:512 sc1
    buffer_load_dwordx2 v[96:97], v9, s[4:7], s48 offen offset:1024 sc1
    s_waitcnt lgkmcnt(5)
    v_mfma_f32_16x16x32_bf16 v[68:71], a[8:11], v[164:167], v[68:71]
    ds_read_b64 v[148:149], v9 offset:10240
    ds_read_b64 v[150:151], v9 offset:10752
    v_mfma_f32_16x16x32_bf16 v[84:87], a[12:15], v[164:167], v[84:87]
    buffer_load_dwordx2 v[98:99], v9, s[4:7], s48 offen offset:1536 sc1
    buffer_load_dwordx2 v[100:101], v9, s[4:7], s48 offen offset:2048 sc1
    s_waitcnt lgkmcnt(6)
    v_mfma_f32_16x16x32_bf16 v[72:75], a[8:11], v[168:171], v[72:75]
    ds_read_b64 v[152:153], v9 offset:11264
    ds_read_b64 v[154:155], v9 offset:11776
    v_mfma_f32_16x16x32_bf16 v[88:91], a[12:15], v[168:171], v[88:91]
    buffer_load_dwordx2 v[102:103], v9, s[4:7], s48 offen offset:2560 sc1
    buffer_load_dwordx2 v[104:105], v9, s[4:7], s48 offen offset:3072 sc1
    s_waitcnt lgkmcnt(6)
    v_mfma_f32_16x16x32_bf16 v[60:63], a[16:19], v[140:143], v[60:63]
    ds_read_b128 v[156:159], v1 offset:12288
    v_mfma_f32_16x16x32_bf16 v[76:79], a[20:23], v[140:143], v[76:79]
    buffer_load_dwordx2 v[106:107], v9, s[4:7], s48 offen offset:3584 sc1
    s_waitcnt lgkmcnt(5)
    v_mfma_f32_16x16x32_bf16 v[64:67], a[16:19], v[144:147], v[64:67]
    ds_read_b128 v[160:163], v1 offset:13312
    v_mfma_f32_16x16x32_bf16 v[80:83], a[20:23], v[144:147], v[80:83]
    s_waitcnt lgkmcnt(4)
    v_mfma_f32_16x16x32_bf16 v[68:71], a[16:19], v[148:151], v[68:71]
    ds_read_b128 v[164:167], v1 offset:14336
    v_mfma_f32_16x16x32_bf16 v[84:87], a[20:23], v[148:151], v[84:87]
    s_waitcnt lgkmcnt(3)
    v_mfma_f32_16x16x32_bf16 v[72:75], a[16:19], v[152:155], v[72:75]
    ds_read_b128 v[168:171], v1 offset:15360
    v_mfma_f32_16x16x32_bf16 v[88:91], a[20:23], v[152:155], v[88:91]
    s_waitcnt vmcnt(20)
    s_barrier
    s_waitcnt lgkmcnt(3)
    v_mfma_f32_16x16x32_bf16 v[60:63], a[24:27], v[156:159], v[60:63]
    ds_read_b128 v[140:143], v1 offset:16384
    v_mfma_f32_16x16x32_bf16 v[76:79], a[28:31], v[156:159], v[76:79]
    s_waitcnt lgkmcnt(3)
    v_mfma_f32_16x16x32_bf16 v[64:67], a[24:27], v[160:163], v[64:67]
    s_mul_i32 s57, s22, 14336
    s_min_u32 s57, s57, 41984
    s_add_u32 s56, s29, 0x5e1000
    s_add_u32 s56, s56, s57
    s_add_u32 m0, s57, 0x14000
    s_nop 0
    buffer_load_dwordx4 v1, s[4:7], s56 offen offset:0 lds
    ds_read_b128 v[144:147], v1 offset:17408
    v_mfma_f32_16x16x32_bf16 v[80:83], a[28:31], v[160:163], v[80:83]
    s_waitcnt lgkmcnt(3)
    v_mfma_f32_16x16x32_bf16 v[68:71], a[24:27], v[164:167], v[68:71]
    ds_read_b128 v[148:151], v1 offset:18432
    v_mfma_f32_16x16x32_bf16 v[84:87], a[28:31], v[164:167], v[84:87]
    s_waitcnt lgkmcnt(3)
    v_mfma_f32_16x16x32_bf16 v[72:75], a[24:27], v[168:171], v[72:75]
    s_add_u32 m0, s57, 0x14000
    s_nop 0
    buffer_load_dwordx4 v1, s[4:7], s56 offen offset:1024 lds
    ds_read_b128 v[152:155], v1 offset:19456
    v_mfma_f32_16x16x32_bf16 v[88:91], a[28:31], v[168:171], v[88:91]
    s_waitcnt lgkmcnt(3)
    v_mfma_f32_16x16x32_bf16 v[60:63], a[32:35], v[140:143], v[60:63]
    ds_read_b128 v[156:159], v1 offset:20480
    v_mfma_f32_16x16x32_bf16 v[76:79], a[36:39], v[140:143], v[76:79]
    s_waitcnt lgkmcnt(3)
    v_mfma_f32_16x16x32_bf16 v[64:67], a[32:35], v[144:147], v[64:67]
    ds_read_b128 v[160:163], v1 offset:21504
    v_mfma_f32_16x16x32_bf16 v[80:83], a[36:39], v[144:147], v[80:83]
    s_add_u32 m0, s57, 0x14000
    s_nop 0
    buffer_load_dwordx4 v1, s[4:7], s56 offen offset:2048 lds
    s_waitcnt lgkmcnt(3)
    v_mfma_f32_16x16x32_bf16 v[68:71], a[32:35], v[148:151], v[68:71]
    ds_read_b128 v[164:167], v1 offset:22528
    v_mfma_f32_16x16x32_bf16 v[84:87], a[36:39], v[148:151], v[84:87]
    s_waitcnt lgkmcnt(3)
    v_mfma_f32_16x16x32_bf16 v[72:75], a[32:35], v[152:155], v[72:75]
    ds_read_b128 v[168:171], v1 offset:23552
    v_mfma_f32_16x16x32_bf16 v[88:91], a[36:39], v[152:155], v[88:91]
    s_waitcnt lgkmcnt(3)
    v_mfma_f32_16x16x32_bf16 v[60:63], a[40:43], v[156:159], v[60:63]
    s_add_u32 m0, s57, 0x14000
    s_nop 0
    buffer_load_dwordx4 v1, s[4:7], s56 offen offset:3072 lds
    ds_read_b128 v[140:143], v1 offset:24576
    v_mfma_f32_16x16x32_bf16 v[76:79], a[44:47], v[156:159], v[76:79]
    s_waitcnt lgkmcnt(3)
    v_mfma_f32_16x16x32_bf16 v[64:67], a[40:43], v[160:163], v[64:67]
    ds_read_b128 v[144:147], v1 offset:25600
    v_mfma_f32_16x16x32_bf16 v[80:83], a[44:47], v[160:163], v[80:83]
    s_waitcnt lgkmcnt(3)
    v_mfma_f32_16x16x32_bf16 v[68:71], a[40:43], v[164:167], v[68:71]
    ds_read_b128 v[148:151], v1 offset:26624
    v_mfma_f32_16x16x32_bf16 v[84:87], a[44:47], v[164:167], v[84:87]
    s_add_u32 s56, s29, 0x5e2000
    s_add_u32 s56, s56, s57
    s_add_u32 m0, s57, 0x15000
    s_nop 0
    buffer_load_dwordx4 v1, s[4:7], s56 offen offset:0 lds
    s_waitcnt lgkmcnt(3)
    v_mfma_f32_16x16x32_bf16 v[72:75], a[40:43], v[168:171], v[72:75]
    ds_read_b128 v[152:155], v1 offset:27648
    v_mfma_f32_16x16x32_bf16 v[88:91], a[44:47], v[168:171], v[88:91]
    s_waitcnt lgkmcnt(3)
    v_mfma_f32_16x16x32_bf16 v[60:63], a[48:51], v[140:143], v[60:63]
    ds_read_b64 v[156:157], v9 offset:28672
    ds_read_b64 v[158:159], v9 offset:29184
    v_mfma_f32_16x16x32_bf16 v[76:79], a[52:55], v[140:143], v[76:79]
    s_add_u32 m0, s57, 0x15000
    s_nop 0
    buffer_load_dwordx4 v1, s[4:7], s56 offen offset:1024 lds
    s_waitcnt lgkmcnt(4)
    v_mfma_f32_16x16x32_bf16 v[64:67], a[48:51], v[144:147], v[64:67]
    ds_read_b64 v[160:161], v9 offset:29696
    ds_read_b64 v[162:163], v9 offset:30208
    v_mfma_f32_16x16x32_bf16 v[80:83], a[52:55], v[144:147], v[80:83]
    s_waitcnt lgkmcnt(5)
    v_mfma_f32_16x16x32_bf16 v[68:71], a[48:51], v[148:151], v[68:71]
    ds_read_b64 v[164:165], v9 offset:30720
    ds_read_b64 v[166:167], v9 offset:31232
    v_mfma_f32_16x16x32_bf16 v[84:87], a[52:55], v[148:151], v[84:87]
    s_waitcnt lgkmcnt(6)
    v_mfma_f32_16x16x32_bf16 v[72:75], a[48:51], v[152:155], v[72:75]
    s_add_u32 m0, s57, 0x15000
    s_nop 0
    buffer_load_dwordx4 v1, s[4:7], s56 offen offset:2048 lds
    ds_read_b64 v[168:169], v9 offset:31744
    ds_read_b64 v[170:171], v9 offset:32256
    v_mfma_f32_16x16x32_bf16 v[88:91], a[52:55], v[152:155], v[88:91]
    s_waitcnt vmcnt(23)
    s_barrier
    s_waitcnt lgkmcnt(6)
    v_mfma_f32_16x16x32_bf16 v[60:63], a[56:59], v[156:159], v[60:63]
    ds_read_b128 v[140:143], v1 offset:32768
    v_mfma_f32_16x16x32_bf16 v[76:79], a[60:63], v[156:159], v[76:79]
    s_waitcnt lgkmcnt(5)
    v_mfma_f32_16x16x32_bf16 v[64:67], a[56:59], v[160:163], v[64:67]
    s_add_u32 m0, s57, 0x15000
    s_nop 0
    buffer_load_dwordx4 v1, s[4:7], s56 offen offset:3072 lds
    ds_read_b128 v[144:147], v1 offset:33792
    v_mfma_f32_16x16x32_bf16 v[80:83], a[60:63], v[160:163], v[80:83]
    s_waitcnt lgkmcnt(4)
    v_mfma_f32_16x16x32_bf16 v[68:71], a[56:59], v[164:167], v[68:71]
    ds_read_b128 v[148:151], v1 offset:34816
    v_mfma_f32_16x16x32_bf16 v[84:87], a[60:63], v[164:167], v[84:87]
    s_waitcnt lgkmcnt(3)
    v_mfma_f32_16x16x32_bf16 v[72:75], a[56:59], v[168:171], v[72:75]
    ds_read_b128 v[152:155], v1 offset:35840
    v_mfma_f32_16x16x32_bf16 v[88:91], a[60:63], v[168:171], v[88:91]
    s_add_u32 s56, s29, 0x5e3000
    s_add_u32 s56, s56, s57
    s_add_u32 m0, s57, 0x16000
    s_nop 0
    buffer_load_dwordx4 v1, s[4:7], s56 offen offset:0 lds
    s_waitcnt lgkmcnt(3)
    v_mfma_f32_16x16x32_bf16 v[60:63], a[64:67], v[140:143], v[60:63]
    ds_read_b128 v[156:159], v1 offset:36864
    v_mfma_f32_16x16x32_bf16 v[76:79], a[68:71], v[140:143], v[76:79]
    s_waitcnt lgkmcnt(3)
    v_mfma_f32_16x16x32_bf16 v[64:67], a[64:67], v[144:147], v[64:67]
    ds_read_b128 v[160:163], v1 offset:37888
    v_mfma_f32_16x16x32_bf16 v[80:83], a[68:71], v[144:147], v[80:83]
    s_add_u32 m0, s57, 0x16000
    s_nop 0
    buffer_load_dwordx4 v1, s[4:7], s56 offen offset:1024 lds
    s_waitcnt lgkmcnt(3)
    v_mfma_f32_16x16x32_bf16 v[68:71], a[64:67], v[148:151], v[68:71]
    ds_read_b128 v[164:167], v1 offset:38912
    v_mfma_f32_16x16x32_bf16 v[84:87], a[68:71], v[148:151], v[84:87]
    s_waitcnt lgkmcnt(3)
    v_mfma_f32_16x16x32_bf16 v[72:75], a[64:67], v[152:155], v[72:75]
    ds_read_b128 v[168:171], v1 offset:39936
    v_mfma_f32_16x16x32_bf16 v[88:91], a[68:71], v[152:155], v[88:91]
    s_waitcnt lgkmcnt(3)
    v_mfma_f32_16x16x32_bf16 v[60:63], a[72:75], v[156:159], v[60:63]
    s_add_u32 m0, s57, 0x16000
    s_nop 0
    buffer_load_dwordx4 v1, s[4:7], s56 offen offset:2048 lds
    ds_read_b128 v[140:143], v1 offset:40960
    v_mfma_f32_16x16x32_bf16 v[76:79], a[76:79], v[156:159], v[76:79]
    s_waitcnt lgkmcnt(3)
    v_mfma_f32_16x16x32_bf16 v[64:67], a[72:75], v[160:163], v[64:67]
    ds_read_b128 v[144:147], v1 offset:41984
    v_mfma_f32_16x16x32_bf16 v[80:83], a[76:79], v[160:163], v[80:83]
    s_waitcnt lgkmcnt(3)
    v_mfma_f32_16x16x32_bf16 v[68:71], a[72:75], v[164:167], v[68:71]
    ds_read_b128 v[148:151], v1 offset:43008
    v_mfma_f32_16x16x32_bf16 v[84:87], a[76:79], v[164:167], v[84:87]
    s_add_u32 m0, s57, 0x16000
    s_nop 0
    buffer_load_dwordx4 v1, s[4:7], s56 offen offset:3072 lds
    s_waitcnt lgkmcnt(3)
    v_mfma_f32_16x16x32_bf16 v[72:75], a[72:75], v[168:171], v[72:75]
    ds_read_b128 v[152:155], v1 offset:44032
    v_mfma_f32_16x16x32_bf16 v[88:91], a[76:79], v[168:171], v[88:91]
    s_waitcnt lgkmcnt(3)
    v_mfma_f32_16x16x32_bf16 v[60:63], a[80:83], v[140:143], v[60:63]
    ds_read_b128 v[156:159], v1 offset:45056
    v_mfma_f32_16x16x32_bf16 v[76:79], a[84:87], v[140:143], v[76:79]
    s_waitcnt lgkmcnt(3)
    v_mfma_f32_16x16x32_bf16 v[64:67], a[80:83], v[144:147], v[64:67]
    s_add_u32 s56, s29, 0x5e4000
    s_add_u32 s56, s56, s57
    s_add_u32 m0, s57, 0x17000
    s_nop 0
    buffer_load_dwordx4 v1, s[4:7], s56 offen offset:0 lds
    ds_read_b128 v[160:163], v1 offset:46080
    v_mfma_f32_16x16x32_bf16 v[80:83], a[84:87], v[144:147], v[80:83]
    s_waitcnt lgkmcnt(3)
    v_mfma_f32_16x16x32_bf16 v[68:71], a[80:83], v[148:151], v[68:71]
    ds_read_b128 v[164:167], v1 offset:47104
    v_mfma_f32_16x16x32_bf16 v[84:87], a[84:87], v[148:151], v[84:87]
    s_waitcnt lgkmcnt(3)
    v_mfma_f32_16x16x32_bf16 v[72:75], a[80:83], v[152:155], v[72:75]
    s_add_u32 m0, s57, 0x17000
    s_nop 0
    buffer_load_dwordx4 v1, s[4:7], s56 offen offset:1024 lds
    ds_read_b128 v[168:171], v1 offset:48128
    v_mfma_f32_16x16x32_bf16 v[88:91], a[84:87], v[152:155], v[88:91]
    s_waitcnt vmcnt(26)
    s_barrier
    s_waitcnt lgkmcnt(3)
    v_mfma_f32_16x16x32_bf16 v[60:63], a[88:91], v[156:159], v[60:63]
    ds_read_b64 v[140:141], v9 offset:49152
    ds_read_b64 v[142:143], v9 offset:49664
    v_mfma_f32_16x16x32_bf16 v[76:79], a[92:95], v[156:159], v[76:79]
    s_waitcnt vmcnt(17)
    v_add_f32 v92, v92, v100
    v_add_f32 v93, v93, v101
    s_waitcnt lgkmcnt(4)
    v_mfma_f32_16x16x32_bf16 v[64:67], a[88:91], v[160:163], v[64:67]
    ds_read_b64 v[144:145], v9 offset:50176
    ds_read_b64 v[146:147], v9 offset:50688
    s_xor_b32 s56, s30, 0x0
    buffer_load_dwordx4 a[0:3], v6, s[4:7], s56 offen offset:0
    v_mfma_f32_16x16x32_bf16 v[80:83], a[92:95], v[160:163], v[80:83]
    s_waitcnt vmcnt(17)
    v_add_f32 v94, v94, v102
    v_add_f32 v95, v95, v103
    s_waitcnt lgkmcnt(5)
    v_mfma_f32_16x16x32_bf16 v[68:71], a[88:91], v[164:167], v[68:71]
    ds_read_b64 v[148:149], v8 offset:0
    ds_read_b64 v[150:151], v8 offset:512
    v_mfma_f32_16x16x32_bf16 v[84:87], a[92:95], v[164:167], v[84:87]
    s_waitcnt vmcnt(16)
    v_add_f32 v96, v96, v104
    v_add_f32 v97, v97, v105
    s_waitcnt lgkmcnt(6)
    v_mfma_f32_16x16x32_bf16 v[72:75], a[88:91], v[168:171], v[72:75]
    buffer_load_dwordx4 a[4:7], v6, s[4:7], s56 offen offset:1024
    ds_read_b64 v[152:153], v8 offset:1024
    ds_read_b64 v[154:155], v8 offset:1536
    v_mfma_f32_16x16x32_bf16 v[88:91], a[92:95], v[168:171], v[88:91]
    s_waitcnt vmcnt(16)
    v_add_f32 v98, v98, v106
    v_add_f32 v99, v99, v107
    s_waitcnt lgkmcnt(6)
    v_mfma_f32_16x16x32_bf16 v[60:63], a[96:99], v[140:143], v[60:63]
    ds_read_b128 v[156:159], v2 offset:2048
    v_mfma_f32_16x16x32_bf16 v[76:79], a[100:103], v[140:143], v[76:79]
    v_add_f32 v92, v92, v96
    v_add_f32 v93, v93, v97
    s_waitcnt lgkmcnt(5)
    v_mfma_f32_16x16x32_bf16 v[64:67], a[96:99], v[144:147], v[64:67]
    ds_read_b128 v[160:163], v2 offset:3072
    v_mfma_f32_16x16x32_bf16 v[80:83], a[100:103], v[144:147], v[80:83]
    buffer_load_dwordx4 a[8:11], v6, s[4:7], s56 offen offset:2048
    v_add_f32 v94, v94, v98
    v_add_f32 v95, v95, v99
    s_waitcnt lgkmcnt(4)
    v_mfma_f32_16x16x32_bf16 v[68:71], a[96:99], v[148:151], v[68:71]
    ds_read_b128 v[164:167], v2 offset:4096
    v_mfma_f32_16x16x32_bf16 v[84:87], a[100:103], v[148:151], v[84:87]
    v_add_f32 v92, v92, v94
    v_add_f32 v93, v93, v95
    s_waitcnt lgkmcnt(3)
    v_mfma_f32_16x16x32_bf16 v[72:75], a[96:99], v[152:155], v[72:75]
    ds_read_b128 v[168:171], v2 offset:5120
    v_mfma_f32_16x16x32_bf16 v[88:91], a[100:103], v[152:155], v[88:91]
    buffer_load_dwordx4 a[12:15], v6, s[4:7], s56 offen offset:3072
    v_mul_f32 v92, 0xbacccccd, v92
    v_mul_f32 v93, 0x3acccccd, v93
    s_waitcnt lgkmcnt(3)
    v_mfma_f32_16x16x32_bf16 v[60:63], a[104:107], v[156:159], v[60:63]
    ds_read_b128 v[140:143], v2 offset:6144
    v_mfma_f32_16x16x32_bf16 v[76:79], a[108:111], v[156:159], v[76:79]
    v_fma_f32 v93, -v92, v92, v93
    v_max_f32 v93, 0, v93
    s_waitcnt lgkmcnt(3)
    v_mfma_f32_16x16x32_bf16 v[64:67], a[104:107], v[160:163], v[64:67]
    ds_read_b128 v[144:147], v2 offset:7168
    v_mfma_f32_16x16x32_bf16 v[80:83], a[108:111], v[160:163], v[80:83]
    v_add_f32 v93, 0x3727c5ac, v93
    v_rsq_f32 v93, v93
    s_xor_b32 s56, s30, 0x1000
    buffer_load_dwordx4 a[16:19], v6, s[4:7], s56 offen offset:0
    s_waitcnt lgkmcnt(3)
    v_mfma_f32_16x16x32_bf16 v[68:71], a[104:107], v[164:167], v[68:71]
    ds_read_b128 v[148:151], v2 offset:8192
    v_mfma_f32_16x16x32_bf16 v[84:87], a[108:111], v[164:167], v[84:87]
    ds_bpermute_b32 v52, v28, v92 offset:0
    ds_bpermute_b32 v53, v28, v93 offset:0
    s_waitcnt lgkmcnt(5)
    v_mfma_f32_16x16x32_bf16 v[72:75], a[104:107], v[168:171], v[72:75]
    ds_read_b128 v[152:155], v2 offset:9216
    v_mfma_f32_16x16x32_bf16 v[88:91], a[108:111], v[168:171], v[88:91]
    buffer_load_dwordx4 a[20:23], v6, s[4:7], s56 offen offset:1024
    ds_bpermute_b32 v54, v28, v92 offset:64
    ds_bpermute_b32 v55, v28, v93 offset:64
    s_waitcnt lgkmcnt(7)
    v_mfma_f32_16x16x32_bf16 v[60:63], a[112:115], v[140:143], v[60:63]
    ds_read_b128 v[156:159], v2 offset:10240
    v_mfma_f32_16x16x32_bf16 v[76:79], a[116:119], v[140:143], v[76:79]
    ds_bpermute_b32 v56, v28, v92 offset:128
    ds_bpermute_b32 v57, v28, v93 offset:128
    s_waitcnt lgkmcnt(9)
    v_mfma_f32_16x16x32_bf16 v[64:67], a[112:115], v[144:147], v[64:67]
    ds_read_b128 v[160:163], v2 offset:11264
    v_mfma_f32_16x16x32_bf16 v[80:83], a[116:119], v[144:147], v[80:83]
    ds_bpermute_b32 v58, v28, v92 offset:192
    ds_bpermute_b32 v59, v28, v93 offset:192
    buffer_load_dwordx4 a[24:27], v6, s[4:7], s56 offen offset:2048
    s_waitcnt lgkmcnt(11)
    v_mfma_f32_16x16x32_bf16 v[68:71], a[112:115], v[148:151], v[68:71]
    ds_read_b128 v[164:167], v2 offset:12288
    v_mfma_f32_16x16x32_bf16 v[84:87], a[116:119], v[148:151], v[84:87]
    s_waitcnt lgkmcnt(9)
    v_mfma_f32_16x16x32_bf16 v[72:75], a[112:115], v[152:155], v[72:75]
    ds_read_b128 v[168:171], v2 offset:13312
    v_mfma_f32_16x16x32_bf16 v[88:91], a[116:119], v[152:155], v[88:91]
    s_barrier
    s_waitcnt lgkmcnt(7)
    v_mfma_f32_16x16x32_bf16 v[60:63], a[120:123], v[156:159], v[60:63]
    buffer_load_dwordx4 a[28:31], v6, s[4:7], s56 offen offset:3072
    ds_read_b128 v[140:143], v2 offset:14336
    v_mfma_f32_16x16x32_bf16 v[76:79], a[124:127], v[156:159], v[76:79]
    s_waitcnt lgkmcnt(5)
    v_mfma_f32_16x16x32_bf16 v[64:67], a[120:123], v[160:163], v[64:67]
    ds_read_b128 v[144:147], v2 offset:15360
    v_mfma_f32_16x16x32_bf16 v[80:83], a[124:127], v[160:163], v[80:83]
    s_waitcnt lgkmcnt(3)
    v_mfma_f32_16x16x32_bf16 v[68:71], a[120:123], v[164:167], v[68:71]
    ds_read_b128 v[148:151], v2 offset:16384
    v_mfma_f32_16x16x32_bf16 v[84:87], a[124:127], v[164:167], v[84:87]
    s_xor_b32 s56, s30, 0x2000
    buffer_load_dwordx4 a[32:35], v6, s[4:7], s56 offen offset:0
    s_waitcnt lgkmcnt(3)
    v_mfma_f32_16x16x32_bf16 v[72:75], a[120:123], v[168:171], v[72:75]
    ds_read_b128 v[152:155], v2 offset:17408
    v_mfma_f32_16x16x32_bf16 v[88:91], a[124:127], v[168:171], v[88:91]
    s_waitcnt lgkmcnt(3)
    v_mfma_f32_16x16x32_bf16 v[60:63], a[128:131], v[140:143], v[60:63]
    ds_read_b64 v[156:157], v8 offset:18432
    ds_read_b64 v[158:159], v8 offset:18944
    v_mfma_f32_16x16x32_bf16 v[76:79], a[132:135], v[140:143], v[76:79]
    s_waitcnt lgkmcnt(4)
    v_mfma_f32_16x16x32_bf16 v[64:67], a[128:131], v[144:147], v[64:67]
    buffer_load_dwordx4 a[36:39], v6, s[4:7], s56 offen offset:1024
    ds_read_b64 v[160:161], v8 offset:19456
    ds_read_b64 v[162:163], v8 offset:19968
    v_mfma_f32_16x16x32_bf16 v[80:83], a[132:135], v[144:147], v[80:83]
    s_waitcnt lgkmcnt(5)
    v_mfma_f32_16x16x32_bf16 v[68:71], a[128:131], v[148:151], v[68:71]
    ds_read_b64 v[164:165], v8 offset:20480
    ds_read_b64 v[166:167], v8 offset:20992
    v_mfma_f32_16x16x32_bf16 v[84:87], a[132:135], v[148:151], v[84:87]
    s_waitcnt lgkmcnt(6)
    v_mfma_f32_16x16x32_bf16 v[72:75], a[128:131], v[152:155], v[72:75]
    buffer_load_dwordx4 a[40:43], v6, s[4:7], s56 offen offset:2048
    ds_read_b64 v[168:169], v8 offset:21504
    ds_read_b64 v[170:171], v8 offset:22016
    v_mfma_f32_16x16x32_bf16 v[88:91], a[132:135], v[152:155], v[88:91]
    s_waitcnt lgkmcnt(6)
    v_mfma_f32_16x16x32_bf16 v[60:63], a[136:139], v[156:159], v[60:63]
    ds_read_b128 v[140:143], v2 offset:22528
    v_mfma_f32_16x16x32_bf16 v[76:79], a[140:143], v[156:159], v[76:79]
    s_waitcnt lgkmcnt(5)
    v_mfma_f32_16x16x32_bf16 v[64:67], a[136:139], v[160:163], v[64:67]
    ds_read_b128 v[144:147], v2 offset:23552
    v_mfma_f32_16x16x32_bf16 v[80:83], a[140:143], v[160:163], v[80:83]
    buffer_load_dwordx4 a[44:47], v6, s[4:7], s56 offen offset:3072
    s_waitcnt lgkmcnt(4)
    v_mfma_f32_16x16x32_bf16 v[68:71], a[136:139], v[164:167], v[68:71]
    ds_read_b128 v[148:151], v2 offset:24576
    v_mfma_f32_16x16x32_bf16 v[84:87], a[140:143], v[164:167], v[84:87]
    s_waitcnt lgkmcnt(3)
    v_mfma_f32_16x16x32_bf16 v[72:75], a[136:139], v[168:171], v[72:75]
    ds_read_b128 v[152:155], v2 offset:25600
    v_mfma_f32_16x16x32_bf16 v[88:91], a[140:143], v[168:171], v[88:91]
    s_waitcnt lgkmcnt(3)
    v_mfma_f32_16x16x32_bf16 v[60:63], a[144:147], v[140:143], v[60:63]
    s_xor_b32 s56, s30, 0x3000
    buffer_load_dwordx4 a[48:51], v6, s[4:7], s56 offen offset:0
    ds_read_b128 v[156:159], v2 offset:26624
    v_mfma_f32_16x16x32_bf16 v[76:79], a[148:151], v[140:143], v[76:79]
    s_waitcnt lgkmcnt(3)
    v_mfma_f32_16x16x32_bf16 v[64:67], a[144:147], v[144:147], v[64:67]
    ds_read_b128 v[160:163], v2 offset:27648
    v_mfma_f32_16x16x32_bf16 v[80:83], a[148:151], v[144:147], v[80:83]
    s_waitcnt lgkmcnt(3)
    v_mfma_f32_16x16x32_bf16 v[68:71], a[144:147], v[148:151], v[68:71]
    ds_read_b128 v[164:167], v2 offset:28672
    v_mfma_f32_16x16x32_bf16 v[84:87], a[148:151], v[148:151], v[84:87]
    buffer_load_dwordx4 a[52:55], v6, s[4:7], s56 offen offset:1024
    s_waitcnt lgkmcnt(3)
    v_mfma_f32_16x16x32_bf16 v[72:75], a[144:147], v[152:155], v[72:75]
    ds_read_b128 v[168:171], v2 offset:29696
    v_mfma_f32_16x16x32_bf16 v[88:91], a[148:151], v[152:155], v[88:91]
    s_waitcnt lgkmcnt(3)
    v_mfma_f32_16x16x32_bf16 v[60:63], a[152:155], v[156:159], v[60:63]
    v_mfma_f32_16x16x32_bf16 v[76:79], a[156:159], v[156:159], v[76:79]
    s_waitcnt lgkmcnt(2)
    v_mfma_f32_16x16x32_bf16 v[64:67], a[152:155], v[160:163], v[64:67]
    buffer_load_dwordx4 a[56:59], v6, s[4:7], s56 offen offset:2048
    v_mfma_f32_16x16x32_bf16 v[80:83], a[156:159], v[160:163], v[80:83]
    s_waitcnt lgkmcnt(1)
    v_mfma_f32_16x16x32_bf16 v[68:71], a[152:155], v[164:167], v[68:71]
    v_mfma_f32_16x16x32_bf16 v[84:87], a[156:159], v[164:167], v[84:87]
    s_waitcnt lgkmcnt(0)
    v_mfma_f32_16x16x32_bf16 v[72:75], a[152:155], v[168:171], v[72:75]
    v_mfma_f32_16x16x32_bf16 v[88:91], a[156:159], v[168:171], v[88:91]
    buffer_load_dwordx4 a[60:63], v6, s[4:7], s56 offen offset:3072
    v_pk_fma_f32 v[60:61], v[124:125], v[52:53], v[60:61] op_sel_hi:[1,0,1]
    v_pk_fma_f32 v[62:63], v[126:127], v[52:53], v[62:63] op_sel_hi:[1,0,1]
    v_pk_mul_f32 v[60:61], v[60:61], v[52:53] op_sel:[0,1]
    v_pk_mul_f32 v[62:63], v[62:63], v[52:53] op_sel:[0,1]
    v_pk_mul_f32 v[180:181], v[60:61], v[60:61]
    v_pk_mul_f32 v[182:183], v[62:63], v[62:63]
    v_pk_fma_f32 v[180:181], v[180:181], s[52:53], s[52:53] op_sel:[0,0,1] op_sel_hi:[1,0,1]
    v_pk_fma_f32 v[182:183], v[182:183], s[52:53], s[52:53] op_sel:[0,0,1] op_sel_hi:[1,0,1]
    v_pk_mul_f32 v[180:181], v[180:181], v[60:61]
    v_pk_mul_f32 v[182:183], v[182:183], v[62:63]
    v_exp_f32 v180, v180
    s_xor_b32 s56, s30, 0x4000
    buffer_load_dwordx4 a[64:67], v6, s[4:7], s56 offen offset:0
    v_exp_f32 v181, v181
    v_exp_f32 v182, v182
    v_exp_f32 v183, v183
    v_pk_add_f32 v[180:181], v[180:181], 1.0 op_sel_hi:[1,0]
    v_pk_add_f32 v[182:183], v[182:183], 1.0 op_sel_hi:[1,0]
    v_rcp_f32 v180, v180
    v_rcp_f32 v181, v181
    v_rcp_f32 v182, v182
    buffer_load_dwordx4 a[68:71], v6, s[4:7], s56 offen offset:1024
    v_rcp_f32 v183, v183
    v_pk_mul_f32 v[60:61], v[60:61], v[180:181]
    v_pk_mul_f32 v[62:63], v[62:63], v[182:183]
    v_pk_fma_f32 v[76:77], v[128:129], v[52:53], v[76:77] op_sel_hi:[1,0,1]
    v_pk_fma_f32 v[78:79], v[130:131], v[52:53], v[78:79] op_sel_hi:[1,0,1]
    v_pk_mul_f32 v[76:77], v[76:77], v[52:53] op_sel:[0,1]
    v_pk_mul_f32 v[78:79], v[78:79], v[52:53] op_sel:[0,1]
    v_pk_mul_f32 v[184:185], v[76:77], v[76:77]
    v_pk_mul_f32 v[186:187], v[78:79], v[78:79]
    v_pk_fma_f32 v[184:185], v[184:185], s[52:53], s[52:53] op_sel:[0,0,1] op_sel_hi:[1,0,1]
    v_pk_fma_f32 v[186:187], v[186:187], s[52:53], s[52:53] op_sel:[0,0,1] op_sel_hi:[1,0,1]
    v_pk_mul_f32 v[184:185], v[184:185], v[76:77]
    v_pk_mul_f32 v[186:187], v[186:187], v[78:79]
    buffer_load_dwordx4 a[72:75], v6, s[4:7], s56 offen offset:2048
    v_exp_f32 v184, v184
    v_exp_f32 v185, v185
    v_exp_f32 v186, v186
    v_exp_f32 v187, v187
    v_pk_add_f32 v[184:185], v[184:185], 1.0 op_sel_hi:[1,0]
    v_pk_add_f32 v[186:187], v[186:187], 1.0 op_sel_hi:[1,0]
    v_rcp_f32 v184, v184
    v_rcp_f32 v185, v185
    buffer_load_dwordx4 a[76:79], v6, s[4:7], s56 offen offset:3072
    v_rcp_f32 v186, v186
    v_rcp_f32 v187, v187
    v_pk_mul_f32 v[76:77], v[76:77], v[184:185]
    v_pk_mul_f32 v[78:79], v[78:79], v[186:187]
    v_pk_add_f32 v[140:141], v[60:61], v[62:63]
    v_pk_mul_f32 v[142:143], v[60:61], v[60:61]
    v_pk_add_f32 v[140:141], v[140:141], v[76:77]
    v_pk_fma_f32 v[142:143], v[62:63], v[62:63], v[142:143]
    v_pk_add_f32 v[140:141], v[140:141], v[78:79]
    v_pk_fma_f32 v[142:143], v[76:77], v[76:77], v[142:143]
    v_pk_fma_f32 v[142:143], v[78:79], v[78:79], v[142:143]
    v_add_f32 v140, v140, v141
    s_xor_b32 s56, s30, 0x5000
    buffer_load_dwordx4 a[80:83], v6, s[4:7], s56 offen offset:0
    v_add_f32 v141, v142, v143
    v_pk_fma_f32 v[64:65], v[124:125], v[54:55], v[64:65] op_sel_hi:[1,0,1]
    v_pk_fma_f32 v[66:67], v[126:127], v[54:55], v[66:67] op_sel_hi:[1,0,1]
    v_pk_mul_f32 v[64:65], v[64:65], v[54:55] op_sel:[0,1]
    v_pk_mul_f32 v[66:67], v[66:67], v[54:55] op_sel:[0,1]
    v_pk_mul_f32 v[180:181], v[64:65], v[64:65]
    v_pk_mul_f32 v[182:183], v[66:67], v[66:67]
    v_pk_fma_f32 v[180:181], v[180:181], s[52:53], s[52:53] op_sel:[0,0,1] op_sel_hi:[1,0,1]
    v_pk_fma_f32 v[182:183], v[182:183], s[52:53], s[52:53] op_sel:[0,0,1] op_sel_hi:[1,0,1]
    v_pk_mul_f32 v[180:181], v[180:181], v[64:65]
    v_pk_mul_f32 v[182:183], v[182:183], v[66:67]
    v_exp_f32 v180, v180
    buffer_load_dwordx4 a[84:87], v6, s[4:7], s56 offen offset:1024
    v_exp_f32 v181, v181
    v_exp_f32 v182, v182
    v_exp_f32 v183, v183
    v_pk_add_f32 v[180:181], v[180:181], 1.0 op_sel_hi:[1,0]
    v_pk_add_f32 v[182:183], v[182:183], 1.0 op_sel_hi:[1,0]
    v_rcp_f32 v180, v180
    v_rcp_f32 v181, v181
    v_rcp_f32 v182, v182
    v_rcp_f32 v183, v183
    buffer_load_dwordx4 a[88:91], v6, s[4:7], s56 offen offset:2048
    v_pk_mul_f32 v[64:65], v[64:65], v[180:181]
    v_pk_mul_f32 v[66:67], v[66:67], v[182:183]
    v_pk_fma_f32 v[80:81], v[128:129], v[54:55], v[80:81] op_sel_hi:[1,0,1]
    v_pk_fma_f32 v[82:83], v[130:131], v[54:55], v[82:83] op_sel_hi:[1,0,1]
    v_pk_mul_f32 v[80:81], v[80:81], v[54:55] op_sel:[0,1]
    v_pk_mul_f32 v[82:83], v[82:83], v[54:55] op_sel:[0,1]
    v_pk_mul_f32 v[184:185], v[80:81], v[80:81]
    v_pk_mul_f32 v[186:187], v[82:83], v[82:83]
    v_pk_fma_f32 v[184:185], v[184:185], s[52:53], s[52:53] op_sel:[0,0,1] op_sel_hi:[1,0,1]
    v_pk_fma_f32 v[186:187], v[186:187], s[52:53], s[52:53] op_sel:[0,0,1] op_sel_hi:[1,0,1]
    v_pk_mul_f32 v[184:185], v[184:185], v[80:81]
    v_pk_mul_f32 v[186:187], v[186:187], v[82:83]
    buffer_load_dwordx4 a[92:95], v6, s[4:7], s56 offen offset:3072
    v_exp_f32 v184, v184
    v_exp_f32 v185, v185
    v_exp_f32 v186, v186
    v_exp_f32 v187, v187
    v_pk_add_f32 v[184:185], v[184:185], 1.0 op_sel_hi:[1,0]
    v_pk_add_f32 v[186:187], v[186:187], 1.0 op_sel_hi:[1,0]
    v_rcp_f32 v184, v184
    v_rcp_f32 v185, v185
    v_rcp_f32 v186, v186
    s_xor_b32 s56, s30, 0x6000
    buffer_load_dwordx4 a[96:99], v6, s[4:7], s56 offen offset:0
    v_rcp_f32 v187, v187
    v_pk_mul_f32 v[80:81], v[80:81], v[184:185]
    v_pk_mul_f32 v[82:83], v[82:83], v[186:187]
    v_pk_add_f32 v[144:145], v[64:65], v[66:67]
    v_pk_mul_f32 v[146:147], v[64:65], v[64:65]
    v_pk_add_f32 v[144:145], v[144:145], v[80:81]
    v_pk_fma_f32 v[146:147], v[66:67], v[66:67], v[146:147]
    v_pk_add_f32 v[144:145], v[144:145], v[82:83]
    v_pk_fma_f32 v[146:147], v[80:81], v[80:81], v[146:147]
    v_pk_fma_f32 v[146:147], v[82:83], v[82:83], v[146:147]
    v_add_f32 v144, v144, v145
    buffer_load_dwordx4 a[100:103], v6, s[4:7], s56 offen offset:1024
    v_add_f32 v145, v146, v147
    v_pk_fma_f32 v[68:69], v[124:125], v[56:57], v[68:69] op_sel_hi:[1,0,1]
    v_pk_fma_f32 v[70:71], v[126:127], v[56:57], v[70:71] op_sel_hi:[1,0,1]
    v_pk_mul_f32 v[68:69], v[68:69], v[56:57] op_sel:[0,1]
    v_pk_mul_f32 v[70:71], v[70:71], v[56:57] op_sel:[0,1]
    v_pk_mul_f32 v[180:181], v[68:69], v[68:69]
    v_pk_mul_f32 v[182:183], v[70:71], v[70:71]
    v_pk_fma_f32 v[180:181], v[180:181], s[52:53], s[52:53] op_sel:[0,0,1] op_sel_hi:[1,0,1]
    v_pk_fma_f32 v[182:183], v[182:183], s[52:53], s[52:53] op_sel:[0,0,1] op_sel_hi:[1,0,1]
    v_pk_mul_f32 v[180:181], v[180:181], v[68:69]
    v_pk_mul_f32 v[182:183], v[182:183], v[70:71]
    v_exp_f32 v180, v180
    v_exp_f32 v181, v181
    buffer_load_dwordx4 a[104:107], v6, s[4:7], s56 offen offset:2048
    v_exp_f32 v182, v182
    v_exp_f32 v183, v183
    v_pk_add_f32 v[180:181], v[180:181], 1.0 op_sel_hi:[1,0]
    v_pk_add_f32 v[182:183], v[182:183], 1.0 op_sel_hi:[1,0]
    v_rcp_f32 v180, v180
    v_rcp_f32 v181, v181
    v_rcp_f32 v182, v182
    v_rcp_f32 v183, v183
    buffer_load_dwordx4 a[108:111], v6, s[4:7], s56 offen offset:3072
    v_pk_mul_f32 v[68:69], v[68:69], v[180:181]
    v_pk_mul_f32 v[70:71], v[70:71], v[182:183]
    v_pk_fma_f32 v[84:85], v[128:129], v[56:57], v[84:85] op_sel_hi:[1,0,1]
    v_pk_fma_f32 v[86:87], v[130:131], v[56:57], v[86:87] op_sel_hi:[1,0,1]
    v_pk_mul_f32 v[84:85], v[84:85], v[56:57] op_sel:[0,1]
    v_pk_mul_f32 v[86:87], v[86:87], v[56:57] op_sel:[0,1]
    v_pk_mul_f32 v[184:185], v[84:85], v[84:85]
    v_pk_mul_f32 v[186:187], v[86:87], v[86:87]
    v_pk_fma_f32 v[184:185], v[184:185], s[52:53], s[52:53] op_sel:[0,0,1] op_sel_hi:[1,0,1]
    v_pk_fma_f32 v[186:187], v[186:187], s[52:53], s[52:53] op_sel:[0,0,1] op_sel_hi:[1,0,1]
    v_pk_mul_f32 v[184:185], v[184:185], v[84:85]
    v_pk_mul_f32 v[186:187], v[186:187], v[86:87]
    v_exp_f32 v184, v184
    s_xor_b32 s56, s30, 0x7000
    buffer_load_dwordx4 a[112:115], v6, s[4:7], s56 offen offset:0
    v_exp_f32 v185, v185
    v_exp_f32 v186, v186
    v_exp_f32 v187, v187
    v_pk_add_f32 v[184:185], v[184:185], 1.0 op_sel_hi:[1,0]
    v_pk_add_f32 v[186:187], v[186:187], 1.0 op_sel_hi:[1,0]
    v_rcp_f32 v184, v184
    v_rcp_f32 v185, v185
    v_rcp_f32 v186, v186
    buffer_load_dwordx4 a[116:119], v6, s[4:7], s56 offen offset:1024
    v_rcp_f32 v187, v187
    v_pk_mul_f32 v[84:85], v[84:85], v[184:185]
    v_pk_mul_f32 v[86:87], v[86:87], v[186:187]
    v_pk_add_f32 v[148:149], v[68:69], v[70:71]
    v_pk_mul_f32 v[150:151], v[68:69], v[68:69]
    v_pk_add_f32 v[148:149], v[148:149], v[84:85]
    v_pk_fma_f32 v[150:151], v[70:71], v[70:71], v[150:151]
    v_pk_add_f32 v[148:149], v[148:149], v[86:87]
    v_pk_fma_f32 v[150:151], v[84:85], v[84:85], v[150:151]
    v_pk_fma_f32 v[150:151], v[86:87], v[86:87], v[150:151]
    v_add_f32 v148, v148, v149
    v_add_f32 v149, v150, v151
    buffer_load_dwordx4 a[120:123], v6, s[4:7], s56 offen offset:2048
    v_pk_fma_f32 v[72:73], v[124:125], v[58:59], v[72:73] op_sel_hi:[1,0,1]
    v_pk_fma_f32 v[74:75], v[126:127], v[58:59], v[74:75] op_sel_hi:[1,0,1]
    v_pk_mul_f32 v[72:73], v[72:73], v[58:59] op_sel:[0,1]
    v_pk_mul_f32 v[74:75], v[74:75], v[58:59] op_sel:[0,1]
    v_pk_mul_f32 v[180:181], v[72:73], v[72:73]
    v_pk_mul_f32 v[182:183], v[74:75], v[74:75]
    v_pk_fma_f32 v[180:181], v[180:181], s[52:53], s[52:53] op_sel:[0,0,1] op_sel_hi:[1,0,1]
    v_pk_fma_f32 v[182:183], v[182:183], s[52:53], s[52:53] op_sel:[0,0,1] op_sel_hi:[1,0,1]
    v_pk_mul_f32 v[180:181], v[180:181], v[72:73]
    v_pk_mul_f32 v[182:183], v[182:183], v[74:75]
    v_exp_f32 v180, v180
    v_exp_f32 v181, v181
    buffer_load_dwordx4 a[124:127], v6, s[4:7], s56 offen offset:3072
    v_exp_f32 v182, v182
    v_exp_f32 v183, v183
    v_pk_add_f32 v[180:181], v[180:181], 1.0 op_sel_hi:[1,0]
    v_pk_add_f32 v[182:183], v[182:183], 1.0 op_sel_hi:[1,0]
    v_rcp_f32 v180, v180
    v_rcp_f32 v181, v181
    v_rcp_f32 v182, v182
    v_rcp_f32 v183, v183
    v_pk_mul_f32 v[72:73], v[72:73], v[180:181]
    s_xor_b32 s56, s30, 0x8000
    buffer_load_dwordx4 a[128:131], v6, s[4:7], s56 offen offset:0
    v_pk_mul_f32 v[74:75], v[74:75], v[182:183]
    v_pk_fma_f32 v[88:89], v[128:129], v[58:59], v[88:89] op_sel_hi:[1,0,1]
    v_pk_fma_f32 v[90:91], v[130:131], v[58:59], v[90:91] op_sel_hi:[1,0,1]
    v_pk_mul_f32 v[88:89], v[88:89], v[58:59] op_sel:[0,1]
    v_pk_mul_f32 v[90:91], v[90:91], v[58:59] op_sel:[0,1]
    v_pk_mul_f32 v[184:185], v[88:89], v[88:89]
    v_pk_mul_f32 v[186:187], v[90:91], v[90:91]
    v_pk_fma_f32 v[184:185], v[184:185], s[52:53], s[52:53] op_sel:[0,0,1] op_sel_hi:[1,0,1]
    v_pk_fma_f32 v[186:187], v[186:187], s[52:53], s[52:53] op_sel:[0,0,1] op_sel_hi:[1,0,1]
    v_pk_mul_f32 v[184:185], v[184:185], v[88:89]
    v_pk_mul_f32 v[186:187], v[186:187], v[90:91]
    v_exp_f32 v184, v184
    buffer_load_dwordx4 a[132:135], v6, s[4:7], s56 offen offset:1024
    v_exp_f32 v185, v185
    v_exp_f32 v186, v186
    v_exp_f32 v187, v187
    v_pk_add_f32 v[184:185], v[184:185], 1.0 op_sel_hi:[1,0]
    v_pk_add_f32 v[186:187], v[186:187], 1.0 op_sel_hi:[1,0]
    v_rcp_f32 v184, v184
    v_rcp_f32 v185, v185
    v_rcp_f32 v186, v186
    buffer_load_dwordx4 a[136:139], v6, s[4:7], s56 offen offset:2048
    v_rcp_f32 v187, v187
    v_pk_mul_f32 v[88:89], v[88:89], v[184:185]
    v_pk_mul_f32 v[90:91], v[90:91], v[186:187]
    v_pk_add_f32 v[152:153], v[72:73], v[74:75]
    v_pk_mul_f32 v[154:155], v[72:73], v[72:73]
    v_pk_add_f32 v[152:153], v[152:153], v[88:89]
    v_pk_fma_f32 v[154:155], v[74:75], v[74:75], v[154:155]
    v_pk_add_f32 v[152:153], v[152:153], v[90:91]
    v_pk_fma_f32 v[154:155], v[88:89], v[88:89], v[154:155]
    v_pk_fma_f32 v[154:155], v[90:91], v[90:91], v[154:155]
    v_add_f32 v152, v152, v153
    v_add_f32 v153, v154, v155
    v_permlane32_swap_b32 v140, v148
    v_permlane32_swap_b32 v144, v152
    v_permlane32_swap_b32 v141, v149
    v_permlane32_swap_b32 v145, v153
    v_pk_add_f32 v[140:141], v[140:141], v[148:149]
    v_pk_add_f32 v[144:145], v[144:145], v[152:153]
    s_nop 1
    v_permlane16_swap_b32 v140, v144
    v_permlane16_swap_b32 v141, v145
    v_pk_add_f32 v[140:141], v[140:141], v[144:145]
    s_mul_i32 s48, s22, 4608
    v_add_u32 v142, 138240, v9
    v_add_u32 v143, s48, v142
    ds_write_b64 v143, v[140:141]
    s_add_u32 s48, s48, 138240
    v_add_u32 v189, s48, v1
    s_add_u32 s48, s46, 0x750000
    s_cmp_eq_u32 s22, 0
    s_cselect_b32 s48, s48, 0x7f000000
    s_waitcnt lgkmcnt(0)
    s_barrier
    ds_read_b64 v[172:173], v142 offset:0
    ds_read_b64 v[174:175], v142 offset:4608
    ds_read_b64 v[176:177], v142 offset:9216
    ds_read_b64 v[178:179], v142 offset:13824
    s_waitcnt lgkmcnt(2)
    v_pk_add_f32 v[172:173], v[172:173], v[174:175]
    s_waitcnt lgkmcnt(0)
    v_pk_add_f32 v[176:177], v[176:177], v[178:179]
    v_pk_add_f32 v[190:191], v[172:173], v[176:177]
    buffer_store_dwordx2 v[190:191], v9, s[4:7], s48 offen offset:0 sc1
    ds_read_b128 v[140:143], v1 offset:0
    ds_read_b128 v[144:147], v1 offset:1024
    ds_read_b128 v[148:151], v1 offset:2048
    ds_read_b128 v[152:155], v1 offset:3072
    s_waitcnt lgkmcnt(3)
    v_mfma_f32_16x16x32_bf16 v[92:95], a[160:163], v[140:143], 0
    buffer_load_dwordx4 a[140:143], v6, s[4:7], s56 offen offset:3072
    ds_read_b128 v[156:159], v1 offset:4096
    v_mfma_f32_16x16x32_bf16 v[108:111], a[164:167], v[140:143], 0
    s_waitcnt lgkmcnt(3)
    v_mfma_f32_16x16x32_bf16 v[96:99], a[160:163], v[144:147], 0
    ds_read_b128 v[160:163], v1 offset:5120
    v_mfma_f32_16x16x32_bf16 v[112:115], a[164:167], v[144:147], 0
    s_waitcnt lgkmcnt(3)
    v_mfma_f32_16x16x32_bf16 v[100:103], a[160:163], v[148:151], 0
    ds_read_b128 v[164:167], v1 offset:6144
    v_mfma_f32_16x16x32_bf16 v[116:119], a[164:167], v[148:151], 0
    s_xor_b32 s56, s30, 0x9000
    buffer_load_dwordx4 a[144:147], v6, s[4:7], s56 offen offset:0
    s_waitcnt lgkmcnt(3)
    v_mfma_f32_16x16x32_bf16 v[104:107], a[160:163], v[152:155], 0
    ds_read_b128 v[168:171], v1 offset:7168
    v_mfma_f32_16x16x32_bf16 v[120:123], a[164:167], v[152:155], 0
    s_waitcnt lgkmcnt(3)
    v_mfma_f32_16x16x32_bf16 v[92:95], a[168:171], v[156:159], v[92:95]
    ds_read_b64 v[140:141], v9 offset:8192
    ds_read_b64 v[142:143], v9 offset:8704
    v_mfma_f32_16x16x32_bf16 v[108:111], a[172:175], v[156:159], v[108:111]
    s_waitcnt lgkmcnt(4)
    v_mfma_f32_16x16x32_bf16 v[96:99], a[168:171], v[160:163], v[96:99]
    buffer_load_dwordx4 a[148:151], v6, s[4:7], s56 offen offset:1024
    ds_read_b64 v[144:145], v9 offset:9216
    ds_read_b64 v[146:147], v9 offset:9728
    v_mfma_f32_16x16x32_bf16 v[112:115], a[172:175], v[160:163], v[112:115]
    s_waitcnt lgkmcnt(5)
    v_mfma_f32_16x16x32_bf16 v[100:103], a[168:171], v[164:167], v[100:103]
    ds_read_b64 v[148:149], v9 offset:10240
    ds_read_b64 v[150:151], v9 offset:10752
    v_mfma_f32_16x16x32_bf16 v[116:119], a[172:175], v[164:167], v[116:119]
    s_waitcnt lgkmcnt(6)
    v_mfma_f32_16x16x32_bf16 v[104:107], a[168:171], v[168:171], v[104:107]
    buffer_load_dwordx4 a[152:155], v6, s[4:7], s56 offen offset:2048
    ds_read_b64 v[152:153], v9 offset:11264
    ds_read_b64 v[154:155], v9 offset:11776
    v_mfma_f32_16x16x32_bf16 v[120:123], a[172:175], v[168:171], v[120:123]
    s_waitcnt lgkmcnt(6)
    v_mfma_f32_16x16x32_bf16 v[92:95], a[176:179], v[140:143], v[92:95]
    ds_read_b128 v[156:159], v1 offset:12288
    v_mfma_f32_16x16x32_bf16 v[108:111], a[180:183], v[140:143], v[108:111]
    s_waitcnt lgkmcnt(5)
    v_mfma_f32_16x16x32_bf16 v[96:99], a[176:179], v[144:147], v[96:99]
    ds_read_b128 v[160:163], v1 offset:13312
    v_mfma_f32_16x16x32_bf16 v[112:115], a[180:183], v[144:147], v[112:115]
    buffer_load_dwordx4 a[156:159], v6, s[4:7], s56 offen offset:3072
    s_waitcnt lgkmcnt(4)
    v_mfma_f32_16x16x32_bf16 v[100:103], a[176:179], v[148:151], v[100:103]
    ds_read_b128 v[164:167], v1 offset:14336
    v_mfma_f32_16x16x32_bf16 v[116:119], a[180:183], v[148:151], v[116:119]
    s_waitcnt lgkmcnt(3)
    v_mfma_f32_16x16x32_bf16 v[104:107], a[176:179], v[152:155], v[104:107]
    ds_read_b128 v[168:171], v1 offset:15360
    v_mfma_f32_16x16x32_bf16 v[120:123], a[180:183], v[152:155], v[120:123]
    s_waitcnt lgkmcnt(3)
    v_mfma_f32_16x16x32_bf16 v[92:95], a[184:187], v[156:159], v[92:95]
    s_xor_b32 s56, s30, 0xa000
    buffer_load_dwordx4 a[160:163], v6, s[4:7], s56 offen offset:0
    ds_read_b128 v[140:143], v1 offset:16384
    v_mfma_f32_16x16x32_bf16 v[108:111], a[188:191], v[156:159], v[108:111]
    s_waitcnt lgkmcnt(3)
    v_mfma_f32_16x16x32_bf16 v[96:99], a[184:187], v[160:163], v[96:99]
    ds_read_b128 v[144:147], v1 offset:17408
    v_mfma_f32_16x16x32_bf16 v[112:115], a[188:191], v[160:163], v[112:115]
    s_waitcnt lgkmcnt(3)
    v_mfma_f32_16x16x32_bf16 v[100:103], a[184:187], v[164:167], v[100:103]
    ds_read_b128 v[148:151], v1 offset:18432
    v_mfma_f32_16x16x32_bf16 v[116:119], a[188:191], v[164:167], v[116:119]
    buffer_load_dwordx4 a[164:167], v6, s[4:7], s56 offen offset:1024
    s_waitcnt lgkmcnt(3)
    v_mfma_f32_16x16x32_bf16 v[104:107], a[184:187], v[168:171], v[104:107]
    ds_read_b128 v[152:155], v1 offset:19456
    v_mfma_f32_16x16x32_bf16 v[120:123], a[188:191], v[168:171], v[120:123]
    s_waitcnt lgkmcnt(3)
    v_mfma_f32_16x16x32_bf16 v[92:95], a[192:195], v[140:143], v[92:95]
    ds_read_b128 v[156:159], v1 offset:20480
    v_mfma_f32_16x16x32_bf16 v[108:111], a[196:199], v[140:143], v[108:111]
    s_waitcnt lgkmcnt(3)
    v_mfma_f32_16x16x32_bf16 v[96:99], a[192:195], v[144:147], v[96:99]
    buffer_load_dwordx4 a[168:171], v6, s[4:7], s56 offen offset:2048
    ds_read_b128 v[160:163], v1 offset:21504
    v_mfma_f32_16x16x32_bf16 v[112:115], a[196:199], v[144:147], v[112:115]
    s_waitcnt lgkmcnt(3)
    v_mfma_f32_16x16x32_bf16 v[100:103], a[192:195], v[148:151], v[100:103]
    ds_read_b128 v[164:167], v1 offset:22528
    v_mfma_f32_16x16x32_bf16 v[116:119], a[196:199], v[148:151], v[116:119]
    s_waitcnt lgkmcnt(3)
    v_mfma_f32_16x16x32_bf16 v[104:107], a[192:195], v[152:155], v[104:107]
    ds_read_b128 v[168:171], v1 offset:23552
    v_mfma_f32_16x16x32_bf16 v[120:123], a[196:199], v[152:155], v[120:123]
    buffer_load_dwordx4 a[172:175], v6, s[4:7], s56 offen offset:3072
    s_waitcnt lgkmcnt(3)
    v_mfma_f32_16x16x32_bf16 v[92:95], a[200:203], v[156:159], v[92:95]
    ds_read_b128 v[140:143], v1 offset:24576
    v_mfma_f32_16x16x32_bf16 v[108:111], a[204:207], v[156:159], v[108:111]
    s_waitcnt lgkmcnt(3)
    v_mfma_f32_16x16x32_bf16 v[96:99], a[200:203], v[160:163], v[96:99]
    ds_read_b128 v[144:147], v1 offset:25600
    v_mfma_f32_16x16x32_bf16 v[112:115], a[204:207], v[160:163], v[112:115]
    s_waitcnt lgkmcnt(3)
    v_mfma_f32_16x16x32_bf16 v[100:103], a[200:203], v[164:167], v[100:103]
    s_xor_b32 s56, s30, 0xb000
    buffer_load_dwordx4 a[176:179], v6, s[4:7], s56 offen offset:0
    ds_read_b128 v[148:151], v1 offset:26624
    v_mfma_f32_16x16x32_bf16 v[116:119], a[204:207], v[164:167], v[116:119]
    s_waitcnt lgkmcnt(3)
    v_mfma_f32_16x16x32_bf16 v[104:107], a[200:203], v[168:171], v[104:107]
    ds_read_b128 v[152:155], v1 offset:27648
    v_mfma_f32_16x16x32_bf16 v[120:123], a[204:207], v[168:171], v[120:123]
    s_waitcnt lgkmcnt(3)
    v_mfma_f32_16x16x32_bf16 v[92:95], a[208:211], v[140:143], v[92:95]
    ds_read_b64 v[156:157], v9 offset:28672
    ds_read_b64 v[158:159], v9 offset:29184
    buffer_load_dwordx4 a[180:183], v6, s[4:7], s56 offen offset:1024
    v_mfma_f32_16x16x32_bf16 v[108:111], a[212:215], v[140:143], v[108:111]
    s_waitcnt lgkmcnt(4)
    v_mfma_f32_16x16x32_bf16 v[96:99], a[208:211], v[144:147], v[96:99]
    ds_read_b64 v[160:161], v9 offset:29696
    ds_read_b64 v[162:163], v9 offset:30208
    v_mfma_f32_16x16x32_bf16 v[112:115], a[212:215], v[144:147], v[112:115]
    s_waitcnt lgkmcnt(5)
    v_mfma_f32_16x16x32_bf16 v[100:103], a[208:211], v[148:151], v[100:103]
    ds_read_b64 v[164:165], v9 offset:30720
    ds_read_b64 v[166:167], v9 offset:31232
    buffer_load_dwordx4 a[184:187], v6, s[4:7], s56 offen offset:2048
    v_mfma_f32_16x16x32_bf16 v[116:119], a[212:215], v[148:151], v[116:119]
    s_waitcnt lgkmcnt(6)
    v_mfma_f32_16x16x32_bf16 v[104:107], a[208:211], v[152:155], v[104:107]
    ds_read_b64 v[168:169], v9 offset:31744
    ds_read_b64 v[170:171], v9 offset:32256
    v_mfma_f32_16x16x32_bf16 v[120:123], a[212:215], v[152:155], v[120:123]
    s_waitcnt lgkmcnt(6)
    v_mfma_f32_16x16x32_bf16 v[92:95], a[216:219], v[156:159], v[92:95]
    ds_read_b128 v[140:143], v1 offset:32768
    v_mfma_f32_16x16x32_bf16 v[108:111], a[220:223], v[156:159], v[108:111]
    buffer_load_dwordx4 a[188:191], v6, s[4:7], s56 offen offset:3072
    s_waitcnt lgkmcnt(5)
    v_mfma_f32_16x16x32_bf16 v[96:99], a[216:219], v[160:163], v[96:99]
    ds_read_b128 v[144:147], v1 offset:33792
    v_mfma_f32_16x16x32_bf16 v[112:115], a[220:223], v[160:163], v[112:115]
    s_waitcnt lgkmcnt(4)
    v_mfma_f32_16x16x32_bf16 v[100:103], a[216:219], v[164:167], v[100:103]
    ds_read_b128 v[148:151], v1 offset:34816
    v_mfma_f32_16x16x32_bf16 v[116:119], a[220:223], v[164:167], v[116:119]
    s_waitcnt lgkmcnt(3)
    v_mfma_f32_16x16x32_bf16 v[104:107], a[216:219], v[168:171], v[104:107]
    s_xor_b32 s56, s30, 0xc000
    buffer_load_dwordx4 a[192:195], v6, s[4:7], s56 offen offset:0
    ds_read_b128 v[152:155], v1 offset:35840
    v_mfma_f32_16x16x32_bf16 v[120:123], a[220:223], v[168:171], v[120:123]
    s_waitcnt lgkmcnt(3)
    v_mfma_f32_16x16x32_bf16 v[92:95], a[224:227], v[140:143], v[92:95]
    ds_read_b128 v[156:159], v1 offset:36864
    v_mfma_f32_16x16x32_bf16 v[108:111], a[228:231], v[140:143], v[108:111]
    s_waitcnt lgkmcnt(3)
    v_mfma_f32_16x16x32_bf16 v[96:99], a[224:227], v[144:147], v[96:99]
    ds_read_b128 v[160:163], v1 offset:37888
    v_mfma_f32_16x16x32_bf16 v[112:115], a[228:231], v[144:147], v[112:115]
    s_waitcnt lgkmcnt(3)
    v_mfma_f32_16x16x32_bf16 v[100:103], a[224:227], v[148:151], v[100:103]
    ds_read_b128 v[164:167], v1 offset:38912
    v_mfma_f32_16x16x32_bf16 v[116:119], a[228:231], v[148:151], v[116:119]
    s_waitcnt lgkmcnt(3)
    v_mfma_f32_16x16x32_bf16 v[104:107], a[224:227], v[152:155], v[104:107]
    ds_read_b128 v[168:171], v1 offset:39936
    v_mfma_f32_16x16x32_bf16 v[120:123], a[228:231], v[152:155], v[120:123]
    s_waitcnt lgkmcnt(3)
    v_mfma_f32_16x16x32_bf16 v[92:95], a[232:235], v[156:159], v[92:95]
    ds_read_b128 v[140:143], v1 offset:40960
    v_mfma_f32_16x16x32_bf16 v[108:111], a[236:239], v[156:159], v[108:111]
    s_add_u32 s48, s44, 0x750000
    buffer_load_dwordx2 v[172:173], v9, s[4:7], s48 offen offset:0 sc1
    s_waitcnt lgkmcnt(3)
    v_mfma_f32_16x16x32_bf16 v[96:99], a[232:235], v[160:163], v[96:99]
    ds_read_b128 v[144:147], v1 offset:41984
    v_mfma_f32_16x16x32_bf16 v[112:115], a[236:239], v[160:163], v[112:115]
    buffer_load_dwordx2 v[174:175], v9, s[4:7], s48 offen offset:512 sc1
    buffer_load_dwordx2 v[176:177], v9, s[4:7], s48 offen offset:1024 sc1
    s_waitcnt lgkmcnt(3)
    v_mfma_f32_16x16x32_bf16 v[100:103], a[232:235], v[164:167], v[100:103]
    ds_read_b128 v[148:151], v1 offset:43008
    v_mfma_f32_16x16x32_bf16 v[116:119], a[236:239], v[164:167], v[116:119]
    buffer_load_dwordx2 v[178:179], v9, s[4:7], s48 offen offset:1536 sc1
    buffer_load_dwordx2 v[180:181], v9, s[4:7], s48 offen offset:2048 sc1
    s_waitcnt lgkmcnt(3)
    v_mfma_f32_16x16x32_bf16 v[104:107], a[232:235], v[168:171], v[104:107]
    ds_read_b128 v[152:155], v1 offset:44032
    v_mfma_f32_16x16x32_bf16 v[120:123], a[236:239], v[168:171], v[120:123]
    buffer_load_dwordx2 v[182:183], v9, s[4:7], s48 offen offset:2560 sc1
    buffer_load_dwordx2 v[184:185], v9, s[4:7], s48 offen offset:3072 sc1
    s_waitcnt lgkmcnt(3)
    v_mfma_f32_16x16x32_bf16 v[92:95], a[240:243], v[140:143], v[92:95]
    buffer_load_dwordx2 v[186:187], v9, s[4:7], s48 offen offset:3584 sc1
    v_mfma_f32_16x16x32_bf16 v[108:111], a[244:247], v[140:143], v[108:111]
    s_waitcnt lgkmcnt(2)
    v_mfma_f32_16x16x32_bf16 v[96:99], a[240:243], v[144:147], v[96:99]
    v_mfma_f32_16x16x32_bf16 v[112:115], a[244:247], v[144:147], v[112:115]
    s_waitcnt lgkmcnt(1)
    v_mfma_f32_16x16x32_bf16 v[100:103], a[240:243], v[148:151], v[100:103]
    v_mfma_f32_16x16x32_bf16 v[116:119], a[244:247], v[148:151], v[116:119]
    s_waitcnt lgkmcnt(0)
    v_mfma_f32_16x16x32_bf16 v[104:107], a[240:243], v[152:155], v[104:107]
    v_mfma_f32_16x16x32_bf16 v[120:123], a[244:247], v[152:155], v[120:123]
    s_mov_b32 s51, 0x20000
    s_nop 6
SPOLL_26:
    s_waitcnt vmcnt(0)
    v_min3_f32 v140, v173, v175, v177
    v_min3_f32 v141, v179, v181, v183
    v_min3_f32 v140, v140, v185, v187
    v_min_f32 v140, v140, v141
    v_cmp_gt_f32 vcc, 0, v140
    s_cbranch_vccz SPOLLD_27
    s_add_u32 s48, s44, 0x750000
    buffer_load_dwordx2 v[172:173], v9, s[4:7], s48 offen offset:0 sc1
    buffer_load_dwordx2 v[174:175], v9, s[4:7], s48 offen offset:512 sc1
    buffer_load_dwordx2 v[176:177], v9, s[4:7], s48 offen offset:1024 sc1
    buffer_load_dwordx2 v[178:179], v9, s[4:7], s48 offen offset:1536 sc1
    buffer_load_dwordx2 v[180:181], v9, s[4:7], s48 offen offset:2048 sc1
    buffer_load_dwordx2 v[182:183], v9, s[4:7], s48 offen offset:2560 sc1
    buffer_load_dwordx2 v[184:185], v9, s[4:7], s48 offen offset:3072 sc1
    buffer_load_dwordx2 v[186:187], v9, s[4:7], s48 offen offset:3584 sc1
    s_sub_u32 s51, s51, 1
    s_cbranch_scc0 SPOLL_26
    s_waitcnt vmcnt(0)
SPOLLD_27:
    buffer_load_dwordx4 a[196:199], v6, s[4:7], s56 offen offset:1024
    buffer_load_dwordx4 a[200:203], v6, s[4:7], s56 offen offset:2048
    buffer_load_dwordx4 a[204:207], v6, s[4:7], s56 offen offset:3072
    s_xor_b32 s56, s30, 0xd000
    buffer_load_dwordx4 a[208:211], v6, s[4:7], s56 offen offset:0
    v_pk_add_f32 v[172:173], v[172:173], v[180:181]
    v_pk_add_f32 v[174:175], v[174:175], v[182:183]
    v_pk_add_f32 v[176:177], v[176:177], v[184:185]
    v_pk_add_f32 v[178:179], v[178:179], v[186:187]
    v_pk_add_f32 v[172:173], v[172:173], v[176:177]
    v_pk_add_f32 v[174:175], v[174:175], v[178:179]
    v_pk_add_f32 v[172:173], v[172:173], v[174:175]
    v_mul_f32 v172, 0xba97b426, v172
    v_mul_f32 v173, 0x3a97b426, v173
    v_fma_f32 v173, -v172, v172, v173
    v_max_f32 v173, 0, v173
    v_add_f32 v173, 0x3727c5ac, v173
    v_rsq_f32 v173, v173
    s_nop 0
    v_mul_f32 v172, v172, v173
    ds_bpermute_b32 v156, v28, v172 offset:0
    ds_bpermute_b32 v157, v28, v173 offset:0
    ds_bpermute_b32 v158, v28, v172 offset:64
    ds_bpermute_b32 v159, v28, v173 offset:64
    ds_bpermute_b32 v160, v28, v172 offset:128
    ds_bpermute_b32 v161, v28, v173 offset:128
    ds_bpermute_b32 v162, v28, v172 offset:192
    ds_bpermute_b32 v163, v28, v173 offset:192
    s_add_u32 s48, s36, 0x1980000
    s_add_u32 s49, s37, 0x1980000
    s_waitcnt lgkmcnt(6)
    v_pk_fma_f32 v[60:61], v[60:61], v[156:157], v[156:157] op_sel:[0,1,0] op_sel_hi:[1,1,0]
    v_pk_fma_f32 v[62:63], v[62:63], v[156:157], v[156:157] op_sel:[0,1,0] op_sel_hi:[1,1,0]
    v_cvt_pk_bf16_f32 v60, v60, v61
    v_cvt_pk_bf16_f32 v61, v62, v63
    ds_write_b64 v33, v[60:61] offset:0
    v_pk_fma_f32 v[76:77], v[76:77], v[156:157], v[156:157] op_sel:[0,1,0] op_sel_hi:[1,1,0]
    v_pk_fma_f32 v[78:79], v[78:79], v[156:157], v[156:157] op_sel:[0,1,0] op_sel_hi:[1,1,0]
    v_cvt_pk_bf16_f32 v76, v76, v77
    v_cvt_pk_bf16_f32 v77, v78, v79
    ds_write_b64 v33, v[76:77] offset:32
    s_waitcnt lgkmcnt(6)
    v_pk_fma_f32 v[64:65], v[64:65], v[158:159], v[158:159] op_sel:[0,1,0] op_sel_hi:[1,1,0]
    v_pk_fma_f32 v[66:67], v[66:67], v[158:159], v[158:159] op_sel:[0,1,0] op_sel_hi:[1,1,0]
    v_cvt_pk_bf16_f32 v64, v64, v65
    v_cvt_pk_bf16_f32 v65, v66, v67
    ds_write_b64 v33, v[64:65] offset:72
    v_pk_fma_f32 v[80:81], v[80:81], v[158:159], v[158:159] op_sel:[0,1,0] op_sel_hi:[1,1,0]
    v_pk_fma_f32 v[82:83], v[82:83], v[158:159], v[158:159] op_sel:[0,1,0] op_sel_hi:[1,1,0]
    v_cvt_pk_bf16_f32 v80, v80, v81
    v_cvt_pk_bf16_f32 v81, v82, v83
    ds_write_b64 v33, v[80:81] offset:104
    ds_read_b64_tr_b16 v[172:173], v34 offset:0
    ds_read_b64_tr_b16 v[174:175], v34 offset:288
    ds_read_b64_tr_b16 v[176:177], v34 offset:32
    ds_read_b64_tr_b16 v[178:179], v34 offset:320
    s_waitcnt lgkmcnt(10)
    v_pk_fma_f32 v[68:69], v[68:69], v[160:161], v[160:161] op_sel:[0,1,0] op_sel_hi:[1,1,0]
    v_pk_fma_f32 v[70:71], v[70:71], v[160:161], v[160:161] op_sel:[0,1,0] op_sel_hi:[1,1,0]
    v_cvt_pk_bf16_f32 v68, v68, v69
    v_cvt_pk_bf16_f32 v69, v70, v71
    ds_write_b64 v33, v[68:69] offset:2304
    v_pk_fma_f32 v[84:85], v[84:85], v[160:161], v[160:161] op_sel:[0,1,0] op_sel_hi:[1,1,0]
    v_pk_fma_f32 v[86:87], v[86:87], v[160:161], v[160:161] op_sel:[0,1,0] op_sel_hi:[1,1,0]
    v_cvt_pk_bf16_f32 v84, v84, v85
    v_cvt_pk_bf16_f32 v85, v86, v87
    ds_write_b64 v33, v[84:85] offset:2336
    s_waitcnt lgkmcnt(10)
    v_pk_fma_f32 v[72:73], v[72:73], v[162:163], v[162:163] op_sel:[0,1,0] op_sel_hi:[1,1,0]
    v_pk_fma_f32 v[74:75], v[74:75], v[162:163], v[162:163] op_sel:[0,1,0] op_sel_hi:[1,1,0]
    v_cvt_pk_bf16_f32 v72, v72, v73
    v_cvt_pk_bf16_f32 v73, v74, v75
    ds_write_b64 v33, v[72:73] offset:2376
    v_pk_fma_f32 v[88:89], v[88:89], v[162:163], v[162:163] op_sel:[0,1,0] op_sel_hi:[1,1,0]
    v_pk_fma_f32 v[90:91], v[90:91], v[162:163], v[162:163] op_sel:[0,1,0] op_sel_hi:[1,1,0]
    v_cvt_pk_bf16_f32 v88, v88, v89
    v_cvt_pk_bf16_f32 v89, v90, v91
    ds_write_b64 v33, v[88:89] offset:2408
    ds_read_b64_tr_b16 v[180:181], v34 offset:2304
    ds_read_b64_tr_b16 v[182:183], v34 offset:2592
    ds_read_b64_tr_b16 v[184:185], v34 offset:2336
    ds_read_b64_tr_b16 v[186:187], v34 offset:2624
    s_waitcnt lgkmcnt(10)
    buffer_store_dwordx4 v[172:175], v1, s[4:7], s48 offen offset:0 sc1
    s_waitcnt lgkmcnt(8)
    buffer_store_dwordx4 v[176:179], v1, s[4:7], s49 offen offset:0 sc1
    s_waitcnt lgkmcnt(2)
    buffer_store_dwordx4 v[180:183], v1, s[4:7], s48 offen offset:1024 sc1
    s_waitcnt lgkmcnt(0)
    buffer_store_dwordx4 v[184:187], v1, s[4:7], s49 offen offset:1024 sc1
    ds_read_b128 v[156:159], v1 offset:45056
    ds_read_b128 v[160:163], v1 offset:46080
    ds_read_b128 v[164:167], v1 offset:47104
    ds_read_b128 v[168:171], v1 offset:48128
    s_waitcnt lgkmcnt(3)
    v_mfma_f32_16x16x32_bf16 v[92:95], a[248:251], v[156:159], v[92:95]
    ds_read_b64 v[140:141], v9 offset:49152
    ds_read_b64 v[142:143], v9 offset:49664
    v_mfma_f32_16x16x32_bf16 v[108:111], a[252:255], v[156:159], v[108:111]
    s_waitcnt lgkmcnt(4)
    v_mfma_f32_16x16x32_bf16 v[96:99], a[248:251], v[160:163], v[96:99]
    ds_read_b64 v[144:145], v9 offset:50176
    ds_read_b64 v[146:147], v9 offset:50688
    v_mfma_f32_16x16x32_bf16 v[112:115], a[252:255], v[160:163], v[112:115]
    s_waitcnt lgkmcnt(5)
    v_mfma_f32_16x16x32_bf16 v[100:103], a[248:251], v[164:167], v[100:103]
    ds_read_b64 v[148:149], v8 offset:0
    ds_read_b64 v[150:151], v8 offset:512
    v_mfma_f32_16x16x32_bf16 v[116:119], a[252:255], v[164:167], v[116:119]
    s_waitcnt lgkmcnt(6)
    v_mfma_f32_16x16x32_bf16 v[104:107], a[248:251], v[168:171], v[104:107]
    ds_read_b64 v[152:153], v8 offset:1024
    ds_read_b64 v[154:155], v8 offset:1536
    v_mfma_f32_16x16x32_bf16 v[120:123], a[252:255], v[168:171], v[120:123]
    s_waitcnt lgkmcnt(6)
    v_mfma_f32_16x16x32_bf16 v[92:95], v[192:195], v[140:143], v[92:95]
    ds_read_b128 v[156:159], v2 offset:2048
    v_mfma_f32_16x16x32_bf16 v[108:111], v[196:199], v[140:143], v[108:111]
    buffer_load_dwordx4 a[212:215], v6, s[4:7], s56 offen offset:1024
    s_waitcnt lgkmcnt(5)
    v_mfma_f32_16x16x32_bf16 v[96:99], v[192:195], v[144:147], v[96:99]
    ds_read_b128 v[160:163], v2 offset:3072
    v_mfma_f32_16x16x32_bf16 v[112:115], v[196:199], v[144:147], v[112:115]
    s_waitcnt lgkmcnt(4)
    v_mfma_f32_16x16x32_bf16 v[100:103], v[192:195], v[148:151], v[100:103]
    ds_read_b128 v[164:167], v2 offset:4096
    v_mfma_f32_16x16x32_bf16 v[116:119], v[196:199], v[148:151], v[116:119]
    s_waitcnt lgkmcnt(3)
    v_mfma_f32_16x16x32_bf16 v[104:107], v[192:195], v[152:155], v[104:107]
    buffer_load_dwordx4 a[216:219], v6, s[4:7], s56 offen offset:2048
    ds_read_b128 v[168:171], v2 offset:5120
    v_mfma_f32_16x16x32_bf16 v[120:123], v[196:199], v[152:155], v[120:123]
    s_waitcnt lgkmcnt(3)
    v_mfma_f32_16x16x32_bf16 v[92:95], v[200:203], v[156:159], v[92:95]
    v_mfma_f32_16x16x32_bf16 v[108:111], v[204:207], v[156:159], v[108:111]
    s_waitcnt lgkmcnt(2)
    v_mfma_f32_16x16x32_bf16 v[96:99], v[200:203], v[160:163], v[96:99]
    v_mfma_f32_16x16x32_bf16 v[112:115], v[204:207], v[160:163], v[112:115]
    buffer_load_dwordx4 a[220:223], v6, s[4:7], s56 offen offset:3072
    s_waitcnt lgkmcnt(1)
    v_mfma_f32_16x16x32_bf16 v[100:103], v[200:203], v[164:167], v[100:103]
    v_mfma_f32_16x16x32_bf16 v[116:119], v[204:207], v[164:167], v[116:119]
    s_waitcnt lgkmcnt(0)
    v_mfma_f32_16x16x32_bf16 v[104:107], v[200:203], v[168:171], v[104:107]
    v_mfma_f32_16x16x32_bf16 v[120:123], v[204:207], v[168:171], v[120:123]
    s_sub_u32 s58, s60, 4
    v_mov_b32 v26, s58
    s_mov_b64 exec, 1
    s_waitcnt vmcnt(3)
    buffer_store_dwordx2 v[26:27], off, s[4:7], s43 sc1
    s_mov_b64 exec, -1
    ds_read_b128 v[140:143], v2 offset:6144
    ds_read_b128 v[144:147], v2 offset:7168
    ds_read_b128 v[148:151], v2 offset:8192
    ds_read_b128 v[152:155], v2 offset:9216
    s_waitcnt lgkmcnt(3)
    v_mfma_f32_16x16x32_bf16 v[92:95], v[208:211], v[140:143], v[92:95]
    s_xor_b32 s56, s30, 0xe000
    buffer_load_dwordx4 a[224:227], v6, s[4:7], s56 offen offset:0
    ds_read_b128 v[156:159], v2 offset:10240
    v_mfma_f32_16x16x32_bf16 v[108:111], v[212:215], v[140:143], v[108:111]
    s_waitcnt lgkmcnt(3)
    v_mfma_f32_16x16x32_bf16 v[96:99], v[208:211], v[144:147], v[96:99]
    ds_read_b128 v[160:163], v2 offset:11264
    v_mfma_f32_16x16x32_bf16 v[112:115], v[212:215], v[144:147], v[112:115]
    s_waitcnt lgkmcnt(3)
    v_mfma_f32_16x16x32_bf16 v[100:103], v[208:211], v[148:151], v[100:103]
    ds_read_b128 v[164:167], v2 offset:12288
    v_mfma_f32_16x16x32_bf16 v[116:119], v[212:215], v[148:151], v[116:119]
    buffer_load_dwordx4 a[228:231], v6, s[4:7], s56 offen offset:1024
    s_waitcnt lgkmcnt(3)
    v_mfma_f32_16x16x32_bf16 v[104:107], v[208:211], v[152:155], v[104:107]
    ds_read_b128 v[168:171], v2 offset:13312
    v_mfma_f32_16x16x32_bf16 v[120:123], v[212:215], v[152:155], v[120:123]
    s_waitcnt lgkmcnt(3)
    v_mfma_f32_16x16x32_bf16 v[92:95], v[216:219], v[156:159], v[92:95]
    ds_read_b128 v[140:143], v2 offset:14336
    v_mfma_f32_16x16x32_bf16 v[108:111], v[220:223], v[156:159], v[108:111]
    s_waitcnt lgkmcnt(3)
    v_mfma_f32_16x16x32_bf16 v[96:99], v[216:219], v[160:163], v[96:99]
    buffer_load_dwordx4 a[232:235], v6, s[4:7], s56 offen offset:2048
    ds_read_b128 v[144:147], v2 offset:15360
    v_mfma_f32_16x16x32_bf16 v[112:115], v[220:223], v[160:163], v[112:115]
    s_waitcnt lgkmcnt(3)
    v_mfma_f32_16x16x32_bf16 v[100:103], v[216:219], v[164:167], v[100:103]
    ds_read_b128 v[148:151], v2 offset:16384
    v_mfma_f32_16x16x32_bf16 v[116:119], v[220:223], v[164:167], v[116:119]
    s_waitcnt lgkmcnt(3)
    v_mfma_f32_16x16x32_bf16 v[104:107], v[216:219], v[168:171], v[104:107]
    ds_read_b128 v[152:155], v2 offset:17408
    v_mfma_f32_16x16x32_bf16 v[120:123], v[220:223], v[168:171], v[120:123]
    buffer_load_dwordx4 a[236:239], v6, s[4:7], s56 offen offset:3072
    s_waitcnt lgkmcnt(3)
    v_mfma_f32_16x16x32_bf16 v[92:95], v[224:227], v[140:143], v[92:95]
    ds_read_b64 v[156:157], v8 offset:18432
    ds_read_b64 v[158:159], v8 offset:18944
    v_mfma_f32_16x16x32_bf16 v[108:111], v[228:231], v[140:143], v[108:111]
    s_waitcnt lgkmcnt(4)
    v_mfma_f32_16x16x32_bf16 v[96:99], v[224:227], v[144:147], v[96:99]
    ds_read_b64 v[160:161], v8 offset:19456
    ds_read_b64 v[162:163], v8 offset:19968
    v_mfma_f32_16x16x32_bf16 v[112:115], v[228:231], v[144:147], v[112:115]
    s_waitcnt lgkmcnt(5)
    v_mfma_f32_16x16x32_bf16 v[100:103], v[224:227], v[148:151], v[100:103]
    s_xor_b32 s56, s30, 0xf000
    buffer_load_dwordx4 a[240:243], v6, s[4:7], s56 offen offset:0
    ds_read_b64 v[164:165], v8 offset:20480
    ds_read_b64 v[166:167], v8 offset:20992
    v_mfma_f32_16x16x32_bf16 v[116:119], v[228:231], v[148:151], v[116:119]
    s_waitcnt lgkmcnt(6)
    v_mfma_f32_16x16x32_bf16 v[104:107], v[224:227], v[152:155], v[104:107]
    ds_read_b64 v[168:169], v8 offset:21504
    ds_read_b64 v[170:171], v8 offset:22016
    v_mfma_f32_16x16x32_bf16 v[120:123], v[228:231], v[152:155], v[120:123]
    s_waitcnt lgkmcnt(6)
    v_mfma_f32_16x16x32_bf16 v[92:95], v[232:235], v[156:159], v[92:95]
    buffer_load_dwordx4 a[244:247], v6, s[4:7], s56 offen offset:1024
    ds_read_b128 v[140:143], v2 offset:22528
    v_mfma_f32_16x16x32_bf16 v[108:111], v[236:239], v[156:159], v[108:111]
    s_waitcnt lgkmcnt(5)
    v_mfma_f32_16x16x32_bf16 v[96:99], v[232:235], v[160:163], v[96:99]
    ds_read_b128 v[144:147], v2 offset:23552
    v_mfma_f32_16x16x32_bf16 v[112:115], v[236:239], v[160:163], v[112:115]
    s_waitcnt lgkmcnt(4)
    v_mfma_f32_16x16x32_bf16 v[100:103], v[232:235], v[164:167], v[100:103]
    ds_read_b128 v[148:151], v2 offset:24576
    v_mfma_f32_16x16x32_bf16 v[116:119], v[236:239], v[164:167], v[116:119]
    buffer_load_dwordx4 a[248:251], v6, s[4:7], s56 offen offset:2048
    s_waitcnt lgkmcnt(3)
    v_mfma_f32_16x16x32_bf16 v[104:107], v[232:235], v[168:171], v[104:107]
    ds_read_b128 v[152:155], v2 offset:25600
    v_mfma_f32_16x16x32_bf16 v[120:123], v[236:239], v[168:171], v[120:123]
    s_waitcnt lgkmcnt(3)
    v_mfma_f32_16x16x32_bf16 v[92:95], v[240:243], v[140:143], v[92:95]
    ds_read_b128 v[156:159], v2 offset:26624
    v_mfma_f32_16x16x32_bf16 v[108:111], v[244:247], v[140:143], v[108:111]
    s_waitcnt lgkmcnt(3)
    v_mfma_f32_16x16x32_bf16 v[96:99], v[240:243], v[144:147], v[96:99]
    buffer_load_dwordx4 a[252:255], v6, s[4:7], s56 offen offset:3072
    ds_read_b128 v[160:163], v2 offset:27648
    v_mfma_f32_16x16x32_bf16 v[112:115], v[244:247], v[144:147], v[112:115]
    s_waitcnt lgkmcnt(3)
    v_mfma_f32_16x16x32_bf16 v[100:103], v[240:243], v[148:151], v[100:103]
    ds_read_b128 v[164:167], v2 offset:28672
    v_mfma_f32_16x16x32_bf16 v[116:119], v[244:247], v[148:151], v[116:119]
    s_waitcnt lgkmcnt(3)
    v_mfma_f32_16x16x32_bf16 v[104:107], v[240:243], v[152:155], v[104:107]
    ds_read_b128 v[168:171], v2 offset:29696
    v_mfma_f32_16x16x32_bf16 v[120:123], v[244:247], v[152:155], v[120:123]
    s_waitcnt lgkmcnt(3)
    v_mfma_f32_16x16x32_bf16 v[92:95], v[248:251], v[156:159], v[92:95]
    v_mfma_f32_16x16x32_bf16 v[108:111], v[252:255], v[156:159], v[108:111]
    s_waitcnt lgkmcnt(2)
    v_mfma_f32_16x16x32_bf16 v[96:99], v[248:251], v[160:163], v[96:99]
    v_mfma_f32_16x16x32_bf16 v[112:115], v[252:255], v[160:163], v[112:115]
    s_waitcnt lgkmcnt(1)
    v_mfma_f32_16x16x32_bf16 v[100:103], v[248:251], v[164:167], v[100:103]
    v_mfma_f32_16x16x32_bf16 v[116:119], v[252:255], v[164:167], v[116:119]
    s_waitcnt lgkmcnt(0)
    v_mfma_f32_16x16x32_bf16 v[104:107], v[248:251], v[168:171], v[104:107]
    v_mfma_f32_16x16x32_bf16 v[120:123], v[252:255], v[168:171], v[120:123]
    s_barrier
    v_mov_b32 v124, v189
    s_mul_i32 s57, s22, 12288
    s_add_u32 s56, s29, 0x5d5000
    s_add_u32 s56, s56, s57
    s_add_u32 m0, s57, 0x8000
    s_nop 0
    buffer_load_dwordx4 v1, s[4:7], s56 offen offset:0 lds
    v_pk_fma_f32 v[92:93], v[132:133], v[52:53], v[92:93] op_sel_hi:[1,0,1]
    v_pk_fma_f32 v[94:95], v[134:135], v[52:53], v[94:95] op_sel_hi:[1,0,1]
    v_pk_mul_f32 v[92:93], v[92:93], v[52:53] op_sel:[0,1]
    v_pk_mul_f32 v[94:95], v[94:95], v[52:53] op_sel:[0,1]
    v_pk_mul_f32 v[140:141], v[92:93], v[92:93]
    v_pk_mul_f32 v[142:143], v[94:95], v[94:95]
    v_pk_fma_f32 v[140:141], v[140:141], s[52:53], s[52:53] op_sel:[0,0,1] op_sel_hi:[1,0,1]
    v_pk_fma_f32 v[142:143], v[142:143], s[52:53], s[52:53] op_sel:[0,0,1] op_sel_hi:[1,0,1]
    v_pk_mul_f32 v[140:141], v[140:141], v[92:93]
    v_pk_mul_f32 v[142:143], v[142:143], v[94:95]
    v_exp_f32 v140, v140
    s_add_u32 m0, s57, 0x8000
    s_nop 0
    buffer_load_dwordx4 v1, s[4:7], s56 offen offset:1024 lds
    v_exp_f32 v141, v141
    v_exp_f32 v142, v142
    v_exp_f32 v143, v143
    v_pk_add_f32 v[140:141], v[140:141], 1.0 op_sel_hi:[1,0]
    v_pk_add_f32 v[142:143], v[142:143], 1.0 op_sel_hi:[1,0]
    v_rcp_f32 v140, v140
    v_rcp_f32 v141, v141
    v_rcp_f32 v142, v142
    s_add_u32 m0, s57, 0x8000
    s_nop 0
    buffer_load_dwordx4 v1, s[4:7], s56 offen offset:2048 lds
    v_rcp_f32 v143, v143
    v_pk_mul_f32 v[92:93], v[92:93], v[140:141]
    v_pk_mul_f32 v[94:95], v[94:95], v[142:143]
    v_cvt_pk_bf16_f32 v44, v92, v93
    v_cvt_pk_bf16_f32 v45, v94, v95
    v_pk_fma_f32 v[108:109], v[136:137], v[52:53], v[108:109] op_sel_hi:[1,0,1]
    v_pk_fma_f32 v[110:111], v[138:139], v[52:53], v[110:111] op_sel_hi:[1,0,1]
    v_pk_mul_f32 v[108:109], v[108:109], v[52:53] op_sel:[0,1]
    v_pk_mul_f32 v[110:111], v[110:111], v[52:53] op_sel:[0,1]
    v_pk_mul_f32 v[144:145], v[108:109], v[108:109]
    v_pk_mul_f32 v[146:147], v[110:111], v[110:111]
    v_pk_fma_f32 v[144:145], v[144:145], s[52:53], s[52:53] op_sel:[0,0,1] op_sel_hi:[1,0,1]
    s_add_u32 m0, s57, 0x8000
    s_nop 0
    buffer_load_dwordx4 v1, s[4:7], s56 offen offset:3072 lds
    v_pk_fma_f32 v[146:147], v[146:147], s[52:53], s[52:53] op_sel:[0,0,1] op_sel_hi:[1,0,1]
    v_pk_mul_f32 v[144:145], v[144:145], v[108:109]
    v_pk_mul_f32 v[146:147], v[146:147], v[110:111]
    v_exp_f32 v144, v144
    v_exp_f32 v145, v145
    v_exp_f32 v146, v146
    v_exp_f32 v147, v147
    v_pk_add_f32 v[144:145], v[144:145], 1.0 op_sel_hi:[1,0]
    v_pk_add_f32 v[146:147], v[146:147], 1.0 op_sel_hi:[1,0]
    s_add_u32 s56, s29, 0x5d6000
    s_add_u32 s56, s56, s57
    s_add_u32 m0, s57, 0x9000
    s_nop 0
    buffer_load_dwordx4 v1, s[4:7], s56 offen offset:0 lds
    v_rcp_f32 v144, v144
    v_rcp_f32 v145, v145
    v_rcp_f32 v146, v146
    v_rcp_f32 v147, v147
    v_pk_mul_f32 v[108:109], v[108:109], v[144:145]
    v_pk_mul_f32 v[110:111], v[110:111], v[146:147]
    v_cvt_pk_bf16_f32 v46, v108, v109
    v_cvt_pk_bf16_f32 v47, v110, v111
    ds_write_b128 v124, v[44:47] offset:0
    s_add_u32 m0, s57, 0x9000
    s_nop 0
    buffer_load_dwordx4 v1, s[4:7], s56 offen offset:1024 lds
    v_pk_fma_f32 v[96:97], v[132:133], v[54:55], v[96:97] op_sel_hi:[1,0,1]
    v_pk_fma_f32 v[98:99], v[134:135], v[54:55], v[98:99] op_sel_hi:[1,0,1]
    v_pk_mul_f32 v[96:97], v[96:97], v[54:55] op_sel:[0,1]
    v_pk_mul_f32 v[98:99], v[98:99], v[54:55] op_sel:[0,1]
    v_pk_mul_f32 v[140:141], v[96:97], v[96:97]
    v_pk_mul_f32 v[142:143], v[98:99], v[98:99]
    v_pk_fma_f32 v[140:141], v[140:141], s[52:53], s[52:53] op_sel:[0,0,1] op_sel_hi:[1,0,1]
    v_pk_fma_f32 v[142:143], v[142:143], s[52:53], s[52:53] op_sel:[0,0,1] op_sel_hi:[1,0,1]
    v_pk_mul_f32 v[140:141], v[140:141], v[96:97]
    v_pk_mul_f32 v[142:143], v[142:143], v[98:99]
    v_exp_f32 v140, v140
    s_add_u32 m0, s57, 0x9000
    s_nop 0
    buffer_load_dwordx4 v1, s[4:7], s56 offen offset:2048 lds
    v_exp_f32 v141, v141
    v_exp_f32 v142, v142
    v_exp_f32 v143, v143
    v_pk_add_f32 v[140:141], v[140:141], 1.0 op_sel_hi:[1,0]
    v_pk_add_f32 v[142:143], v[142:143], 1.0 op_sel_hi:[1,0]
    v_rcp_f32 v140, v140
    v_rcp_f32 v141, v141
    v_rcp_f32 v142, v142
    s_add_u32 m0, s57, 0x9000
    s_nop 0
    buffer_load_dwordx4 v1, s[4:7], s56 offen offset:3072 lds
    v_rcp_f32 v143, v143
    v_pk_mul_f32 v[96:97], v[96:97], v[140:141]
    v_pk_mul_f32 v[98:99], v[98:99], v[142:143]
    v_cvt_pk_bf16_f32 v48, v96, v97
    v_cvt_pk_bf16_f32 v49, v98, v99
    v_pk_fma_f32 v[112:113], v[136:137], v[54:55], v[112:113] op_sel_hi:[1,0,1]
    v_pk_fma_f32 v[114:115], v[138:139], v[54:55], v[114:115] op_sel_hi:[1,0,1]
    v_pk_mul_f32 v[112:113], v[112:113], v[54:55] op_sel:[0,1]
    v_pk_mul_f32 v[114:115], v[114:115], v[54:55] op_sel:[0,1]
    v_pk_mul_f32 v[144:145], v[112:113], v[112:113]
    v_pk_mul_f32 v[146:147], v[114:115], v[114:115]
    v_pk_fma_f32 v[144:145], v[144:145], s[52:53], s[52:53] op_sel:[0,0,1] op_sel_hi:[1,0,1]
    s_add_u32 s56, s29, 0x5d7000
    s_add_u32 s56, s56, s57
    s_add_u32 m0, s57, 0xa000
    s_nop 0
    buffer_load_dwordx4 v1, s[4:7], s56 offen offset:0 lds
    v_pk_fma_f32 v[146:147], v[146:147], s[52:53], s[52:53] op_sel:[0,0,1] op_sel_hi:[1,0,1]
    v_pk_mul_f32 v[144:145], v[144:145], v[112:113]
    v_pk_mul_f32 v[146:147], v[146:147], v[114:115]
    v_exp_f32 v144, v144
    v_exp_f32 v145, v145
    v_exp_f32 v146, v146
    v_exp_f32 v147, v147
    v_pk_add_f32 v[144:145], v[144:145], 1.0 op_sel_hi:[1,0]
    v_pk_add_f32 v[146:147], v[146:147], 1.0 op_sel_hi:[1,0]
    s_add_u32 m0, s57, 0xa000
    s_nop 0
    buffer_load_dwordx4 v1, s[4:7], s56 offen offset:1024 lds
    v_rcp_f32 v144, v144
    v_rcp_f32 v145, v145
    v_rcp_f32 v146, v146
    v_rcp_f32 v147, v147
    v_pk_mul_f32 v[112:113], v[112:113], v[144:145]
    v_pk_mul_f32 v[114:115], v[114:115], v[146:147]
    v_cvt_pk_bf16_f32 v50, v112, v113
    v_cvt_pk_bf16_f32 v51, v114, v115
    ds_write_b128 v124, v[48:51] offset:1024
    s_add_u32 m0, s57, 0xa000
    s_nop 0
    buffer_load_dwordx4 v1, s[4:7], s56 offen offset:2048 lds
    v_pk_fma_f32 v[100:101], v[132:133], v[56:57], v[100:101] op_sel_hi:[1,0,1]
    v_pk_fma_f32 v[102:103], v[134:135], v[56:57], v[102:103] op_sel_hi:[1,0,1]
    v_pk_mul_f32 v[100:101], v[100:101], v[56:57] op_sel:[0,1]
    v_pk_mul_f32 v[102:103], v[102:103], v[56:57] op_sel:[0,1]
    v_pk_mul_f32 v[140:141], v[100:101], v[100:101]
    v_pk_mul_f32 v[142:143], v[102:103], v[102:103]
    v_pk_fma_f32 v[140:141], v[140:141], s[52:53], s[52:53] op_sel:[0,0,1] op_sel_hi:[1,0,1]
    v_pk_fma_f32 v[142:143], v[142:143], s[52:53], s[52:53] op_sel:[0,0,1] op_sel_hi:[1,0,1]
    v_pk_mul_f32 v[140:141], v[140:141], v[100:101]
    v_pk_mul_f32 v[142:143], v[142:143], v[102:103]
    v_exp_f32 v140, v140
    s_add_u32 m0, s57, 0xa000
    s_nop 0
    buffer_load_dwordx4 v1, s[4:7], s56 offen offset:3072 lds
    v_exp_f32 v141, v141
    v_exp_f32 v142, v142
    v_exp_f32 v143, v143
    v_pk_add_f32 v[140:141], v[140:141], 1.0 op_sel_hi:[1,0]
    v_pk_add_f32 v[142:143], v[142:143], 1.0 op_sel_hi:[1,0]
    v_rcp_f32 v140, v140
    v_rcp_f32 v141, v141
    v_rcp_f32 v142, v142
    v_rcp_f32 v143, v143
    v_pk_mul_f32 v[100:101], v[100:101], v[140:141]
    v_pk_mul_f32 v[102:103], v[102:103], v[142:143]
    v_cvt_pk_bf16_f32 v52, v100, v101
    v_cvt_pk_bf16_f32 v53, v102, v103
    v_lshrrev_b32 v42, 2, v7
    v_and_b32 v43, 3, v0
    v_lshlrev_b32 v42, 12, v42
    v_lshl_add_u32 v42, v43, 10, v42
    s_lshl_b32 s48, s22, 15
    s_lshl_b32 s49, s21, 7
    s_add_u32 s48, s48, s49
    s_add_u32 s48, s48, 0x702000
    v_add_u32 v42, s48, v42
    buffer_load_dwordx2 v[40:41], v42, s[4:7], 0 offen sc1
    s_mov_b32 s51, 0x20000
    s_waitcnt vmcnt(0)
    v_cmp_gt_u64 vcc, s[58:59], v[40:41]
    v_cmp_lt_u64 s[48:49], s[60:61], v[40:41]
    s_nop 0
    s_or_b64 vcc, vcc, s[48:49]
    s_cbranch_scc0 POLLD_29
    s_nop 1
POLL_28:
    buffer_load_dwordx2 v[40:41], v42, s[4:7], 0 offen sc1
    s_sub_u32 s51, s51, 1
    s_cbranch_scc1 POLLD_29X
    s_waitcnt vmcnt(0)
    v_cmp_gt_u64 vcc, s[58:59], v[40:41]
    v_cmp_lt_u64 s[48:49], s[60:61], v[40:41]
    s_nop 0
    s_or_b64 vcc, vcc, s[48:49]
    s_cbranch_scc1 POLL_28
POLLD_29X:
    s_waitcnt vmcnt(0)
POLLD_29:
    s_xor_b32 s48, s38, 0x0
    s_add_u32 s48, s48, 0x1980000
    buffer_load_dwordx4 v[148:151], v1, s[4:7], s48 offen offset:0 sc1
    buffer_load_dwordx4 v[152:155], v1, s[4:7], s48 offen offset:1024 sc1
    buffer_load_dwordx4 v[156:159], v1, s[4:7], s48 offen offset:2048 sc1
    buffer_load_dwordx4 v[160:163], v1, s[4:7], s48 offen offset:3072 sc1
    s_xor_b32 s48, s38, 0x1000
    s_add_u32 s48, s48, 0x1980000
    buffer_load_dwordx4 v[164:167], v1, s[4:7], s48 offen offset:0 sc1
    buffer_load_dwordx4 v[168:171], v1, s[4:7], s48 offen offset:1024 sc1
    v_pk_fma_f32 v[116:117], v[136:137], v[56:57], v[116:117] op_sel_hi:[1,0,1]
    v_pk_fma_f32 v[118:119], v[138:139], v[56:57], v[118:119] op_sel_hi:[1,0,1]
    v_pk_mul_f32 v[116:117], v[116:117], v[56:57] op_sel:[0,1]
    v_pk_mul_f32 v[118:119], v[118:119], v[56:57] op_sel:[0,1]
    v_pk_mul_f32 v[144:145], v[116:117], v[116:117]
    buffer_load_dwordx4 v[172:175], v1, s[4:7], s48 offen offset:2048 sc1
    v_pk_mul_f32 v[146:147], v[118:119], v[118:119]
    v_pk_fma_f32 v[144:145], v[144:145], s[52:53], s[52:53] op_sel:[0,0,1] op_sel_hi:[1,0,1]
    v_pk_fma_f32 v[146:147], v[146:147], s[52:53], s[52:53] op_sel:[0,0,1] op_sel_hi:[1,0,1]
    v_pk_mul_f32 v[144:145], v[144:145], v[116:117]
    v_pk_mul_f32 v[146:147], v[146:147], v[118:119]
    buffer_load_dwordx4 v[176:179], v1, s[4:7], s48 offen offset:3072 sc1
    v_exp_f32 v144, v144
    v_exp_f32 v145, v145
    v_exp_f32 v146, v146
    v_exp_f32 v147, v147
    v_pk_add_f32 v[144:145], v[144:145], 1.0 op_sel_hi:[1,0]
    s_xor_b32 s48, s38, 0x2000
    s_add_u32 s48, s48, 0x1980000
    buffer_load_dwordx4 v[180:183], v1, s[4:7], s48 offen offset:0 sc1
    v_pk_add_f32 v[146:147], v[146:147], 1.0 op_sel_hi:[1,0]
    v_rcp_f32 v144, v144
    v_rcp_f32 v145, v145
    v_rcp_f32 v146, v146
    v_rcp_f32 v147, v147
    buffer_load_dwordx4 v[184:187], v1, s[4:7], s48 offen offset:1024 sc1
    v_pk_mul_f32 v[116:117], v[116:117], v[144:145]
    v_pk_mul_f32 v[118:119], v[118:119], v[146:147]
    v_cvt_pk_bf16_f32 v54, v116, v117
    v_cvt_pk_bf16_f32 v55, v118, v119
    ds_write_b128 v124, v[52:55] offset:2048
    buffer_load_dwordx4 v[188:191], v1, s[4:7], s48 offen offset:2048 sc1
    v_pk_fma_f32 v[104:105], v[132:133], v[58:59], v[104:105] op_sel_hi:[1,0,1]
    v_pk_fma_f32 v[106:107], v[134:135], v[58:59], v[106:107] op_sel_hi:[1,0,1]
    v_pk_mul_f32 v[104:105], v[104:105], v[58:59] op_sel:[0,1]
    v_pk_mul_f32 v[106:107], v[106:107], v[58:59] op_sel:[0,1]
    v_pk_mul_f32 v[140:141], v[104:105], v[104:105]
    buffer_load_dwordx4 v[192:195], v1, s[4:7], s48 offen offset:3072 sc1
    v_pk_mul_f32 v[142:143], v[106:107], v[106:107]
    v_pk_fma_f32 v[140:141], v[140:141], s[52:53], s[52:53] op_sel:[0,0,1] op_sel_hi:[1,0,1]
    v_pk_fma_f32 v[142:143], v[142:143], s[52:53], s[52:53] op_sel:[0,0,1] op_sel_hi:[1,0,1]
    v_pk_mul_f32 v[140:141], v[140:141], v[104:105]
    v_pk_mul_f32 v[142:143], v[142:143], v[106:107]
    s_xor_b32 s48, s38, 0x3000
    s_add_u32 s48, s48, 0x1980000
    buffer_load_dwordx4 v[196:199], v1, s[4:7], s48 offen offset:0 sc1
    v_exp_f32 v140, v140
    v_exp_f32 v141, v141
    v_exp_f32 v142, v142
    v_exp_f32 v143, v143
    v_pk_add_f32 v[140:141], v[140:141], 1.0 op_sel_hi:[1,0]
    buffer_load_dwordx4 v[200:203], v1, s[4:7], s48 offen offset:1024 sc1
    v_pk_add_f32 v[142:143], v[142:143], 1.0 op_sel_hi:[1,0]
    v_rcp_f32 v140, v140
    v_rcp_f32 v141, v141
    v_rcp_f32 v142, v142
    v_rcp_f32 v143, v143
    buffer_load_dwordx4 v[204:207], v1, s[4:7], s48 offen offset:2048 sc1
    v_pk_mul_f32 v[104:105], v[104:105], v[140:141]
    v_pk_mul_f32 v[106:107], v[106:107], v[142:143]
    v_cvt_pk_bf16_f32 v56, v104, v105
    v_cvt_pk_bf16_f32 v57, v106, v107
    v_pk_fma_f32 v[120:121], v[136:137], v[58:59], v[120:121] op_sel_hi:[1,0,1]
    buffer_load_dwordx4 v[208:211], v1, s[4:7], s48 offen offset:3072 sc1
    v_pk_fma_f32 v[122:123], v[138:139], v[58:59], v[122:123] op_sel_hi:[1,0,1]
    v_pk_mul_f32 v[120:121], v[120:121], v[58:59] op_sel:[0,1]
    v_pk_mul_f32 v[122:123], v[122:123], v[58:59] op_sel:[0,1]
    v_pk_mul_f32 v[144:145], v[120:121], v[120:121]
    v_pk_mul_f32 v[146:147], v[122:123], v[122:123]
    s_xor_b32 s48, s38, 0x0
    s_add_u32 s48, s48, 0x1990000
    buffer_load_dwordx4 v[212:215], v1, s[4:7], s48 offen offset:0 sc1
    v_pk_fma_f32 v[144:145], v[144:145], s[52:53], s[52:53] op_sel:[0,0,1] op_sel_hi:[1,0,1]
    v_pk_fma_f32 v[146:147], v[146:147], s[52:53], s[52:53] op_sel:[0,0,1] op_sel_hi:[1,0,1]
    v_pk_mul_f32 v[144:145], v[144:145], v[120:121]
    v_pk_mul_f32 v[146:147], v[146:147], v[122:123]
    v_exp_f32 v144, v144
    buffer_load_dwordx4 v[216:219], v1, s[4:7], s48 offen offset:1024 sc1
    v_exp_f32 v145, v145
    v_exp_f32 v146, v146
    v_exp_f32 v147, v147
    v_pk_add_f32 v[144:145], v[144:145], 1.0 op_sel_hi:[1,0]
    v_pk_add_f32 v[146:147], v[146:147], 1.0 op_sel_hi:[1,0]
    buffer_load_dwordx4 v[220:223], v1, s[4:7], s48 offen offset:2048 sc1
    v_rcp_f32 v144, v144
    v_rcp_f32 v145, v145
    v_rcp_f32 v146, v146
    v_rcp_f32 v147, v147
    v_pk_mul_f32 v[120:121], v[120:121], v[144:145]
    buffer_load_dwordx4 v[224:227], v1, s[4:7], s48 offen offset:3072 sc1
    v_pk_mul_f32 v[122:123], v[122:123], v[146:147]
    v_cvt_pk_bf16_f32 v58, v120, v121
    v_cvt_pk_bf16_f32 v59, v122, v123
    ds_write_b128 v124, v[56:59] offset:3072
    s_lshl_b32 s54, s22, 12
    v_add_u32 v97, s54, v1
    s_lshl_b32 s54, s22, 10
    v_add_u32 v42, s54, v1
    v_add_u32 v43, 138240, v42
    s_add_u32 s52, s39, 0x2060000
    s_add_u32 s53, s40, 0x2060000
    s_add_u32 s55, s52, 2048
    s_cmp_eq_u32 s21, 7
    s_cselect_b32 s55, 0x7f000000, s55
    s_lshl_b32 s14, s22, 12
    s_add_u32 s15, s29, s14
    s_waitcnt vmcnt(19)
    v_mfma_f32_16x16x32_bf16 v[44:47], v[148:151], a[0:3], 0
    v_mfma_f32_16x16x32_bf16 v[48:51], v[148:151], a[4:7], 0
    v_mfma_f32_16x16x32_bf16 v[52:55], v[148:151], a[8:11], 0
    v_mfma_f32_16x16x32_bf16 v[56:59], v[148:151], a[12:15], 0
    s_xor_b32 s48, s38, 0x1000
    s_add_u32 s48, s48, 0x1990000
    buffer_load_dwordx4 v[228:231], v1, s[4:7], s48 offen offset:0 sc1
    s_waitcnt vmcnt(19)
    v_mfma_f32_16x16x32_bf16 v[44:47], v[152:155], a[16:19], v[44:47]
    v_mfma_f32_16x16x32_bf16 v[48:51], v[152:155], a[20:23], v[48:51]
    v_mfma_f32_16x16x32_bf16 v[52:55], v[152:155], a[24:27], v[52:55]
    v_mfma_f32_16x16x32_bf16 v[56:59], v[152:155], a[28:31], v[56:59]
    buffer_load_dwordx4 v[232:235], v1, s[4:7], s48 offen offset:1024 sc1
    s_waitcnt vmcnt(19)
    v_mfma_f32_16x16x32_bf16 v[44:47], v[156:159], a[32:35], v[44:47]
    v_mfma_f32_16x16x32_bf16 v[48:51], v[156:159], a[36:39], v[48:51]
    v_mfma_f32_16x16x32_bf16 v[52:55], v[156:159], a[40:43], v[52:55]
    v_mfma_f32_16x16x32_bf16 v[56:59], v[156:159], a[44:47], v[56:59]
    buffer_load_dwordx4 v[236:239], v1, s[4:7], s48 offen offset:2048 sc1
    s_waitcnt vmcnt(19)
    v_mfma_f32_16x16x32_bf16 v[44:47], v[160:163], a[48:51], v[44:47]
    v_mfma_f32_16x16x32_bf16 v[48:51], v[160:163], a[52:55], v[48:51]
    v_mfma_f32_16x16x32_bf16 v[52:55], v[160:163], a[56:59], v[52:55]
    v_mfma_f32_16x16x32_bf16 v[56:59], v[160:163], a[60:63], v[56:59]
    buffer_load_dwordx4 v[240:243], v1, s[4:7], s48 offen offset:3072 sc1
    s_waitcnt vmcnt(19)
    v_mfma_f32_16x16x32_bf16 v[44:47], v[164:167], a[64:67], v[44:47]
    v_mfma_f32_16x16x32_bf16 v[48:51], v[164:167], a[68:71], v[48:51]
    v_mfma_f32_16x16x32_bf16 v[52:55], v[164:167], a[72:75], v[52:55]
    v_mfma_f32_16x16x32_bf16 v[56:59], v[164:167], a[76:79], v[56:59]
    s_xor_b32 s48, s38, 0x2000
    s_add_u32 s48, s48, 0x1990000
    buffer_load_dwordx4 v[244:247], v1, s[4:7], s48 offen offset:0 sc1
    s_waitcnt vmcnt(19)
    v_mfma_f32_16x16x32_bf16 v[44:47], v[168:171], a[80:83], v[44:47]
    v_mfma_f32_16x16x32_bf16 v[48:51], v[168:171], a[84:87], v[48:51]
    v_mfma_f32_16x16x32_bf16 v[52:55], v[168:171], a[88:91], v[52:55]
    v_mfma_f32_16x16x32_bf16 v[56:59], v[168:171], a[92:95], v[56:59]
    buffer_load_dwordx4 v[248:251], v1, s[4:7], s48 offen offset:1024 sc1
    s_waitcnt vmcnt(19)
    v_mfma_f32_16x16x32_bf16 v[44:47], v[172:175], a[96:99], v[44:47]
    v_mfma_f32_16x16x32_bf16 v[48:51], v[172:175], a[100:103], v[48:51]
    v_mfma_f32_16x16x32_bf16 v[52:55], v[172:175], a[104:107], v[52:55]
    v_mfma_f32_16x16x32_bf16 v[56:59], v[172:175], a[108:111], v[56:59]
    buffer_load_dwordx4 v[252:255], v1, s[4:7], s48 offen offset:2048 sc1
    s_waitcnt vmcnt(19)
    v_mfma_f32_16x16x32_bf16 v[44:47], v[176:179], a[112:115], v[44:47]
    v_mfma_f32_16x16x32_bf16 v[48:51], v[176:179], a[116:119], v[48:51]
    v_mfma_f32_16x16x32_bf16 v[52:55], v[176:179], a[120:123], v[52:55]
    v_mfma_f32_16x16x32_bf16 v[56:59], v[176:179], a[124:127], v[56:59]
    buffer_load_dwordx4 v[112:115], v1, s[4:7], s48 offen offset:3072 sc1
    s_waitcnt vmcnt(19)
    v_mfma_f32_16x16x32_bf16 v[44:47], v[180:183], a[128:131], v[44:47]
    v_mfma_f32_16x16x32_bf16 v[48:51], v[180:183], a[132:135], v[48:51]
    v_mfma_f32_16x16x32_bf16 v[52:55], v[180:183], a[136:139], v[52:55]
    v_mfma_f32_16x16x32_bf16 v[56:59], v[180:183], a[140:143], v[56:59]
    s_xor_b32 s48, s38, 0x3000
    s_add_u32 s48, s48, 0x1990000
    buffer_load_dwordx4 v[116:119], v1, s[4:7], s48 offen offset:0 sc1
    s_waitcnt vmcnt(19)
    v_mfma_f32_16x16x32_bf16 v[44:47], v[184:187], a[144:147], v[44:47]
    v_mfma_f32_16x16x32_bf16 v[48:51], v[184:187], a[148:151], v[48:51]
    v_mfma_f32_16x16x32_bf16 v[52:55], v[184:187], a[152:155], v[52:55]
    v_mfma_f32_16x16x32_bf16 v[56:59], v[184:187], a[156:159], v[56:59]
    buffer_load_dwordx4 v[120:123], v1, s[4:7], s48 offen offset:1024 sc1
    s_waitcnt vmcnt(19)
    v_mfma_f32_16x16x32_bf16 v[44:47], v[188:191], a[160:163], v[44:47]
    v_mfma_f32_16x16x32_bf16 v[48:51], v[188:191], a[164:167], v[48:51]
    v_mfma_f32_16x16x32_bf16 v[52:55], v[188:191], a[168:171], v[52:55]
    v_mfma_f32_16x16x32_bf16 v[56:59], v[188:191], a[172:175], v[56:59]
    buffer_load_dwordx4 v[124:127], v1, s[4:7], s48 offen offset:2048 sc1
    s_waitcnt vmcnt(19)
    v_mfma_f32_16x16x32_bf16 v[44:47], v[192:195], a[176:179], v[44:47]
    v_mfma_f32_16x16x32_bf16 v[48:51], v[192:195], a[180:183], v[48:51]
    v_mfma_f32_16x16x32_bf16 v[52:55], v[192:195], a[184:187], v[52:55]
    v_mfma_f32_16x16x32_bf16 v[56:59], v[192:195], a[188:191], v[56:59]
    buffer_load_dwordx4 v[128:131], v1, s[4:7], s48 offen offset:3072 sc1
    s_waitcnt vmcnt(19)
    v_mfma_f32_16x16x32_bf16 v[44:47], v[196:199], a[192:195], v[44:47]
    v_mfma_f32_16x16x32_bf16 v[48:51], v[196:199], a[196:199], v[48:51]
    v_mfma_f32_16x16x32_bf16 v[52:55], v[196:199], a[200:203], v[52:55]
    v_mfma_f32_16x16x32_bf16 v[56:59], v[196:199], a[204:207], v[56:59]
    s_xor_b32 s48, s38, 0x0
    s_add_u32 s48, s48, 0x19a0000
    buffer_load_dwordx4 v[132:135], v1, s[4:7], s48 offen offset:0 sc1
    s_waitcnt vmcnt(19)
    v_mfma_f32_16x16x32_bf16 v[44:47], v[200:203], a[208:211], v[44:47]
    v_mfma_f32_16x16x32_bf16 v[48:51], v[200:203], a[212:215], v[48:51]
    v_mfma_f32_16x16x32_bf16 v[52:55], v[200:203], a[216:219], v[52:55]
    v_mfma_f32_16x16x32_bf16 v[56:59], v[200:203], a[220:223], v[56:59]
    buffer_load_dwordx4 v[136:139], v1, s[4:7], s48 offen offset:1024 sc1
    s_waitcnt vmcnt(19)
    v_mfma_f32_16x16x32_bf16 v[44:47], v[204:207], a[224:227], v[44:47]
    v_mfma_f32_16x16x32_bf16 v[48:51], v[204:207], a[228:231], v[48:51]
    v_mfma_f32_16x16x32_bf16 v[52:55], v[204:207], a[232:235], v[52:55]
    v_mfma_f32_16x16x32_bf16 v[56:59], v[204:207], a[236:239], v[56:59]
    buffer_load_dwordx4 v[140:143], v1, s[4:7], s48 offen offset:2048 sc1
    s_waitcnt vmcnt(19)
    v_mfma_f32_16x16x32_bf16 v[44:47], v[208:211], a[240:243], v[44:47]
    v_mfma_f32_16x16x32_bf16 v[48:51], v[208:211], a[244:247], v[48:51]
    v_mfma_f32_16x16x32_bf16 v[52:55], v[208:211], a[248:251], v[52:55]
    v_mfma_f32_16x16x32_bf16 v[56:59], v[208:211], a[252:255], v[56:59]
    buffer_load_dwordx4 v[144:147], v1, s[4:7], s48 offen offset:3072 sc1
    s_waitcnt vmcnt(19)
    v_mfma_f32_16x16x32_bf16 v[60:63], v[212:215], a[0:3], 0
    v_mfma_f32_16x16x32_bf16 v[64:67], v[212:215], a[4:7], 0
    v_mfma_f32_16x16x32_bf16 v[68:71], v[212:215], a[8:11], 0
    v_mfma_f32_16x16x32_bf16 v[72:75], v[212:215], a[12:15], 0
    s_xor_b32 s48, s38, 0x1000
    s_add_u32 s48, s48, 0x19a0000
    buffer_load_dwordx4 v[148:151], v1, s[4:7], s48 offen offset:0 sc1
    s_waitcnt vmcnt(19)
    v_mfma_f32_16x16x32_bf16 v[60:63], v[216:219], a[16:19], v[60:63]
    v_mfma_f32_16x16x32_bf16 v[64:67], v[216:219], a[20:23], v[64:67]
    ds_write_b128 v97, v[44:47] offset:0
    v_mfma_f32_16x16x32_bf16 v[68:71], v[216:219], a[24:27], v[68:71]
    v_mfma_f32_16x16x32_bf16 v[72:75], v[216:219], a[28:31], v[72:75]
    buffer_load_dwordx4 v[152:155], v1, s[4:7], s48 offen offset:1024 sc1
    s_waitcnt vmcnt(19)
    v_mfma_f32_16x16x32_bf16 v[60:63], v[220:223], a[32:35], v[60:63]
    v_mfma_f32_16x16x32_bf16 v[64:67], v[220:223], a[36:39], v[64:67]
    ds_write_b128 v97, v[48:51] offset:1024
    v_mfma_f32_16x16x32_bf16 v[68:71], v[220:223], a[40:43], v[68:71]
    v_mfma_f32_16x16x32_bf16 v[72:75], v[220:223], a[44:47], v[72:75]
    buffer_load_dwordx4 v[156:159], v1, s[4:7], s48 offen offset:2048 sc1
    s_waitcnt vmcnt(19)
    v_mfma_f32_16x16x32_bf16 v[60:63], v[224:227], a[48:51], v[60:63]
    v_mfma_f32_16x16x32_bf16 v[64:67], v[224:227], a[52:55], v[64:67]
    ds_write_b128 v97, v[52:55] offset:2048
    v_mfma_f32_16x16x32_bf16 v[68:71], v[224:227], a[56:59], v[68:71]
    v_mfma_f32_16x16x32_bf16 v[72:75], v[224:227], a[60:63], v[72:75]
    buffer_load_dwordx4 v[160:163], v1, s[4:7], s48 offen offset:3072 sc1
    s_waitcnt vmcnt(19)
    v_mfma_f32_16x16x32_bf16 v[60:63], v[228:231], a[64:67], v[60:63]
    v_mfma_f32_16x16x32_bf16 v[64:67], v[228:231], a[68:71], v[64:67]
    ds_write_b128 v97, v[56:59] offset:3072
    v_mfma_f32_16x16x32_bf16 v[68:71], v[228:231], a[72:75], v[68:71]
    v_mfma_f32_16x16x32_bf16 v[72:75], v[228:231], a[76:79], v[72:75]
    s_xor_b32 s48, s38, 0x2000
    s_add_u32 s48, s48, 0x19a0000
    buffer_load_dwordx4 v[164:167], v1, s[4:7], s48 offen offset:0 sc1
    s_waitcnt vmcnt(19)
    v_mfma_f32_16x16x32_bf16 v[60:63], v[232:235], a[80:83], v[60:63]
    v_mfma_f32_16x16x32_bf16 v[64:67], v[232:235], a[84:87], v[64:67]
    v_mfma_f32_16x16x32_bf16 v[68:71], v[232:235], a[88:91], v[68:71]
    v_mfma_f32_16x16x32_bf16 v[72:75], v[232:235], a[92:95], v[72:75]
    buffer_load_dwordx4 v[168:171], v1, s[4:7], s48 offen offset:1024 sc1
    s_waitcnt lgkmcnt(0)
    s_barrier
    s_waitcnt vmcnt(19)
    v_mfma_f32_16x16x32_bf16 v[60:63], v[236:239], a[96:99], v[60:63]
    ds_read_b128 v[92:95], v43 offset:0
    ds_read_b128 v[76:79], v42 offset:0
    v_mfma_f32_16x16x32_bf16 v[64:67], v[236:239], a[100:103], v[64:67]
    ds_read_b128 v[80:83], v42 offset:4096
    v_mfma_f32_16x16x32_bf16 v[68:71], v[236:239], a[104:107], v[68:71]
    ds_read_b128 v[84:87], v42 offset:8192
    ds_read_b128 v[88:91], v42 offset:12288
    v_mfma_f32_16x16x32_bf16 v[72:75], v[236:239], a[108:111], v[72:75]
    buffer_load_dwordx4 v[172:175], v1, s[4:7], s48 offen offset:2048 sc1
    s_waitcnt vmcnt(19)
    v_mfma_f32_16x16x32_bf16 v[60:63], v[240:243], a[112:115], v[60:63]
    v_mfma_f32_16x16x32_bf16 v[64:67], v[240:243], a[116:119], v[64:67]
    v_mfma_f32_16x16x32_bf16 v[68:71], v[240:243], a[120:123], v[68:71]
    v_mfma_f32_16x16x32_bf16 v[72:75], v[240:243], a[124:127], v[72:75]
    buffer_load_dwordx4 v[176:179], v1, s[4:7], s48 offen offset:3072 sc1
    s_waitcnt vmcnt(19)
    v_mfma_f32_16x16x32_bf16 v[60:63], v[244:247], a[128:131], v[60:63]
    v_mfma_f32_16x16x32_bf16 v[64:67], v[244:247], a[132:135], v[64:67]
    v_mfma_f32_16x16x32_bf16 v[68:71], v[244:247], a[136:139], v[68:71]
    v_mfma_f32_16x16x32_bf16 v[72:75], v[244:247], a[140:143], v[72:75]
    s_xor_b32 s48, s38, 0x3000
    s_add_u32 s48, s48, 0x19a0000
    buffer_load_dwordx4 v[180:183], v1, s[4:7], s48 offen offset:0 sc1
    s_waitcnt vmcnt(19)
    v_mfma_f32_16x16x32_bf16 v[60:63], v[248:251], a[144:147], v[60:63]
    s_waitcnt lgkmcnt(4)
    v_lshlrev_b32 v100, 16, v92
    v_and_b32 v101, 0xffff0000, v92
    v_mfma_f32_16x16x32_bf16 v[64:67], v[248:251], a[148:151], v[64:67]
    v_lshlrev_b32 v102, 16, v93
    v_mfma_f32_16x16x32_bf16 v[68:71], v[248:251], a[152:155], v[68:71]
    v_and_b32 v103, 0xffff0000, v93
    s_waitcnt lgkmcnt(3)
    v_add_f32 v76, v76, v24
    v_mfma_f32_16x16x32_bf16 v[72:75], v[248:251], a[156:159], v[72:75]
    buffer_load_dwordx4 v[184:187], v1, s[4:7], s48 offen offset:1024 sc1
    s_waitcnt vmcnt(19)
    v_mfma_f32_16x16x32_bf16 v[60:63], v[252:255], a[160:163], v[60:63]
    v_add_f32 v77, v77, v24
    v_add_f32 v78, v78, v24
    v_mfma_f32_16x16x32_bf16 v[64:67], v[252:255], a[164:167], v[64:67]
    v_add_f32 v79, v79, v24
    v_mfma_f32_16x16x32_bf16 v[68:71], v[252:255], a[168:171], v[68:71]
    s_waitcnt lgkmcnt(2)
    v_add_f32 v76, v76, v80
    v_add_f32 v77, v77, v81
    v_mfma_f32_16x16x32_bf16 v[72:75], v[252:255], a[172:175], v[72:75]
    buffer_load_dwordx4 v[188:191], v1, s[4:7], s48 offen offset:2048 sc1
    s_waitcnt vmcnt(19)
    v_mfma_f32_16x16x32_bf16 v[60:63], v[112:115], a[176:179], v[60:63]
    v_add_f32 v78, v78, v82
    v_add_f32 v79, v79, v83
    v_mfma_f32_16x16x32_bf16 v[64:67], v[112:115], a[180:183], v[64:67]
    s_waitcnt lgkmcnt(0)
    v_add_f32 v84, v84, v88
    v_mfma_f32_16x16x32_bf16 v[68:71], v[112:115], a[184:187], v[68:71]
    v_add_f32 v85, v85, v89
    v_add_f32 v86, v86, v90
    v_mfma_f32_16x16x32_bf16 v[72:75], v[112:115], a[188:191], v[72:75]
    buffer_load_dwordx4 v[192:195], v1, s[4:7], s48 offen offset:3072 sc1
    s_waitcnt vmcnt(19)
    v_mfma_f32_16x16x32_bf16 v[60:63], v[116:119], a[192:195], v[60:63]
    v_add_f32 v87, v87, v91
    v_add_f32 v76, v76, v84
    v_mfma_f32_16x16x32_bf16 v[64:67], v[116:119], a[196:199], v[64:67]
    v_add_f32 v77, v77, v85
    v_mfma_f32_16x16x32_bf16 v[68:71], v[116:119], a[200:203], v[68:71]
    v_add_f32 v78, v78, v86
    v_add_f32 v79, v79, v87
    v_mfma_f32_16x16x32_bf16 v[72:75], v[116:119], a[204:207], v[72:75]
    s_xor_b32 s48, s38, 0x0
    s_add_u32 s48, s48, 0x19b0000
    buffer_load_dwordx4 v[196:199], v1, s[4:7], s48 offen offset:0 sc1
    s_waitcnt vmcnt(19)
    v_mfma_f32_16x16x32_bf16 v[60:63], v[120:123], a[208:211], v[60:63]
    v_mul_f32 v76, v76, v100
    v_mul_f32 v77, v77, v101
    v_mfma_f32_16x16x32_bf16 v[64:67], v[120:123], a[212:215], v[64:67]
    v_mul_f32 v78, v78, v102
    v_mfma_f32_16x16x32_bf16 v[68:71], v[120:123], a[216:219], v[68:71]
    v_mul_f32 v79, v79, v103
    v_cvt_pk_bf16_f32 v104, v76, v77
    v_mfma_f32_16x16x32_bf16 v[72:75], v[120:123], a[220:223], v[72:75]
    buffer_load_dwordx4 v[200:203], v1, s[4:7], s48 offen offset:1024 sc1
    s_waitcnt vmcnt(19)
    v_mfma_f32_16x16x32_bf16 v[60:63], v[124:127], a[224:227], v[60:63]
    v_cvt_pk_bf16_f32 v105, v78, v79
    v_mfma_f32_16x16x32_bf16 v[64:67], v[124:127], a[228:231], v[64:67]
    v_mfma_f32_16x16x32_bf16 v[68:71], v[124:127], a[232:235], v[68:71]
    v_mfma_f32_16x16x32_bf16 v[72:75], v[124:127], a[236:239], v[72:75]
    buffer_load_dwordx4 v[204:207], v1, s[4:7], s48 offen offset:2048 sc1
    s_waitcnt vmcnt(19)
    v_mfma_f32_16x16x32_bf16 v[60:63], v[128:131], a[240:243], v[60:63]
    v_mfma_f32_16x16x32_bf16 v[64:67], v[128:131], a[244:247], v[64:67]
    v_mfma_f32_16x16x32_bf16 v[68:71], v[128:131], a[248:251], v[68:71]
    v_mfma_f32_16x16x32_bf16 v[72:75], v[128:131], a[252:255], v[72:75]
    buffer_load_dwordx4 v[208:211], v1, s[4:7], s48 offen offset:3072 sc1
    s_waitcnt vmcnt(19)
    v_mfma_f32_16x16x32_bf16 v[44:47], v[132:135], a[0:3], 0
    v_mfma_f32_16x16x32_bf16 v[48:51], v[132:135], a[4:7], 0
    v_mfma_f32_16x16x32_bf16 v[52:55], v[132:135], a[8:11], 0
    v_mfma_f32_16x16x32_bf16 v[56:59], v[132:135], a[12:15], 0
    s_xor_b32 s48, s38, 0x1000
    s_add_u32 s48, s48, 0x19b0000
    buffer_load_dwordx4 v[212:215], v1, s[4:7], s48 offen offset:0 sc1
    s_waitcnt vmcnt(19)
    v_mfma_f32_16x16x32_bf16 v[44:47], v[136:139], a[16:19], v[44:47]
    v_mfma_f32_16x16x32_bf16 v[48:51], v[136:139], a[20:23], v[48:51]
    ds_write_b128 v97, v[60:63] offset:16384
    v_mfma_f32_16x16x32_bf16 v[52:55], v[136:139], a[24:27], v[52:55]
    v_mfma_f32_16x16x32_bf16 v[56:59], v[136:139], a[28:31], v[56:59]
    buffer_load_dwordx4 v[216:219], v1, s[4:7], s48 offen offset:1024 sc1
    s_waitcnt vmcnt(19)
    v_mfma_f32_16x16x32_bf16 v[44:47], v[140:143], a[32:35], v[44:47]
    v_mfma_f32_16x16x32_bf16 v[48:51], v[140:143], a[36:39], v[48:51]
    ds_write_b128 v97, v[64:67] offset:17408
    v_mfma_f32_16x16x32_bf16 v[52:55], v[140:143], a[40:43], v[52:55]
    v_mfma_f32_16x16x32_bf16 v[56:59], v[140:143], a[44:47], v[56:59]
    buffer_load_dwordx4 v[220:223], v1, s[4:7], s48 offen offset:2048 sc1
    s_waitcnt vmcnt(19)
    v_mfma_f32_16x16x32_bf16 v[44:47], v[144:147], a[48:51], v[44:47]
    v_mfma_f32_16x16x32_bf16 v[48:51], v[144:147], a[52:55], v[48:51]
    ds_write_b128 v97, v[68:71] offset:18432
    v_mfma_f32_16x16x32_bf16 v[52:55], v[144:147], a[56:59], v[52:55]
    v_mfma_f32_16x16x32_bf16 v[56:59], v[144:147], a[60:63], v[56:59]
    buffer_load_dwordx4 v[224:227], v1, s[4:7], s48 offen offset:3072 sc1
    s_waitcnt vmcnt(19)
    v_mfma_f32_16x16x32_bf16 v[44:47], v[148:151], a[64:67], v[44:47]
    v_mfma_f32_16x16x32_bf16 v[48:51], v[148:151], a[68:71], v[48:51]
    ds_write_b128 v97, v[72:75] offset:19456
    v_mfma_f32_16x16x32_bf16 v[52:55], v[148:151], a[72:75], v[52:55]
    v_mfma_f32_16x16x32_bf16 v[56:59], v[148:151], a[76:79], v[56:59]
    s_xor_b32 s48, s38, 0x2000
    s_add_u32 s48, s48, 0x19b0000
    buffer_load_dwordx4 v[228:231], v1, s[4:7], s48 offen offset:0 sc1
    s_waitcnt vmcnt(19)
    v_mfma_f32_16x16x32_bf16 v[44:47], v[152:155], a[80:83], v[44:47]
    v_mfma_f32_16x16x32_bf16 v[48:51], v[152:155], a[84:87], v[48:51]
    v_mfma_f32_16x16x32_bf16 v[52:55], v[152:155], a[88:91], v[52:55]
    v_mfma_f32_16x16x32_bf16 v[56:59], v[152:155], a[92:95], v[56:59]
    buffer_load_dwordx4 v[232:235], v1, s[4:7], s48 offen offset:1024 sc1
    s_waitcnt lgkmcnt(0)
    s_barrier
    s_waitcnt vmcnt(19)
    v_mfma_f32_16x16x32_bf16 v[44:47], v[156:159], a[96:99], v[44:47]
    ds_read_b128 v[76:79], v42 offset:16384
    ds_read_b128 v[80:83], v42 offset:20480
    v_mfma_f32_16x16x32_bf16 v[48:51], v[156:159], a[100:103], v[48:51]
    ds_read_b128 v[84:87], v42 offset:24576
    v_mfma_f32_16x16x32_bf16 v[52:55], v[156:159], a[104:107], v[52:55]
    ds_read_b128 v[88:91], v42 offset:28672
    v_mfma_f32_16x16x32_bf16 v[56:59], v[156:159], a[108:111], v[56:59]
    buffer_load_dwordx4 v[236:239], v1, s[4:7], s48 offen offset:2048 sc1
    s_waitcnt vmcnt(19)
    v_mfma_f32_16x16x32_bf16 v[44:47], v[160:163], a[112:115], v[44:47]
    v_mfma_f32_16x16x32_bf16 v[48:51], v[160:163], a[116:119], v[48:51]
    v_mfma_f32_16x16x32_bf16 v[52:55], v[160:163], a[120:123], v[52:55]
    v_mfma_f32_16x16x32_bf16 v[56:59], v[160:163], a[124:127], v[56:59]
    buffer_load_dwordx4 v[240:243], v1, s[4:7], s48 offen offset:3072 sc1
    s_waitcnt vmcnt(19)
    v_mfma_f32_16x16x32_bf16 v[44:47], v[164:167], a[128:131], v[44:47]
    v_mfma_f32_16x16x32_bf16 v[48:51], v[164:167], a[132:135], v[48:51]
    v_mfma_f32_16x16x32_bf16 v[52:55], v[164:167], a[136:139], v[52:55]
    v_mfma_f32_16x16x32_bf16 v[56:59], v[164:167], a[140:143], v[56:59]
    s_xor_b32 s48, s38, 0x3000
    s_add_u32 s48, s48, 0x19b0000
    buffer_load_dwordx4 v[244:247], v1, s[4:7], s48 offen offset:0 sc1
    s_waitcnt vmcnt(19)
    v_mfma_f32_16x16x32_bf16 v[44:47], v[168:171], a[144:147], v[44:47]
    v_lshlrev_b32 v100, 16, v94
    v_and_b32 v101, 0xffff0000, v94
    v_mfma_f32_16x16x32_bf16 v[48:51], v[168:171], a[148:151], v[48:51]
    v_lshlrev_b32 v102, 16, v95
    v_mfma_f32_16x16x32_bf16 v[52:55], v[168:171], a[152:155], v[52:55]
    v_and_b32 v103, 0xffff0000, v95
    s_waitcnt lgkmcnt(3)
    v_add_f32 v76, v76, v24
    v_mfma_f32_16x16x32_bf16 v[56:59], v[168:171], a[156:159], v[56:59]
    buffer_load_dwordx4 v[248:251], v1, s[4:7], s48 offen offset:1024 sc1
    s_waitcnt vmcnt(19)
    v_mfma_f32_16x16x32_bf16 v[44:47], v[172:175], a[160:163], v[44:47]
    v_add_f32 v77, v77, v24
    v_add_f32 v78, v78, v24
    v_mfma_f32_16x16x32_bf16 v[48:51], v[172:175], a[164:167], v[48:51]
    v_add_f32 v79, v79, v24
    v_mfma_f32_16x16x32_bf16 v[52:55], v[172:175], a[168:171], v[52:55]
    s_waitcnt lgkmcnt(2)
    v_add_f32 v76, v76, v80
    v_add_f32 v77, v77, v81
    v_mfma_f32_16x16x32_bf16 v[56:59], v[172:175], a[172:175], v[56:59]
    buffer_load_dwordx4 v[252:255], v1, s[4:7], s48 offen offset:2048 sc1
    s_waitcnt vmcnt(19)
    v_mfma_f32_16x16x32_bf16 v[44:47], v[176:179], a[176:179], v[44:47]
    v_add_f32 v78, v78, v82
    v_add_f32 v79, v79, v83
    v_mfma_f32_16x16x32_bf16 v[48:51], v[176:179], a[180:183], v[48:51]
    s_waitcnt lgkmcnt(0)
    v_add_f32 v84, v84, v88
    v_mfma_f32_16x16x32_bf16 v[52:55], v[176:179], a[184:187], v[52:55]
    v_add_f32 v85, v85, v89
    v_add_f32 v86, v86, v90
    v_mfma_f32_16x16x32_bf16 v[56:59], v[176:179], a[188:191], v[56:59]
    buffer_load_dwordx4 v[112:115], v1, s[4:7], s48 offen offset:3072 sc1
    s_waitcnt vmcnt(19)
    v_mfma_f32_16x16x32_bf16 v[44:47], v[180:183], a[192:195], v[44:47]
    v_add_f32 v87, v87, v91
    v_add_f32 v76, v76, v84
    v_mfma_f32_16x16x32_bf16 v[48:51], v[180:183], a[196:199], v[48:51]
    v_add_f32 v77, v77, v85
    v_mfma_f32_16x16x32_bf16 v[52:55], v[180:183], a[200:203], v[52:55]
    v_add_f32 v78, v78, v86
    v_add_f32 v79, v79, v87
    v_mfma_f32_16x16x32_bf16 v[56:59], v[180:183], a[204:207], v[56:59]
    s_xor_b32 s48, s38, 0x0
    s_add_u32 s48, s48, 0x19c0000
    buffer_load_dwordx4 v[116:119], v1, s[4:7], s48 offen offset:0 sc1
    s_waitcnt vmcnt(19)
    v_mfma_f32_16x16x32_bf16 v[44:47], v[184:187], a[208:211], v[44:47]
    v_mul_f32 v76, v76, v100
    v_mul_f32 v77, v77, v101
    v_mfma_f32_16x16x32_bf16 v[48:51], v[184:187], a[212:215], v[48:51]
    v_mul_f32 v78, v78, v102
    v_mfma_f32_16x16x32_bf16 v[52:55], v[184:187], a[216:219], v[52:55]
    v_mul_f32 v79, v79, v103
    v_cvt_pk_bf16_f32 v106, v76, v77
    v_mfma_f32_16x16x32_bf16 v[56:59], v[184:187], a[220:223], v[56:59]
    buffer_load_dwordx4 v[120:123], v1, s[4:7], s48 offen offset:1024 sc1
    s_waitcnt vmcnt(19)
    v_mfma_f32_16x16x32_bf16 v[44:47], v[188:191], a[224:227], v[44:47]
    v_cvt_pk_bf16_f32 v107, v78, v79
    buffer_store_dwordx4 v[104:107], v1, s[4:7], s52 offen offset:0 sc1
    v_mfma_f32_16x16x32_bf16 v[48:51], v[188:191], a[228:231], v[48:51]
    v_mfma_f32_16x16x32_bf16 v[52:55], v[188:191], a[232:235], v[52:55]
    v_mfma_f32_16x16x32_bf16 v[56:59], v[188:191], a[236:239], v[56:59]
    buffer_load_dwordx4 v[124:127], v1, s[4:7], s48 offen offset:2048 sc1
    s_waitcnt vmcnt(20)
    v_mfma_f32_16x16x32_bf16 v[44:47], v[192:195], a[240:243], v[44:47]
    v_mfma_f32_16x16x32_bf16 v[48:51], v[192:195], a[244:247], v[48:51]
    v_mfma_f32_16x16x32_bf16 v[52:55], v[192:195], a[248:251], v[52:55]
    v_mfma_f32_16x16x32_bf16 v[56:59], v[192:195], a[252:255], v[56:59]
    buffer_load_dwordx4 v[128:131], v1, s[4:7], s48 offen offset:3072 sc1
    s_waitcnt vmcnt(20)
    v_mfma_f32_16x16x32_bf16 v[60:63], v[196:199], a[0:3], 0
    v_mfma_f32_16x16x32_bf16 v[64:67], v[196:199], a[4:7], 0
    v_mfma_f32_16x16x32_bf16 v[68:71], v[196:199], a[8:11], 0
    v_mfma_f32_16x16x32_bf16 v[72:75], v[196:199], a[12:15], 0
    s_xor_b32 s48, s38, 0x1000
    s_add_u32 s48, s48, 0x19c0000
    buffer_load_dwordx4 v[132:135], v1, s[4:7], s48 offen offset:0 sc1
    s_waitcnt vmcnt(20)
    v_mfma_f32_16x16x32_bf16 v[60:63], v[200:203], a[16:19], v[60:63]
    v_mfma_f32_16x16x32_bf16 v[64:67], v[200:203], a[20:23], v[64:67]
    ds_write_b128 v97, v[44:47] offset:0
    v_mfma_f32_16x16x32_bf16 v[68:71], v[200:203], a[24:27], v[68:71]
    v_mfma_f32_16x16x32_bf16 v[72:75], v[200:203], a[28:31], v[72:75]
    buffer_load_dwordx4 v[136:139], v1, s[4:7], s48 offen offset:1024 sc1
    s_waitcnt vmcnt(20)
    v_mfma_f32_16x16x32_bf16 v[60:63], v[204:207], a[32:35], v[60:63]
    v_mfma_f32_16x16x32_bf16 v[64:67], v[204:207], a[36:39], v[64:67]
    ds_write_b128 v97, v[48:51] offset:1024
    v_mfma_f32_16x16x32_bf16 v[68:71], v[204:207], a[40:43], v[68:71]
    v_mfma_f32_16x16x32_bf16 v[72:75], v[204:207], a[44:47], v[72:75]
    buffer_load_dwordx4 v[140:143], v1, s[4:7], s48 offen offset:2048 sc1
    s_waitcnt vmcnt(20)
    v_mfma_f32_16x16x32_bf16 v[60:63], v[208:211], a[48:51], v[60:63]
    v_mfma_f32_16x16x32_bf16 v[64:67], v[208:211], a[52:55], v[64:67]
    ds_write_b128 v97, v[52:55] offset:2048
    v_mfma_f32_16x16x32_bf16 v[68:71], v[208:211], a[56:59], v[68:71]
    v_mfma_f32_16x16x32_bf16 v[72:75], v[208:211], a[60:63], v[72:75]
    buffer_load_dwordx4 v[144:147], v1, s[4:7], s48 offen offset:3072 sc1
    s_waitcnt vmcnt(20)
    v_mfma_f32_16x16x32_bf16 v[60:63], v[212:215], a[64:67], v[60:63]
    v_mfma_f32_16x16x32_bf16 v[64:67], v[212:215], a[68:71], v[64:67]
    ds_write_b128 v97, v[56:59] offset:3072
    v_mfma_f32_16x16x32_bf16 v[68:71], v[212:215], a[72:75], v[68:71]
    v_mfma_f32_16x16x32_bf16 v[72:75], v[212:215], a[76:79], v[72:75]
    s_xor_b32 s48, s38, 0x2000
    s_add_u32 s48, s48, 0x19c0000
    buffer_load_dwordx4 v[148:151], v1, s[4:7], s48 offen offset:0 sc1
    s_waitcnt vmcnt(20)
    v_mfma_f32_16x16x32_bf16 v[60:63], v[216:219], a[80:83], v[60:63]
    v_mfma_f32_16x16x32_bf16 v[64:67], v[216:219], a[84:87], v[64:67]
    v_mfma_f32_16x16x32_bf16 v[68:71], v[216:219], a[88:91], v[68:71]
    v_mfma_f32_16x16x32_bf16 v[72:75], v[216:219], a[92:95], v[72:75]
    buffer_load_dwordx4 v[152:155], v1, s[4:7], s48 offen offset:1024 sc1
    s_waitcnt lgkmcnt(0)
    s_barrier
    s_waitcnt vmcnt(20)
    v_mfma_f32_16x16x32_bf16 v[60:63], v[220:223], a[96:99], v[60:63]
    ds_read_b128 v[92:95], v43 offset:4608
    ds_read_b128 v[76:79], v42 offset:0
    v_mfma_f32_16x16x32_bf16 v[64:67], v[220:223], a[100:103], v[64:67]
    ds_read_b128 v[80:83], v42 offset:4096
    v_mfma_f32_16x16x32_bf16 v[68:71], v[220:223], a[104:107], v[68:71]
    ds_read_b128 v[84:87], v42 offset:8192
    ds_read_b128 v[88:91], v42 offset:12288
    v_mfma_f32_16x16x32_bf16 v[72:75], v[220:223], a[108:111], v[72:75]
    buffer_load_dwordx4 v[156:159], v1, s[4:7], s48 offen offset:2048 sc1
    s_waitcnt vmcnt(20)
    v_mfma_f32_16x16x32_bf16 v[60:63], v[224:227], a[112:115], v[60:63]
    v_mfma_f32_16x16x32_bf16 v[64:67], v[224:227], a[116:119], v[64:67]
    v_mfma_f32_16x16x32_bf16 v[68:71], v[224:227], a[120:123], v[68:71]
    v_mfma_f32_16x16x32_bf16 v[72:75], v[224:227], a[124:127], v[72:75]
    buffer_load_dwordx4 v[160:163], v1, s[4:7], s48 offen offset:3072 sc1
    s_waitcnt vmcnt(20)
    v_mfma_f32_16x16x32_bf16 v[60:63], v[228:231], a[128:131], v[60:63]
    v_mfma_f32_16x16x32_bf16 v[64:67], v[228:231], a[132:135], v[64:67]
    v_mfma_f32_16x16x32_bf16 v[68:71], v[228:231], a[136:139], v[68:71]
    v_mfma_f32_16x16x32_bf16 v[72:75], v[228:231], a[140:143], v[72:75]
    s_xor_b32 s48, s38, 0x3000
    s_add_u32 s48, s48, 0x19c0000
    buffer_load_dwordx4 v[164:167], v1, s[4:7], s48 offen offset:0 sc1
    s_waitcnt vmcnt(20)
    v_mfma_f32_16x16x32_bf16 v[60:63], v[232:235], a[144:147], v[60:63]
    s_waitcnt lgkmcnt(4)
    v_lshlrev_b32 v100, 16, v92
    v_and_b32 v101, 0xffff0000, v92
    v_mfma_f32_16x16x32_bf16 v[64:67], v[232:235], a[148:151], v[64:67]
    v_lshlrev_b32 v102, 16, v93
    v_mfma_f32_16x16x32_bf16 v[68:71], v[232:235], a[152:155], v[68:71]
    v_and_b32 v103, 0xffff0000, v93
    s_waitcnt lgkmcnt(3)
    v_add_f32 v76, v76, v24
    v_mfma_f32_16x16x32_bf16 v[72:75], v[232:235], a[156:159], v[72:75]
    buffer_load_dwordx4 v[168:171], v1, s[4:7], s48 offen offset:1024 sc1
    s_waitcnt vmcnt(20)
    v_mfma_f32_16x16x32_bf16 v[60:63], v[236:239], a[160:163], v[60:63]
    v_add_f32 v77, v77, v24
    v_add_f32 v78, v78, v24
    v_mfma_f32_16x16x32_bf16 v[64:67], v[236:239], a[164:167], v[64:67]
    v_add_f32 v79, v79, v24
    v_mfma_f32_16x16x32_bf16 v[68:71], v[236:239], a[168:171], v[68:71]
    s_waitcnt lgkmcnt(2)
    v_add_f32 v76, v76, v80
    v_add_f32 v77, v77, v81
    v_mfma_f32_16x16x32_bf16 v[72:75], v[236:239], a[172:175], v[72:75]
    buffer_load_dwordx4 v[172:175], v1, s[4:7], s48 offen offset:2048 sc1
    s_waitcnt vmcnt(20)
    v_mfma_f32_16x16x32_bf16 v[60:63], v[240:243], a[176:179], v[60:63]
    v_add_f32 v78, v78, v82
    v_add_f32 v79, v79, v83
    v_mfma_f32_16x16x32_bf16 v[64:67], v[240:243], a[180:183], v[64:67]
    s_waitcnt lgkmcnt(0)
    v_add_f32 v84, v84, v88
    v_mfma_f32_16x16x32_bf16 v[68:71], v[240:243], a[184:187], v[68:71]
    v_add_f32 v85, v85, v89
    v_add_f32 v86, v86, v90
    v_mfma_f32_16x16x32_bf16 v[72:75], v[240:243], a[188:191], v[72:75]
    buffer_load_dwordx4 v[176:179], v1, s[4:7], s48 offen offset:3072 sc1
    s_waitcnt vmcnt(20)
    v_mfma_f32_16x16x32_bf16 v[60:63], v[244:247], a[192:195], v[60:63]
    v_add_f32 v87, v87, v91
    v_add_f32 v76, v76, v84
    v_mfma_f32_16x16x32_bf16 v[64:67], v[244:247], a[196:199], v[64:67]
    v_add_f32 v77, v77, v85
    v_mfma_f32_16x16x32_bf16 v[68:71], v[244:247], a[200:203], v[68:71]
    v_add_f32 v78, v78, v86
    v_add_f32 v79, v79, v87
    v_mfma_f32_16x16x32_bf16 v[72:75], v[244:247], a[204:207], v[72:75]
    s_xor_b32 s48, s38, 0x0
    s_add_u32 s48, s48, 0x19d0000
    buffer_load_dwordx4 v[180:183], v1, s[4:7], s48 offen offset:0 sc1
    s_waitcnt vmcnt(20)
    v_mfma_f32_16x16x32_bf16 v[60:63], v[248:251], a[208:211], v[60:63]
    v_mul_f32 v76, v76, v100
    v_mul_f32 v77, v77, v101
    v_mfma_f32_16x16x32_bf16 v[64:67], v[248:251], a[212:215], v[64:67]
    v_mul_f32 v78, v78, v102
    v_mfma_f32_16x16x32_bf16 v[68:71], v[248:251], a[216:219], v[68:71]
    v_mul_f32 v79, v79, v103
    v_cvt_pk_bf16_f32 v108, v76, v77
    v_mfma_f32_16x16x32_bf16 v[72:75], v[248:251], a[220:223], v[72:75]
    buffer_load_dwordx4 v[184:187], v1, s[4:7], s48 offen offset:1024 sc1
    s_waitcnt vmcnt(20)
    v_mfma_f32_16x16x32_bf16 v[60:63], v[252:255], a[224:227], v[60:63]
    v_cvt_pk_bf16_f32 v109, v78, v79
    v_mfma_f32_16x16x32_bf16 v[64:67], v[252:255], a[228:231], v[64:67]
    v_mfma_f32_16x16x32_bf16 v[68:71], v[252:255], a[232:235], v[68:71]
    v_mfma_f32_16x16x32_bf16 v[72:75], v[252:255], a[236:239], v[72:75]
    buffer_load_dwordx4 v[188:191], v1, s[4:7], s48 offen offset:2048 sc1
    s_waitcnt vmcnt(20)
    v_mfma_f32_16x16x32_bf16 v[60:63], v[112:115], a[240:243], v[60:63]
    v_mfma_f32_16x16x32_bf16 v[64:67], v[112:115], a[244:247], v[64:67]
    v_mfma_f32_16x16x32_bf16 v[68:71], v[112:115], a[248:251], v[68:71]
    v_mfma_f32_16x16x32_bf16 v[72:75], v[112:115], a[252:255], v[72:75]
    buffer_load_dwordx4 v[192:195], v1, s[4:7], s48 offen offset:3072 sc1
    s_waitcnt vmcnt(20)
    v_mfma_f32_16x16x32_bf16 v[44:47], v[116:119], a[0:3], 0
    v_mfma_f32_16x16x32_bf16 v[48:51], v[116:119], a[4:7], 0
    v_mfma_f32_16x16x32_bf16 v[52:55], v[116:119], a[8:11], 0
    v_mfma_f32_16x16x32_bf16 v[56:59], v[116:119], a[12:15], 0
    s_xor_b32 s48, s38, 0x1000
    s_add_u32 s48, s48, 0x19d0000
    buffer_load_dwordx4 v[196:199], v1, s[4:7], s48 offen offset:0 sc1
    s_waitcnt vmcnt(20)
    v_mfma_f32_16x16x32_bf16 v[44:47], v[120:123], a[16:19], v[44:47]
    v_mfma_f32_16x16x32_bf16 v[48:51], v[120:123], a[20:23], v[48:51]
    ds_write_b128 v97, v[60:63] offset:16384
    v_mfma_f32_16x16x32_bf16 v[52:55], v[120:123], a[24:27], v[52:55]
    v_mfma_f32_16x16x32_bf16 v[56:59], v[120:123], a[28:31], v[56:59]
    buffer_load_dwordx4 v[200:203], v1, s[4:7], s48 offen offset:1024 sc1
    s_waitcnt vmcnt(19)
    v_mfma_f32_16x16x32_bf16 v[44:47], v[124:127], a[32:35], v[44:47]
    v_mfma_f32_16x16x32_bf16 v[48:51], v[124:127], a[36:39], v[48:51]
    ds_write_b128 v97, v[64:67] offset:17408
    v_mfma_f32_16x16x32_bf16 v[52:55], v[124:127], a[40:43], v[52:55]
    v_mfma_f32_16x16x32_bf16 v[56:59], v[124:127], a[44:47], v[56:59]
    buffer_load_dwordx4 v[204:207], v1, s[4:7], s48 offen offset:2048 sc1
    s_waitcnt vmcnt(19)
    v_mfma_f32_16x16x32_bf16 v[44:47], v[128:131], a[48:51], v[44:47]
    v_mfma_f32_16x16x32_bf16 v[48:51], v[128:131], a[52:55], v[48:51]
    ds_write_b128 v97, v[68:71] offset:18432
    v_mfma_f32_16x16x32_bf16 v[52:55], v[128:131], a[56:59], v[52:55]
    v_mfma_f32_16x16x32_bf16 v[56:59], v[128:131], a[60:63], v[56:59]
    buffer_load_dwordx4 v[208:211], v1, s[4:7], s48 offen offset:3072 sc1
    s_waitcnt vmcnt(19)
    v_mfma_f32_16x16x32_bf16 v[44:47], v[132:135], a[64:67], v[44:47]
    v_mfma_f32_16x16x32_bf16 v[48:51], v[132:135], a[68:71], v[48:51]
    ds_write_b128 v97, v[72:75] offset:19456
    v_mfma_f32_16x16x32_bf16 v[52:55], v[132:135], a[72:75], v[52:55]
    v_mfma_f32_16x16x32_bf16 v[56:59], v[132:135], a[76:79], v[56:59]
    s_xor_b32 s48, s38, 0x2000
    s_add_u32 s48, s48, 0x19d0000
    buffer_load_dwordx4 v[212:215], v1, s[4:7], s48 offen offset:0 sc1
    s_waitcnt vmcnt(19)
    v_mfma_f32_16x16x32_bf16 v[44:47], v[136:139], a[80:83], v[44:47]
    v_mfma_f32_16x16x32_bf16 v[48:51], v[136:139], a[84:87], v[48:51]
    v_mfma_f32_16x16x32_bf16 v[52:55], v[136:139], a[88:91], v[52:55]
    v_mfma_f32_16x16x32_bf16 v[56:59], v[136:139], a[92:95], v[56:59]
    buffer_load_dwordx4 v[216:219], v1, s[4:7], s48 offen offset:1024 sc1
    s_waitcnt lgkmcnt(0)
    s_barrier
    s_waitcnt vmcnt(19)
    v_mfma_f32_16x16x32_bf16 v[44:47], v[140:143], a[96:99], v[44:47]
    ds_read_b128 v[76:79], v42 offset:16384
    ds_read_b128 v[80:83], v42 offset:20480
    v_mfma_f32_16x16x32_bf16 v[48:51], v[140:143], a[100:103], v[48:51]
    ds_read_b128 v[84:87], v42 offset:24576
    v_mfma_f32_16x16x32_bf16 v[52:55], v[140:143], a[104:107], v[52:55]
    ds_read_b128 v[88:91], v42 offset:28672
    v_mfma_f32_16x16x32_bf16 v[56:59], v[140:143], a[108:111], v[56:59]
    buffer_load_dwordx4 v[220:223], v1, s[4:7], s48 offen offset:2048 sc1
    s_waitcnt vmcnt(19)
    v_mfma_f32_16x16x32_bf16 v[44:47], v[144:147], a[112:115], v[44:47]
    v_mfma_f32_16x16x32_bf16 v[48:51], v[144:147], a[116:119], v[48:51]
    v_mfma_f32_16x16x32_bf16 v[52:55], v[144:147], a[120:123], v[52:55]
    v_mfma_f32_16x16x32_bf16 v[56:59], v[144:147], a[124:127], v[56:59]
    buffer_load_dwordx4 v[224:227], v1, s[4:7], s48 offen offset:3072 sc1
    s_waitcnt vmcnt(19)
    v_mfma_f32_16x16x32_bf16 v[44:47], v[148:151], a[128:131], v[44:47]
    v_mfma_f32_16x16x32_bf16 v[48:51], v[148:151], a[132:135], v[48:51]
    v_mfma_f32_16x16x32_bf16 v[52:55], v[148:151], a[136:139], v[52:55]
    v_mfma_f32_16x16x32_bf16 v[56:59], v[148:151], a[140:143], v[56:59]
    s_xor_b32 s48, s38, 0x3000
    s_add_u32 s48, s48, 0x19d0000
    buffer_load_dwordx4 v[228:231], v1, s[4:7], s48 offen offset:0 sc1
    s_waitcnt vmcnt(19)
    v_mfma_f32_16x16x32_bf16 v[44:47], v[152:155], a[144:147], v[44:47]
    v_lshlrev_b32 v100, 16, v94
    v_and_b32 v101, 0xffff0000, v94
    v_mfma_f32_16x16x32_bf16 v[48:51], v[152:155], a[148:151], v[48:51]
    v_lshlrev_b32 v102, 16, v95
    v_mfma_f32_16x16x32_bf16 v[52:55], v[152:155], a[152:155], v[52:55]
    v_and_b32 v103, 0xffff0000, v95
    s_waitcnt lgkmcnt(3)
    v_add_f32 v76, v76, v24
    v_mfma_f32_16x16x32_bf16 v[56:59], v[152:155], a[156:159], v[56:59]
    buffer_load_dwordx4 v[232:235], v1, s[4:7], s48 offen offset:1024 sc1
    s_waitcnt vmcnt(19)
    v_mfma_f32_16x16x32_bf16 v[44:47], v[156:159], a[160:163], v[44:47]
    v_add_f32 v77, v77, v24
    v_add_f32 v78, v78, v24
    v_mfma_f32_16x16x32_bf16 v[48:51], v[156:159], a[164:167], v[48:51]
    v_add_f32 v79, v79, v24
    v_mfma_f32_16x16x32_bf16 v[52:55], v[156:159], a[168:171], v[52:55]
    s_waitcnt lgkmcnt(2)
    v_add_f32 v76, v76, v80
    v_add_f32 v77, v77, v81
    v_mfma_f32_16x16x32_bf16 v[56:59], v[156:159], a[172:175], v[56:59]
    buffer_load_dwordx4 v[236:239], v1, s[4:7], s48 offen offset:2048 sc1
    s_waitcnt vmcnt(19)
    v_mfma_f32_16x16x32_bf16 v[44:47], v[160:163], a[176:179], v[44:47]
    v_add_f32 v78, v78, v82
    v_add_f32 v79, v79, v83
    v_mfma_f32_16x16x32_bf16 v[48:51], v[160:163], a[180:183], v[48:51]
    s_waitcnt lgkmcnt(0)
    v_add_f32 v84, v84, v88
    v_mfma_f32_16x16x32_bf16 v[52:55], v[160:163], a[184:187], v[52:55]
    v_add_f32 v85, v85, v89
    v_add_f32 v86, v86, v90
    v_mfma_f32_16x16x32_bf16 v[56:59], v[160:163], a[188:191], v[56:59]
    buffer_load_dwordx4 v[240:243], v1, s[4:7], s48 offen offset:3072 sc1
    s_waitcnt vmcnt(19)
    v_mfma_f32_16x16x32_bf16 v[44:47], v[164:167], a[192:195], v[44:47]
    v_add_f32 v87, v87, v91
    v_add_f32 v76, v76, v84
    v_mfma_f32_16x16x32_bf16 v[48:51], v[164:167], a[196:199], v[48:51]
    v_add_f32 v77, v77, v85
    v_mfma_f32_16x16x32_bf16 v[52:55], v[164:167], a[200:203], v[52:55]
    v_add_f32 v78, v78, v86
    v_add_f32 v79, v79, v87
    v_mfma_f32_16x16x32_bf16 v[56:59], v[164:167], a[204:207], v[56:59]
    s_xor_b32 s48, s38, 0x0
    s_add_u32 s48, s48, 0x19e0000
    buffer_load_dwordx4 v[244:247], v1, s[4:7], s48 offen offset:0 sc1
    s_waitcnt vmcnt(19)
    v_mfma_f32_16x16x32_bf16 v[44:47], v[168:171], a[208:211], v[44:47]
    v_mul_f32 v76, v76, v100
    v_mul_f32 v77, v77, v101
    v_mfma_f32_16x16x32_bf16 v[48:51], v[168:171], a[212:215], v[48:51]
    v_mul_f32 v78, v78, v102
    v_mfma_f32_16x16x32_bf16 v[52:55], v[168:171], a[216:219], v[52:55]
    v_mul_f32 v79, v79, v103
    v_cvt_pk_bf16_f32 v110, v76, v77
    v_mfma_f32_16x16x32_bf16 v[56:59], v[168:171], a[220:223], v[56:59]
    buffer_load_dwordx4 v[248:251], v1, s[4:7], s48 offen offset:1024 sc1
    s_waitcnt vmcnt(19)
    v_mfma_f32_16x16x32_bf16 v[44:47], v[172:175], a[224:227], v[44:47]
    v_cvt_pk_bf16_f32 v111, v78, v79
    buffer_store_dwordx4 v[108:111], v1, s[4:7], s52 offen offset:1024 sc1
    v_mfma_f32_16x16x32_bf16 v[48:51], v[172:175], a[228:231], v[48:51]
    v_mfma_f32_16x16x32_bf16 v[52:55], v[172:175], a[232:235], v[52:55]
    v_mfma_f32_16x16x32_bf16 v[56:59], v[172:175], a[236:239], v[56:59]
    buffer_load_dwordx4 v[252:255], v1, s[4:7], s48 offen offset:2048 sc1
    s_waitcnt vmcnt(20)
    v_mfma_f32_16x16x32_bf16 v[44:47], v[176:179], a[240:243], v[44:47]
    v_mfma_f32_16x16x32_bf16 v[48:51], v[176:179], a[244:247], v[48:51]
    v_mfma_f32_16x16x32_bf16 v[52:55], v[176:179], a[248:251], v[52:55]
    v_mfma_f32_16x16x32_bf16 v[56:59], v[176:179], a[252:255], v[56:59]
    buffer_load_dwordx4 v[112:115], v1, s[4:7], s48 offen offset:3072 sc1
    s_waitcnt vmcnt(20)
    v_mfma_f32_16x16x32_bf16 v[60:63], v[180:183], a[0:3], 0
    v_mfma_f32_16x16x32_bf16 v[64:67], v[180:183], a[4:7], 0
    v_mfma_f32_16x16x32_bf16 v[68:71], v[180:183], a[8:11], 0
    v_mfma_f32_16x16x32_bf16 v[72:75], v[180:183], a[12:15], 0
    s_xor_b32 s48, s38, 0x1000
    s_add_u32 s48, s48, 0x19e0000
    buffer_load_dwordx4 v[116:119], v1, s[4:7], s48 offen offset:0 sc1
    s_waitcnt vmcnt(20)
    v_mfma_f32_16x16x32_bf16 v[60:63], v[184:187], a[16:19], v[60:63]
    v_mfma_f32_16x16x32_bf16 v[64:67], v[184:187], a[20:23], v[64:67]
    ds_write_b128 v97, v[44:47] offset:0
    v_mfma_f32_16x16x32_bf16 v[68:71], v[184:187], a[24:27], v[68:71]
    v_mfma_f32_16x16x32_bf16 v[72:75], v[184:187], a[28:31], v[72:75]
    buffer_load_dwordx4 v[120:123], v1, s[4:7], s48 offen offset:1024 sc1
    s_waitcnt vmcnt(20)
    v_mfma_f32_16x16x32_bf16 v[60:63], v[188:191], a[32:35], v[60:63]
    v_mfma_f32_16x16x32_bf16 v[64:67], v[188:191], a[36:39], v[64:67]
    ds_write_b128 v97, v[48:51] offset:1024
    v_mfma_f32_16x16x32_bf16 v[68:71], v[188:191], a[40:43], v[68:71]
    v_mfma_f32_16x16x32_bf16 v[72:75], v[188:191], a[44:47], v[72:75]
    buffer_load_dwordx4 v[124:127], v1, s[4:7], s48 offen offset:2048 sc1
    s_waitcnt vmcnt(20)
    v_mfma_f32_16x16x32_bf16 v[60:63], v[192:195], a[48:51], v[60:63]
    v_mfma_f32_16x16x32_bf16 v[64:67], v[192:195], a[52:55], v[64:67]
    ds_write_b128 v97, v[52:55] offset:2048
    v_mfma_f32_16x16x32_bf16 v[68:71], v[192:195], a[56:59], v[68:71]
    v_mfma_f32_16x16x32_bf16 v[72:75], v[192:195], a[60:63], v[72:75]
    buffer_load_dwordx4 v[128:131], v1, s[4:7], s48 offen offset:3072 sc1
    s_waitcnt vmcnt(20)
    v_mfma_f32_16x16x32_bf16 v[60:63], v[196:199], a[64:67], v[60:63]
    v_mfma_f32_16x16x32_bf16 v[64:67], v[196:199], a[68:71], v[64:67]
    ds_write_b128 v97, v[56:59] offset:3072
    v_mfma_f32_16x16x32_bf16 v[68:71], v[196:199], a[72:75], v[68:71]
    v_mfma_f32_16x16x32_bf16 v[72:75], v[196:199], a[76:79], v[72:75]
    s_xor_b32 s48, s38, 0x2000
    s_add_u32 s48, s48, 0x19e0000
    buffer_load_dwordx4 v[132:135], v1, s[4:7], s48 offen offset:0 sc1
    s_waitcnt vmcnt(20)
    v_mfma_f32_16x16x32_bf16 v[60:63], v[200:203], a[80:83], v[60:63]
    v_mfma_f32_16x16x32_bf16 v[64:67], v[200:203], a[84:87], v[64:67]
    v_mfma_f32_16x16x32_bf16 v[68:71], v[200:203], a[88:91], v[68:71]
    v_mfma_f32_16x16x32_bf16 v[72:75], v[200:203], a[92:95], v[72:75]
    buffer_load_dwordx4 v[136:139], v1, s[4:7], s48 offen offset:1024 sc1
    s_waitcnt lgkmcnt(0)
    s_barrier
    s_waitcnt vmcnt(20)
    v_mfma_f32_16x16x32_bf16 v[60:63], v[204:207], a[96:99], v[60:63]
    ds_read_b128 v[92:95], v43 offset:9216
    ds_read_b128 v[76:79], v42 offset:0
    v_mfma_f32_16x16x32_bf16 v[64:67], v[204:207], a[100:103], v[64:67]
    ds_read_b128 v[80:83], v42 offset:4096
    v_mfma_f32_16x16x32_bf16 v[68:71], v[204:207], a[104:107], v[68:71]
    ds_read_b128 v[84:87], v42 offset:8192
    ds_read_b128 v[88:91], v42 offset:12288
    v_mfma_f32_16x16x32_bf16 v[72:75], v[204:207], a[108:111], v[72:75]
    buffer_load_dwordx4 v[140:143], v1, s[4:7], s48 offen offset:2048 sc1
    s_waitcnt vmcnt(20)
    v_mfma_f32_16x16x32_bf16 v[60:63], v[208:211], a[112:115], v[60:63]
    v_mfma_f32_16x16x32_bf16 v[64:67], v[208:211], a[116:119], v[64:67]
    v_mfma_f32_16x16x32_bf16 v[68:71], v[208:211], a[120:123], v[68:71]
    v_mfma_f32_16x16x32_bf16 v[72:75], v[208:211], a[124:127], v[72:75]
    buffer_load_dwordx4 v[144:147], v1, s[4:7], s48 offen offset:3072 sc1
    s_waitcnt vmcnt(20)
    v_mfma_f32_16x16x32_bf16 v[60:63], v[212:215], a[128:131], v[60:63]
    v_mfma_f32_16x16x32_bf16 v[64:67], v[212:215], a[132:135], v[64:67]
    v_mfma_f32_16x16x32_bf16 v[68:71], v[212:215], a[136:139], v[68:71]
    v_mfma_f32_16x16x32_bf16 v[72:75], v[212:215], a[140:143], v[72:75]
    s_xor_b32 s48, s38, 0x3000
    s_add_u32 s48, s48, 0x19e0000
    buffer_load_dwordx4 v[148:151], v1, s[4:7], s48 offen offset:0 sc1
    s_waitcnt vmcnt(20)
    v_mfma_f32_16x16x32_bf16 v[60:63], v[216:219], a[144:147], v[60:63]
    s_waitcnt lgkmcnt(4)
    v_lshlrev_b32 v100, 16, v92
    v_and_b32 v101, 0xffff0000, v92
    v_mfma_f32_16x16x32_bf16 v[64:67], v[216:219], a[148:151], v[64:67]
    v_lshlrev_b32 v102, 16, v93
    v_mfma_f32_16x16x32_bf16 v[68:71], v[216:219], a[152:155], v[68:71]
    v_and_b32 v103, 0xffff0000, v93
    s_waitcnt lgkmcnt(3)
    v_add_f32 v76, v76, v24
    v_mfma_f32_16x16x32_bf16 v[72:75], v[216:219], a[156:159], v[72:75]
    buffer_load_dwordx4 v[152:155], v1, s[4:7], s48 offen offset:1024 sc1
    s_waitcnt vmcnt(20)
    v_mfma_f32_16x16x32_bf16 v[60:63], v[220:223], a[160:163], v[60:63]
    v_add_f32 v77, v77, v24
    v_add_f32 v78, v78, v24
    v_mfma_f32_16x16x32_bf16 v[64:67], v[220:223], a[164:167], v[64:67]
    v_add_f32 v79, v79, v24
    v_mfma_f32_16x16x32_bf16 v[68:71], v[220:223], a[168:171], v[68:71]
    s_waitcnt lgkmcnt(2)
    v_add_f32 v76, v76, v80
    v_add_f32 v77, v77, v81
    v_mfma_f32_16x16x32_bf16 v[72:75], v[220:223], a[172:175], v[72:75]
    buffer_load_dwordx4 v[156:159], v1, s[4:7], s48 offen offset:2048 sc1
    s_waitcnt vmcnt(20)
    v_mfma_f32_16x16x32_bf16 v[60:63], v[224:227], a[176:179], v[60:63]
    v_add_f32 v78, v78, v82
    v_add_f32 v79, v79, v83
    v_mfma_f32_16x16x32_bf16 v[64:67], v[224:227], a[180:183], v[64:67]
    s_waitcnt lgkmcnt(0)
    v_add_f32 v84, v84, v88
    v_mfma_f32_16x16x32_bf16 v[68:71], v[224:227], a[184:187], v[68:71]
    v_add_f32 v85, v85, v89
    v_add_f32 v86, v86, v90
    v_mfma_f32_16x16x32_bf16 v[72:75], v[224:227], a[188:191], v[72:75]
    buffer_load_dwordx4 v[160:163], v1, s[4:7], s48 offen offset:3072 sc1
    s_barrier
    s_waitcnt vmcnt(20)
    v_mfma_f32_16x16x32_bf16 v[60:63], v[228:231], a[192:195], v[60:63]
    v_add_f32 v87, v87, v91
    v_add_f32 v76, v76, v84
    v_mfma_f32_16x16x32_bf16 v[64:67], v[228:231], a[196:199], v[64:67]
    v_add_f32 v77, v77, v85
    v_mfma_f32_16x16x32_bf16 v[68:71], v[228:231], a[200:203], v[68:71]
    v_add_f32 v78, v78, v86
    v_add_f32 v79, v79, v87
    v_mfma_f32_16x16x32_bf16 v[72:75], v[228:231], a[204:207], v[72:75]
    s_add_u32 s49, s15, 0x5eec00
    s_add_u32 m0, s14, 16384
    s_nop 0
    buffer_load_dwordx4 v1, s[4:7], s49 offen offset:0 lds
    s_waitcnt vmcnt(20)
    v_mfma_f32_16x16x32_bf16 v[60:63], v[232:235], a[208:211], v[60:63]
    v_mul_f32 v76, v76, v100
    v_mul_f32 v77, v77, v101
    v_mfma_f32_16x16x32_bf16 v[64:67], v[232:235], a[212:215], v[64:67]
    v_mul_f32 v78, v78, v102
    v_mfma_f32_16x16x32_bf16 v[68:71], v[232:235], a[216:219], v[68:71]
    v_mul_f32 v79, v79, v103
    v_cvt_pk_bf16_f32 v104, v76, v77
    v_mfma_f32_16x16x32_bf16 v[72:75], v[232:235], a[220:223], v[72:75]
    s_add_u32 s49, s15, 0x5eec00
    s_add_u32 m0, s14, 16384
    s_nop 0
    buffer_load_dwordx4 v1, s[4:7], s49 offen offset:1024 lds
    s_waitcnt vmcnt(20)
    v_mfma_f32_16x16x32_bf16 v[60:63], v[236:239], a[224:227], v[60:63]
    v_cvt_pk_bf16_f32 v105, v78, v79
    v_mfma_f32_16x16x32_bf16 v[64:67], v[236:239], a[228:231], v[64:67]
    v_mfma_f32_16x16x32_bf16 v[68:71], v[236:239], a[232:235], v[68:71]
    v_mfma_f32_16x16x32_bf16 v[72:75], v[236:239], a[236:239], v[72:75]
    s_add_u32 s49, s15, 0x5eec00
    s_add_u32 m0, s14, 16384
    s_nop 0
    buffer_load_dwordx4 v1, s[4:7], s49 offen offset:2048 lds
    s_waitcnt vmcnt(20)
    v_mfma_f32_16x16x32_bf16 v[60:63], v[240:243], a[240:243], v[60:63]
    v_mfma_f32_16x16x32_bf16 v[64:67], v[240:243], a[244:247], v[64:67]
    v_mfma_f32_16x16x32_bf16 v[68:71], v[240:243], a[248:251], v[68:71]
    v_mfma_f32_16x16x32_bf16 v[72:75], v[240:243], a[252:255], v[72:75]
    s_add_u32 s49, s15, 0x5eec00
    s_add_u32 m0, s14, 16384
    s_nop 0
    buffer_load_dwordx4 v1, s[4:7], s49 offen offset:3072 lds
    s_waitcnt vmcnt(20)
    v_mfma_f32_16x16x32_bf16 v[44:47], v[244:247], a[0:3], 0
    v_mfma_f32_16x16x32_bf16 v[48:51], v[244:247], a[4:7], 0
    v_mfma_f32_16x16x32_bf16 v[52:55], v[244:247], a[8:11], 0
    v_mfma_f32_16x16x32_bf16 v[56:59], v[244:247], a[12:15], 0
    s_waitcnt vmcnt(19)
    v_mfma_f32_16x16x32_bf16 v[44:47], v[248:251], a[16:19], v[44:47]
    v_mfma_f32_16x16x32_bf16 v[48:51], v[248:251], a[20:23], v[48:51]
    ds_write_b128 v97, v[60:63] offset:0
    v_mfma_f32_16x16x32_bf16 v[52:55], v[248:251], a[24:27], v[52:55]
    v_mfma_f32_16x16x32_bf16 v[56:59], v[248:251], a[28:31], v[56:59]
    s_waitcnt vmcnt(17)
    v_mfma_f32_16x16x32_bf16 v[44:47], v[252:255], a[32:35], v[44:47]
    v_mfma_f32_16x16x32_bf16 v[48:51], v[252:255], a[36:39], v[48:51]
    ds_write_b128 v97, v[64:67] offset:1024
    v_mfma_f32_16x16x32_bf16 v[52:55], v[252:255], a[40:43], v[52:55]
    v_mfma_f32_16x16x32_bf16 v[56:59], v[252:255], a[44:47], v[56:59]
    s_waitcnt vmcnt(16)
    v_mfma_f32_16x16x32_bf16 v[44:47], v[112:115], a[48:51], v[44:47]
    v_mfma_f32_16x16x32_bf16 v[48:51], v[112:115], a[52:55], v[48:51]
    ds_write_b128 v97, v[68:71] offset:2048
    v_mfma_f32_16x16x32_bf16 v[52:55], v[112:115], a[56:59], v[52:55]
    v_mfma_f32_16x16x32_bf16 v[56:59], v[112:115], a[60:63], v[56:59]
    s_sub_u32 s58, s60, 3
    v_mov_b32 v26, s58
    v_lshl_add_u32 v96, v7, 3, s34
    s_mov_b64 exec, 1
    buffer_store_dwordx2 v[26:27], off, s[4:7], s35
    s_mov_b64 exec, -1
    s_waitcnt vmcnt(16)
    v_mfma_f32_16x16x32_bf16 v[44:47], v[116:119], a[64:67], v[44:47]
    v_mfma_f32_16x16x32_bf16 v[48:51], v[116:119], a[68:71], v[48:51]
    ds_write_b128 v97, v[72:75] offset:3072
    v_mfma_f32_16x16x32_bf16 v[52:55], v[116:119], a[72:75], v[52:55]
    v_mfma_f32_16x16x32_bf16 v[56:59], v[116:119], a[76:79], v[56:59]
    s_waitcnt vmcnt(15)
    v_mfma_f32_16x16x32_bf16 v[44:47], v[120:123], a[80:83], v[44:47]
    v_mfma_f32_16x16x32_bf16 v[48:51], v[120:123], a[84:87], v[48:51]
    v_mfma_f32_16x16x32_bf16 v[52:55], v[120:123], a[88:91], v[52:55]
    v_mfma_f32_16x16x32_bf16 v[56:59], v[120:123], a[92:95], v[56:59]
    s_waitcnt lgkmcnt(0)
    s_barrier
    s_waitcnt vmcnt(14)
    v_mfma_f32_16x16x32_bf16 v[44:47], v[124:127], a[96:99], v[44:47]
    ds_read_b128 v[76:79], v42 offset:0
    ds_read_b128 v[80:83], v42 offset:4096
    v_mfma_f32_16x16x32_bf16 v[48:51], v[124:127], a[100:103], v[48:51]
    ds_read_b128 v[84:87], v42 offset:8192
    v_mfma_f32_16x16x32_bf16 v[52:55], v[124:127], a[104:107], v[52:55]
    ds_read_b128 v[88:91], v42 offset:12288
    v_mfma_f32_16x16x32_bf16 v[56:59], v[124:127], a[108:111], v[56:59]
    s_waitcnt vmcnt(13)
    v_mfma_f32_16x16x32_bf16 v[44:47], v[128:131], a[112:115], v[44:47]
    v_mfma_f32_16x16x32_bf16 v[48:51], v[128:131], a[116:119], v[48:51]
    v_mfma_f32_16x16x32_bf16 v[52:55], v[128:131], a[120:123], v[52:55]
    v_mfma_f32_16x16x32_bf16 v[56:59], v[128:131], a[124:127], v[56:59]
    s_waitcnt vmcnt(12)
    v_mfma_f32_16x16x32_bf16 v[44:47], v[132:135], a[128:131], v[44:47]
    v_mfma_f32_16x16x32_bf16 v[48:51], v[132:135], a[132:135], v[48:51]
    v_mfma_f32_16x16x32_bf16 v[52:55], v[132:135], a[136:139], v[52:55]
    v_mfma_f32_16x16x32_bf16 v[56:59], v[132:135], a[140:143], v[56:59]
    s_waitcnt vmcnt(11)
    v_mfma_f32_16x16x32_bf16 v[44:47], v[136:139], a[144:147], v[44:47]
    v_lshlrev_b32 v100, 16, v94
    v_and_b32 v101, 0xffff0000, v94
    v_mfma_f32_16x16x32_bf16 v[48:51], v[136:139], a[148:151], v[48:51]
    v_lshlrev_b32 v102, 16, v95
    v_mfma_f32_16x16x32_bf16 v[52:55], v[136:139], a[152:155], v[52:55]
    v_and_b32 v103, 0xffff0000, v95
    s_waitcnt lgkmcnt(3)
    v_add_f32 v76, v76, v24
    v_mfma_f32_16x16x32_bf16 v[56:59], v[136:139], a[156:159], v[56:59]
    s_waitcnt vmcnt(10)
    v_mfma_f32_16x16x32_bf16 v[44:47], v[140:143], a[160:163], v[44:47]
    v_add_f32 v77, v77, v24
    v_add_f32 v78, v78, v24
    v_mfma_f32_16x16x32_bf16 v[48:51], v[140:143], a[164:167], v[48:51]
    v_add_f32 v79, v79, v24
    v_mfma_f32_16x16x32_bf16 v[52:55], v[140:143], a[168:171], v[52:55]
    s_waitcnt lgkmcnt(2)
    v_add_f32 v76, v76, v80
    v_add_f32 v77, v77, v81
    v_mfma_f32_16x16x32_bf16 v[56:59], v[140:143], a[172:175], v[56:59]
    s_waitcnt vmcnt(9)
    v_mfma_f32_16x16x32_bf16 v[44:47], v[144:147], a[176:179], v[44:47]
    v_add_f32 v78, v78, v82
    v_add_f32 v79, v79, v83
    v_mfma_f32_16x16x32_bf16 v[48:51], v[144:147], a[180:183], v[48:51]
    s_waitcnt lgkmcnt(0)
    v_add_f32 v84, v84, v88
    v_mfma_f32_16x16x32_bf16 v[52:55], v[144:147], a[184:187], v[52:55]
    v_add_f32 v85, v85, v89
    v_add_f32 v86, v86, v90
    v_mfma_f32_16x16x32_bf16 v[56:59], v[144:147], a[188:191], v[56:59]
    s_barrier
    s_waitcnt vmcnt(8)
    v_mfma_f32_16x16x32_bf16 v[44:47], v[148:151], a[192:195], v[44:47]
    v_add_f32 v87, v87, v91
    v_add_f32 v76, v76, v84
    v_mfma_f32_16x16x32_bf16 v[48:51], v[148:151], a[196:199], v[48:51]
    v_add_f32 v77, v77, v85
    v_mfma_f32_16x16x32_bf16 v[52:55], v[148:151], a[200:203], v[52:55]
    v_add_f32 v78, v78, v86
    v_add_f32 v79, v79, v87
    v_mfma_f32_16x16x32_bf16 v[56:59], v[148:151], a[204:207], v[56:59]
    buffer_load_dwordx2 v[40:41], v96, s[4:7], 0 offen sc1
    s_waitcnt vmcnt(8)
    v_mfma_f32_16x16x32_bf16 v[44:47], v[152:155], a[208:211], v[44:47]
    v_mul_f32 v76, v76, v100
    v_mul_f32 v77, v77, v101
    v_mfma_f32_16x16x32_bf16 v[48:51], v[152:155], a[212:215], v[48:51]
    v_mul_f32 v78, v78, v102
    v_mfma_f32_16x16x32_bf16 v[52:55], v[152:155], a[216:219], v[52:55]
    v_mul_f32 v79, v79, v103
    v_cvt_pk_bf16_f32 v106, v76, v77
    v_mfma_f32_16x16x32_bf16 v[56:59], v[152:155], a[220:223], v[56:59]
    s_waitcnt vmcnt(7)
    v_mfma_f32_16x16x32_bf16 v[44:47], v[156:159], a[224:227], v[44:47]
    v_cvt_pk_bf16_f32 v107, v78, v79
    buffer_store_dwordx4 v[104:107], v1, s[4:7], s55 offen offset:0 sc1
    v_mfma_f32_16x16x32_bf16 v[48:51], v[156:159], a[228:231], v[48:51]
    v_mfma_f32_16x16x32_bf16 v[52:55], v[156:159], a[232:235], v[52:55]
    v_mfma_f32_16x16x32_bf16 v[56:59], v[156:159], a[236:239], v[56:59]
    s_waitcnt vmcnt(7)
    v_mfma_f32_16x16x32_bf16 v[44:47], v[160:163], a[240:243], v[44:47]
    v_mfma_f32_16x16x32_bf16 v[48:51], v[160:163], a[244:247], v[48:51]
    v_mfma_f32_16x16x32_bf16 v[52:55], v[160:163], a[248:251], v[52:55]
    v_mfma_f32_16x16x32_bf16 v[56:59], v[160:163], a[252:255], v[56:59]
    s_nop 4
    ds_write_b128 v97, v[44:47] offset:0
    ds_write_b128 v97, v[48:51] offset:1024
    ds_write_b128 v97, v[52:55] offset:2048
    ds_write_b128 v97, v[56:59] offset:3072
    s_waitcnt lgkmcnt(0)
    s_barrier
    ds_read_b128 v[92:95], v43 offset:13824
    ds_read_b128 v[76:79], v42 offset:0
    ds_read_b128 v[80:83], v42 offset:4096
    ds_read_b128 v[84:87], v42 offset:8192
    ds_read_b128 v[88:91], v42 offset:12288
    v_lshlrev_b32 v43, 7, v7
    v_add_u32 v43, s42, v43
    v_mov_b32 v42, v96
    s_waitcnt lgkmcnt(4)
    v_lshlrev_b32 v100, 16, v92
    v_and_b32 v101, 0xffff0000, v92
    v_lshlrev_b32 v102, 16, v93
    v_and_b32 v103, 0xffff0000, v93
    s_waitcnt lgkmcnt(3)
    v_pk_add_f32 v[76:77], v[76:77], v[24:25] op_sel_hi:[1,0]
    v_pk_add_f32 v[78:79], v[78:79], v[24:25] op_sel_hi:[1,0]
    s_waitcnt lgkmcnt(2)
    v_pk_add_f32 v[76:77], v[76:77], v[80:81]
    v_pk_add_f32 v[78:79], v[78:79], v[82:83]
    s_waitcnt lgkmcnt(0)
    v_pk_add_f32 v[84:85], v[84:85], v[88:89]
    v_pk_add_f32 v[86:87], v[86:87], v[90:91]
    v_pk_add_f32 v[76:77], v[76:77], v[84:85]
    v_pk_add_f32 v[78:79], v[78:79], v[86:87]
    v_pk_mul_f32 v[76:77], v[76:77], v[100:101]
    v_pk_mul_f32 v[78:79], v[78:79], v[102:103]
    v_cvt_pk_bf16_f32 v108, v76, v77
    v_cvt_pk_bf16_f32 v109, v78, v79
    buffer_store_dwordx2 v[108:109], v9, s[4:7], s53 offen offset:0 sc1
    s_mov_b32 s51, 0x20000
    s_waitcnt vmcnt(2)
    v_cmp_gt_u64 vcc, s[58:59], v[40:41]
    v_cmp_lt_u64 s[48:49], s[60:61], v[40:41]
    s_nop 0
    s_or_b64 vcc, vcc, s[48:49]
    s_cbranch_scc0 POLLD_31
    s_mov_b64 exec, 1
    buffer_store_dwordx2 v[26:27], off, s[4:7], s43 sc1
    s_mov_b64 exec, -1
POLL_30:
    buffer_load_dwordx2 v[40:41], v42, s[4:7], 0 offen sc1
    s_sub_u32 s51, s51, 1
    s_cbranch_scc1 POLLD_31X
    s_cmp_eq_u32 s51, 0x1ffd8
    s_cselect_b64 vcc, -1, 0
    v_cndmask_b32 v42, v42, v43, vcc
    s_waitcnt vmcnt(0)
    v_cmp_gt_u64 vcc, s[58:59], v[40:41]
    v_cmp_lt_u64 s[48:49], s[60:61], v[40:41]
    s_nop 0
    s_or_b64 vcc, vcc, s[48:49]
    s_cbranch_scc1 POLL_30
POLLD_31X:
    s_waitcnt vmcnt(0)
POLLD_31:
    s_add_u32 s48, s41, 0x2060000
    buffer_load_dwordx4 v[112:115], v1, s[4:7], s48 offen offset:0 sc1
    buffer_load_dwordx4 v[116:119], v1, s[4:7], s48 offen offset:1024 sc1
    buffer_load_dwordx4 v[120:123], v1, s[4:7], s48 offen offset:3072 sc1
    s_add_u32 s48, s41, 0x2061000
    buffer_load_dwordx4 v[124:127], v1, s[4:7], s48 offen offset:0 sc1
    buffer_load_dwordx4 v[128:131], v1, s[4:7], s48 offen offset:2048 sc1
    buffer_load_dwordx4 v[132:135], v1, s[4:7], s48 offen offset:3072 sc1
    s_add_u32 s48, s41, 0x2062400
    buffer_load_dwordx4 v[136:139], v1, s[4:7], s48 offen offset:0 sc1
    buffer_load_dwordx4 v[140:143], v1, s[4:7], s48 offen offset:1024 sc1
    s_sub_u32 s58, s60, 2
    v_mov_b32 v26, s58
    s_mov_b64 exec, 1
    s_waitcnt vmcnt(8)
    buffer_store_dwordx2 v[26:27], off, s[4:7], s35
    s_mov_b64 exec, -1
    s_add_u32 s48, s41, 0x2063000
    buffer_load_dwordx4 v[144:147], v1, s[4:7], s48 offen offset:0 sc1
    buffer_load_dwordx4 v[148:151], v1, s[4:7], s48 offen offset:1024 sc1
    buffer_load_dwordx4 v[152:155], v1, s[4:7], s48 offen offset:3072 sc1
    s_add_u32 s48, s41, 0x2064000
    buffer_load_dwordx4 v[156:159], v1, s[4:7], s48 offen offset:0 sc1
    buffer_load_dwordx4 v[160:163], v1, s[4:7], s48 offen offset:2048 sc1
    buffer_load_dwordx4 v[164:167], v1, s[4:7], s48 offen offset:3072 sc1
    s_add_u32 s48, s41, 0x2065400
    buffer_load_dwordx4 v[168:171], v1, s[4:7], s48 offen offset:0 sc1
    buffer_load_dwordx4 v[64:67], v1, s[4:7], s48 offen offset:1024 sc1
    s_barrier
    s_lshl_b32 s54, s22, 12
    s_add_u32 s52, s29, s54
    v_lshlrev_b32 v44, 16, v16
    v_and_b32 v45, 0xffff0000, v16
    v_lshlrev_b32 v46, 16, v17
    v_and_b32 v47, 0xffff0000, v17
    v_lshlrev_b32 v48, 16, v18
    v_and_b32 v49, 0xffff0000, v18
    v_lshlrev_b32 v50, 16, v19
    v_and_b32 v51, 0xffff0000, v19
    v_lshlrev_b32 v52, 16, v20
    v_and_b32 v53, 0xffff0000, v20
    v_lshlrev_b32 v54, 16, v21
    v_and_b32 v55, 0xffff0000, v21
    v_lshlrev_b32 v56, 16, v22
    v_and_b32 v57, 0xffff0000, v22
    v_lshlrev_b32 v58, 16, v23
    v_and_b32 v59, 0xffff0000, v23
    v_lshlrev_b32 v60, 16, v14
    v_and_b32 v61, 0xffff0000, v14
    v_lshlrev_b32 v62, 16, v15
    v_and_b32 v63, 0xffff0000, v15
    ds_read_b128 v[172:175], v1 offset:32768
    ds_read_b128 v[176:179], v1 offset:33792
    ds_read_b128 v[180:183], v1 offset:34816
    ds_read_b128 v[184:187], v1 offset:35840
    ds_read_b128 v[188:191], v1 offset:36864
    ds_read_b128 v[192:195], v1 offset:37888
    ds_read_b128 v[196:199], v1 offset:38912
    ds_read_b128 v[200:203], v1 offset:39936
    buffer_load_dwordx2 v[40:41], v42, s[4:7], 0 offen sc1
    s_mov_b32 s51, 0x20000
    s_mov_b64 exec, 1
    buffer_store_dwordx2 v[26:27], off, s[4:7], s43 sc1
    s_mov_b64 exec, -1
    s_waitcnt vmcnt(18) lgkmcnt(7)
    v_mfma_f32_16x16x32_bf16 v[44:47], v[172:175], v[112:115], v[44:47]
    ds_read_b128 v[172:175], v1 offset:40960
    s_waitcnt lgkmcnt(7)
    v_mfma_f32_16x16x32_bf16 v[48:51], v[176:179], v[112:115], v[48:51]
    ds_read_b128 v[176:179], v1 offset:41984
    s_waitcnt lgkmcnt(7)
    v_mfma_f32_16x16x32_bf16 v[52:55], v[180:183], v[112:115], v[52:55]
    ds_read_b128 v[180:183], v1 offset:48128
    s_waitcnt lgkmcnt(7)
    v_mfma_f32_16x16x32_bf16 v[56:59], v[184:187], v[112:115], v[56:59]
    ds_read_b128 v[184:187], v1 offset:49152
    s_waitcnt lgkmcnt(7)
    v_mfma_f32_16x16x32_bf16 v[60:63], v[188:191], v[112:115], v[60:63]
    ds_read_b128 v[188:191], v1 offset:50176
    s_waitcnt vmcnt(17) lgkmcnt(7)
    v_mfma_f32_16x16x32_bf16 v[44:47], v[192:195], v[116:119], v[44:47]
    ds_read_b128 v[192:195], v2 offset:0
    s_waitcnt lgkmcnt(7)
    v_mfma_f32_16x16x32_bf16 v[48:51], v[196:199], v[116:119], v[48:51]
    ds_read_b128 v[196:199], v2 offset:1024
    s_waitcnt lgkmcnt(7)
    v_mfma_f32_16x16x32_bf16 v[52:55], v[200:203], v[116:119], v[52:55]
    ds_read_b128 v[200:203], v2 offset:2048
    s_waitcnt lgkmcnt(7)
    v_mfma_f32_16x16x32_bf16 v[56:59], v[172:175], v[116:119], v[56:59]
    ds_read_b128 v[172:175], v2 offset:3072
    s_waitcnt lgkmcnt(7)
    v_mfma_f32_16x16x32_bf16 v[60:63], v[176:179], v[116:119], v[60:63]
    ds_read_b128 v[176:179], v2 offset:4096
    s_waitcnt vmcnt(16) lgkmcnt(7)
    v_mfma_f32_16x16x32_bf16 v[44:47], v[180:183], v[120:123], v[44:47]
    ds_read_b128 v[180:183], v2 offset:5120
    s_waitcnt lgkmcnt(7)
    v_mfma_f32_16x16x32_bf16 v[48:51], v[184:187], v[120:123], v[48:51]
    ds_read_b128 v[184:187], v2 offset:6144
    s_waitcnt lgkmcnt(7)
    v_mfma_f32_16x16x32_bf16 v[52:55], v[188:191], v[120:123], v[52:55]
    ds_read_b128 v[188:191], v2 offset:12288
    s_waitcnt lgkmcnt(7)
    v_mfma_f32_16x16x32_bf16 v[56:59], v[192:195], v[120:123], v[56:59]
    ds_read_b128 v[192:195], v2 offset:13312
    s_waitcnt lgkmcnt(7)
    v_mfma_f32_16x16x32_bf16 v[60:63], v[196:199], v[120:123], v[60:63]
    ds_read_b128 v[196:199], v2 offset:14336
    s_waitcnt vmcnt(15) lgkmcnt(7)
    v_mfma_f32_16x16x32_bf16 v[44:47], v[200:203], v[124:127], v[44:47]
    ds_read_b128 v[200:203], v2 offset:15360
    s_waitcnt lgkmcnt(7)
    v_mfma_f32_16x16x32_bf16 v[48:51], v[172:175], v[124:127], v[48:51]
    ds_read_b128 v[172:175], v2 offset:16384
    s_waitcnt lgkmcnt(7)
    v_mfma_f32_16x16x32_bf16 v[52:55], v[176:179], v[124:127], v[52:55]
    ds_read_b128 v[176:179], v2 offset:17408
    s_waitcnt lgkmcnt(7)
    v_mfma_f32_16x16x32_bf16 v[56:59], v[180:183], v[124:127], v[56:59]
    ds_read_b128 v[180:183], v2 offset:18432
    s_waitcnt lgkmcnt(7)
    v_mfma_f32_16x16x32_bf16 v[60:63], v[184:187], v[124:127], v[60:63]
    ds_read_b128 v[184:187], v2 offset:19456
    s_waitcnt vmcnt(14) lgkmcnt(7)
    v_mfma_f32_16x16x32_bf16 v[44:47], v[188:191], v[128:131], v[44:47]
    ds_read_b128 v[188:191], v2 offset:20480
    s_waitcnt lgkmcnt(7)
    v_mfma_f32_16x16x32_bf16 v[48:51], v[192:195], v[128:131], v[48:51]
    ds_read_b128 v[192:195], v2 offset:21504
    s_waitcnt lgkmcnt(7)
    v_mfma_f32_16x16x32_bf16 v[52:55], v[196:199], v[128:131], v[52:55]
    ds_read_b128 v[196:199], v2 offset:27648
    s_waitcnt lgkmcnt(7)
    v_mfma_f32_16x16x32_bf16 v[56:59], v[200:203], v[128:131], v[56:59]
    ds_read_b128 v[200:203], v2 offset:28672
    s_waitcnt lgkmcnt(7)
    v_mfma_f32_16x16x32_bf16 v[60:63], v[172:175], v[128:131], v[60:63]
    ds_read_b128 v[172:175], v2 offset:29696
    s_waitcnt vmcnt(13) lgkmcnt(7)
    v_mfma_f32_16x16x32_bf16 v[44:47], v[176:179], v[132:135], v[44:47]
    ds_read_b128 v[176:179], v2 offset:30720
    s_waitcnt lgkmcnt(7)
    v_mfma_f32_16x16x32_bf16 v[48:51], v[180:183], v[132:135], v[48:51]
    ds_read_b128 v[180:183], v2 offset:31744
    s_waitcnt lgkmcnt(7)
    v_mfma_f32_16x16x32_bf16 v[52:55], v[184:187], v[132:135], v[52:55]
    ds_read_b128 v[184:187], v2 offset:32768
    s_waitcnt lgkmcnt(7)
    v_mfma_f32_16x16x32_bf16 v[56:59], v[188:191], v[132:135], v[56:59]
    ds_read_b128 v[188:191], v2 offset:33792
    s_waitcnt lgkmcnt(7)
    v_mfma_f32_16x16x32_bf16 v[60:63], v[192:195], v[132:135], v[60:63]
    ds_read_b128 v[192:195], v2 offset:34816
    s_waitcnt vmcnt(1)
    v_cmp_gt_u64 vcc, s[58:59], v[40:41]
    v_cmp_lt_u64 s[48:49], s[60:61], v[40:41]
    s_nop 0
    s_or_b64 vcc, vcc, s[48:49]
    s_cbranch_scc0 POLLD_33
    s_nop 1
POLL_32:
    buffer_load_dwordx2 v[40:41], v42, s[4:7], 0 offen sc1
    s_sub_u32 s51, s51, 1
    s_cbranch_scc1 POLLD_33X
    s_cmp_eq_u32 s51, 0x1ffd8
    s_cselect_b64 vcc, -1, 0
    v_cndmask_b32 v42, v42, v43, vcc
    s_waitcnt vmcnt(0)
    v_cmp_gt_u64 vcc, s[58:59], v[40:41]
    v_cmp_lt_u64 s[48:49], s[60:61], v[40:41]
    s_nop 0
    s_or_b64 vcc, vcc, s[48:49]
    s_cbranch_scc1 POLL_32
POLLD_33X:
    s_waitcnt vmcnt(0)
POLLD_33:
    s_add_u32 s48, s41, 0x2060800
    buffer_load_dwordx4 v[68:71], v1, s[4:7], s48 offen offset:0 sc1
    s_waitcnt lgkmcnt(7)
    v_mfma_f32_16x16x32_bf16 v[44:47], v[196:199], v[136:139], v[44:47]
    ds_read_b128 v[196:199], v2 offset:35840
    s_waitcnt lgkmcnt(7)
    v_mfma_f32_16x16x32_bf16 v[48:51], v[200:203], v[136:139], v[48:51]
    ds_read_b128 v[200:203], v2 offset:36864
    buffer_load_dwordx4 v[72:75], v1, s[4:7], s48 offen offset:3072 sc1
    s_waitcnt lgkmcnt(7)
    v_mfma_f32_16x16x32_bf16 v[52:55], v[172:175], v[136:139], v[52:55]
    ds_read_b128 v[172:175], v2 offset:43008
    s_waitcnt lgkmcnt(7)
    v_mfma_f32_16x16x32_bf16 v[56:59], v[176:179], v[136:139], v[56:59]
    ds_read_b128 v[176:179], v2 offset:44032
    s_add_u32 s48, s41, 0x2062000
    buffer_load_dwordx4 v[76:79], v1, s[4:7], s48 offen offset:0 sc1
    s_waitcnt lgkmcnt(7)
    v_mfma_f32_16x16x32_bf16 v[60:63], v[180:183], v[136:139], v[60:63]
    ds_read_b128 v[180:183], v2 offset:45056
    s_waitcnt lgkmcnt(7)
    v_mfma_f32_16x16x32_bf16 v[44:47], v[184:187], v[140:143], v[44:47]
    ds_read_b128 v[184:187], v2 offset:46080
    buffer_load_dwordx4 v[80:83], v1, s[4:7], s48 offen offset:3072 sc1
    s_waitcnt lgkmcnt(7)
    v_mfma_f32_16x16x32_bf16 v[48:51], v[188:191], v[140:143], v[48:51]
    ds_read_b128 v[188:191], v2 offset:47104
    s_waitcnt lgkmcnt(7)
    v_mfma_f32_16x16x32_bf16 v[52:55], v[192:195], v[140:143], v[52:55]
    ds_read_b128 v[192:195], v2 offset:48128
    s_add_u32 s48, s41, 0x2063800
    buffer_load_dwordx4 v[84:87], v1, s[4:7], s48 offen offset:0 sc1
    s_waitcnt lgkmcnt(7)
    v_mfma_f32_16x16x32_bf16 v[56:59], v[196:199], v[140:143], v[56:59]
    ds_read_b128 v[196:199], v2 offset:49152
    s_waitcnt lgkmcnt(7)
    v_mfma_f32_16x16x32_bf16 v[60:63], v[200:203], v[140:143], v[60:63]
    ds_read_b128 v[200:203], v2 offset:50176
    buffer_load_dwordx4 v[88:91], v1, s[4:7], s48 offen offset:3072 sc1
    s_waitcnt lgkmcnt(7)
    v_mfma_f32_16x16x32_bf16 v[44:47], v[172:175], v[144:147], v[44:47]
    ds_read_b128 v[172:175], v3 offset:0
    s_waitcnt lgkmcnt(7)
    v_mfma_f32_16x16x32_bf16 v[48:51], v[176:179], v[144:147], v[48:51]
    ds_read_b128 v[176:179], v3 offset:1024
    s_add_u32 s48, s41, 0x2065000
    buffer_load_dwordx4 v[92:95], v1, s[4:7], s48 offen offset:0 sc1
    s_waitcnt lgkmcnt(7)
    v_mfma_f32_16x16x32_bf16 v[52:55], v[180:183], v[144:147], v[52:55]
    ds_read_b128 v[180:183], v3 offset:7168
    s_waitcnt lgkmcnt(7)
    v_mfma_f32_16x16x32_bf16 v[56:59], v[184:187], v[144:147], v[56:59]
    ds_read_b128 v[184:187], v3 offset:8192
    s_add_u32 s48, s41, 0x2065c00
    buffer_load_dwordx2 v[96:97], v9, s[4:7], s48 offen offset:0 sc1
    s_waitcnt lgkmcnt(7)
    v_mfma_f32_16x16x32_bf16 v[60:63], v[188:191], v[144:147], v[60:63]
    ds_read_b128 v[188:191], v3 offset:9216
    s_waitcnt lgkmcnt(7)
    v_mfma_f32_16x16x32_bf16 v[44:47], v[192:195], v[148:151], v[44:47]
    ds_read_b128 v[192:195], v3 offset:10240
    buffer_load_dwordx2 v[98:99], v9, s[4:7], s48 offen offset:512 sc1
    s_waitcnt lgkmcnt(7)
    v_mfma_f32_16x16x32_bf16 v[48:51], v[196:199], v[148:151], v[48:51]
    ds_read_b128 v[196:199], v3 offset:11264
    s_waitcnt lgkmcnt(7)
    v_mfma_f32_16x16x32_bf16 v[52:55], v[200:203], v[148:151], v[52:55]
    ds_read_b128 v[200:203], v3 offset:12288
    buffer_load_dwordx2 v[100:101], v9, s[4:7], s48 offen offset:1024 sc1
    s_waitcnt lgkmcnt(7)
    v_mfma_f32_16x16x32_bf16 v[56:59], v[172:175], v[148:151], v[56:59]
    ds_read_b128 v[172:175], v3 offset:13312
    s_waitcnt lgkmcnt(7)
    v_mfma_f32_16x16x32_bf16 v[60:63], v[176:179], v[148:151], v[60:63]
    ds_read_b128 v[176:179], v3 offset:14336
    buffer_load_dwordx2 v[102:103], v9, s[4:7], s48 offen offset:1536 sc1
    s_waitcnt lgkmcnt(7)
    v_mfma_f32_16x16x32_bf16 v[44:47], v[180:183], v[152:155], v[44:47]
    ds_read_b128 v[180:183], v3 offset:15360
    s_waitcnt lgkmcnt(7)
    v_mfma_f32_16x16x32_bf16 v[48:51], v[184:187], v[152:155], v[48:51]
    ds_read_b128 v[184:187], v3 offset:16384
    buffer_load_dwordx2 v[104:105], v9, s[4:7], s48 offen offset:2048 sc1
    s_waitcnt lgkmcnt(7)
    v_mfma_f32_16x16x32_bf16 v[52:55], v[188:191], v[152:155], v[52:55]
    ds_read_b128 v[188:191], v3 offset:22528
    s_waitcnt lgkmcnt(7)
    v_mfma_f32_16x16x32_bf16 v[56:59], v[192:195], v[152:155], v[56:59]
    ds_read_b128 v[192:195], v3 offset:23552
    buffer_load_dwordx2 v[106:107], v9, s[4:7], s48 offen offset:2560 sc1
    s_waitcnt lgkmcnt(7)
    v_mfma_f32_16x16x32_bf16 v[60:63], v[196:199], v[152:155], v[60:63]
    ds_read_b128 v[196:199], v3 offset:24576
    s_waitcnt lgkmcnt(7)
    v_mfma_f32_16x16x32_bf16 v[44:47], v[200:203], v[156:159], v[44:47]
    ds_read_b128 v[200:203], v3 offset:25600
    buffer_load_dwordx2 v[108:109], v9, s[4:7], s48 offen offset:3072 sc1
    s_waitcnt lgkmcnt(7)
    v_mfma_f32_16x16x32_bf16 v[48:51], v[172:175], v[156:159], v[48:51]
    ds_read_b128 v[172:175], v3 offset:26624
    s_waitcnt lgkmcnt(7)
    v_mfma_f32_16x16x32_bf16 v[52:55], v[176:179], v[156:159], v[52:55]
    ds_read_b128 v[176:179], v3 offset:27648
    buffer_load_dwordx2 v[110:111], v9, s[4:7], s48 offen offset:3584 sc1
    s_waitcnt lgkmcnt(7)
    v_mfma_f32_16x16x32_bf16 v[56:59], v[180:183], v[156:159], v[56:59]
    ds_read_b128 v[180:183], v3 offset:28672
    s_waitcnt lgkmcnt(7)
    v_mfma_f32_16x16x32_bf16 v[60:63], v[184:187], v[156:159], v[60:63]
    ds_read_b128 v[184:187], v3 offset:29696
    s_add_u32 s49, s52, 0x5f2c00
    s_add_u32 m0, s54, 0x0
    s_nop 0
    buffer_load_dwordx4 v1, s[4:7], s49 offen offset:0 lds
    s_waitcnt lgkmcnt(7)
    v_mfma_f32_16x16x32_bf16 v[44:47], v[188:191], v[160:163], v[44:47]
    ds_read_b128 v[188:191], v3 offset:30720
    s_waitcnt lgkmcnt(7)
    v_mfma_f32_16x16x32_bf16 v[48:51], v[192:195], v[160:163], v[48:51]
    ds_read_b128 v[192:195], v3 offset:31744
    buffer_load_dwordx4 v1, s[4:7], s49 offen offset:1024 lds
    s_waitcnt lgkmcnt(7)
    v_mfma_f32_16x16x32_bf16 v[52:55], v[196:199], v[160:163], v[52:55]
    ds_read_b128 v[196:199], v1 offset:18432
    s_waitcnt lgkmcnt(7)
    v_mfma_f32_16x16x32_bf16 v[56:59], v[200:203], v[160:163], v[56:59]
    ds_read_b128 v[200:203], v1 offset:19456
    buffer_load_dwordx4 v1, s[4:7], s49 offen offset:2048 lds
    s_waitcnt lgkmcnt(7)
    v_mfma_f32_16x16x32_bf16 v[60:63], v[172:175], v[160:163], v[60:63]
    ds_read_b128 v[172:175], v1 offset:20480
    s_waitcnt lgkmcnt(7)
    v_mfma_f32_16x16x32_bf16 v[44:47], v[176:179], v[164:167], v[44:47]
    ds_read_b128 v[176:179], v1 offset:21504
    buffer_load_dwordx4 v1, s[4:7], s49 offen offset:3072 lds
    s_waitcnt lgkmcnt(7)
    v_mfma_f32_16x16x32_bf16 v[48:51], v[180:183], v[164:167], v[48:51]
    ds_read_b128 v[180:183], v1 offset:22528
    s_waitcnt lgkmcnt(7)
    v_mfma_f32_16x16x32_bf16 v[52:55], v[184:187], v[164:167], v[52:55]
    ds_read_b128 v[184:187], v1 offset:23552
    s_waitcnt lgkmcnt(7)
    v_mfma_f32_16x16x32_bf16 v[56:59], v[188:191], v[164:167], v[56:59]
    ds_read_b128 v[188:191], v1 offset:24576
    s_mov_b32 s12, s16
    s_waitcnt lgkmcnt(7)
    v_mfma_f32_16x16x32_bf16 v[60:63], v[192:195], v[164:167], v[60:63]
    ds_read_b128 v[192:195], v1 offset:25600
    s_and_b32 s13, s17, 0xffff
    s_waitcnt lgkmcnt(7)
    v_mfma_f32_16x16x32_bf16 v[44:47], v[196:199], v[168:171], v[44:47]
    ds_read_b128 v[196:199], v1 offset:26624
    s_mov_b32 s14, 0x280000
    s_waitcnt lgkmcnt(7)
    v_mfma_f32_16x16x32_bf16 v[48:51], v[200:203], v[168:171], v[48:51]
    ds_read_b128 v[200:203], v1 offset:27648
    s_mov_b32 s15, 0x20000
    s_waitcnt lgkmcnt(7)
    v_mfma_f32_16x16x32_bf16 v[52:55], v[172:175], v[168:171], v[52:55]
    ds_read_b128 v[172:175], v1 offset:43008
    v_mul_u32_u24 v41, 2560, v4
    s_waitcnt lgkmcnt(7)
    v_mfma_f32_16x16x32_bf16 v[56:59], v[176:179], v[168:171], v[56:59]
    ds_read_b128 v[176:179], v1 offset:44032
    v_lshl_add_u32 v41, v5, 3, v41
    s_waitcnt lgkmcnt(7)
    v_mfma_f32_16x16x32_bf16 v[60:63], v[180:183], v[168:171], v[60:63]
    ds_read_b128 v[180:183], v1 offset:45056
    s_lshl_b32 s48, s20, 6
    s_waitcnt lgkmcnt(7)
    v_mfma_f32_16x16x32_bf16 v[44:47], v[184:187], v[64:67], v[44:47]
    ds_read_b128 v[184:187], v1 offset:46080
    s_lshr_b32 s49, s22, 1
    s_waitcnt lgkmcnt(7)
    v_mfma_f32_16x16x32_bf16 v[48:51], v[188:191], v[64:67], v[48:51]
    ds_read_b128 v[188:191], v1 offset:47104
    s_lshl_b32 s49, s49, 5
    s_waitcnt lgkmcnt(7)
    v_mfma_f32_16x16x32_bf16 v[52:55], v[192:195], v[64:67], v[52:55]
    ds_read_b128 v[192:195], v2 offset:7168
    s_add_u32 s48, s48, s49
    s_waitcnt lgkmcnt(7)
    v_mfma_f32_16x16x32_bf16 v[56:59], v[196:199], v[64:67], v[56:59]
    ds_read_b128 v[196:199], v2 offset:8192
    s_and_b32 s49, s22, 1
    s_waitcnt lgkmcnt(7)
    v_mfma_f32_16x16x32_bf16 v[60:63], v[200:203], v[64:67], v[60:63]
    ds_read_b128 v[200:203], v2 offset:9216
    s_add_u32 s48, s48, s49
    s_waitcnt vmcnt(18) lgkmcnt(7)
    v_mfma_f32_16x16x32_bf16 v[44:47], v[172:175], v[68:71], v[44:47]
    ds_read_b128 v[172:175], v2 offset:10240
    s_mul_i32 s48, s48, 1280
    s_waitcnt lgkmcnt(7)
    v_mfma_f32_16x16x32_bf16 v[48:51], v[176:179], v[68:71], v[48:51]
    ds_read_b128 v[176:179], v2 offset:11264
    s_mul_i32 s49, s21, 160
    s_waitcnt lgkmcnt(7)
    v_mfma_f32_16x16x32_bf16 v[52:55], v[180:183], v[68:71], v[52:55]
    ds_read_b128 v[180:183], v2 offset:22528
    s_add_u32 s48, s48, s49
    s_waitcnt lgkmcnt(7)
    v_mfma_f32_16x16x32_bf16 v[56:59], v[184:187], v[68:71], v[56:59]
    ds_read_b128 v[184:187], v2 offset:23552
    s_and_b32 s49, s21, 1
    s_waitcnt lgkmcnt(7)
    v_mfma_f32_16x16x32_bf16 v[60:63], v[188:191], v[68:71], v[60:63]
    ds_read_b128 v[188:191], v2 offset:24576
    s_lshl_b32 s50, s49, 5
    s_waitcnt vmcnt(17) lgkmcnt(7)
    v_mfma_f32_16x16x32_bf16 v[44:47], v[192:195], v[72:75], v[44:47]
    ds_read_b128 v[192:195], v2 offset:25600
    s_add_u32 s50, s50, s48
    s_waitcnt lgkmcnt(7)
    v_mfma_f32_16x16x32_bf16 v[48:51], v[196:199], v[72:75], v[48:51]
    ds_read_b128 v[196:199], v2 offset:26624
    s_cmp_eq_u32 s49, 1
    s_cselect_b32 s49, 0, 128
    s_waitcnt lgkmcnt(7)
    v_mfma_f32_16x16x32_bf16 v[52:55], v[200:203], v[72:75], v[52:55]
    ds_read_b128 v[200:203], v2 offset:37888
    s_add_u32 s48, s48, s49
    s_waitcnt lgkmcnt(7)
    v_mfma_f32_16x16x32_bf16 v[56:59], v[172:175], v[72:75], v[56:59]
    ds_read_b128 v[172:175], v2 offset:38912
    s_waitcnt lgkmcnt(7)
    v_mfma_f32_16x16x32_bf16 v[60:63], v[176:179], v[72:75], v[60:63]
    ds_read_b128 v[176:179], v2 offset:39936
    s_waitcnt vmcnt(16) lgkmcnt(7)
    v_mfma_f32_16x16x32_bf16 v[44:47], v[180:183], v[76:79], v[44:47]
    ds_read_b128 v[180:183], v2 offset:40960
    s_waitcnt lgkmcnt(7)
    v_mfma_f32_16x16x32_bf16 v[48:51], v[184:187], v[76:79], v[48:51]
    ds_read_b128 v[184:187], v2 offset:41984
    s_waitcnt lgkmcnt(7)
    v_mfma_f32_16x16x32_bf16 v[52:55], v[188:191], v[76:79], v[52:55]
    ds_read_b128 v[188:191], v3 offset:2048
    s_waitcnt lgkmcnt(7)
    v_mfma_f32_16x16x32_bf16 v[56:59], v[192:195], v[76:79], v[56:59]
    ds_read_b128 v[192:195], v3 offset:3072
    s_waitcnt lgkmcnt(7)
    v_mfma_f32_16x16x32_bf16 v[60:63], v[196:199], v[76:79], v[60:63]
    ds_read_b128 v[196:199], v3 offset:4096
    s_waitcnt vmcnt(15) lgkmcnt(7)
    v_mfma_f32_16x16x32_bf16 v[44:47], v[200:203], v[80:83], v[44:47]
    ds_read_b128 v[200:203], v3 offset:5120
    s_waitcnt lgkmcnt(7)
    v_mfma_f32_16x16x32_bf16 v[48:51], v[172:175], v[80:83], v[48:51]
    ds_read_b128 v[172:175], v3 offset:6144
    s_waitcnt lgkmcnt(7)
    v_mfma_f32_16x16x32_bf16 v[52:55], v[176:179], v[80:83], v[52:55]
    ds_read_b128 v[176:179], v3 offset:17408
    s_waitcnt lgkmcnt(7)
    v_mfma_f32_16x16x32_bf16 v[56:59], v[180:183], v[80:83], v[56:59]
    ds_read_b128 v[180:183], v3 offset:18432
    s_waitcnt lgkmcnt(7)
    v_mfma_f32_16x16x32_bf16 v[60:63], v[184:187], v[80:83], v[60:63]
    ds_read_b128 v[184:187], v3 offset:19456
    s_waitcnt vmcnt(14) lgkmcnt(7)
    v_mfma_f32_16x16x32_bf16 v[44:47], v[188:191], v[84:87], v[44:47]
    ds_read_b128 v[188:191], v3 offset:20480
    s_waitcnt lgkmcnt(7)
    v_mfma_f32_16x16x32_bf16 v[48:51], v[192:195], v[84:87], v[48:51]
    ds_read_b128 v[192:195], v3 offset:21504
    s_waitcnt lgkmcnt(7)
    v_mfma_f32_16x16x32_bf16 v[52:55], v[196:199], v[84:87], v[52:55]
    ds_read_b128 v[196:199], v3 offset:32768
    s_waitcnt lgkmcnt(7)
    v_mfma_f32_16x16x32_bf16 v[56:59], v[200:203], v[84:87], v[56:59]
    ds_read_b128 v[200:203], v3 offset:33792
    s_waitcnt lgkmcnt(7)
    v_mfma_f32_16x16x32_bf16 v[60:63], v[172:175], v[84:87], v[60:63]
    ds_read_b128 v[172:175], v3 offset:34816
    s_waitcnt vmcnt(13) lgkmcnt(7)
    v_mfma_f32_16x16x32_bf16 v[44:47], v[176:179], v[88:91], v[44:47]
    ds_read_b128 v[176:179], v1 offset:16384
    s_waitcnt lgkmcnt(7)
    v_mfma_f32_16x16x32_bf16 v[48:51], v[180:183], v[88:91], v[48:51]
    ds_read_b128 v[180:183], v1 offset:17408
    s_waitcnt lgkmcnt(7)
    v_mfma_f32_16x16x32_bf16 v[52:55], v[184:187], v[88:91], v[52:55]
    ds_read_b128 v[184:187], v1 offset:28672
    s_waitcnt lgkmcnt(7)
    v_mfma_f32_16x16x32_bf16 v[56:59], v[188:191], v[88:91], v[56:59]
    ds_read_b128 v[188:191], v1 offset:29696
    s_waitcnt lgkmcnt(7)
    v_mfma_f32_16x16x32_bf16 v[60:63], v[192:195], v[88:91], v[60:63]
    ds_read_b128 v[192:195], v1 offset:30720
    s_waitcnt vmcnt(12) lgkmcnt(7)
    v_mfma_f32_16x16x32_bf16 v[44:47], v[196:199], v[92:95], v[44:47]
    ds_read_b128 v[196:199], v1 offset:31744
    s_waitcnt vmcnt(0)
    s_barrier
    s_waitcnt lgkmcnt(7)
    v_mfma_f32_16x16x32_bf16 v[48:51], v[200:203], v[92:95], v[48:51]
    ds_read_b128 v[200:203], v1 offset:0
    s_waitcnt lgkmcnt(7)
    v_mfma_f32_16x16x32_bf16 v[52:55], v[172:175], v[92:95], v[52:55]
    ds_read_b128 v[172:175], v1 offset:1024
    s_waitcnt lgkmcnt(7)
    v_mfma_f32_16x16x32_bf16 v[56:59], v[176:179], v[92:95], v[56:59]
    ds_read_b128 v[176:179], v1 offset:2048
    s_waitcnt lgkmcnt(7)
    v_mfma_f32_16x16x32_bf16 v[60:63], v[180:183], v[92:95], v[60:63]
    ds_read_b128 v[180:183], v1 offset:3072
    s_waitcnt lgkmcnt(7)
    v_mfma_f32_16x16x32_bf16 v[44:47], v[184:187], v[96:99], v[44:47]
    ds_read_b128 v[184:187], v1 offset:4096
    s_waitcnt lgkmcnt(7)
    v_mfma_f32_16x16x32_bf16 v[48:51], v[188:191], v[96:99], v[48:51]
    ds_read_b128 v[188:191], v1 offset:5120
    s_waitcnt lgkmcnt(7)
    v_mfma_f32_16x16x32_bf16 v[52:55], v[192:195], v[96:99], v[52:55]
    ds_read_b128 v[192:195], v1 offset:6144
    s_waitcnt lgkmcnt(7)
    v_mfma_f32_16x16x32_bf16 v[56:59], v[196:199], v[96:99], v[56:59]
    ds_read_b128 v[196:199], v1 offset:7168
    s_waitcnt lgkmcnt(7)
    v_mfma_f32_16x16x32_bf16 v[60:63], v[200:203], v[96:99], v[60:63]
    ds_read_b128 v[200:203], v1 offset:8192
    s_waitcnt lgkmcnt(7)
    v_mfma_f32_16x16x32_bf16 v[44:47], v[172:175], v[100:103], v[44:47]
    ds_read_b128 v[172:175], v1 offset:9216
    s_waitcnt lgkmcnt(7)
    v_mfma_f32_16x16x32_bf16 v[48:51], v[176:179], v[100:103], v[48:51]
    ds_read_b128 v[176:179], v1 offset:10240
    s_waitcnt lgkmcnt(7)
    v_mfma_f32_16x16x32_bf16 v[52:55], v[180:183], v[100:103], v[52:55]
    ds_read_b128 v[180:183], v1 offset:11264
    s_waitcnt lgkmcnt(7)
    v_mfma_f32_16x16x32_bf16 v[56:59], v[184:187], v[100:103], v[56:59]
    ds_read_b128 v[184:187], v1 offset:12288
    s_waitcnt lgkmcnt(7)
    v_mfma_f32_16x16x32_bf16 v[60:63], v[188:191], v[100:103], v[60:63]
    ds_read_b128 v[188:191], v1 offset:13312
    s_waitcnt lgkmcnt(7)
    v_mfma_f32_16x16x32_bf16 v[44:47], v[192:195], v[104:107], v[44:47]
    ds_read_b128 v[192:195], v1 offset:14336
    s_waitcnt lgkmcnt(7)
    v_mfma_f32_16x16x32_bf16 v[48:51], v[196:199], v[104:107], v[48:51]
    ds_read_b128 v[196:199], v1 offset:15360
    s_waitcnt lgkmcnt(7)
    v_mfma_f32_16x16x32_bf16 v[52:55], v[200:203], v[104:107], v[52:55]
    s_waitcnt lgkmcnt(6)
    v_mfma_f32_16x16x32_bf16 v[56:59], v[172:175], v[104:107], v[56:59]
    s_waitcnt lgkmcnt(5)
    v_mfma_f32_16x16x32_bf16 v[60:63], v[176:179], v[104:107], v[60:63]
    s_waitcnt lgkmcnt(4)
    v_mfma_f32_16x16x32_bf16 v[44:47], v[180:183], v[108:111], v[44:47]
    s_waitcnt lgkmcnt(3)
    v_mfma_f32_16x16x32_bf16 v[48:51], v[184:187], v[108:111], v[48:51]
    s_waitcnt lgkmcnt(2)
    v_mfma_f32_16x16x32_bf16 v[52:55], v[188:191], v[108:111], v[52:55]
    s_waitcnt lgkmcnt(1)
    v_mfma_f32_16x16x32_bf16 v[56:59], v[192:195], v[108:111], v[56:59]
    s_waitcnt lgkmcnt(0)
    v_mfma_f32_16x16x32_bf16 v[60:63], v[196:199], v[108:111], v[60:63]
    v_cvt_pk_bf16_f32 v16, v44, v45
    v_cvt_pk_bf16_f32 v17, v46, v47
    v_cvt_pk_bf16_f32 v18, v48, v49
    v_cvt_pk_bf16_f32 v19, v50, v51
    v_cvt_pk_bf16_f32 v20, v52, v53
    v_cvt_pk_bf16_f32 v21, v54, v55
    v_cvt_pk_bf16_f32 v22, v56, v57
    v_cvt_pk_bf16_f32 v23, v58, v59
    v_cvt_pk_bf16_f32 v14, v60, v61
    v_cvt_pk_bf16_f32 v15, v62, v63
    buffer_store_dwordx2 v[16:17], v41, s[12:15], s50 offen offset:0
    buffer_store_dwordx2 v[18:19], v41, s[12:15], s50 offen offset:32
    buffer_store_dwordx2 v[20:21], v41, s[12:15], s50 offen offset:64
    buffer_store_dwordx2 v[22:23], v41, s[12:15], s50 offen offset:96
    buffer_store_dwordx2 v[14:15], v41, s[12:15], s48 offen
MK_end:
    s_endpgm
MK_codeend:
.section .rodata,"a"
.p2align 6
.amdhsa_kernel interleave_layers__sliding_local_dilated__mixer_gmlp__prompt_kernel
  .amdhsa_next_free_vgpr 512
  .amdhsa_next_free_sgpr 102
  .amdhsa_accum_offset 256
  .amdhsa_group_segment_fixed_size 0
  .amdhsa_kernarg_size 88
  .amdhsa_user_sgpr_count 2
  .amdhsa_user_sgpr_kernarg_segment_ptr 1
  .amdhsa_system_sgpr_workgroup_id_x 1
.end_amdhsa_kernel
```
